```python
import torch

def _softmax(x, axis=-1):
    return torch.softmax(x, dim=axis)

def _gelu(x):
    return torch.nn.functional.gelu(x, approximate='tanh')

def _silu(x):
    return torch.nn.functional.silu(x)

def _sigmoid(x):
    return torch.sigmoid(x)

def _layernorm(x, axis=-1, eps=1e-05):
    m = x.mean(dim=axis, keepdim=True)
    v = x.var(dim=axis, keepdim=True, unbiased=False)
    return (x - m) / torch.sqrt(v + eps)

def _scatter_add(tgt, idx, src, axis=0):
    return tgt.clone().index_add_(axis, idx, src)

def _segment_sum(src, seg, n):
    out = torch.zeros((n,) + src.shape[1:], dtype=src.dtype)
    return out.index_add_(0, seg, src)

def _pad(x, pw):
    flat = tuple((v for pair in reversed(pw) for v in pair))
    return torch.nn.functional.pad(x, flat)
kernel_name = 'sequential_preLN__memory_aug_recurrent_mem_tr__geglu_ffn__prompt'

def setup_inputs():

    _w = lambda a: (lambda t: t.to(torch.bfloat16) if t.is_floating_point() else t)(torch.as_tensor(a))

    def _A_setup():
        B, S, Dm = (1, 2048, 576)
        H, Dh = (32, 128)
        M, seg = (8, 32)
        seg = min(seg, S)
        S = S // seg * seg
        return {'x': _w((lambda *s: torch.randn(*s, dtype=torch.bfloat16) * 0.05)(B, S, Dm)), 'mem0': _w((lambda *s: torch.randn(*s, dtype=torch.bfloat16) * 0.2)(B, M, Dm)), 'Wq': _w((lambda *s: torch.randn(*s, dtype=torch.bfloat16) * 1.6)(Dm, H, Dh) * Dm ** (-0.5)), 'Wk': _w((lambda *s: torch.randn(*s, dtype=torch.bfloat16) * 1.6)(Dm, H, Dh) * Dm ** (-0.5)), 'Wv': _w((lambda *s: torch.randn(*s, dtype=torch.bfloat16) * 0.2)(Dm, H, Dh) * Dm ** (-0.5)), 'Wo': _w((lambda *s: torch.randn(*s, dtype=torch.bfloat16) * 0.2)(H, Dh, Dm) * (H * Dh) ** (-0.5)), 'seg_len': seg}
    _A_in = _A_setup()

    def _B_setup():
        B, S, D, F = (1, 2048, 576, 4608)
        return {'x': _w((lambda *s: torch.randn(*s, dtype=torch.bfloat16) * 0.05)(B, S, D)), 'w_gate': _w((lambda *s: torch.randn(*s, dtype=torch.bfloat16) * 0.05)(D, F)), 'w_up': _w((lambda *s: torch.randn(*s, dtype=torch.bfloat16) * 0.05)(D, F)), 'w_down': _w((lambda *s: torch.randn(*s, dtype=torch.bfloat16) * 0.05)(F, D))}
    _B_in = _B_setup()
    return {'A_x': _A_in['x'], 'A_mem0': _A_in['mem0'], 'A_Wq': _A_in['Wq'], 'A_Wk': _A_in['Wk'], 'A_Wv': _A_in['Wv'], 'A_Wo': _A_in['Wo'], 'A_seg_len': _A_in['seg_len'], 'B_x': _B_in['x'], 'B_w_gate': _B_in['w_gate'], 'B_w_up': _B_in['w_up'], 'B_w_down': _B_in['w_down']}

def reference(A_x, A_mem0, A_Wq, A_Wk, A_Wv, A_Wo, A_seg_len, B_x, B_w_gate, B_w_up, B_w_down):

    def _A_ref(x, mem0, Wq, Wk, Wv, Wo, seg_len):
        B, S, Dm = x.shape
        H, Dh = (Wq.shape[1], Wq.shape[2])
        M = mem0.shape[1]
        scale = Dh ** (-0.5)
        n_seg = S // seg_len
        L = M + seg_len
        idx = torch.arange(L)
        mask = (idx[:, None] < M) | (idx[:, None] >= idx[None, :])
        mem = mem0
        outs = []
        for s in range(n_seg):
            xs = x[:, s * seg_len:(s + 1) * seg_len, :].clone()
            h = torch.concatenate([mem, xs], axis=1)
            q = torch.einsum('btd,dhe->bhte', h, Wq)
            k = torch.einsum('btd,dhe->bhte', h, Wk)
            v = torch.einsum('btd,dhe->bhte', h, Wv)
            scores = torch.einsum('bhqe,bhke->bhqk', q, k) * scale
            scores = torch.where(mask[None, None], scores, -1000000000.0)
            p = _softmax(scores, axis=-1)
            o = torch.einsum('bhqk,bhke->bhqe', p, v)
            o = torch.einsum('bhte,hed->btd', o, Wo)
            mem = o[:, :M, :].clone()
            outs.append(o[:, M:, :])
        return torch.concatenate(outs, axis=1)

    def _B_ref(x, w_gate, w_up, w_down):
        return _gelu(x @ w_gate) * (x @ w_up) @ w_down
    x = A_x
    h = x + _A_ref(_layernorm(x, axis=-1), A_mem0, A_Wq, A_Wk, A_Wv, A_Wo, A_seg_len)
    h2 = h + _B_ref(_layernorm(h, axis=-1), B_w_gate, B_w_up, B_w_down)
    return h2
```

```asm
; @launch grid=(256,1,1) block=(256,1,1) lds=163840
.amdgcn_target "amdgcn-amd-amdhsa--gfx950"
.text
.globl sequential_preLN__memory_aug_recurrent_mem_tr__geglu_ffn__prompt_kernel
.p2align 8
.type sequential_preLN__memory_aug_recurrent_mem_tr__geglu_ffn__prompt_kernel,@function
sequential_preLN__memory_aug_recurrent_mem_tr__geglu_ffn__prompt_kernel:
    s_cmp_ge_u32 s2, 256
    s_cbranch_scc1 L_end
    s_load_dwordx16 s[4:19], s[0:1], 0
    s_load_dwordx8 s[20:27], s[0:1], 64
    s_load_dwordx4 s[28:31], s[0:1], 96
    s_getreg_b32 s56, hwreg(HW_REG_XCC_ID, 0, 4)
    v_lshrrev_b32 v1, 6, v0
    v_lshlrev_b32 v8, 4, v0
    v_readfirstlane_b32 s52, v1
    v_and_b32 v0, 63, v0
    s_mov_b32 s54, 200000
    s_min_u32 s56, s56, 7
    s_lshl_b32 s57, s56, 5
    v_mov_b32 v1, s57
    v_mov_b32 v2, 1
    v_mov_b32 v9, 163832
    s_waitcnt lgkmcnt(0)
    s_mov_b32 s32, s30
    s_and_b32 s33, s31, 0xffff
    s_mov_b32 s34, 268435456
    s_mov_b32 s35, 0x20000
    s_cmp_lg_u32 s52, 0
    s_cbranch_scc1 L_notk
    s_mov_b64 exec, 1
    global_atomic_add v3, v1, v2, s[28:29] sc0 sc1
    s_mov_b64 exec, -1
L_notk:
    s_cmp_lg_u32 s52, 0
    s_cbranch_scc1 L_gottk
    s_waitcnt vmcnt(0)
    v_readfirstlane_b32 s58, v3
    s_nop 0
    s_add_u32 s59, s57, s58
    s_cmp_lt_u32 s58, 32
    s_cbranch_scc1 L_puttk
    v_mov_b32 v4, 4
    s_mov_b64 exec, 1
    global_atomic_add v3, v4, v2, s[28:29] sc0 sc1
    s_waitcnt vmcnt(0)
    v_readfirstlane_b32 s58, v3
    s_mov_b64 exec, -1
    v_and_b32 v4, 7, v0
    v_lshlrev_b32 v4, 5, v4
    s_mov_b32 s60, 32
    s_mov_b32 s61, 32
    s_mov_b32 s62, 32
    s_mov_b32 s63, 32
    s_mov_b32 s64, 32
    s_mov_b32 s65, 32
    s_mov_b32 s66, 32
    s_mov_b32 s67, 32
wovf_1:
    global_load_dword v5, v4, s[28:29] sc1
    s_sub_i32 s54, s54, 1
    s_cmp_lt_i32 s54, 0
    s_waitcnt vmcnt(0)
    s_cbranch_scc1 wovfd_2
    v_readlane_b32 s60, v5, 0
    v_readlane_b32 s61, v5, 1
    v_readlane_b32 s62, v5, 2
    v_readlane_b32 s63, v5, 3
    v_readlane_b32 s64, v5, 4
    v_readlane_b32 s65, v5, 5
    v_readlane_b32 s66, v5, 6
    v_readlane_b32 s67, v5, 7
    s_nop 1
    s_add_u32 s59, s60, s61
    s_add_u32 s59, s59, s62
    s_add_u32 s59, s59, s63
    s_add_u32 s59, s59, s64
    s_add_u32 s59, s59, s65
    s_add_u32 s59, s59, s66
    s_add_u32 s59, s59, s67
    v_mov_b32 v6, s59
    v_cmp_gt_u32 vcc, 0x100, v6
    s_cbranch_vccz wovfd_2
    s_sleep 2
    s_branch wovf_1
wovfd_2:
    s_min_u32 s60, s60, 32
    s_add_u32 s59, s60, s58
    s_cmp_lt_u32 s59, 32
    s_cselect_b32 s68, 1, 0
    s_sub_u32 s58, s59, 32
    s_add_u32 s59, s59, 0
    s_cmp_lg_u32 s68, 0
    s_cbranch_scc1 L_puttk
    s_min_u32 s61, s61, 32
    s_add_u32 s59, s61, s58
    s_cmp_lt_u32 s59, 32
    s_cselect_b32 s68, 1, 0
    s_sub_u32 s58, s59, 32
    s_add_u32 s59, s59, 32
    s_cmp_lg_u32 s68, 0
    s_cbranch_scc1 L_puttk
    s_min_u32 s62, s62, 32
    s_add_u32 s59, s62, s58
    s_cmp_lt_u32 s59, 32
    s_cselect_b32 s68, 1, 0
    s_sub_u32 s58, s59, 32
    s_add_u32 s59, s59, 64
    s_cmp_lg_u32 s68, 0
    s_cbranch_scc1 L_puttk
    s_min_u32 s63, s63, 32
    s_add_u32 s59, s63, s58
    s_cmp_lt_u32 s59, 32
    s_cselect_b32 s68, 1, 0
    s_sub_u32 s58, s59, 32
    s_add_u32 s59, s59, 96
    s_cmp_lg_u32 s68, 0
    s_cbranch_scc1 L_puttk
    s_min_u32 s64, s64, 32
    s_add_u32 s59, s64, s58
    s_cmp_lt_u32 s59, 32
    s_cselect_b32 s68, 1, 0
    s_sub_u32 s58, s59, 32
    s_add_u32 s59, s59, 128
    s_cmp_lg_u32 s68, 0
    s_cbranch_scc1 L_puttk
    s_min_u32 s65, s65, 32
    s_add_u32 s59, s65, s58
    s_cmp_lt_u32 s59, 32
    s_cselect_b32 s68, 1, 0
    s_sub_u32 s58, s59, 32
    s_add_u32 s59, s59, 160
    s_cmp_lg_u32 s68, 0
    s_cbranch_scc1 L_puttk
    s_min_u32 s66, s66, 32
    s_add_u32 s59, s66, s58
    s_cmp_lt_u32 s59, 32
    s_cselect_b32 s68, 1, 0
    s_sub_u32 s58, s59, 32
    s_add_u32 s59, s59, 192
    s_cmp_lg_u32 s68, 0
    s_cbranch_scc1 L_puttk
    s_min_u32 s67, s67, 32
    s_add_u32 s59, s67, s58
    s_cmp_lt_u32 s59, 32
    s_cselect_b32 s68, 1, 0
    s_sub_u32 s58, s59, 32
    s_add_u32 s59, s59, 224
    s_cmp_lg_u32 s68, 0
    s_cbranch_scc1 L_puttk
    s_mov_b32 s59, 256
L_puttk:
    v_mov_b32 v3, s59
    ds_write_b32 v9, v3
    s_waitcnt lgkmcnt(0)
L_gottk:
    s_barrier
    ds_read_b32 v3, v9
    s_waitcnt lgkmcnt(0)
    v_readfirstlane_b32 s55, v3
    s_nop 0
    s_cmp_ge_u32 s55, 256
    s_cbranch_scc1 L_end
    s_mov_b32 s53, s55
    s_cmp_lt_u32 s55, 32
    s_cbranch_scc1 L_team
    s_getpc_b64 s[58:59]
L_pc:
    s_add_u32 s58, s58, L_table-L_pc-128
    s_addc_u32 s59, s59, 0
    s_lshl_b32 s57, s55, 2
    s_load_dword s56, s[58:59], s57
    s_waitcnt lgkmcnt(0)
    s_and_b32 s53, s56, 255
    s_lshr_b32 s56, s56, 8
    s_cmp_eq_u32 s56, 1
    s_cbranch_scc1 L_proj
    s_cmp_eq_u32 s56, 2
    s_cbranch_scc1 L_att
    s_cmp_eq_u32 s56, 3
    s_cbranch_scc1 L_lnr
    s_cmp_eq_u32 s56, 4
    s_cbranch_scc1 L_ffn
    v_mov_b32 v4, 0
    v_mov_b32 v5, 0
    v_mov_b32 v6, 0
    v_mov_b32 v7, 0
    s_mul_i32 s58, s53, 36864
    buffer_store_dwordx4 v[4:7], v8, s[32:35], s58 offen sc1
    s_add_u32 s58, s58, 4096
    buffer_store_dwordx4 v[4:7], v8, s[32:35], s58 offen sc1
    s_add_u32 s58, s58, 4096
    buffer_store_dwordx4 v[4:7], v8, s[32:35], s58 offen sc1
    s_add_u32 s58, s58, 4096
    buffer_store_dwordx4 v[4:7], v8, s[32:35], s58 offen sc1
    s_add_u32 s58, s58, 4096
    buffer_store_dwordx4 v[4:7], v8, s[32:35], s58 offen sc1
    s_add_u32 s58, s58, 4096
    buffer_store_dwordx4 v[4:7], v8, s[32:35], s58 offen sc1
    s_add_u32 s58, s58, 4096
    buffer_store_dwordx4 v[4:7], v8, s[32:35], s58 offen sc1
    s_add_u32 s58, s58, 4096
    buffer_store_dwordx4 v[4:7], v8, s[32:35], s58 offen sc1
    s_add_u32 s58, s58, 4096
    buffer_store_dwordx4 v[4:7], v8, s[32:35], s58 offen sc1
    s_add_u32 s58, s58, 4096
    s_nop 0
    v_mov_b32 v4, 136
    s_waitcnt vmcnt(0)
    s_barrier
    s_mov_b32 s61, 63
    s_add_u32 s60, s53, 12
    s_cmp_lg_u32 s52, 0
    s_cbranch_scc1 L_att2
    s_mov_b64 exec, 1
    global_atomic_add v4, v2, s[28:29] sc1
    s_mov_b64 exec, -1
    s_branch L_att2
L_end:
    s_endpgm
L_proj:
    s_cmp_ge_u32 s53, 32
    s_cbranch_scc1 pq_3
    s_mov_b32 s36, s10
    s_and_b32 s37, s11, 0xffff
    s_mov_b32 s38, 4718592
    s_mov_b32 s39, 0x20000
    s_mov_b32 s40, s12
    s_and_b32 s41, s13, 0xffff
    s_mov_b32 s42, 4718592
    s_mov_b32 s43, 0x20000
    s_lshl_b32 s60, s53, 8
    s_mov_b32 s61, s60
    s_mul_i32 s62, s53, 24576
    s_add_u32 s62, s62, 22028288
    s_add_u32 s63, s62, 8192
    s_branch pj_4
pq_3:
    s_mov_b32 s36, s8
    s_and_b32 s37, s9, 0xffff
    s_mov_b32 s38, 4718592
    s_mov_b32 s39, 0x20000
    s_mov_b32 s40, s8
    s_and_b32 s41, s9, 0xffff
    s_mov_b32 s42, 4718592
    s_mov_b32 s43, 0x20000
    s_sub_u32 s57, s53, 32
    s_lshl_b32 s60, s57, 9
    s_add_u32 s61, s60, 256
    s_mul_i32 s62, s57, 49152
    s_add_u32 s62, s62, 22020096
    s_add_u32 s63, s62, 24576
pj_4:
    s_lshl_b32 s57, s52, 11
    s_add_u32 s62, s62, s57
    s_add_u32 s63, s63, s57
    s_lshl_b32 s56, s52, 10
    s_lshr_b32 s57, s52, 1
    s_lshl_b32 s57, s57, 2
    s_lshl_b32 s58, s52, 2
    v_lshrrev_b32 v10, 4, v0
    v_or_b32 v11, s57, v10
    v_lshlrev_b32 v11, 1, v11
    v_and_b32 v12, 15, v0
    v_xor_b32 v11, v11, v12
    v_lshlrev_b32 v11, 4, v11
    v_add_u32 v10, s58, v10
    s_mov_b32 s57, 8192
    v_mul_lo_u32 v10, v10, s57
    v_add_u32 v9, v10, v11
    v_bfe_u32 v10, v0, 2, 3
    s_lshl_b32 s57, s52, 1
    v_xor_b32 v10, s57, v10
    v_lshlrev_b32 v10, 5, v10
    v_and_b32 v11, 3, v0
    v_lshl_add_u32 v10, v11, 3, v10
    v_bfe_u32 v11, v0, 2, 2
    v_lshl_add_u32 v10, v11, 8, v10
    v_lshrrev_b32 v11, 4, v0
    v_lshl_add_u32 v5, v11, 11, v10
    v_xor_b32 v6, 32, v5
    s_add_u32 m0, s56, 0
    s_add_u32 s59, s60, 0
    buffer_load_dwordx4 v9, s[36:39], s59 offen lds
    s_add_u32 m0, s56, 4096
    s_add_u32 s59, s60, 131072
    buffer_load_dwordx4 v9, s[36:39], s59 offen lds
    s_add_u32 m0, s56, 8192
    s_add_u32 s59, s60, 262144
    buffer_load_dwordx4 v9, s[36:39], s59 offen lds
    s_add_u32 m0, s56, 12288
    s_add_u32 s59, s60, 393216
    buffer_load_dwordx4 v9, s[36:39], s59 offen lds
    s_add_u32 m0, s56, 16384
    s_add_u32 s59, s61, 0
    buffer_load_dwordx4 v9, s[40:43], s59 offen lds
    s_add_u32 m0, s56, 20480
    s_add_u32 s59, s61, 131072
    buffer_load_dwordx4 v9, s[40:43], s59 offen lds
    s_add_u32 m0, s56, 24576
    s_add_u32 s59, s61, 262144
    buffer_load_dwordx4 v9, s[40:43], s59 offen lds
    s_add_u32 m0, s56, 28672
    s_add_u32 s59, s61, 393216
    buffer_load_dwordx4 v9, s[40:43], s59 offen lds
    s_add_u32 m0, s56, 32768
    s_add_u32 s59, s60, 524288
    buffer_load_dwordx4 v9, s[36:39], s59 offen lds
    s_add_u32 m0, s56, 36864
    s_add_u32 s59, s60, 655360
    buffer_load_dwordx4 v9, s[36:39], s59 offen lds
    s_add_u32 m0, s56, 40960
    s_add_u32 s59, s60, 786432
    buffer_load_dwordx4 v9, s[36:39], s59 offen lds
    s_add_u32 m0, s56, 45056
    s_add_u32 s59, s60, 917504
    buffer_load_dwordx4 v9, s[36:39], s59 offen lds
    s_add_u32 m0, s56, 49152
    s_add_u32 s59, s61, 524288
    buffer_load_dwordx4 v9, s[40:43], s59 offen lds
    s_add_u32 m0, s56, 53248
    s_add_u32 s59, s61, 655360
    buffer_load_dwordx4 v9, s[40:43], s59 offen lds
    s_add_u32 m0, s56, 57344
    s_add_u32 s59, s61, 786432
    buffer_load_dwordx4 v9, s[40:43], s59 offen lds
    s_add_u32 m0, s56, 61440
    s_add_u32 s59, s61, 917504
    buffer_load_dwordx4 v9, s[40:43], s59 offen lds
    s_add_u32 m0, s56, 65536
    s_add_u32 s59, s60, 1048576
    buffer_load_dwordx4 v9, s[36:39], s59 offen lds
    s_add_u32 m0, s56, 69632
    s_add_u32 s59, s60, 1179648
    buffer_load_dwordx4 v9, s[36:39], s59 offen lds
    s_add_u32 m0, s56, 73728
    s_add_u32 s59, s60, 1310720
    buffer_load_dwordx4 v9, s[36:39], s59 offen lds
    s_add_u32 m0, s56, 77824
    s_add_u32 s59, s60, 1441792
    buffer_load_dwordx4 v9, s[36:39], s59 offen lds
    s_add_u32 m0, s56, 81920
    s_add_u32 s59, s61, 1048576
    buffer_load_dwordx4 v9, s[40:43], s59 offen lds
    s_add_u32 m0, s56, 86016
    s_add_u32 s59, s61, 1179648
    buffer_load_dwordx4 v9, s[40:43], s59 offen lds
    s_add_u32 m0, s56, 90112
    s_add_u32 s59, s61, 1310720
    buffer_load_dwordx4 v9, s[40:43], s59 offen lds
    s_add_u32 m0, s56, 94208
    s_add_u32 s59, s61, 1441792
    buffer_load_dwordx4 v9, s[40:43], s59 offen lds
    s_add_u32 m0, s56, 98304
    s_add_u32 s59, s60, 1572864
    buffer_load_dwordx4 v9, s[36:39], s59 offen lds
    s_add_u32 m0, s56, 102400
    s_add_u32 s59, s60, 1703936
    buffer_load_dwordx4 v9, s[36:39], s59 offen lds
    s_add_u32 m0, s56, 106496
    s_add_u32 s59, s60, 1835008
    buffer_load_dwordx4 v9, s[36:39], s59 offen lds
    s_add_u32 m0, s56, 110592
    s_add_u32 s59, s60, 1966080
    buffer_load_dwordx4 v9, s[36:39], s59 offen lds
    s_add_u32 m0, s56, 114688
    s_add_u32 s59, s61, 1572864
    buffer_load_dwordx4 v9, s[40:43], s59 offen lds
    s_add_u32 m0, s56, 118784
    s_add_u32 s59, s61, 1703936
    buffer_load_dwordx4 v9, s[40:43], s59 offen lds
    s_add_u32 m0, s56, 122880
    s_add_u32 s59, s61, 1835008
    buffer_load_dwordx4 v9, s[40:43], s59 offen lds
    s_add_u32 m0, s56, 126976
    s_add_u32 s59, s61, 1966080
    buffer_load_dwordx4 v9, s[40:43], s59 offen lds
    s_add_u32 m0, s56, 131072
    s_add_u32 s59, s60, 2097152
    buffer_load_dwordx4 v9, s[36:39], s59 offen lds
    s_add_u32 m0, s56, 135168
    s_add_u32 s59, s60, 2228224
    buffer_load_dwordx4 v9, s[36:39], s59 offen lds
    s_add_u32 m0, s56, 139264
    s_add_u32 s59, s60, 2359296
    buffer_load_dwordx4 v9, s[36:39], s59 offen lds
    s_add_u32 m0, s56, 143360
    s_add_u32 s59, s60, 2490368
    buffer_load_dwordx4 v9, s[36:39], s59 offen lds
    s_waitcnt vmcnt(32) lgkmcnt(0)
    s_barrier
    v_add_u32 v7, 0, v5
    v_add_u32 v8, 0, v6
    ds_read_b64_tr_b16 a[0:1], v7 offset:0
    ds_read_b64_tr_b16 a[2:3], v7 offset:1024
    ds_read_b64_tr_b16 a[72:73], v8 offset:0
    ds_read_b64_tr_b16 a[74:75], v8 offset:1024
    ds_read_b64_tr_b16 a[4:5], v7 offset:8192
    ds_read_b64_tr_b16 a[6:7], v7 offset:9216
    ds_read_b64_tr_b16 a[76:77], v8 offset:8192
    ds_read_b64_tr_b16 a[78:79], v8 offset:9216
    s_waitcnt vmcnt(28) lgkmcnt(0)
    s_barrier
    s_add_u32 m0, s56, 0
    s_add_u32 s59, s61, 2097152
    buffer_load_dwordx4 v9, s[40:43], s59 offen lds
    s_add_u32 m0, s56, 4096
    s_add_u32 s59, s61, 2228224
    buffer_load_dwordx4 v9, s[40:43], s59 offen lds
    s_add_u32 m0, s56, 8192
    s_add_u32 s59, s61, 2359296
    buffer_load_dwordx4 v9, s[40:43], s59 offen lds
    s_add_u32 m0, s56, 12288
    s_add_u32 s59, s61, 2490368
    buffer_load_dwordx4 v9, s[40:43], s59 offen lds
    v_add_u32 v7, 16384, v5
    v_add_u32 v8, 16384, v6
    ds_read_b64_tr_b16 a[144:145], v7 offset:0
    ds_read_b64_tr_b16 a[146:147], v7 offset:1024
    ds_read_b64_tr_b16 a[216:217], v8 offset:0
    ds_read_b64_tr_b16 a[218:219], v8 offset:1024
    ds_read_b64_tr_b16 a[148:149], v7 offset:8192
    ds_read_b64_tr_b16 a[150:151], v7 offset:9216
    ds_read_b64_tr_b16 a[220:221], v8 offset:8192
    ds_read_b64_tr_b16 a[222:223], v8 offset:9216
    s_waitcnt vmcnt(28) lgkmcnt(0)
    s_barrier
    s_add_u32 m0, s56, 16384
    s_add_u32 s59, s60, 2621440
    buffer_load_dwordx4 v9, s[36:39], s59 offen lds
    s_add_u32 m0, s56, 20480
    s_add_u32 s59, s60, 2752512
    buffer_load_dwordx4 v9, s[36:39], s59 offen lds
    s_add_u32 m0, s56, 24576
    s_add_u32 s59, s60, 2883584
    buffer_load_dwordx4 v9, s[36:39], s59 offen lds
    s_add_u32 m0, s56, 28672
    s_add_u32 s59, s60, 3014656
    buffer_load_dwordx4 v9, s[36:39], s59 offen lds
    v_add_u32 v7, 32768, v5
    v_add_u32 v8, 32768, v6
    ds_read_b64_tr_b16 a[8:9], v7 offset:0
    ds_read_b64_tr_b16 a[10:11], v7 offset:1024
    ds_read_b64_tr_b16 a[80:81], v8 offset:0
    ds_read_b64_tr_b16 a[82:83], v8 offset:1024
    ds_read_b64_tr_b16 a[12:13], v7 offset:8192
    ds_read_b64_tr_b16 a[14:15], v7 offset:9216
    ds_read_b64_tr_b16 a[84:85], v8 offset:8192
    ds_read_b64_tr_b16 a[86:87], v8 offset:9216
    s_waitcnt vmcnt(28) lgkmcnt(0)
    s_barrier
    s_add_u32 m0, s56, 32768
    s_add_u32 s59, s61, 2621440
    buffer_load_dwordx4 v9, s[40:43], s59 offen lds
    s_add_u32 m0, s56, 36864
    s_add_u32 s59, s61, 2752512
    buffer_load_dwordx4 v9, s[40:43], s59 offen lds
    s_add_u32 m0, s56, 40960
    s_add_u32 s59, s61, 2883584
    buffer_load_dwordx4 v9, s[40:43], s59 offen lds
    s_add_u32 m0, s56, 45056
    s_add_u32 s59, s61, 3014656
    buffer_load_dwordx4 v9, s[40:43], s59 offen lds
    v_add_u32 v7, 49152, v5
    v_add_u32 v8, 49152, v6
    ds_read_b64_tr_b16 a[152:153], v7 offset:0
    ds_read_b64_tr_b16 a[154:155], v7 offset:1024
    ds_read_b64_tr_b16 a[224:225], v8 offset:0
    ds_read_b64_tr_b16 a[226:227], v8 offset:1024
    ds_read_b64_tr_b16 a[156:157], v7 offset:8192
    ds_read_b64_tr_b16 a[158:159], v7 offset:9216
    ds_read_b64_tr_b16 a[228:229], v8 offset:8192
    ds_read_b64_tr_b16 a[230:231], v8 offset:9216
    s_waitcnt vmcnt(28) lgkmcnt(0)
    s_barrier
    s_add_u32 m0, s56, 49152
    s_add_u32 s59, s60, 3145728
    buffer_load_dwordx4 v9, s[36:39], s59 offen lds
    s_add_u32 m0, s56, 53248
    s_add_u32 s59, s60, 3276800
    buffer_load_dwordx4 v9, s[36:39], s59 offen lds
    s_add_u32 m0, s56, 57344
    s_add_u32 s59, s60, 3407872
    buffer_load_dwordx4 v9, s[36:39], s59 offen lds
    s_add_u32 m0, s56, 61440
    s_add_u32 s59, s60, 3538944
    buffer_load_dwordx4 v9, s[36:39], s59 offen lds
    v_add_u32 v7, 65536, v5
    v_add_u32 v8, 65536, v6
    ds_read_b64_tr_b16 a[16:17], v7 offset:0
    ds_read_b64_tr_b16 a[18:19], v7 offset:1024
    ds_read_b64_tr_b16 a[88:89], v8 offset:0
    ds_read_b64_tr_b16 a[90:91], v8 offset:1024
    ds_read_b64_tr_b16 a[20:21], v7 offset:8192
    ds_read_b64_tr_b16 a[22:23], v7 offset:9216
    ds_read_b64_tr_b16 a[92:93], v8 offset:8192
    ds_read_b64_tr_b16 a[94:95], v8 offset:9216
    s_waitcnt vmcnt(28) lgkmcnt(0)
    s_barrier
    s_add_u32 m0, s56, 65536
    s_add_u32 s59, s61, 3145728
    buffer_load_dwordx4 v9, s[40:43], s59 offen lds
    s_add_u32 m0, s56, 69632
    s_add_u32 s59, s61, 3276800
    buffer_load_dwordx4 v9, s[40:43], s59 offen lds
    s_add_u32 m0, s56, 73728
    s_add_u32 s59, s61, 3407872
    buffer_load_dwordx4 v9, s[40:43], s59 offen lds
    s_add_u32 m0, s56, 77824
    s_add_u32 s59, s61, 3538944
    buffer_load_dwordx4 v9, s[40:43], s59 offen lds
    v_add_u32 v7, 81920, v5
    v_add_u32 v8, 81920, v6
    ds_read_b64_tr_b16 a[160:161], v7 offset:0
    ds_read_b64_tr_b16 a[162:163], v7 offset:1024
    ds_read_b64_tr_b16 a[232:233], v8 offset:0
    ds_read_b64_tr_b16 a[234:235], v8 offset:1024
    ds_read_b64_tr_b16 a[164:165], v7 offset:8192
    ds_read_b64_tr_b16 a[166:167], v7 offset:9216
    ds_read_b64_tr_b16 a[236:237], v8 offset:8192
    ds_read_b64_tr_b16 a[238:239], v8 offset:9216
    s_waitcnt vmcnt(28) lgkmcnt(0)
    s_barrier
    s_add_u32 m0, s56, 81920
    s_add_u32 s59, s60, 3670016
    buffer_load_dwordx4 v9, s[36:39], s59 offen lds
    s_add_u32 m0, s56, 86016
    s_add_u32 s59, s60, 3801088
    buffer_load_dwordx4 v9, s[36:39], s59 offen lds
    s_add_u32 m0, s56, 90112
    s_add_u32 s59, s60, 3932160
    buffer_load_dwordx4 v9, s[36:39], s59 offen lds
    s_add_u32 m0, s56, 94208
    s_add_u32 s59, s60, 4063232
    buffer_load_dwordx4 v9, s[36:39], s59 offen lds
    v_add_u32 v7, 98304, v5
    v_add_u32 v8, 98304, v6
    ds_read_b64_tr_b16 a[24:25], v7 offset:0
    ds_read_b64_tr_b16 a[26:27], v7 offset:1024
    ds_read_b64_tr_b16 a[96:97], v8 offset:0
    ds_read_b64_tr_b16 a[98:99], v8 offset:1024
    ds_read_b64_tr_b16 a[28:29], v7 offset:8192
    ds_read_b64_tr_b16 a[30:31], v7 offset:9216
    ds_read_b64_tr_b16 a[100:101], v8 offset:8192
    ds_read_b64_tr_b16 a[102:103], v8 offset:9216
    s_waitcnt vmcnt(28) lgkmcnt(0)
    s_barrier
    s_add_u32 m0, s56, 98304
    s_add_u32 s59, s61, 3670016
    buffer_load_dwordx4 v9, s[40:43], s59 offen lds
    s_add_u32 m0, s56, 102400
    s_add_u32 s59, s61, 3801088
    buffer_load_dwordx4 v9, s[40:43], s59 offen lds
    s_add_u32 m0, s56, 106496
    s_add_u32 s59, s61, 3932160
    buffer_load_dwordx4 v9, s[40:43], s59 offen lds
    s_add_u32 m0, s56, 110592
    s_add_u32 s59, s61, 4063232
    buffer_load_dwordx4 v9, s[40:43], s59 offen lds
    v_add_u32 v7, 114688, v5
    v_add_u32 v8, 114688, v6
    ds_read_b64_tr_b16 a[168:169], v7 offset:0
    ds_read_b64_tr_b16 a[170:171], v7 offset:1024
    ds_read_b64_tr_b16 a[240:241], v8 offset:0
    ds_read_b64_tr_b16 a[242:243], v8 offset:1024
    ds_read_b64_tr_b16 a[172:173], v7 offset:8192
    ds_read_b64_tr_b16 a[174:175], v7 offset:9216
    ds_read_b64_tr_b16 a[244:245], v8 offset:8192
    ds_read_b64_tr_b16 a[246:247], v8 offset:9216
    s_waitcnt vmcnt(28) lgkmcnt(0)
    s_barrier
    s_add_u32 m0, s56, 114688
    s_add_u32 s59, s60, 4194304
    buffer_load_dwordx4 v9, s[36:39], s59 offen lds
    s_add_u32 m0, s56, 118784
    s_add_u32 s59, s60, 4325376
    buffer_load_dwordx4 v9, s[36:39], s59 offen lds
    s_add_u32 m0, s56, 122880
    s_add_u32 s59, s60, 4456448
    buffer_load_dwordx4 v9, s[36:39], s59 offen lds
    s_add_u32 m0, s56, 126976
    s_add_u32 s59, s60, 4587520
    buffer_load_dwordx4 v9, s[36:39], s59 offen lds
    v_add_u32 v7, 131072, v5
    v_add_u32 v8, 131072, v6
    ds_read_b64_tr_b16 a[32:33], v7 offset:0
    ds_read_b64_tr_b16 a[34:35], v7 offset:1024
    ds_read_b64_tr_b16 a[104:105], v8 offset:0
    ds_read_b64_tr_b16 a[106:107], v8 offset:1024
    ds_read_b64_tr_b16 a[36:37], v7 offset:8192
    ds_read_b64_tr_b16 a[38:39], v7 offset:9216
    ds_read_b64_tr_b16 a[108:109], v8 offset:8192
    ds_read_b64_tr_b16 a[110:111], v8 offset:9216
    s_waitcnt vmcnt(28) lgkmcnt(0)
    s_barrier
    s_add_u32 m0, s56, 131072
    s_add_u32 s59, s61, 4194304
    buffer_load_dwordx4 v9, s[40:43], s59 offen lds
    s_add_u32 m0, s56, 135168
    s_add_u32 s59, s61, 4325376
    buffer_load_dwordx4 v9, s[40:43], s59 offen lds
    s_add_u32 m0, s56, 139264
    s_add_u32 s59, s61, 4456448
    buffer_load_dwordx4 v9, s[40:43], s59 offen lds
    s_add_u32 m0, s56, 143360
    s_add_u32 s59, s61, 4587520
    buffer_load_dwordx4 v9, s[40:43], s59 offen lds
    v_add_u32 v7, 0, v5
    v_add_u32 v8, 0, v6
    ds_read_b64_tr_b16 a[176:177], v7 offset:0
    ds_read_b64_tr_b16 a[178:179], v7 offset:1024
    ds_read_b64_tr_b16 a[248:249], v8 offset:0
    ds_read_b64_tr_b16 a[250:251], v8 offset:1024
    ds_read_b64_tr_b16 a[180:181], v7 offset:8192
    ds_read_b64_tr_b16 a[182:183], v7 offset:9216
    ds_read_b64_tr_b16 a[252:253], v8 offset:8192
    ds_read_b64_tr_b16 a[254:255], v8 offset:9216
    s_waitcnt vmcnt(28) lgkmcnt(0)
    s_barrier
    v_add_u32 v7, 16384, v5
    v_add_u32 v8, 16384, v6
    ds_read_b64_tr_b16 a[40:41], v7 offset:0
    ds_read_b64_tr_b16 a[42:43], v7 offset:1024
    ds_read_b64_tr_b16 a[112:113], v8 offset:0
    ds_read_b64_tr_b16 a[114:115], v8 offset:1024
    ds_read_b64_tr_b16 a[44:45], v7 offset:8192
    ds_read_b64_tr_b16 a[46:47], v7 offset:9216
    ds_read_b64_tr_b16 a[116:117], v8 offset:8192
    ds_read_b64_tr_b16 a[118:119], v8 offset:9216
    s_waitcnt vmcnt(24) lgkmcnt(0)
    s_barrier
    v_add_u32 v7, 32768, v5
    v_add_u32 v8, 32768, v6
    ds_read_b64_tr_b16 a[184:185], v7 offset:0
    ds_read_b64_tr_b16 a[186:187], v7 offset:1024
    ds_read_b64_tr_b16 v[224:225], v8 offset:0
    ds_read_b64_tr_b16 v[226:227], v8 offset:1024
    ds_read_b64_tr_b16 a[188:189], v7 offset:8192
    ds_read_b64_tr_b16 a[190:191], v7 offset:9216
    ds_read_b64_tr_b16 v[228:229], v8 offset:8192
    ds_read_b64_tr_b16 v[230:231], v8 offset:9216
    s_waitcnt vmcnt(20) lgkmcnt(0)
    s_barrier
    v_add_u32 v7, 49152, v5
    v_add_u32 v8, 49152, v6
    ds_read_b64_tr_b16 a[48:49], v7 offset:0
    ds_read_b64_tr_b16 a[50:51], v7 offset:1024
    ds_read_b64_tr_b16 a[120:121], v8 offset:0
    ds_read_b64_tr_b16 a[122:123], v8 offset:1024
    ds_read_b64_tr_b16 a[52:53], v7 offset:8192
    ds_read_b64_tr_b16 a[54:55], v7 offset:9216
    ds_read_b64_tr_b16 a[124:125], v8 offset:8192
    ds_read_b64_tr_b16 a[126:127], v8 offset:9216
    s_waitcnt vmcnt(16) lgkmcnt(0)
    s_barrier
    v_add_u32 v7, 65536, v5
    v_add_u32 v8, 65536, v6
    ds_read_b64_tr_b16 a[192:193], v7 offset:0
    ds_read_b64_tr_b16 a[194:195], v7 offset:1024
    ds_read_b64_tr_b16 v[232:233], v8 offset:0
    ds_read_b64_tr_b16 v[234:235], v8 offset:1024
    ds_read_b64_tr_b16 a[196:197], v7 offset:8192
    ds_read_b64_tr_b16 a[198:199], v7 offset:9216
    ds_read_b64_tr_b16 v[236:237], v8 offset:8192
    ds_read_b64_tr_b16 v[238:239], v8 offset:9216
    s_waitcnt vmcnt(12) lgkmcnt(0)
    s_barrier
    v_add_u32 v7, 81920, v5
    v_add_u32 v8, 81920, v6
    ds_read_b64_tr_b16 a[56:57], v7 offset:0
    ds_read_b64_tr_b16 a[58:59], v7 offset:1024
    ds_read_b64_tr_b16 a[128:129], v8 offset:0
    ds_read_b64_tr_b16 a[130:131], v8 offset:1024
    ds_read_b64_tr_b16 a[60:61], v7 offset:8192
    ds_read_b64_tr_b16 a[62:63], v7 offset:9216
    ds_read_b64_tr_b16 a[132:133], v8 offset:8192
    ds_read_b64_tr_b16 a[134:135], v8 offset:9216
    s_waitcnt vmcnt(8) lgkmcnt(0)
    s_barrier
    v_add_u32 v7, 98304, v5
    v_add_u32 v8, 98304, v6
    ds_read_b64_tr_b16 a[200:201], v7 offset:0
    ds_read_b64_tr_b16 a[202:203], v7 offset:1024
    ds_read_b64_tr_b16 v[240:241], v8 offset:0
    ds_read_b64_tr_b16 v[242:243], v8 offset:1024
    ds_read_b64_tr_b16 a[204:205], v7 offset:8192
    ds_read_b64_tr_b16 a[206:207], v7 offset:9216
    ds_read_b64_tr_b16 v[244:245], v8 offset:8192
    ds_read_b64_tr_b16 v[246:247], v8 offset:9216
    s_waitcnt vmcnt(4) lgkmcnt(0)
    s_barrier
    v_add_u32 v7, 114688, v5
    v_add_u32 v8, 114688, v6
    ds_read_b64_tr_b16 a[64:65], v7 offset:0
    ds_read_b64_tr_b16 a[66:67], v7 offset:1024
    ds_read_b64_tr_b16 a[136:137], v8 offset:0
    ds_read_b64_tr_b16 a[138:139], v8 offset:1024
    ds_read_b64_tr_b16 a[68:69], v7 offset:8192
    ds_read_b64_tr_b16 a[70:71], v7 offset:9216
    ds_read_b64_tr_b16 a[140:141], v8 offset:8192
    ds_read_b64_tr_b16 a[142:143], v8 offset:9216
    s_waitcnt vmcnt(0) lgkmcnt(0)
    s_barrier
    v_add_u32 v7, 131072, v5
    v_add_u32 v8, 131072, v6
    ds_read_b64_tr_b16 a[208:209], v7 offset:0
    ds_read_b64_tr_b16 a[210:211], v7 offset:1024
    ds_read_b64_tr_b16 v[248:249], v8 offset:0
    ds_read_b64_tr_b16 v[250:251], v8 offset:1024
    ds_read_b64_tr_b16 a[212:213], v7 offset:8192
    ds_read_b64_tr_b16 a[214:215], v7 offset:9216
    ds_read_b64_tr_b16 v[252:253], v8 offset:8192
    ds_read_b64_tr_b16 v[254:255], v8 offset:9216
    s_waitcnt lgkmcnt(0)
    s_barrier
    v_mov_b32 v1, 136
winit_5:
    global_load_dword v2, v1, s[28:29] sc1
    s_sub_i32 s54, s54, 1
    s_cmp_lt_i32 s54, 0
    s_waitcnt vmcnt(0)
    s_cbranch_scc1 winitd_6
    v_cmp_gt_u32 vcc, 4, v2
    s_cbranch_vccz winitd_6
    s_sleep 8
    s_branch winit_5
winitd_6:
    v_lshlrev_b32 v1, 8, v0
wxn_7:
    buffer_load_dword v2, v1, s[32:35], 0 offen sc1
    buffer_load_dword v3, v1, s[32:35], 0 offen offset:128 sc1
    s_sub_i32 s54, s54, 1
    s_cmp_lt_i32 s54, 0
    s_waitcnt vmcnt(0)
    s_cbranch_scc1 wxnd_8
    v_and_b32 v2, v2, v3
    v_cmp_eq_u32 vcc, 0, v2
    s_cbranch_vccz wxnd_8
    s_sleep 2
    s_branch wxn_7
wxnd_8:
    v_lshlrev_b32 v1, 4, v0
    s_mul_i32 s65, s52, 9216
    s_add_u32 s66, s65, 196608
    s_lshl_b32 s64, s53, 9
    s_lshl_b32 s57, s52, 7
    s_add_u32 s64, s64, s57
    s_add_u32 s64, s64, 16384
    v_mov_b32 v3, 2130706432
    v_cmp_eq_u32 vcc, 0, v0
    s_nop 1
    v_cndmask_b32 v3, v3, 0, vcc
    s_mov_b32 s67, 0
    s_add_u32 s68, s65, 0
    s_add_u32 m0, s68, 0
    s_nop 0
    buffer_load_dwordx4 v1, s[32:35], s66 offen offset:0 sc1 lds
    buffer_load_dwordx4 v1, s[32:35], s66 offen offset:1024 sc1 lds
    buffer_load_dwordx4 v1, s[32:35], s66 offen offset:2048 sc1 lds
    buffer_load_dwordx4 v1, s[32:35], s66 offen offset:3072 sc1 lds
    s_add_u32 m0, s68, 4096
    s_add_u32 s66, s66, 4096
    buffer_load_dwordx4 v1, s[32:35], s66 offen offset:0 sc1 lds
    buffer_load_dwordx4 v1, s[32:35], s66 offen offset:1024 sc1 lds
    buffer_load_dwordx4 v1, s[32:35], s66 offen offset:2048 sc1 lds
    buffer_load_dwordx4 v1, s[32:35], s66 offen offset:3072 sc1 lds
    s_add_u32 m0, s68, 8192
    s_add_u32 s66, s66, 4096
    buffer_load_dwordx4 v1, s[32:35], s66 offen offset:0 sc1 lds
    s_add_u32 s66, s66, 28672
    s_add_u32 s68, s65, 36864
    s_add_u32 m0, s68, 0
    s_nop 0
    buffer_load_dwordx4 v1, s[32:35], s66 offen offset:0 sc1 lds
    buffer_load_dwordx4 v1, s[32:35], s66 offen offset:1024 sc1 lds
    buffer_load_dwordx4 v1, s[32:35], s66 offen offset:2048 sc1 lds
    buffer_load_dwordx4 v1, s[32:35], s66 offen offset:3072 sc1 lds
    s_add_u32 m0, s68, 4096
    s_add_u32 s66, s66, 4096
    buffer_load_dwordx4 v1, s[32:35], s66 offen offset:0 sc1 lds
    buffer_load_dwordx4 v1, s[32:35], s66 offen offset:1024 sc1 lds
    buffer_load_dwordx4 v1, s[32:35], s66 offen offset:2048 sc1 lds
    buffer_load_dwordx4 v1, s[32:35], s66 offen offset:3072 sc1 lds
    s_add_u32 m0, s68, 8192
    s_add_u32 s66, s66, 4096
    buffer_load_dwordx4 v1, s[32:35], s66 offen offset:0 sc1 lds
    s_add_u32 s66, s66, 28672
    s_add_u32 s68, s65, 73728
    s_add_u32 m0, s68, 0
    s_nop 0
    buffer_load_dwordx4 v1, s[32:35], s66 offen offset:0 sc1 lds
    buffer_load_dwordx4 v1, s[32:35], s66 offen offset:1024 sc1 lds
    buffer_load_dwordx4 v1, s[32:35], s66 offen offset:2048 sc1 lds
    buffer_load_dwordx4 v1, s[32:35], s66 offen offset:3072 sc1 lds
    s_add_u32 m0, s68, 4096
    s_add_u32 s66, s66, 4096
    buffer_load_dwordx4 v1, s[32:35], s66 offen offset:0 sc1 lds
    buffer_load_dwordx4 v1, s[32:35], s66 offen offset:1024 sc1 lds
    buffer_load_dwordx4 v1, s[32:35], s66 offen offset:2048 sc1 lds
    buffer_load_dwordx4 v1, s[32:35], s66 offen offset:3072 sc1 lds
    s_add_u32 m0, s68, 8192
    s_add_u32 s66, s66, 4096
    buffer_load_dwordx4 v1, s[32:35], s66 offen offset:0 sc1 lds
    s_add_u32 s66, s66, 28672
    s_waitcnt vmcnt(9)
    s_mov_b32 s69, 0
    s_mov_b32 s70, 110592
    s_cmp_lt_u32 s53, 32
    s_cbranch_scc1 pv_9
ploop_11:
    s_barrier
    s_add_u32 s68, s65, s70
    v_add_u32 v2, s69, v1
    s_max_u32 s57, s67, 1
    s_sub_u32 s57, s57, 1
    s_min_u32 s58, s67, 4
    s_max_u32 s57, s57, s58
    v_mov_b32 v4, s57
    ds_read_b128 v[48:51], v2 offset:0
    ds_read_b128 v[52:55], v2 offset:1024
    ds_read_b128 v[68:71], v2 offset:5120
    s_waitcnt lgkmcnt(2)
    v_mfma_f32_16x16x32_bf16 v[24:27], a[72:75], v[48:51], 0
    s_waitcnt lgkmcnt(1)
    v_mfma_f32_16x16x32_bf16 v[24:27], a[76:79], v[52:55], v[24:27]
    ds_read_b128 v[56:59], v2 offset:2048
    v_mfma_f32_16x16x32_bf16 v[32:35], a[144:147], v[48:51], 0
    v_mfma_f32_16x16x32_bf16 v[32:35], a[148:151], v[52:55], v[32:35]
    ds_read_b128 v[60:63], v2 offset:3072
    v_mfma_f32_16x16x32_bf16 v[40:43], a[216:219], v[48:51], 0
    v_mfma_f32_16x16x32_bf16 v[40:43], a[220:223], v[52:55], v[40:43]
    s_waitcnt lgkmcnt(1)
    v_mfma_f32_16x16x32_bf16 v[40:43], a[224:227], v[56:59], v[40:43]
    ds_read_b128 v[64:67], v2 offset:4096
    v_mfma_f32_16x16x32_bf16 v[16:19], a[0:3], v[48:51], 0
    s_add_u32 m0, s68, 0
    v_mfma_f32_16x16x32_bf16 v[32:35], a[152:155], v[56:59], v[32:35]
    v_mfma_f32_16x16x32_bf16 v[16:19], a[4:7], v[52:55], v[16:19]
    s_waitcnt lgkmcnt(1)
    v_mfma_f32_16x16x32_bf16 v[32:35], a[156:159], v[60:63], v[32:35]
    ds_read_b128 v[48:51], v2 offset:6144
    v_mfma_f32_16x16x32_bf16 v[16:19], a[8:11], v[56:59], v[16:19]
    v_mfma_f32_16x16x32_bf16 v[24:27], a[80:83], v[56:59], v[24:27]
    v_mfma_f32_16x16x32_bf16 v[40:43], a[228:231], v[60:63], v[40:43]
    s_waitcnt lgkmcnt(1)
    v_mfma_f32_16x16x32_bf16 v[40:43], a[232:235], v[64:67], v[40:43]
    ds_read_b128 v[52:55], v2 offset:7168
    v_mfma_f32_16x16x32_bf16 v[40:43], a[236:239], v[68:71], v[40:43]
    s_waitcnt lgkmcnt(1)
    v_mfma_f32_16x16x32_bf16 v[40:43], a[240:243], v[48:51], v[40:43]
    buffer_load_dwordx4 v1, s[32:35], s66 offen offset:0 sc1 lds
    v_mfma_f32_16x16x32_bf16 v[24:27], a[84:87], v[60:63], v[24:27]
    v_mfma_f32_16x16x32_bf16 v[16:19], a[12:15], v[60:63], v[16:19]
    v_mfma_f32_16x16x32_bf16 v[24:27], a[88:91], v[64:67], v[24:27]
    v_mfma_f32_16x16x32_bf16 v[24:27], a[92:95], v[68:71], v[24:27]
    v_mfma_f32_16x16x32_bf16 v[24:27], a[96:99], v[48:51], v[24:27]
    ds_read_b128 v[60:63], v2 offset:9216
    v_mfma_f32_16x16x32_bf16 v[32:35], a[160:163], v[64:67], v[32:35]
    v_mfma_f32_16x16x32_bf16 v[32:35], a[164:167], v[68:71], v[32:35]
    ds_read_b128 v[56:59], v2 offset:8192
    v_mfma_f32_16x16x32_bf16 v[32:35], a[168:171], v[48:51], v[32:35]
    v_mfma_f32_16x16x32_bf16 v[16:19], a[16:19], v[64:67], v[16:19]
    v_mfma_f32_16x16x32_bf16 v[16:19], a[20:23], v[68:71], v[16:19]
    v_mfma_f32_16x16x32_bf16 v[16:19], a[24:27], v[48:51], v[16:19]
    s_waitcnt lgkmcnt(2)
    v_mfma_f32_16x16x32_bf16 v[16:19], a[28:31], v[52:55], v[16:19]
    s_waitcnt lgkmcnt(0)
    v_mfma_f32_16x16x32_bf16 v[16:19], a[32:35], v[56:59], v[16:19]
    ds_read_b128 v[68:71], v2 offset:11264
    ds_read_b128 v[64:67], v2 offset:10240
    v_mfma_f32_16x16x32_bf16 v[32:35], a[172:175], v[52:55], v[32:35]
    v_mfma_f32_16x16x32_bf16 v[24:27], a[100:103], v[52:55], v[24:27]
    v_mfma_f32_16x16x32_bf16 v[32:35], a[176:179], v[56:59], v[32:35]
    ds_read_b128 v[48:51], v2 offset:12288
    v_mfma_f32_16x16x32_bf16 v[16:19], a[36:39], v[60:63], v[16:19]
    buffer_load_dwordx4 v1, s[32:35], s66 offen offset:2048 sc1 lds
    v_mfma_f32_16x16x32_bf16 v[40:43], a[244:247], v[52:55], v[40:43]
    v_mfma_f32_16x16x32_bf16 v[24:27], a[104:107], v[56:59], v[24:27]
    v_mfma_f32_16x16x32_bf16 v[24:27], a[108:111], v[60:63], v[24:27]
    s_waitcnt lgkmcnt(1)
    v_mfma_f32_16x16x32_bf16 v[24:27], a[112:115], v[64:67], v[24:27]
    v_mfma_f32_16x16x32_bf16 v[40:43], a[248:251], v[56:59], v[40:43]
    ds_read_b128 v[52:55], v2 offset:13312
    v_mfma_f32_16x16x32_bf16 v[24:27], a[116:119], v[68:71], v[24:27]
    v_mfma_f32_16x16x32_bf16 v[16:19], a[40:43], v[64:67], v[16:19]
    v_mfma_f32_16x16x32_bf16 v[16:19], a[44:47], v[68:71], v[16:19]
    v_mfma_f32_16x16x32_bf16 v[32:35], a[180:183], v[60:63], v[32:35]
    v_mfma_f32_16x16x32_bf16 v[40:43], a[252:255], v[60:63], v[40:43]
    v_mfma_f32_16x16x32_bf16 v[32:35], a[184:187], v[64:67], v[32:35]
    ds_read_b128 v[56:59], v2 offset:14336
    v_mfma_f32_16x16x32_bf16 v[32:35], a[188:191], v[68:71], v[32:35]
    ds_read_b128 v[60:63], v2 offset:15360
    s_waitcnt lgkmcnt(3)
    v_mfma_f32_16x16x32_bf16 v[32:35], a[192:195], v[48:51], v[32:35]
    v_mfma_f32_16x16x32_bf16 v[40:43], v[224:227], v[64:67], v[40:43]
    v_mfma_f32_16x16x32_bf16 v[40:43], v[228:231], v[68:71], v[40:43]
    v_mfma_f32_16x16x32_bf16 v[16:19], a[48:51], v[48:51], v[16:19]
    v_mfma_f32_16x16x32_bf16 v[40:43], v[232:235], v[48:51], v[40:43]
    s_waitcnt lgkmcnt(2)
    v_mfma_f32_16x16x32_bf16 v[40:43], v[236:239], v[52:55], v[40:43]
    v_mfma_f32_16x16x32_bf16 v[24:27], a[120:123], v[48:51], v[24:27]
    ds_read_b128 v[48:51], v2 offset:18432
    v_mfma_f32_16x16x32_bf16 v[16:19], a[52:55], v[52:55], v[16:19]
    s_waitcnt lgkmcnt(2)
    v_mfma_f32_16x16x32_bf16 v[16:19], a[56:59], v[56:59], v[16:19]
    v_mfma_f32_16x16x32_bf16 v[24:27], a[124:127], v[52:55], v[24:27]
    v_mfma_f32_16x16x32_bf16 v[32:35], a[196:199], v[52:55], v[32:35]
    ds_read_b128 v[52:55], v2 offset:19456
    s_waitcnt lgkmcnt(1)
    v_mfma_f32_16x16x32_bf16 v[20:23], a[0:3], v[48:51], 0
    v_mfma_f32_16x16x32_bf16 v[32:35], a[200:203], v[56:59], v[32:35]
    ds_read_b128 v[68:71], v2 offset:17408
    v_mfma_f32_16x16x32_bf16 v[32:35], a[204:207], v[60:63], v[32:35]
    v_mfma_f32_16x16x32_bf16 v[16:19], a[60:63], v[60:63], v[16:19]
    s_waitcnt lgkmcnt(1)
    v_mfma_f32_16x16x32_bf16 v[20:23], a[4:7], v[52:55], v[20:23]
    ds_read_b128 v[64:67], v2 offset:16384
    v_mfma_f32_16x16x32_bf16 v[28:31], a[72:75], v[48:51], 0
    v_mfma_f32_16x16x32_bf16 v[28:31], a[76:79], v[52:55], v[28:31]
    v_mfma_f32_16x16x32_bf16 v[40:43], v[240:243], v[56:59], v[40:43]
    v_mfma_f32_16x16x32_bf16 v[24:27], a[128:131], v[56:59], v[24:27]
    v_mfma_f32_16x16x32_bf16 v[24:27], a[132:135], v[60:63], v[24:27]
    ds_read_b128 v[56:59], v2 offset:20480
    s_waitcnt lgkmcnt(1)
    v_mfma_f32_16x16x32_bf16 v[32:35], a[208:211], v[64:67], v[32:35]
    v_mfma_f32_16x16x32_bf16 v[24:27], a[136:139], v[64:67], v[24:27]
    v_mfma_f32_16x16x32_bf16 v[32:35], a[212:215], v[68:71], v[32:35]
    buffer_load_dwordx4 v1, s[32:35], s66 offen offset:3072 sc1 lds
    v_mfma_f32_16x16x32_bf16 v[16:19], a[64:67], v[64:67], v[16:19]
    v_mfma_f32_16x16x32_bf16 v[40:43], v[244:247], v[60:63], v[40:43]
    buffer_load_dwordx4 v1, s[32:35], s66 offen offset:1024 sc1 lds
    v_mfma_f32_16x16x32_bf16 v[44:47], a[216:219], v[48:51], 0
    v_mfma_f32_16x16x32_bf16 v[36:39], a[144:147], v[48:51], 0
    ds_read_b128 v[60:63], v2 offset:21504
    v_mfma_f32_16x16x32_bf16 v[44:47], a[220:223], v[52:55], v[44:47]
    v_mfma_f32_16x16x32_bf16 v[24:27], a[140:143], v[68:71], v[24:27]
    v_mfma_f32_16x16x32_bf16 v[16:19], a[68:71], v[68:71], v[16:19]
    s_add_u32 m0, s68, 4096
    s_waitcnt lgkmcnt(1)
    v_mfma_f32_16x16x32_bf16 v[20:23], a[8:11], v[56:59], v[20:23]
    v_mfma_f32_16x16x32_bf16 v[28:31], a[80:83], v[56:59], v[28:31]
    s_add_u32 s66, s66, 4096
    v_mfma_f32_16x16x32_bf16 v[40:43], v[248:251], v[64:67], v[40:43]
    ds_read_b128 v[64:67], v2 offset:22528
    s_waitcnt lgkmcnt(1)
    v_mfma_f32_16x16x32_bf16 v[28:31], a[84:87], v[60:63], v[28:31]
    ds_read_b128 v[48:51], v2 offset:24576
    v_mfma_f32_16x16x32_bf16 v[40:43], v[252:255], v[68:71], v[40:43]
    buffer_load_dwordx4 v1, s[32:35], s66 offen offset:2048 sc1 lds
    v_mfma_f32_16x16x32_bf16 v[36:39], a[148:151], v[52:55], v[36:39]
    v_cvt_pk_bf16_f32 v82, v24, v25
    v_mfma_f32_16x16x32_bf16 v[20:23], a[12:15], v[60:63], v[20:23]
    buffer_load_dwordx4 v1, s[32:35], s66 offen offset:1024 sc1 lds
    s_waitcnt lgkmcnt(1)
    v_mfma_f32_16x16x32_bf16 v[20:23], a[16:19], v[64:67], v[20:23]
    v_mfma_f32_16x16x32_bf16 v[36:39], a[152:155], v[56:59], v[36:39]
    v_mfma_f32_16x16x32_bf16 v[28:31], a[88:91], v[64:67], v[28:31]
    ds_read_b128 v[68:71], v2 offset:23552
    v_cvt_pk_bf16_f32 v91, v42, v43
    v_mfma_f32_16x16x32_bf16 v[44:47], a[224:227], v[56:59], v[44:47]
    v_cvt_pk_bf16_f32 v81, v18, v19
    v_mfma_f32_16x16x32_bf16 v[36:39], a[156:159], v[60:63], v[36:39]
    ds_read_b128 v[56:59], v2 offset:26624
    v_mfma_f32_16x16x32_bf16 v[36:39], a[160:163], v[64:67], v[36:39]
    ds_read_b128 v[52:55], v2 offset:25600
    v_mfma_f32_16x16x32_bf16 v[44:47], a[228:231], v[60:63], v[44:47]
    s_waitcnt lgkmcnt(2)
    v_mfma_f32_16x16x32_bf16 v[20:23], a[20:23], v[68:71], v[20:23]
    v_mfma_f32_16x16x32_bf16 v[44:47], a[232:235], v[64:67], v[44:47]
    v_mfma_f32_16x16x32_bf16 v[28:31], a[92:95], v[68:71], v[28:31]
    buffer_load_dwordx4 v1, s[32:35], s66 offen offset:0 sc1 lds
    v_mfma_f32_16x16x32_bf16 v[44:47], a[236:239], v[68:71], v[44:47]
    ds_read_b128 v[64:67], v2 offset:28672
    v_mfma_f32_16x16x32_bf16 v[28:31], a[96:99], v[48:51], v[28:31]
    v_mfma_f32_16x16x32_bf16 v[44:47], a[240:243], v[48:51], v[44:47]
    ds_read_b128 v[60:63], v2 offset:27648
    s_waitcnt lgkmcnt(2)
    v_mfma_f32_16x16x32_bf16 v[28:31], a[100:103], v[52:55], v[28:31]
    v_mfma_f32_16x16x32_bf16 v[44:47], a[244:247], v[52:55], v[44:47]
    v_mfma_f32_16x16x32_bf16 v[44:47], a[248:251], v[56:59], v[44:47]
    v_mfma_f32_16x16x32_bf16 v[28:31], a[104:107], v[56:59], v[28:31]
    buffer_load_dwordx4 v1, s[32:35], s66 offen offset:3072 sc1 lds
    v_cvt_pk_bf16_f32 v88, v32, v33
    v_mfma_f32_16x16x32_bf16 v[36:39], a[164:167], v[68:71], v[36:39]
    ds_read_b128 v[68:71], v2 offset:29696
    v_mfma_f32_16x16x32_bf16 v[20:23], a[24:27], v[48:51], v[20:23]
    v_mfma_f32_16x16x32_bf16 v[36:39], a[168:171], v[48:51], v[36:39]
    v_mfma_f32_16x16x32_bf16 v[36:39], a[172:175], v[52:55], v[36:39]
    s_waitcnt lgkmcnt(1)
    v_mfma_f32_16x16x32_bf16 v[28:31], a[108:111], v[60:63], v[28:31]
    s_add_u32 m0, s68, 8192
    v_mfma_f32_16x16x32_bf16 v[36:39], a[176:179], v[56:59], v[36:39]
    v_cvt_pk_bf16_f32 v90, v40, v41
    v_cvt_pk_bf16_f32 v83, v26, v27
    v_mfma_f32_16x16x32_bf16 v[20:23], a[28:31], v[52:55], v[20:23]
    v_mfma_f32_16x16x32_bf16 v[28:31], a[112:115], v[64:67], v[28:31]
    v_mfma_f32_16x16x32_bf16 v[20:23], a[32:35], v[56:59], v[20:23]
    ds_read_b128 v[48:51], v2 offset:30720
    v_mfma_f32_16x16x32_bf16 v[20:23], a[36:39], v[60:63], v[20:23]
    v_mfma_f32_16x16x32_bf16 v[20:23], a[40:43], v[64:67], v[20:23]
    ds_read_b128 v[52:55], v2 offset:31744
    v_mfma_f32_16x16x32_bf16 v[44:47], a[252:255], v[60:63], v[44:47]
    ds_read_b128 v[56:59], v2 offset:32768
    s_add_u32 s66, s66, 4096
    v_mfma_f32_16x16x32_bf16 v[36:39], a[180:183], v[60:63], v[36:39]
    s_waitcnt lgkmcnt(3)
    v_mfma_f32_16x16x32_bf16 v[20:23], a[44:47], v[68:71], v[20:23]
    ds_read_b128 v[60:63], v2 offset:33792
    v_mfma_f32_16x16x32_bf16 v[36:39], a[184:187], v[64:67], v[36:39]
    v_mfma_f32_16x16x32_bf16 v[36:39], a[188:191], v[68:71], v[36:39]
    v_cvt_pk_bf16_f32 v89, v34, v35
    s_waitcnt lgkmcnt(3)
    v_mfma_f32_16x16x32_bf16 v[20:23], a[48:51], v[48:51], v[20:23]
    v_mfma_f32_16x16x32_bf16 v[44:47], v[224:227], v[64:67], v[44:47]
    s_waitcnt lgkmcnt(2)
    v_mfma_f32_16x16x32_bf16 v[20:23], a[52:55], v[52:55], v[20:23]
    s_waitcnt lgkmcnt(1)
    v_mfma_f32_16x16x32_bf16 v[20:23], a[56:59], v[56:59], v[20:23]
    v_mfma_f32_16x16x32_bf16 v[44:47], v[228:231], v[68:71], v[44:47]
    v_mfma_f32_16x16x32_bf16 v[44:47], v[232:235], v[48:51], v[44:47]
    buffer_load_dwordx4 v1, s[32:35], s66 offen offset:0 sc1 lds
    s_add_u32 s66, s66, 28672
    v_mfma_f32_16x16x32_bf16 v[36:39], a[192:195], v[48:51], v[36:39]
    v_mfma_f32_16x16x32_bf16 v[36:39], a[196:199], v[52:55], v[36:39]
    ds_read_b128 v[64:67], v2 offset:34816
    v_mfma_f32_16x16x32_bf16 v[44:47], v[236:239], v[52:55], v[44:47]
    v_mfma_f32_16x16x32_bf16 v[28:31], a[116:119], v[68:71], v[28:31]
    ds_read_b128 v[68:71], v2 offset:35840
    v_mfma_f32_16x16x32_bf16 v[28:31], a[120:123], v[48:51], v[28:31]
    v_cvt_pk_bf16_f32 v80, v16, v17
    s_waitcnt lgkmcnt(2)
    v_mfma_f32_16x16x32_bf16 v[20:23], a[60:63], v[60:63], v[20:23]
    s_waitcnt vmcnt(23)
    buffer_store_dword v4, v3, s[32:35], s64 offen sc1
    s_waitcnt lgkmcnt(1)
    v_mfma_f32_16x16x32_bf16 v[20:23], a[64:67], v[64:67], v[20:23]
    v_mfma_f32_16x16x32_bf16 v[36:39], a[200:203], v[56:59], v[36:39]
    buffer_store_dwordx4 v[88:91], v1, s[32:35], s63 offen offset:0 sc1
    v_mfma_f32_16x16x32_bf16 v[36:39], a[204:207], v[60:63], v[36:39]
    v_mfma_f32_16x16x32_bf16 v[36:39], a[208:211], v[64:67], v[36:39]
    s_waitcnt lgkmcnt(0)
    v_mfma_f32_16x16x32_bf16 v[36:39], a[212:215], v[68:71], v[36:39]
    v_mfma_f32_16x16x32_bf16 v[44:47], v[240:243], v[56:59], v[44:47]
    v_mfma_f32_16x16x32_bf16 v[44:47], v[244:247], v[60:63], v[44:47]
    v_mfma_f32_16x16x32_bf16 v[44:47], v[248:251], v[64:67], v[44:47]
    v_mfma_f32_16x16x32_bf16 v[44:47], v[252:255], v[68:71], v[44:47]
    buffer_store_dwordx4 v[80:83], v1, s[32:35], s62 offen offset:0 sc1
    v_mfma_f32_16x16x32_bf16 v[28:31], a[124:127], v[52:55], v[28:31]
    v_cvt_pk_bf16_f32 v93, v38, v39
    s_nop 2
    v_cvt_pk_bf16_f32 v94, v44, v45
    v_mfma_f32_16x16x32_bf16 v[28:31], a[128:131], v[56:59], v[28:31]
    v_mfma_f32_16x16x32_bf16 v[28:31], a[132:135], v[60:63], v[28:31]
    v_cvt_pk_bf16_f32 v95, v46, v47
    v_cvt_pk_bf16_f32 v92, v36, v37
    v_mfma_f32_16x16x32_bf16 v[20:23], a[68:71], v[68:71], v[20:23]
    v_mfma_f32_16x16x32_bf16 v[28:31], a[136:139], v[64:67], v[28:31]
    v_mfma_f32_16x16x32_bf16 v[28:31], a[140:143], v[68:71], v[28:31]
    buffer_store_dwordx4 v[92:95], v1, s[32:35], s63 offen offset:1024 sc1
    v_cvt_pk_bf16_f32 v84, v20, v21
    v_cvt_pk_bf16_f32 v85, v22, v23
    s_nop 4
    v_cvt_pk_bf16_f32 v86, v28, v29
    v_cvt_pk_bf16_f32 v87, v30, v31
    buffer_store_dwordx4 v[84:87], v1, s[32:35], s62 offen offset:1024 sc1
    s_mov_b32 s70, s69
    s_add_u32 s69, s69, 36864
    s_cmp_eq_u32 s69, 147456
    s_cselect_b32 s69, 0, s69
    s_add_u32 s62, s62, 786432
    s_add_u32 s63, s63, 786432
    s_add_u32 s67, s67, 1
    s_cmp_gt_u32 s67, 4
    s_cbranch_scc1 ploop_11x
    v_mov_b32 v4, s67
    s_waitcnt vmcnt(0)
    buffer_store_dword v4, v3, s[32:35], s64 offen sc1
ploop_11x:
    s_cmp_lt_u32 s67, 64
    s_cbranch_scc1 ploop_11
    s_branch pe_10
pv_9:
ploop_12:
    s_barrier
    s_add_u32 s68, s65, s70
    v_add_u32 v2, s69, v1
    s_max_u32 s57, s67, 1
    s_sub_u32 s57, s57, 1
    s_min_u32 s58, s67, 4
    s_max_u32 s57, s57, s58
    v_mov_b32 v4, s57
    ds_read_b128 v[48:51], v2 offset:0
    ds_read_b128 v[52:55], v2 offset:1024
    s_add_u32 m0, s68, 0
    s_waitcnt lgkmcnt(1)
    v_mfma_f32_16x16x32_bf16 v[24:27], a[72:75], v[48:51], 0
    ds_read_b128 v[56:59], v2 offset:2048
    v_mfma_f32_16x16x32_bf16 v[40:43], v[48:51], a[216:219], 0
    ds_read_b128 v[68:71], v2 offset:5120
    v_mfma_f32_16x16x32_bf16 v[32:35], v[48:51], a[144:147], 0
    ds_read_b128 v[60:63], v2 offset:3072
    v_mfma_f32_16x16x32_bf16 v[16:19], a[0:3], v[48:51], 0
    s_waitcnt lgkmcnt(3)
    v_mfma_f32_16x16x32_bf16 v[24:27], a[76:79], v[52:55], v[24:27]
    ds_read_b128 v[64:67], v2 offset:4096
    s_waitcnt lgkmcnt(3)
    v_mfma_f32_16x16x32_bf16 v[24:27], a[80:83], v[56:59], v[24:27]
    v_mfma_f32_16x16x32_bf16 v[16:19], a[4:7], v[52:55], v[16:19]
    v_mfma_f32_16x16x32_bf16 v[16:19], a[8:11], v[56:59], v[16:19]
    s_waitcnt lgkmcnt(1)
    v_mfma_f32_16x16x32_bf16 v[16:19], a[12:15], v[60:63], v[16:19]
    v_mfma_f32_16x16x32_bf16 v[24:27], a[84:87], v[60:63], v[24:27]
    s_waitcnt lgkmcnt(0)
    v_mfma_f32_16x16x32_bf16 v[16:19], a[16:19], v[64:67], v[16:19]
    v_mfma_f32_16x16x32_bf16 v[32:35], v[52:55], a[148:151], v[32:35]
    v_mfma_f32_16x16x32_bf16 v[40:43], v[52:55], a[220:223], v[40:43]
    v_mfma_f32_16x16x32_bf16 v[16:19], a[20:23], v[68:71], v[16:19]
    v_mfma_f32_16x16x32_bf16 v[32:35], v[56:59], a[152:155], v[32:35]
    v_mfma_f32_16x16x32_bf16 v[32:35], v[60:63], a[156:159], v[32:35]
    v_mfma_f32_16x16x32_bf16 v[24:27], a[88:91], v[64:67], v[24:27]
    ds_read_b128 v[48:51], v2 offset:6144
    v_mfma_f32_16x16x32_bf16 v[40:43], v[56:59], a[224:227], v[40:43]
    v_mfma_f32_16x16x32_bf16 v[40:43], v[60:63], a[228:231], v[40:43]
    ds_read_b128 v[56:59], v2 offset:8192
    v_mfma_f32_16x16x32_bf16 v[32:35], v[64:67], a[160:163], v[32:35]
    ds_read_b128 v[52:55], v2 offset:7168
    v_mfma_f32_16x16x32_bf16 v[40:43], v[64:67], a[232:235], v[40:43]
    v_mfma_f32_16x16x32_bf16 v[32:35], v[68:71], a[164:167], v[32:35]
    v_mfma_f32_16x16x32_bf16 v[24:27], a[92:95], v[68:71], v[24:27]
    s_waitcnt lgkmcnt(2)
    v_mfma_f32_16x16x32_bf16 v[24:27], a[96:99], v[48:51], v[24:27]
    ds_read_b128 v[60:63], v2 offset:9216
    v_mfma_f32_16x16x32_bf16 v[40:43], v[68:71], a[236:239], v[40:43]
    buffer_load_dwordx4 v1, s[32:35], s66 offen offset:2048 sc1 lds
    v_mfma_f32_16x16x32_bf16 v[16:19], a[24:27], v[48:51], v[16:19]
    v_mfma_f32_16x16x32_bf16 v[32:35], v[48:51], a[168:171], v[32:35]
    s_waitcnt lgkmcnt(1)
    v_mfma_f32_16x16x32_bf16 v[32:35], v[52:55], a[172:175], v[32:35]
    v_mfma_f32_16x16x32_bf16 v[40:43], v[48:51], a[240:243], v[40:43]
    ds_read_b128 v[48:51], v2 offset:12288
    v_mfma_f32_16x16x32_bf16 v[24:27], a[100:103], v[52:55], v[24:27]
    ds_read_b128 v[64:67], v2 offset:10240
    v_mfma_f32_16x16x32_bf16 v[16:19], a[28:31], v[52:55], v[16:19]
    ds_read_b128 v[68:71], v2 offset:11264
    v_mfma_f32_16x16x32_bf16 v[32:35], v[56:59], a[176:179], v[32:35]
    v_mfma_f32_16x16x32_bf16 v[16:19], a[32:35], v[56:59], v[16:19]
    v_mfma_f32_16x16x32_bf16 v[24:27], a[104:107], v[56:59], v[24:27]
    s_waitcnt lgkmcnt(3)
    v_mfma_f32_16x16x32_bf16 v[16:19], a[36:39], v[60:63], v[16:19]
    v_mfma_f32_16x16x32_bf16 v[40:43], v[52:55], a[244:247], v[40:43]
    v_mfma_f32_16x16x32_bf16 v[40:43], v[56:59], a[248:251], v[40:43]
    v_mfma_f32_16x16x32_bf16 v[24:27], a[108:111], v[60:63], v[24:27]
    ds_read_b128 v[56:59], v2 offset:14336
    v_mfma_f32_16x16x32_bf16 v[32:35], v[60:63], a[180:183], v[32:35]
    s_waitcnt lgkmcnt(2)
    v_mfma_f32_16x16x32_bf16 v[32:35], v[64:67], a[184:187], v[32:35]
    buffer_load_dwordx4 v1, s[32:35], s66 offen offset:1024 sc1 lds
    v_mfma_f32_16x16x32_bf16 v[40:43], v[60:63], a[252:255], v[40:43]
    v_mfma_f32_16x16x32_bf16 v[24:27], a[112:115], v[64:67], v[24:27]
    ds_read_b128 v[52:55], v2 offset:13312
    v_mfma_f32_16x16x32_bf16 v[16:19], a[40:43], v[64:67], v[16:19]
    s_waitcnt lgkmcnt(2)
    v_mfma_f32_16x16x32_bf16 v[16:19], a[44:47], v[68:71], v[16:19]
    ds_read_b128 v[60:63], v2 offset:15360
    v_mfma_f32_16x16x32_bf16 v[40:43], v[64:67], v[224:227], v[40:43]
    v_mfma_f32_16x16x32_bf16 v[40:43], v[68:71], v[228:231], v[40:43]
    v_mfma_f32_16x16x32_bf16 v[40:43], v[48:51], v[232:235], v[40:43]
    s_waitcnt lgkmcnt(1)
    v_mfma_f32_16x16x32_bf16 v[40:43], v[52:55], v[236:239], v[40:43]
    v_mfma_f32_16x16x32_bf16 v[24:27], a[116:119], v[68:71], v[24:27]
    v_mfma_f32_16x16x32_bf16 v[32:35], v[68:71], a[188:191], v[32:35]
    v_mfma_f32_16x16x32_bf16 v[24:27], a[120:123], v[48:51], v[24:27]
    ds_read_b128 v[64:67], v2 offset:16384
    v_mfma_f32_16x16x32_bf16 v[24:27], a[124:127], v[52:55], v[24:27]
    buffer_load_dwordx4 v1, s[32:35], s66 offen offset:0 sc1 lds
    v_mfma_f32_16x16x32_bf16 v[16:19], a[48:51], v[48:51], v[16:19]
    v_mfma_f32_16x16x32_bf16 v[24:27], a[128:131], v[56:59], v[24:27]
    buffer_load_dwordx4 v1, s[32:35], s66 offen offset:3072 sc1 lds
    v_mfma_f32_16x16x32_bf16 v[32:35], v[48:51], a[192:195], v[32:35]
    ds_read_b128 v[68:71], v2 offset:17408
    v_mfma_f32_16x16x32_bf16 v[32:35], v[52:55], a[196:199], v[32:35]
    ds_read_b128 v[48:51], v2 offset:18432
    v_mfma_f32_16x16x32_bf16 v[40:43], v[56:59], v[240:243], v[40:43]
    v_mfma_f32_16x16x32_bf16 v[32:35], v[56:59], a[200:203], v[32:35]
    v_mfma_f32_16x16x32_bf16 v[16:19], a[52:55], v[52:55], v[16:19]
    ds_read_b128 v[52:55], v2 offset:19456
    s_waitcnt lgkmcnt(4)
    v_mfma_f32_16x16x32_bf16 v[24:27], a[132:135], v[60:63], v[24:27]
    v_mfma_f32_16x16x32_bf16 v[16:19], a[56:59], v[56:59], v[16:19]
    v_mfma_f32_16x16x32_bf16 v[16:19], a[60:63], v[60:63], v[16:19]
    s_waitcnt lgkmcnt(1)
    v_mfma_f32_16x16x32_bf16 v[44:47], v[48:51], a[216:219], 0
    v_mfma_f32_16x16x32_bf16 v[20:23], a[0:3], v[48:51], 0
    ds_read_b128 v[56:59], v2 offset:20480
    s_waitcnt lgkmcnt(1)
    v_mfma_f32_16x16x32_bf16 v[44:47], v[52:55], a[220:223], v[44:47]
    v_mfma_f32_16x16x32_bf16 v[32:35], v[60:63], a[204:207], v[32:35]
    s_add_u32 m0, s68, 4096
    v_mfma_f32_16x16x32_bf16 v[40:43], v[60:63], v[244:247], v[40:43]
    v_mfma_f32_16x16x32_bf16 v[40:43], v[64:67], v[248:251], v[40:43]
    v_mfma_f32_16x16x32_bf16 v[28:31], a[72:75], v[48:51], 0
    v_mfma_f32_16x16x32_bf16 v[16:19], a[64:67], v[64:67], v[16:19]
    v_mfma_f32_16x16x32_bf16 v[16:19], a[68:71], v[68:71], v[16:19]
    v_mfma_f32_16x16x32_bf16 v[24:27], a[136:139], v[64:67], v[24:27]
    v_mfma_f32_16x16x32_bf16 v[36:39], v[48:51], a[144:147], 0
    v_mfma_f32_16x16x32_bf16 v[32:35], v[64:67], a[208:211], v[32:35]
    v_mfma_f32_16x16x32_bf16 v[20:23], a[4:7], v[52:55], v[20:23]
    v_mfma_f32_16x16x32_bf16 v[40:43], v[68:71], v[252:255], v[40:43]
    ds_read_b128 v[60:63], v2 offset:21504
    s_add_u32 s66, s66, 4096
    v_mfma_f32_16x16x32_bf16 v[28:31], a[76:79], v[52:55], v[28:31]
    buffer_load_dwordx4 v1, s[32:35], s66 offen offset:0 sc1 lds
    v_mfma_f32_16x16x32_bf16 v[32:35], v[68:71], a[212:215], v[32:35]
    ds_read_b128 v[64:67], v2 offset:22528
    s_waitcnt lgkmcnt(2)
    v_mfma_f32_16x16x32_bf16 v[44:47], v[56:59], a[224:227], v[44:47]
    v_mfma_f32_16x16x32_bf16 v[20:23], a[8:11], v[56:59], v[20:23]
    ds_read_b128 v[48:51], v2 offset:24576
    v_mfma_f32_16x16x32_bf16 v[24:27], a[140:143], v[68:71], v[24:27]
    v_mfma_f32_16x16x32_bf16 v[36:39], v[52:55], a[148:151], v[36:39]
    buffer_load_dwordx4 v1, s[32:35], s66 offen offset:1024 sc1 lds
    s_waitcnt lgkmcnt(2)
    v_mfma_f32_16x16x32_bf16 v[20:23], a[12:15], v[60:63], v[20:23]
    v_mfma_f32_16x16x32_bf16 v[36:39], v[56:59], a[152:155], v[36:39]
    v_mfma_f32_16x16x32_bf16 v[36:39], v[60:63], a[156:159], v[36:39]
    v_mfma_f32_16x16x32_bf16 v[28:31], a[80:83], v[56:59], v[28:31]
    v_mfma_f32_16x16x32_bf16 v[28:31], a[84:87], v[60:63], v[28:31]
    v_mfma_f32_16x16x32_bf16 v[44:47], v[60:63], a[228:231], v[44:47]
    ds_read_b128 v[60:63], v2 offset:27648
    ds_read_b128 v[68:71], v2 offset:23552
    s_waitcnt lgkmcnt(3)
    v_mfma_f32_16x16x32_bf16 v[44:47], v[64:67], a[232:235], v[44:47]
    v_mfma_f32_16x16x32_bf16 v[36:39], v[64:67], a[160:163], v[36:39]
    v_mfma_f32_16x16x32_bf16 v[28:31], a[88:91], v[64:67], v[28:31]
    v_mfma_f32_16x16x32_bf16 v[20:23], a[16:19], v[64:67], v[20:23]
    ds_read_b128 v[56:59], v2 offset:26624
    s_waitcnt lgkmcnt(1)
    v_mfma_f32_16x16x32_bf16 v[36:39], v[68:71], a[164:167], v[36:39]
    ds_read_b128 v[52:55], v2 offset:25600
    v_mfma_f32_16x16x32_bf16 v[20:23], a[20:23], v[68:71], v[20:23]
    v_cvt_pk_bf16_f32 v81, v18, v19
    v_mfma_f32_16x16x32_bf16 v[20:23], a[24:27], v[48:51], v[20:23]
    v_mfma_f32_16x16x32_bf16 v[28:31], a[92:95], v[68:71], v[28:31]
    v_mfma_f32_16x16x32_bf16 v[36:39], v[48:51], a[168:171], v[36:39]
    buffer_load_dwordx4 v1, s[32:35], s66 offen offset:2048 sc1 lds
    s_waitcnt lgkmcnt(0)
    v_mfma_f32_16x16x32_bf16 v[36:39], v[52:55], a[172:175], v[36:39]
    v_cvt_pk_bf16_f32 v89, v34, v35
    v_mfma_f32_16x16x32_bf16 v[44:47], v[68:71], a[236:239], v[44:47]
    v_mfma_f32_16x16x32_bf16 v[44:47], v[48:51], a[240:243], v[44:47]
    v_cvt_pk_bf16_f32 v82, v24, v25
    v_cvt_pk_bf16_f32 v92, v40, v41
    v_mfma_f32_16x16x32_bf16 v[44:47], v[52:55], a[244:247], v[44:47]
    v_mfma_f32_16x16x32_bf16 v[28:31], a[96:99], v[48:51], v[28:31]
    ds_read_b128 v[48:51], v2 offset:30720
    ds_read_b128 v[64:67], v2 offset:28672
    v_mfma_f32_16x16x32_bf16 v[44:47], v[56:59], a[248:251], v[44:47]
    v_mfma_f32_16x16x32_bf16 v[20:23], a[28:31], v[52:55], v[20:23]
    buffer_load_dwordx4 v1, s[32:35], s66 offen offset:3072 sc1 lds
    v_mfma_f32_16x16x32_bf16 v[28:31], a[100:103], v[52:55], v[28:31]
    v_mfma_f32_16x16x32_bf16 v[28:31], a[104:107], v[56:59], v[28:31]
    ds_read_b128 v[68:71], v2 offset:29696
    ds_read_b128 v[52:55], v2 offset:31744
    v_mfma_f32_16x16x32_bf16 v[44:47], v[60:63], a[252:255], v[44:47]
    v_mfma_f32_16x16x32_bf16 v[20:23], a[32:35], v[56:59], v[20:23]
    v_mfma_f32_16x16x32_bf16 v[36:39], v[56:59], a[176:179], v[36:39]
    v_mfma_f32_16x16x32_bf16 v[36:39], v[60:63], a[180:183], v[36:39]
    v_mfma_f32_16x16x32_bf16 v[28:31], a[108:111], v[60:63], v[28:31]
    v_mfma_f32_16x16x32_bf16 v[20:23], a[36:39], v[60:63], v[20:23]
    s_waitcnt lgkmcnt(2)
    v_mfma_f32_16x16x32_bf16 v[20:23], a[40:43], v[64:67], v[20:23]
    v_cvt_pk_bf16_f32 v83, v26, v27
    v_mfma_f32_16x16x32_bf16 v[28:31], a[112:115], v[64:67], v[28:31]
    s_waitcnt lgkmcnt(1)
    v_mfma_f32_16x16x32_bf16 v[20:23], a[44:47], v[68:71], v[20:23]
    v_mfma_f32_16x16x32_bf16 v[36:39], v[64:67], a[184:187], v[36:39]
    v_mfma_f32_16x16x32_bf16 v[44:47], v[64:67], v[224:227], v[44:47]
    v_mfma_f32_16x16x32_bf16 v[20:23], a[48:51], v[48:51], v[20:23]
    v_mfma_f32_16x16x32_bf16 v[36:39], v[68:71], a[188:191], v[36:39]
    ds_read_b128 v[64:67], v2 offset:34816
    ds_read_b128 v[56:59], v2 offset:32768
    v_mfma_f32_16x16x32_bf16 v[36:39], v[48:51], a[192:195], v[36:39]
    s_add_u32 s66, s66, 4096
    v_mfma_f32_16x16x32_bf16 v[28:31], a[116:119], v[68:71], v[28:31]
    v_cvt_pk_bf16_f32 v80, v16, v17
    v_mfma_f32_16x16x32_bf16 v[28:31], a[120:123], v[48:51], v[28:31]
    s_waitcnt lgkmcnt(2)
    v_mfma_f32_16x16x32_bf16 v[20:23], a[52:55], v[52:55], v[20:23]
    ds_read_b128 v[60:63], v2 offset:33792
    v_mfma_f32_16x16x32_bf16 v[28:31], a[124:127], v[52:55], v[28:31]
    s_waitcnt lgkmcnt(1)
    v_mfma_f32_16x16x32_bf16 v[28:31], a[128:131], v[56:59], v[28:31]
    s_add_u32 m0, s68, 8192
    v_mfma_f32_16x16x32_bf16 v[20:23], a[56:59], v[56:59], v[20:23]
    buffer_load_dwordx4 v1, s[32:35], s66 offen offset:0 sc1 lds
    v_mfma_f32_16x16x32_bf16 v[36:39], v[52:55], a[196:199], v[36:39]
    v_mfma_f32_16x16x32_bf16 v[44:47], v[68:71], v[228:231], v[44:47]
    ds_read_b128 v[68:71], v2 offset:35840
    v_mfma_f32_16x16x32_bf16 v[36:39], v[56:59], a[200:203], v[36:39]
    s_waitcnt lgkmcnt(1)
    v_mfma_f32_16x16x32_bf16 v[36:39], v[60:63], a[204:207], v[36:39]
    v_cvt_pk_bf16_f32 v93, v42, v43
    v_cvt_pk_bf16_f32 v88, v32, v33
    v_mfma_f32_16x16x32_bf16 v[44:47], v[48:51], v[232:235], v[44:47]
    v_mfma_f32_16x16x32_bf16 v[20:23], a[60:63], v[60:63], v[20:23]
    s_waitcnt vmcnt(23)
    buffer_store_dword v4, v3, s[32:35], s64 offen sc1
    v_mfma_f32_16x16x32_bf16 v[36:39], v[64:67], a[208:211], v[36:39]
    s_waitcnt lgkmcnt(0)
    v_mfma_f32_16x16x32_bf16 v[36:39], v[68:71], a[212:215], v[36:39]
    v_mfma_f32_16x16x32_bf16 v[20:23], a[64:67], v[64:67], v[20:23]
    buffer_store_dwordx4 v[80:83], v1, s[32:35], s62 offen offset:0 sc1
    s_nop 3
    v_cvt_pk_bf16_f32 v90, v36, v37
    v_mfma_f32_16x16x32_bf16 v[28:31], a[132:135], v[60:63], v[28:31]
    v_cvt_pk_bf16_f32 v91, v38, v39
    v_mfma_f32_16x16x32_bf16 v[20:23], a[68:71], v[68:71], v[20:23]
    v_mfma_f32_16x16x32_bf16 v[28:31], a[136:139], v[64:67], v[28:31]
    v_mfma_f32_16x16x32_bf16 v[28:31], a[140:143], v[68:71], v[28:31]
    buffer_store_dwordx4 v[88:91], v1, s[32:35], s63 offen offset:0 sc1
    v_mfma_f32_16x16x32_bf16 v[44:47], v[52:55], v[236:239], v[44:47]
    v_mfma_f32_16x16x32_bf16 v[44:47], v[56:59], v[240:243], v[44:47]
    v_cvt_pk_bf16_f32 v85, v22, v23
    v_cvt_pk_bf16_f32 v84, v20, v21
    v_mfma_f32_16x16x32_bf16 v[44:47], v[60:63], v[244:247], v[44:47]
    v_cvt_pk_bf16_f32 v86, v28, v29
    s_add_u32 s66, s66, 28672
    v_mfma_f32_16x16x32_bf16 v[44:47], v[64:67], v[248:251], v[44:47]
    v_cvt_pk_bf16_f32 v87, v30, v31
    v_mfma_f32_16x16x32_bf16 v[44:47], v[68:71], v[252:255], v[44:47]
    buffer_store_dwordx4 v[84:87], v1, s[32:35], s62 offen offset:1024 sc1
    s_nop 6
    v_cvt_pk_bf16_f32 v94, v44, v45
    v_cvt_pk_bf16_f32 v95, v46, v47
    buffer_store_dwordx4 v[92:95], v1, s[32:35], s63 offen offset:1024 sc1
    s_mov_b32 s70, s69
    s_add_u32 s69, s69, 36864
    s_cmp_eq_u32 s69, 147456
    s_cselect_b32 s69, 0, s69
    s_add_u32 s62, s62, 786432
    s_add_u32 s63, s63, 786432
    s_add_u32 s67, s67, 1
    s_cmp_gt_u32 s67, 4
    s_cbranch_scc1 ploop_12x
    v_mov_b32 v4, s67
    s_waitcnt vmcnt(0)
    buffer_store_dword v4, v3, s[32:35], s64 offen sc1
ploop_12x:
    s_cmp_lt_u32 s67, 64
    s_cbranch_scc1 ploop_12
pe_10:
    v_mov_b32 v4, 64
    s_waitcnt vmcnt(0)
    buffer_store_dword v4, v3, s[32:35], s64 offen sc1
    s_barrier
    s_mov_b32 s61, 63
    s_mov_b32 s60, s53
    s_cmp_lt_u32 s53, 36
    s_cbranch_scc1 L_ffn2
    s_sub_u32 s60, s53, 36
    s_branch L_att2
L_ffn:
    s_cmp_ge_u32 s53, 64
    s_cbranch_scc1 L_noln1
    s_cmp_ge_u32 s52, 2
    s_cbranch_scc1 L_noln1
    s_lshl_b32 s56, s53, 1
    s_add_u32 s56, s56, s52
    s_mov_b32 s36, s4
    s_and_b32 s37, s5, 0xffff
    s_mov_b32 s38, 2359296
    s_mov_b32 s39, 0x20000
    v_and_b32 v1, 15, v0
    v_lshrrev_b32 v2, 4, v0
    v_mul_u32_u24 v1, 1152, v1
    v_lshl_add_u32 v1, v2, 4, v1
    s_mul_i32 s57, s56, 18432
    buffer_load_dwordx4 v[160:163], v1, s[36:39], s57 offen offset:0
    buffer_load_dwordx4 v[164:167], v1, s[36:39], s57 offen offset:64
    buffer_load_dwordx4 v[168:171], v1, s[36:39], s57 offen offset:128
    buffer_load_dwordx4 v[172:175], v1, s[36:39], s57 offen offset:192
    buffer_load_dwordx4 v[176:179], v1, s[36:39], s57 offen offset:256
    buffer_load_dwordx4 v[180:183], v1, s[36:39], s57 offen offset:320
    buffer_load_dwordx4 v[184:187], v1, s[36:39], s57 offen offset:384
    buffer_load_dwordx4 v[188:191], v1, s[36:39], s57 offen offset:448
    buffer_load_dwordx4 v[192:195], v1, s[36:39], s57 offen offset:512
    buffer_load_dwordx4 v[196:199], v1, s[36:39], s57 offen offset:576
    buffer_load_dwordx4 v[200:203], v1, s[36:39], s57 offen offset:640
    buffer_load_dwordx4 v[204:207], v1, s[36:39], s57 offen offset:704
    buffer_load_dwordx4 v[208:211], v1, s[36:39], s57 offen offset:768
    buffer_load_dwordx4 v[212:215], v1, s[36:39], s57 offen offset:832
    buffer_load_dwordx4 v[216:219], v1, s[36:39], s57 offen offset:896
    buffer_load_dwordx4 v[220:223], v1, s[36:39], s57 offen offset:960
    buffer_load_dwordx4 v[224:227], v1, s[36:39], s57 offen offset:1024
    buffer_load_dwordx4 v[228:231], v1, s[36:39], s57 offen offset:1088
    s_mov_b32 s58, 0xffff0000
    s_waitcnt vmcnt(17)
    v_lshlrev_b32 v8, 16, v160
    v_and_b32 v9, s58, v160
    v_lshlrev_b32 v10, 16, v161
    v_and_b32 v11, s58, v161
    v_lshlrev_b32 v12, 16, v162
    v_and_b32 v13, s58, v162
    v_lshlrev_b32 v14, 16, v163
    v_and_b32 v15, s58, v163
    v_pk_add_f32 v[2:3], v[8:9], v[10:11]
    v_pk_add_f32 v[4:5], v[12:13], v[14:15]
    s_waitcnt vmcnt(16)
    v_lshlrev_b32 v16, 16, v164
    v_and_b32 v17, s58, v164
    v_lshlrev_b32 v18, 16, v165
    v_and_b32 v19, s58, v165
    v_lshlrev_b32 v20, 16, v166
    v_and_b32 v21, s58, v166
    v_lshlrev_b32 v22, 16, v167
    v_and_b32 v23, s58, v167
    v_pk_add_f32 v[2:3], v[2:3], v[16:17]
    v_pk_add_f32 v[4:5], v[4:5], v[18:19]
    v_pk_add_f32 v[2:3], v[2:3], v[20:21]
    v_pk_add_f32 v[4:5], v[4:5], v[22:23]
    s_waitcnt vmcnt(15)
    v_lshlrev_b32 v24, 16, v168
    v_and_b32 v25, s58, v168
    v_lshlrev_b32 v26, 16, v169
    v_and_b32 v27, s58, v169
    v_lshlrev_b32 v28, 16, v170
    v_and_b32 v29, s58, v170
    v_lshlrev_b32 v30, 16, v171
    v_and_b32 v31, s58, v171
    v_pk_add_f32 v[2:3], v[2:3], v[24:25]
    v_pk_add_f32 v[4:5], v[4:5], v[26:27]
    v_pk_add_f32 v[2:3], v[2:3], v[28:29]
    v_pk_add_f32 v[4:5], v[4:5], v[30:31]
    s_waitcnt vmcnt(14)
    v_lshlrev_b32 v32, 16, v172
    v_and_b32 v33, s58, v172
    v_lshlrev_b32 v34, 16, v173
    v_and_b32 v35, s58, v173
    v_lshlrev_b32 v36, 16, v174
    v_and_b32 v37, s58, v174
    v_lshlrev_b32 v38, 16, v175
    v_and_b32 v39, s58, v175
    v_pk_add_f32 v[2:3], v[2:3], v[32:33]
    v_pk_add_f32 v[4:5], v[4:5], v[34:35]
    v_pk_add_f32 v[2:3], v[2:3], v[36:37]
    v_pk_add_f32 v[4:5], v[4:5], v[38:39]
    s_waitcnt vmcnt(13)
    v_lshlrev_b32 v40, 16, v176
    v_and_b32 v41, s58, v176
    v_lshlrev_b32 v42, 16, v177
    v_and_b32 v43, s58, v177
    v_lshlrev_b32 v44, 16, v178
    v_and_b32 v45, s58, v178
    v_lshlrev_b32 v46, 16, v179
    v_and_b32 v47, s58, v179
    v_pk_add_f32 v[2:3], v[2:3], v[40:41]
    v_pk_add_f32 v[4:5], v[4:5], v[42:43]
    v_pk_add_f32 v[2:3], v[2:3], v[44:45]
    v_pk_add_f32 v[4:5], v[4:5], v[46:47]
    s_waitcnt vmcnt(12)
    v_lshlrev_b32 v48, 16, v180
    v_and_b32 v49, s58, v180
    v_lshlrev_b32 v50, 16, v181
    v_and_b32 v51, s58, v181
    v_lshlrev_b32 v52, 16, v182
    v_and_b32 v53, s58, v182
    v_lshlrev_b32 v54, 16, v183
    v_and_b32 v55, s58, v183
    v_pk_add_f32 v[2:3], v[2:3], v[48:49]
    v_pk_add_f32 v[4:5], v[4:5], v[50:51]
    v_pk_add_f32 v[2:3], v[2:3], v[52:53]
    v_pk_add_f32 v[4:5], v[4:5], v[54:55]
    s_waitcnt vmcnt(11)
    v_lshlrev_b32 v56, 16, v184
    v_and_b32 v57, s58, v184
    v_lshlrev_b32 v58, 16, v185
    v_and_b32 v59, s58, v185
    v_lshlrev_b32 v60, 16, v186
    v_and_b32 v61, s58, v186
    v_lshlrev_b32 v62, 16, v187
    v_and_b32 v63, s58, v187
    v_pk_add_f32 v[2:3], v[2:3], v[56:57]
    v_pk_add_f32 v[4:5], v[4:5], v[58:59]
    v_pk_add_f32 v[2:3], v[2:3], v[60:61]
    v_pk_add_f32 v[4:5], v[4:5], v[62:63]
    s_waitcnt vmcnt(10)
    v_lshlrev_b32 v64, 16, v188
    v_and_b32 v65, s58, v188
    v_lshlrev_b32 v66, 16, v189
    v_and_b32 v67, s58, v189
    v_lshlrev_b32 v68, 16, v190
    v_and_b32 v69, s58, v190
    v_lshlrev_b32 v70, 16, v191
    v_and_b32 v71, s58, v191
    v_pk_add_f32 v[2:3], v[2:3], v[64:65]
    v_pk_add_f32 v[4:5], v[4:5], v[66:67]
    v_pk_add_f32 v[2:3], v[2:3], v[68:69]
    v_pk_add_f32 v[4:5], v[4:5], v[70:71]
    s_waitcnt vmcnt(9)
    v_lshlrev_b32 v72, 16, v192
    v_and_b32 v73, s58, v192
    v_lshlrev_b32 v74, 16, v193
    v_and_b32 v75, s58, v193
    v_lshlrev_b32 v76, 16, v194
    v_and_b32 v77, s58, v194
    v_lshlrev_b32 v78, 16, v195
    v_and_b32 v79, s58, v195
    v_pk_add_f32 v[2:3], v[2:3], v[72:73]
    v_pk_add_f32 v[4:5], v[4:5], v[74:75]
    v_pk_add_f32 v[2:3], v[2:3], v[76:77]
    v_pk_add_f32 v[4:5], v[4:5], v[78:79]
    s_waitcnt vmcnt(8)
    v_lshlrev_b32 v80, 16, v196
    v_and_b32 v81, s58, v196
    v_lshlrev_b32 v82, 16, v197
    v_and_b32 v83, s58, v197
    v_lshlrev_b32 v84, 16, v198
    v_and_b32 v85, s58, v198
    v_lshlrev_b32 v86, 16, v199
    v_and_b32 v87, s58, v199
    v_pk_add_f32 v[2:3], v[2:3], v[80:81]
    v_pk_add_f32 v[4:5], v[4:5], v[82:83]
    v_pk_add_f32 v[2:3], v[2:3], v[84:85]
    v_pk_add_f32 v[4:5], v[4:5], v[86:87]
    s_waitcnt vmcnt(7)
    v_lshlrev_b32 v88, 16, v200
    v_and_b32 v89, s58, v200
    v_lshlrev_b32 v90, 16, v201
    v_and_b32 v91, s58, v201
    v_lshlrev_b32 v92, 16, v202
    v_and_b32 v93, s58, v202
    v_lshlrev_b32 v94, 16, v203
    v_and_b32 v95, s58, v203
    v_pk_add_f32 v[2:3], v[2:3], v[88:89]
    v_pk_add_f32 v[4:5], v[4:5], v[90:91]
    v_pk_add_f32 v[2:3], v[2:3], v[92:93]
    v_pk_add_f32 v[4:5], v[4:5], v[94:95]
    s_waitcnt vmcnt(6)
    v_lshlrev_b32 v96, 16, v204
    v_and_b32 v97, s58, v204
    v_lshlrev_b32 v98, 16, v205
    v_and_b32 v99, s58, v205
    v_lshlrev_b32 v100, 16, v206
    v_and_b32 v101, s58, v206
    v_lshlrev_b32 v102, 16, v207
    v_and_b32 v103, s58, v207
    v_pk_add_f32 v[2:3], v[2:3], v[96:97]
    v_pk_add_f32 v[4:5], v[4:5], v[98:99]
    v_pk_add_f32 v[2:3], v[2:3], v[100:101]
    v_pk_add_f32 v[4:5], v[4:5], v[102:103]
    s_waitcnt vmcnt(5)
    v_lshlrev_b32 v104, 16, v208
    v_and_b32 v105, s58, v208
    v_lshlrev_b32 v106, 16, v209
    v_and_b32 v107, s58, v209
    v_lshlrev_b32 v108, 16, v210
    v_and_b32 v109, s58, v210
    v_lshlrev_b32 v110, 16, v211
    v_and_b32 v111, s58, v211
    v_pk_add_f32 v[2:3], v[2:3], v[104:105]
    v_pk_add_f32 v[4:5], v[4:5], v[106:107]
    v_pk_add_f32 v[2:3], v[2:3], v[108:109]
    v_pk_add_f32 v[4:5], v[4:5], v[110:111]
    s_waitcnt vmcnt(4)
    v_lshlrev_b32 v112, 16, v212
    v_and_b32 v113, s58, v212
    v_lshlrev_b32 v114, 16, v213
    v_and_b32 v115, s58, v213
    v_lshlrev_b32 v116, 16, v214
    v_and_b32 v117, s58, v214
    v_lshlrev_b32 v118, 16, v215
    v_and_b32 v119, s58, v215
    v_pk_add_f32 v[2:3], v[2:3], v[112:113]
    v_pk_add_f32 v[4:5], v[4:5], v[114:115]
    v_pk_add_f32 v[2:3], v[2:3], v[116:117]
    v_pk_add_f32 v[4:5], v[4:5], v[118:119]
    s_waitcnt vmcnt(3)
    v_lshlrev_b32 v120, 16, v216
    v_and_b32 v121, s58, v216
    v_lshlrev_b32 v122, 16, v217
    v_and_b32 v123, s58, v217
    v_lshlrev_b32 v124, 16, v218
    v_and_b32 v125, s58, v218
    v_lshlrev_b32 v126, 16, v219
    v_and_b32 v127, s58, v219
    v_pk_add_f32 v[2:3], v[2:3], v[120:121]
    v_pk_add_f32 v[4:5], v[4:5], v[122:123]
    v_pk_add_f32 v[2:3], v[2:3], v[124:125]
    v_pk_add_f32 v[4:5], v[4:5], v[126:127]
    s_waitcnt vmcnt(2)
    v_lshlrev_b32 v128, 16, v220
    v_and_b32 v129, s58, v220
    v_lshlrev_b32 v130, 16, v221
    v_and_b32 v131, s58, v221
    v_lshlrev_b32 v132, 16, v222
    v_and_b32 v133, s58, v222
    v_lshlrev_b32 v134, 16, v223
    v_and_b32 v135, s58, v223
    v_pk_add_f32 v[2:3], v[2:3], v[128:129]
    v_pk_add_f32 v[4:5], v[4:5], v[130:131]
    v_pk_add_f32 v[2:3], v[2:3], v[132:133]
    v_pk_add_f32 v[4:5], v[4:5], v[134:135]
    s_waitcnt vmcnt(1)
    v_lshlrev_b32 v136, 16, v224
    v_and_b32 v137, s58, v224
    v_lshlrev_b32 v138, 16, v225
    v_and_b32 v139, s58, v225
    v_lshlrev_b32 v140, 16, v226
    v_and_b32 v141, s58, v226
    v_lshlrev_b32 v142, 16, v227
    v_and_b32 v143, s58, v227
    v_pk_add_f32 v[2:3], v[2:3], v[136:137]
    v_pk_add_f32 v[4:5], v[4:5], v[138:139]
    v_pk_add_f32 v[2:3], v[2:3], v[140:141]
    v_pk_add_f32 v[4:5], v[4:5], v[142:143]
    s_waitcnt vmcnt(0)
    v_lshlrev_b32 v144, 16, v228
    v_and_b32 v145, s58, v228
    v_lshlrev_b32 v146, 16, v229
    v_and_b32 v147, s58, v229
    v_lshlrev_b32 v148, 16, v230
    v_and_b32 v149, s58, v230
    v_lshlrev_b32 v150, 16, v231
    v_and_b32 v151, s58, v231
    v_pk_add_f32 v[2:3], v[2:3], v[144:145]
    v_pk_add_f32 v[4:5], v[4:5], v[146:147]
    v_pk_add_f32 v[2:3], v[2:3], v[148:149]
    v_pk_add_f32 v[4:5], v[4:5], v[150:151]
    v_pk_add_f32 v[2:3], v[2:3], v[4:5]
    v_add_f32 v2, v2, v3
    v_mov_b32 v3, v2
    s_nop 1
    v_permlane32_swap_b32 v2, v3
    v_add_f32 v2, v2, v3
    v_mov_b32 v3, v2
    s_nop 1
    v_permlane16_swap_b32 v2, v3
    v_add_f32 v2, v2, v3
    v_mul_f32 v2, 0xbae38e39, v2
    v_mov_b32 v3, v2
    v_mov_b32 v4, 0
    v_mov_b32 v5, 0
    v_mov_b32 v6, 0
    v_mov_b32 v7, 0
    v_pk_add_f32 v[152:153], v[8:9], v[2:3]
    v_pk_add_f32 v[154:155], v[10:11], v[2:3]
    v_pk_fma_f32 v[4:5], v[152:153], v[152:153], v[4:5]
    v_pk_fma_f32 v[6:7], v[154:155], v[154:155], v[6:7]
    v_pk_add_f32 v[152:153], v[12:13], v[2:3]
    v_pk_add_f32 v[154:155], v[14:15], v[2:3]
    v_pk_fma_f32 v[4:5], v[152:153], v[152:153], v[4:5]
    v_pk_fma_f32 v[6:7], v[154:155], v[154:155], v[6:7]
    v_pk_add_f32 v[152:153], v[16:17], v[2:3]
    v_pk_add_f32 v[154:155], v[18:19], v[2:3]
    v_pk_fma_f32 v[4:5], v[152:153], v[152:153], v[4:5]
    v_pk_fma_f32 v[6:7], v[154:155], v[154:155], v[6:7]
    v_pk_add_f32 v[152:153], v[20:21], v[2:3]
    v_pk_add_f32 v[154:155], v[22:23], v[2:3]
    v_pk_fma_f32 v[4:5], v[152:153], v[152:153], v[4:5]
    v_pk_fma_f32 v[6:7], v[154:155], v[154:155], v[6:7]
    v_pk_add_f32 v[152:153], v[24:25], v[2:3]
    v_pk_add_f32 v[154:155], v[26:27], v[2:3]
    v_pk_fma_f32 v[4:5], v[152:153], v[152:153], v[4:5]
    v_pk_fma_f32 v[6:7], v[154:155], v[154:155], v[6:7]
    v_pk_add_f32 v[152:153], v[28:29], v[2:3]
    v_pk_add_f32 v[154:155], v[30:31], v[2:3]
    v_pk_fma_f32 v[4:5], v[152:153], v[152:153], v[4:5]
    v_pk_fma_f32 v[6:7], v[154:155], v[154:155], v[6:7]
    v_pk_add_f32 v[152:153], v[32:33], v[2:3]
    v_pk_add_f32 v[154:155], v[34:35], v[2:3]
    v_pk_fma_f32 v[4:5], v[152:153], v[152:153], v[4:5]
    v_pk_fma_f32 v[6:7], v[154:155], v[154:155], v[6:7]
    v_pk_add_f32 v[152:153], v[36:37], v[2:3]
    v_pk_add_f32 v[154:155], v[38:39], v[2:3]
    v_pk_fma_f32 v[4:5], v[152:153], v[152:153], v[4:5]
    v_pk_fma_f32 v[6:7], v[154:155], v[154:155], v[6:7]
    v_pk_add_f32 v[152:153], v[40:41], v[2:3]
    v_pk_add_f32 v[154:155], v[42:43], v[2:3]
    v_pk_fma_f32 v[4:5], v[152:153], v[152:153], v[4:5]
    v_pk_fma_f32 v[6:7], v[154:155], v[154:155], v[6:7]
    v_pk_add_f32 v[152:153], v[44:45], v[2:3]
    v_pk_add_f32 v[154:155], v[46:47], v[2:3]
    v_pk_fma_f32 v[4:5], v[152:153], v[152:153], v[4:5]
    v_pk_fma_f32 v[6:7], v[154:155], v[154:155], v[6:7]
    v_pk_add_f32 v[152:153], v[48:49], v[2:3]
    v_pk_add_f32 v[154:155], v[50:51], v[2:3]
    v_pk_fma_f32 v[4:5], v[152:153], v[152:153], v[4:5]
    v_pk_fma_f32 v[6:7], v[154:155], v[154:155], v[6:7]
    v_pk_add_f32 v[152:153], v[52:53], v[2:3]
    v_pk_add_f32 v[154:155], v[54:55], v[2:3]
    v_pk_fma_f32 v[4:5], v[152:153], v[152:153], v[4:5]
    v_pk_fma_f32 v[6:7], v[154:155], v[154:155], v[6:7]
    v_pk_add_f32 v[152:153], v[56:57], v[2:3]
    v_pk_add_f32 v[154:155], v[58:59], v[2:3]
    v_pk_fma_f32 v[4:5], v[152:153], v[152:153], v[4:5]
    v_pk_fma_f32 v[6:7], v[154:155], v[154:155], v[6:7]
    v_pk_add_f32 v[152:153], v[60:61], v[2:3]
    v_pk_add_f32 v[154:155], v[62:63], v[2:3]
    v_pk_fma_f32 v[4:5], v[152:153], v[152:153], v[4:5]
    v_pk_fma_f32 v[6:7], v[154:155], v[154:155], v[6:7]
    v_pk_add_f32 v[152:153], v[64:65], v[2:3]
    v_pk_add_f32 v[154:155], v[66:67], v[2:3]
    v_pk_fma_f32 v[4:5], v[152:153], v[152:153], v[4:5]
    v_pk_fma_f32 v[6:7], v[154:155], v[154:155], v[6:7]
    v_pk_add_f32 v[152:153], v[68:69], v[2:3]
    v_pk_add_f32 v[154:155], v[70:71], v[2:3]
    v_pk_fma_f32 v[4:5], v[152:153], v[152:153], v[4:5]
    v_pk_fma_f32 v[6:7], v[154:155], v[154:155], v[6:7]
    v_pk_add_f32 v[152:153], v[72:73], v[2:3]
    v_pk_add_f32 v[154:155], v[74:75], v[2:3]
    v_pk_fma_f32 v[4:5], v[152:153], v[152:153], v[4:5]
    v_pk_fma_f32 v[6:7], v[154:155], v[154:155], v[6:7]
    v_pk_add_f32 v[152:153], v[76:77], v[2:3]
    v_pk_add_f32 v[154:155], v[78:79], v[2:3]
    v_pk_fma_f32 v[4:5], v[152:153], v[152:153], v[4:5]
    v_pk_fma_f32 v[6:7], v[154:155], v[154:155], v[6:7]
    v_pk_add_f32 v[152:153], v[80:81], v[2:3]
    v_pk_add_f32 v[154:155], v[82:83], v[2:3]
    v_pk_fma_f32 v[4:5], v[152:153], v[152:153], v[4:5]
    v_pk_fma_f32 v[6:7], v[154:155], v[154:155], v[6:7]
    v_pk_add_f32 v[152:153], v[84:85], v[2:3]
    v_pk_add_f32 v[154:155], v[86:87], v[2:3]
    v_pk_fma_f32 v[4:5], v[152:153], v[152:153], v[4:5]
    v_pk_fma_f32 v[6:7], v[154:155], v[154:155], v[6:7]
    v_pk_add_f32 v[152:153], v[88:89], v[2:3]
    v_pk_add_f32 v[154:155], v[90:91], v[2:3]
    v_pk_fma_f32 v[4:5], v[152:153], v[152:153], v[4:5]
    v_pk_fma_f32 v[6:7], v[154:155], v[154:155], v[6:7]
    v_pk_add_f32 v[152:153], v[92:93], v[2:3]
    v_pk_add_f32 v[154:155], v[94:95], v[2:3]
    v_pk_fma_f32 v[4:5], v[152:153], v[152:153], v[4:5]
    v_pk_fma_f32 v[6:7], v[154:155], v[154:155], v[6:7]
    v_pk_add_f32 v[152:153], v[96:97], v[2:3]
    v_pk_add_f32 v[154:155], v[98:99], v[2:3]
    v_pk_fma_f32 v[4:5], v[152:153], v[152:153], v[4:5]
    v_pk_fma_f32 v[6:7], v[154:155], v[154:155], v[6:7]
    v_pk_add_f32 v[152:153], v[100:101], v[2:3]
    v_pk_add_f32 v[154:155], v[102:103], v[2:3]
    v_pk_fma_f32 v[4:5], v[152:153], v[152:153], v[4:5]
    v_pk_fma_f32 v[6:7], v[154:155], v[154:155], v[6:7]
    v_pk_add_f32 v[152:153], v[104:105], v[2:3]
    v_pk_add_f32 v[154:155], v[106:107], v[2:3]
    v_pk_fma_f32 v[4:5], v[152:153], v[152:153], v[4:5]
    v_pk_fma_f32 v[6:7], v[154:155], v[154:155], v[6:7]
    v_pk_add_f32 v[152:153], v[108:109], v[2:3]
    v_pk_add_f32 v[154:155], v[110:111], v[2:3]
    v_pk_fma_f32 v[4:5], v[152:153], v[152:153], v[4:5]
    v_pk_fma_f32 v[6:7], v[154:155], v[154:155], v[6:7]
    v_pk_add_f32 v[152:153], v[112:113], v[2:3]
    v_pk_add_f32 v[154:155], v[114:115], v[2:3]
    v_pk_fma_f32 v[4:5], v[152:153], v[152:153], v[4:5]
    v_pk_fma_f32 v[6:7], v[154:155], v[154:155], v[6:7]
    v_pk_add_f32 v[152:153], v[116:117], v[2:3]
    v_pk_add_f32 v[154:155], v[118:119], v[2:3]
    v_pk_fma_f32 v[4:5], v[152:153], v[152:153], v[4:5]
    v_pk_fma_f32 v[6:7], v[154:155], v[154:155], v[6:7]
    v_pk_add_f32 v[152:153], v[120:121], v[2:3]
    v_pk_add_f32 v[154:155], v[122:123], v[2:3]
    v_pk_fma_f32 v[4:5], v[152:153], v[152:153], v[4:5]
    v_pk_fma_f32 v[6:7], v[154:155], v[154:155], v[6:7]
    v_pk_add_f32 v[152:153], v[124:125], v[2:3]
    v_pk_add_f32 v[154:155], v[126:127], v[2:3]
    v_pk_fma_f32 v[4:5], v[152:153], v[152:153], v[4:5]
    v_pk_fma_f32 v[6:7], v[154:155], v[154:155], v[6:7]
    v_pk_add_f32 v[152:153], v[128:129], v[2:3]
    v_pk_add_f32 v[154:155], v[130:131], v[2:3]
    v_pk_fma_f32 v[4:5], v[152:153], v[152:153], v[4:5]
    v_pk_fma_f32 v[6:7], v[154:155], v[154:155], v[6:7]
    v_pk_add_f32 v[152:153], v[132:133], v[2:3]
    v_pk_add_f32 v[154:155], v[134:135], v[2:3]
    v_pk_fma_f32 v[4:5], v[152:153], v[152:153], v[4:5]
    v_pk_fma_f32 v[6:7], v[154:155], v[154:155], v[6:7]
    v_pk_add_f32 v[152:153], v[136:137], v[2:3]
    v_pk_add_f32 v[154:155], v[138:139], v[2:3]
    v_pk_fma_f32 v[4:5], v[152:153], v[152:153], v[4:5]
    v_pk_fma_f32 v[6:7], v[154:155], v[154:155], v[6:7]
    v_pk_add_f32 v[152:153], v[140:141], v[2:3]
    v_pk_add_f32 v[154:155], v[142:143], v[2:3]
    v_pk_fma_f32 v[4:5], v[152:153], v[152:153], v[4:5]
    v_pk_fma_f32 v[6:7], v[154:155], v[154:155], v[6:7]
    v_pk_add_f32 v[152:153], v[144:145], v[2:3]
    v_pk_add_f32 v[154:155], v[146:147], v[2:3]
    v_pk_fma_f32 v[4:5], v[152:153], v[152:153], v[4:5]
    v_pk_fma_f32 v[6:7], v[154:155], v[154:155], v[6:7]
    v_pk_add_f32 v[152:153], v[148:149], v[2:3]
    v_pk_add_f32 v[154:155], v[150:151], v[2:3]
    v_pk_fma_f32 v[4:5], v[152:153], v[152:153], v[4:5]
    v_pk_fma_f32 v[6:7], v[154:155], v[154:155], v[6:7]
    v_pk_add_f32 v[4:5], v[4:5], v[6:7]
    v_add_f32 v4, v4, v5
    v_mov_b32 v5, v4
    s_nop 1
    v_permlane32_swap_b32 v4, v5
    v_add_f32 v4, v4, v5
    v_mov_b32 v5, v4
    s_nop 1
    v_permlane16_swap_b32 v4, v5
    v_add_f32 v4, v4, v5
    v_mul_f32 v4, 0x3ae38e39, v4
    v_cvt_pk_bf16_f32 v4, v4, v4
    v_lshlrev_b32 v4, 16, v4
    v_add_f32 v4, 0x3727c5ac, v4
    v_cvt_pk_bf16_f32 v4, v4, v4
    v_lshlrev_b32 v4, 16, v4
    v_sqrt_f32 v4, v4
    s_nop 0
    v_cvt_pk_bf16_f32 v4, v4, v4
    v_lshlrev_b32 v4, 16, v4
    v_rcp_f32 v4, v4
    v_cvt_pk_bf16_f32 v2, v2, v2
    v_lshlrev_b32 v2, 16, v2
    v_mov_b32 v3, v2
    v_mov_b32 v5, v4
    v_lshlrev_b32 v1, 4, v0
    s_mul_i32 s57, s56, 18432
    s_add_u32 s57, s57, 196608
    v_pk_add_f32 v[8:9], v[8:9], v[2:3]
    v_cvt_pk_bf16_f32 v160, v8, v9
    v_lshlrev_b32 v8, 16, v160
    v_and_b32 v9, s58, v160
    v_pk_mul_f32 v[8:9], v[8:9], v[4:5]
    v_cvt_pk_bf16_f32 v160, v8, v9
    v_pk_add_f32 v[10:11], v[10:11], v[2:3]
    v_cvt_pk_bf16_f32 v161, v10, v11
    v_lshlrev_b32 v10, 16, v161
    v_and_b32 v11, s58, v161
    v_pk_mul_f32 v[10:11], v[10:11], v[4:5]
    v_cvt_pk_bf16_f32 v161, v10, v11
    v_pk_add_f32 v[12:13], v[12:13], v[2:3]
    v_cvt_pk_bf16_f32 v162, v12, v13
    v_lshlrev_b32 v12, 16, v162
    v_and_b32 v13, s58, v162
    v_pk_mul_f32 v[12:13], v[12:13], v[4:5]
    v_cvt_pk_bf16_f32 v162, v12, v13
    v_pk_add_f32 v[14:15], v[14:15], v[2:3]
    v_cvt_pk_bf16_f32 v163, v14, v15
    v_lshlrev_b32 v14, 16, v163
    v_and_b32 v15, s58, v163
    v_pk_mul_f32 v[14:15], v[14:15], v[4:5]
    v_cvt_pk_bf16_f32 v163, v14, v15
    buffer_store_dwordx4 v[160:163], v1, s[32:35], s57 offen offset:0 sc1
    v_pk_add_f32 v[16:17], v[16:17], v[2:3]
    v_cvt_pk_bf16_f32 v164, v16, v17
    v_lshlrev_b32 v16, 16, v164
    v_and_b32 v17, s58, v164
    v_pk_mul_f32 v[16:17], v[16:17], v[4:5]
    v_cvt_pk_bf16_f32 v164, v16, v17
    v_pk_add_f32 v[18:19], v[18:19], v[2:3]
    v_cvt_pk_bf16_f32 v165, v18, v19
    v_lshlrev_b32 v18, 16, v165
    v_and_b32 v19, s58, v165
    v_pk_mul_f32 v[18:19], v[18:19], v[4:5]
    v_cvt_pk_bf16_f32 v165, v18, v19
    v_pk_add_f32 v[20:21], v[20:21], v[2:3]
    v_cvt_pk_bf16_f32 v166, v20, v21
    v_lshlrev_b32 v20, 16, v166
    v_and_b32 v21, s58, v166
    v_pk_mul_f32 v[20:21], v[20:21], v[4:5]
    v_cvt_pk_bf16_f32 v166, v20, v21
    v_pk_add_f32 v[22:23], v[22:23], v[2:3]
    v_cvt_pk_bf16_f32 v167, v22, v23
    v_lshlrev_b32 v22, 16, v167
    v_and_b32 v23, s58, v167
    v_pk_mul_f32 v[22:23], v[22:23], v[4:5]
    v_cvt_pk_bf16_f32 v167, v22, v23
    buffer_store_dwordx4 v[164:167], v1, s[32:35], s57 offen offset:1024 sc1
    v_pk_add_f32 v[24:25], v[24:25], v[2:3]
    v_cvt_pk_bf16_f32 v168, v24, v25
    v_lshlrev_b32 v24, 16, v168
    v_and_b32 v25, s58, v168
    v_pk_mul_f32 v[24:25], v[24:25], v[4:5]
    v_cvt_pk_bf16_f32 v168, v24, v25
    v_pk_add_f32 v[26:27], v[26:27], v[2:3]
    v_cvt_pk_bf16_f32 v169, v26, v27
    v_lshlrev_b32 v26, 16, v169
    v_and_b32 v27, s58, v169
    v_pk_mul_f32 v[26:27], v[26:27], v[4:5]
    v_cvt_pk_bf16_f32 v169, v26, v27
    v_pk_add_f32 v[28:29], v[28:29], v[2:3]
    v_cvt_pk_bf16_f32 v170, v28, v29
    v_lshlrev_b32 v28, 16, v170
    v_and_b32 v29, s58, v170
    v_pk_mul_f32 v[28:29], v[28:29], v[4:5]
    v_cvt_pk_bf16_f32 v170, v28, v29
    v_pk_add_f32 v[30:31], v[30:31], v[2:3]
    v_cvt_pk_bf16_f32 v171, v30, v31
    v_lshlrev_b32 v30, 16, v171
    v_and_b32 v31, s58, v171
    v_pk_mul_f32 v[30:31], v[30:31], v[4:5]
    v_cvt_pk_bf16_f32 v171, v30, v31
    buffer_store_dwordx4 v[168:171], v1, s[32:35], s57 offen offset:2048 sc1
    v_pk_add_f32 v[32:33], v[32:33], v[2:3]
    v_cvt_pk_bf16_f32 v172, v32, v33
    v_lshlrev_b32 v32, 16, v172
    v_and_b32 v33, s58, v172
    v_pk_mul_f32 v[32:33], v[32:33], v[4:5]
    v_cvt_pk_bf16_f32 v172, v32, v33
    v_pk_add_f32 v[34:35], v[34:35], v[2:3]
    v_cvt_pk_bf16_f32 v173, v34, v35
    v_lshlrev_b32 v34, 16, v173
    v_and_b32 v35, s58, v173
    v_pk_mul_f32 v[34:35], v[34:35], v[4:5]
    v_cvt_pk_bf16_f32 v173, v34, v35
    v_pk_add_f32 v[36:37], v[36:37], v[2:3]
    v_cvt_pk_bf16_f32 v174, v36, v37
    v_lshlrev_b32 v36, 16, v174
    v_and_b32 v37, s58, v174
    v_pk_mul_f32 v[36:37], v[36:37], v[4:5]
    v_cvt_pk_bf16_f32 v174, v36, v37
    v_pk_add_f32 v[38:39], v[38:39], v[2:3]
    v_cvt_pk_bf16_f32 v175, v38, v39
    v_lshlrev_b32 v38, 16, v175
    v_and_b32 v39, s58, v175
    v_pk_mul_f32 v[38:39], v[38:39], v[4:5]
    v_cvt_pk_bf16_f32 v175, v38, v39
    buffer_store_dwordx4 v[172:175], v1, s[32:35], s57 offen offset:3072 sc1
    s_add_u32 s57, s57, 4096
    v_pk_add_f32 v[40:41], v[40:41], v[2:3]
    v_cvt_pk_bf16_f32 v176, v40, v41
    v_lshlrev_b32 v40, 16, v176
    v_and_b32 v41, s58, v176
    v_pk_mul_f32 v[40:41], v[40:41], v[4:5]
    v_cvt_pk_bf16_f32 v176, v40, v41
    v_pk_add_f32 v[42:43], v[42:43], v[2:3]
    v_cvt_pk_bf16_f32 v177, v42, v43
    v_lshlrev_b32 v42, 16, v177
    v_and_b32 v43, s58, v177
    v_pk_mul_f32 v[42:43], v[42:43], v[4:5]
    v_cvt_pk_bf16_f32 v177, v42, v43
    v_pk_add_f32 v[44:45], v[44:45], v[2:3]
    v_cvt_pk_bf16_f32 v178, v44, v45
    v_lshlrev_b32 v44, 16, v178
    v_and_b32 v45, s58, v178
    v_pk_mul_f32 v[44:45], v[44:45], v[4:5]
    v_cvt_pk_bf16_f32 v178, v44, v45
    v_pk_add_f32 v[46:47], v[46:47], v[2:3]
    v_cvt_pk_bf16_f32 v179, v46, v47
    v_lshlrev_b32 v46, 16, v179
    v_and_b32 v47, s58, v179
    v_pk_mul_f32 v[46:47], v[46:47], v[4:5]
    v_cvt_pk_bf16_f32 v179, v46, v47
    buffer_store_dwordx4 v[176:179], v1, s[32:35], s57 offen offset:0 sc1
    v_pk_add_f32 v[48:49], v[48:49], v[2:3]
    v_cvt_pk_bf16_f32 v180, v48, v49
    v_lshlrev_b32 v48, 16, v180
    v_and_b32 v49, s58, v180
    v_pk_mul_f32 v[48:49], v[48:49], v[4:5]
    v_cvt_pk_bf16_f32 v180, v48, v49
    v_pk_add_f32 v[50:51], v[50:51], v[2:3]
    v_cvt_pk_bf16_f32 v181, v50, v51
    v_lshlrev_b32 v50, 16, v181
    v_and_b32 v51, s58, v181
    v_pk_mul_f32 v[50:51], v[50:51], v[4:5]
    v_cvt_pk_bf16_f32 v181, v50, v51
    v_pk_add_f32 v[52:53], v[52:53], v[2:3]
    v_cvt_pk_bf16_f32 v182, v52, v53
    v_lshlrev_b32 v52, 16, v182
    v_and_b32 v53, s58, v182
    v_pk_mul_f32 v[52:53], v[52:53], v[4:5]
    v_cvt_pk_bf16_f32 v182, v52, v53
    v_pk_add_f32 v[54:55], v[54:55], v[2:3]
    v_cvt_pk_bf16_f32 v183, v54, v55
    v_lshlrev_b32 v54, 16, v183
    v_and_b32 v55, s58, v183
    v_pk_mul_f32 v[54:55], v[54:55], v[4:5]
    v_cvt_pk_bf16_f32 v183, v54, v55
    buffer_store_dwordx4 v[180:183], v1, s[32:35], s57 offen offset:1024 sc1
    v_pk_add_f32 v[56:57], v[56:57], v[2:3]
    v_cvt_pk_bf16_f32 v184, v56, v57
    v_lshlrev_b32 v56, 16, v184
    v_and_b32 v57, s58, v184
    v_pk_mul_f32 v[56:57], v[56:57], v[4:5]
    v_cvt_pk_bf16_f32 v184, v56, v57
    v_pk_add_f32 v[58:59], v[58:59], v[2:3]
    v_cvt_pk_bf16_f32 v185, v58, v59
    v_lshlrev_b32 v58, 16, v185
    v_and_b32 v59, s58, v185
    v_pk_mul_f32 v[58:59], v[58:59], v[4:5]
    v_cvt_pk_bf16_f32 v185, v58, v59
    v_pk_add_f32 v[60:61], v[60:61], v[2:3]
    v_cvt_pk_bf16_f32 v186, v60, v61
    v_lshlrev_b32 v60, 16, v186
    v_and_b32 v61, s58, v186
    v_pk_mul_f32 v[60:61], v[60:61], v[4:5]
    v_cvt_pk_bf16_f32 v186, v60, v61
    v_pk_add_f32 v[62:63], v[62:63], v[2:3]
    v_cvt_pk_bf16_f32 v187, v62, v63
    v_lshlrev_b32 v62, 16, v187
    v_and_b32 v63, s58, v187
    v_pk_mul_f32 v[62:63], v[62:63], v[4:5]
    v_cvt_pk_bf16_f32 v187, v62, v63
    buffer_store_dwordx4 v[184:187], v1, s[32:35], s57 offen offset:2048 sc1
    v_pk_add_f32 v[64:65], v[64:65], v[2:3]
    v_cvt_pk_bf16_f32 v188, v64, v65
    v_lshlrev_b32 v64, 16, v188
    v_and_b32 v65, s58, v188
    v_pk_mul_f32 v[64:65], v[64:65], v[4:5]
    v_cvt_pk_bf16_f32 v188, v64, v65
    v_pk_add_f32 v[66:67], v[66:67], v[2:3]
    v_cvt_pk_bf16_f32 v189, v66, v67
    v_lshlrev_b32 v66, 16, v189
    v_and_b32 v67, s58, v189
    v_pk_mul_f32 v[66:67], v[66:67], v[4:5]
    v_cvt_pk_bf16_f32 v189, v66, v67
    v_pk_add_f32 v[68:69], v[68:69], v[2:3]
    v_cvt_pk_bf16_f32 v190, v68, v69
    v_lshlrev_b32 v68, 16, v190
    v_and_b32 v69, s58, v190
    v_pk_mul_f32 v[68:69], v[68:69], v[4:5]
    v_cvt_pk_bf16_f32 v190, v68, v69
    v_pk_add_f32 v[70:71], v[70:71], v[2:3]
    v_cvt_pk_bf16_f32 v191, v70, v71
    v_lshlrev_b32 v70, 16, v191
    v_and_b32 v71, s58, v191
    v_pk_mul_f32 v[70:71], v[70:71], v[4:5]
    v_cvt_pk_bf16_f32 v191, v70, v71
    buffer_store_dwordx4 v[188:191], v1, s[32:35], s57 offen offset:3072 sc1
    s_add_u32 s57, s57, 4096
    v_pk_add_f32 v[72:73], v[72:73], v[2:3]
    v_cvt_pk_bf16_f32 v192, v72, v73
    v_lshlrev_b32 v72, 16, v192
    v_and_b32 v73, s58, v192
    v_pk_mul_f32 v[72:73], v[72:73], v[4:5]
    v_cvt_pk_bf16_f32 v192, v72, v73
    v_pk_add_f32 v[74:75], v[74:75], v[2:3]
    v_cvt_pk_bf16_f32 v193, v74, v75
    v_lshlrev_b32 v74, 16, v193
    v_and_b32 v75, s58, v193
    v_pk_mul_f32 v[74:75], v[74:75], v[4:5]
    v_cvt_pk_bf16_f32 v193, v74, v75
    v_pk_add_f32 v[76:77], v[76:77], v[2:3]
    v_cvt_pk_bf16_f32 v194, v76, v77
    v_lshlrev_b32 v76, 16, v194
    v_and_b32 v77, s58, v194
    v_pk_mul_f32 v[76:77], v[76:77], v[4:5]
    v_cvt_pk_bf16_f32 v194, v76, v77
    v_pk_add_f32 v[78:79], v[78:79], v[2:3]
    v_cvt_pk_bf16_f32 v195, v78, v79
    v_lshlrev_b32 v78, 16, v195
    v_and_b32 v79, s58, v195
    v_pk_mul_f32 v[78:79], v[78:79], v[4:5]
    v_cvt_pk_bf16_f32 v195, v78, v79
    buffer_store_dwordx4 v[192:195], v1, s[32:35], s57 offen offset:0 sc1
    v_pk_add_f32 v[80:81], v[80:81], v[2:3]
    v_cvt_pk_bf16_f32 v196, v80, v81
    v_lshlrev_b32 v80, 16, v196
    v_and_b32 v81, s58, v196
    v_pk_mul_f32 v[80:81], v[80:81], v[4:5]
    v_cvt_pk_bf16_f32 v196, v80, v81
    v_pk_add_f32 v[82:83], v[82:83], v[2:3]
    v_cvt_pk_bf16_f32 v197, v82, v83
    v_lshlrev_b32 v82, 16, v197
    v_and_b32 v83, s58, v197
    v_pk_mul_f32 v[82:83], v[82:83], v[4:5]
    v_cvt_pk_bf16_f32 v197, v82, v83
    v_pk_add_f32 v[84:85], v[84:85], v[2:3]
    v_cvt_pk_bf16_f32 v198, v84, v85
    v_lshlrev_b32 v84, 16, v198
    v_and_b32 v85, s58, v198
    v_pk_mul_f32 v[84:85], v[84:85], v[4:5]
    v_cvt_pk_bf16_f32 v198, v84, v85
    v_pk_add_f32 v[86:87], v[86:87], v[2:3]
    v_cvt_pk_bf16_f32 v199, v86, v87
    v_lshlrev_b32 v86, 16, v199
    v_and_b32 v87, s58, v199
    v_pk_mul_f32 v[86:87], v[86:87], v[4:5]
    v_cvt_pk_bf16_f32 v199, v86, v87
    buffer_store_dwordx4 v[196:199], v1, s[32:35], s57 offen offset:1024 sc1
    v_pk_add_f32 v[88:89], v[88:89], v[2:3]
    v_cvt_pk_bf16_f32 v200, v88, v89
    v_lshlrev_b32 v88, 16, v200
    v_and_b32 v89, s58, v200
    v_pk_mul_f32 v[88:89], v[88:89], v[4:5]
    v_cvt_pk_bf16_f32 v200, v88, v89
    v_pk_add_f32 v[90:91], v[90:91], v[2:3]
    v_cvt_pk_bf16_f32 v201, v90, v91
    v_lshlrev_b32 v90, 16, v201
    v_and_b32 v91, s58, v201
    v_pk_mul_f32 v[90:91], v[90:91], v[4:5]
    v_cvt_pk_bf16_f32 v201, v90, v91
    v_pk_add_f32 v[92:93], v[92:93], v[2:3]
    v_cvt_pk_bf16_f32 v202, v92, v93
    v_lshlrev_b32 v92, 16, v202
    v_and_b32 v93, s58, v202
    v_pk_mul_f32 v[92:93], v[92:93], v[4:5]
    v_cvt_pk_bf16_f32 v202, v92, v93
    v_pk_add_f32 v[94:95], v[94:95], v[2:3]
    v_cvt_pk_bf16_f32 v203, v94, v95
    v_lshlrev_b32 v94, 16, v203
    v_and_b32 v95, s58, v203
    v_pk_mul_f32 v[94:95], v[94:95], v[4:5]
    v_cvt_pk_bf16_f32 v203, v94, v95
    buffer_store_dwordx4 v[200:203], v1, s[32:35], s57 offen offset:2048 sc1
    v_pk_add_f32 v[96:97], v[96:97], v[2:3]
    v_cvt_pk_bf16_f32 v204, v96, v97
    v_lshlrev_b32 v96, 16, v204
    v_and_b32 v97, s58, v204
    v_pk_mul_f32 v[96:97], v[96:97], v[4:5]
    v_cvt_pk_bf16_f32 v204, v96, v97
    v_pk_add_f32 v[98:99], v[98:99], v[2:3]
    v_cvt_pk_bf16_f32 v205, v98, v99
    v_lshlrev_b32 v98, 16, v205
    v_and_b32 v99, s58, v205
    v_pk_mul_f32 v[98:99], v[98:99], v[4:5]
    v_cvt_pk_bf16_f32 v205, v98, v99
    v_pk_add_f32 v[100:101], v[100:101], v[2:3]
    v_cvt_pk_bf16_f32 v206, v100, v101
    v_lshlrev_b32 v100, 16, v206
    v_and_b32 v101, s58, v206
    v_pk_mul_f32 v[100:101], v[100:101], v[4:5]
    v_cvt_pk_bf16_f32 v206, v100, v101
    v_pk_add_f32 v[102:103], v[102:103], v[2:3]
    v_cvt_pk_bf16_f32 v207, v102, v103
    v_lshlrev_b32 v102, 16, v207
    v_and_b32 v103, s58, v207
    v_pk_mul_f32 v[102:103], v[102:103], v[4:5]
    v_cvt_pk_bf16_f32 v207, v102, v103
    buffer_store_dwordx4 v[204:207], v1, s[32:35], s57 offen offset:3072 sc1
    s_add_u32 s57, s57, 4096
    v_pk_add_f32 v[104:105], v[104:105], v[2:3]
    v_cvt_pk_bf16_f32 v208, v104, v105
    v_lshlrev_b32 v104, 16, v208
    v_and_b32 v105, s58, v208
    v_pk_mul_f32 v[104:105], v[104:105], v[4:5]
    v_cvt_pk_bf16_f32 v208, v104, v105
    v_pk_add_f32 v[106:107], v[106:107], v[2:3]
    v_cvt_pk_bf16_f32 v209, v106, v107
    v_lshlrev_b32 v106, 16, v209
    v_and_b32 v107, s58, v209
    v_pk_mul_f32 v[106:107], v[106:107], v[4:5]
    v_cvt_pk_bf16_f32 v209, v106, v107
    v_pk_add_f32 v[108:109], v[108:109], v[2:3]
    v_cvt_pk_bf16_f32 v210, v108, v109
    v_lshlrev_b32 v108, 16, v210
    v_and_b32 v109, s58, v210
    v_pk_mul_f32 v[108:109], v[108:109], v[4:5]
    v_cvt_pk_bf16_f32 v210, v108, v109
    v_pk_add_f32 v[110:111], v[110:111], v[2:3]
    v_cvt_pk_bf16_f32 v211, v110, v111
    v_lshlrev_b32 v110, 16, v211
    v_and_b32 v111, s58, v211
    v_pk_mul_f32 v[110:111], v[110:111], v[4:5]
    v_cvt_pk_bf16_f32 v211, v110, v111
    buffer_store_dwordx4 v[208:211], v1, s[32:35], s57 offen offset:0 sc1
    v_pk_add_f32 v[112:113], v[112:113], v[2:3]
    v_cvt_pk_bf16_f32 v212, v112, v113
    v_lshlrev_b32 v112, 16, v212
    v_and_b32 v113, s58, v212
    v_pk_mul_f32 v[112:113], v[112:113], v[4:5]
    v_cvt_pk_bf16_f32 v212, v112, v113
    v_pk_add_f32 v[114:115], v[114:115], v[2:3]
    v_cvt_pk_bf16_f32 v213, v114, v115
    v_lshlrev_b32 v114, 16, v213
    v_and_b32 v115, s58, v213
    v_pk_mul_f32 v[114:115], v[114:115], v[4:5]
    v_cvt_pk_bf16_f32 v213, v114, v115
    v_pk_add_f32 v[116:117], v[116:117], v[2:3]
    v_cvt_pk_bf16_f32 v214, v116, v117
    v_lshlrev_b32 v116, 16, v214
    v_and_b32 v117, s58, v214
    v_pk_mul_f32 v[116:117], v[116:117], v[4:5]
    v_cvt_pk_bf16_f32 v214, v116, v117
    v_pk_add_f32 v[118:119], v[118:119], v[2:3]
    v_cvt_pk_bf16_f32 v215, v118, v119
    v_lshlrev_b32 v118, 16, v215
    v_and_b32 v119, s58, v215
    v_pk_mul_f32 v[118:119], v[118:119], v[4:5]
    v_cvt_pk_bf16_f32 v215, v118, v119
    buffer_store_dwordx4 v[212:215], v1, s[32:35], s57 offen offset:1024 sc1
    v_pk_add_f32 v[120:121], v[120:121], v[2:3]
    v_cvt_pk_bf16_f32 v216, v120, v121
    v_lshlrev_b32 v120, 16, v216
    v_and_b32 v121, s58, v216
    v_pk_mul_f32 v[120:121], v[120:121], v[4:5]
    v_cvt_pk_bf16_f32 v216, v120, v121
    v_pk_add_f32 v[122:123], v[122:123], v[2:3]
    v_cvt_pk_bf16_f32 v217, v122, v123
    v_lshlrev_b32 v122, 16, v217
    v_and_b32 v123, s58, v217
    v_pk_mul_f32 v[122:123], v[122:123], v[4:5]
    v_cvt_pk_bf16_f32 v217, v122, v123
    v_pk_add_f32 v[124:125], v[124:125], v[2:3]
    v_cvt_pk_bf16_f32 v218, v124, v125
    v_lshlrev_b32 v124, 16, v218
    v_and_b32 v125, s58, v218
    v_pk_mul_f32 v[124:125], v[124:125], v[4:5]
    v_cvt_pk_bf16_f32 v218, v124, v125
    v_pk_add_f32 v[126:127], v[126:127], v[2:3]
    v_cvt_pk_bf16_f32 v219, v126, v127
    v_lshlrev_b32 v126, 16, v219
    v_and_b32 v127, s58, v219
    v_pk_mul_f32 v[126:127], v[126:127], v[4:5]
    v_cvt_pk_bf16_f32 v219, v126, v127
    buffer_store_dwordx4 v[216:219], v1, s[32:35], s57 offen offset:2048 sc1
    v_pk_add_f32 v[128:129], v[128:129], v[2:3]
    v_cvt_pk_bf16_f32 v220, v128, v129
    v_lshlrev_b32 v128, 16, v220
    v_and_b32 v129, s58, v220
    v_pk_mul_f32 v[128:129], v[128:129], v[4:5]
    v_cvt_pk_bf16_f32 v220, v128, v129
    v_pk_add_f32 v[130:131], v[130:131], v[2:3]
    v_cvt_pk_bf16_f32 v221, v130, v131
    v_lshlrev_b32 v130, 16, v221
    v_and_b32 v131, s58, v221
    v_pk_mul_f32 v[130:131], v[130:131], v[4:5]
    v_cvt_pk_bf16_f32 v221, v130, v131
    v_pk_add_f32 v[132:133], v[132:133], v[2:3]
    v_cvt_pk_bf16_f32 v222, v132, v133
    v_lshlrev_b32 v132, 16, v222
    v_and_b32 v133, s58, v222
    v_pk_mul_f32 v[132:133], v[132:133], v[4:5]
    v_cvt_pk_bf16_f32 v222, v132, v133
    v_pk_add_f32 v[134:135], v[134:135], v[2:3]
    v_cvt_pk_bf16_f32 v223, v134, v135
    v_lshlrev_b32 v134, 16, v223
    v_and_b32 v135, s58, v223
    v_pk_mul_f32 v[134:135], v[134:135], v[4:5]
    v_cvt_pk_bf16_f32 v223, v134, v135
    buffer_store_dwordx4 v[220:223], v1, s[32:35], s57 offen offset:3072 sc1
    s_add_u32 s57, s57, 4096
    v_pk_add_f32 v[136:137], v[136:137], v[2:3]
    v_cvt_pk_bf16_f32 v224, v136, v137
    v_lshlrev_b32 v136, 16, v224
    v_and_b32 v137, s58, v224
    v_pk_mul_f32 v[136:137], v[136:137], v[4:5]
    v_cvt_pk_bf16_f32 v224, v136, v137
    v_pk_add_f32 v[138:139], v[138:139], v[2:3]
    v_cvt_pk_bf16_f32 v225, v138, v139
    v_lshlrev_b32 v138, 16, v225
    v_and_b32 v139, s58, v225
    v_pk_mul_f32 v[138:139], v[138:139], v[4:5]
    v_cvt_pk_bf16_f32 v225, v138, v139
    v_pk_add_f32 v[140:141], v[140:141], v[2:3]
    v_cvt_pk_bf16_f32 v226, v140, v141
    v_lshlrev_b32 v140, 16, v226
    v_and_b32 v141, s58, v226
    v_pk_mul_f32 v[140:141], v[140:141], v[4:5]
    v_cvt_pk_bf16_f32 v226, v140, v141
    v_pk_add_f32 v[142:143], v[142:143], v[2:3]
    v_cvt_pk_bf16_f32 v227, v142, v143
    v_lshlrev_b32 v142, 16, v227
    v_and_b32 v143, s58, v227
    v_pk_mul_f32 v[142:143], v[142:143], v[4:5]
    v_cvt_pk_bf16_f32 v227, v142, v143
    buffer_store_dwordx4 v[224:227], v1, s[32:35], s57 offen offset:0 sc1
    v_pk_add_f32 v[144:145], v[144:145], v[2:3]
    v_cvt_pk_bf16_f32 v228, v144, v145
    v_lshlrev_b32 v144, 16, v228
    v_and_b32 v145, s58, v228
    v_pk_mul_f32 v[144:145], v[144:145], v[4:5]
    v_cvt_pk_bf16_f32 v228, v144, v145
    v_pk_add_f32 v[146:147], v[146:147], v[2:3]
    v_cvt_pk_bf16_f32 v229, v146, v147
    v_lshlrev_b32 v146, 16, v229
    v_and_b32 v147, s58, v229
    v_pk_mul_f32 v[146:147], v[146:147], v[4:5]
    v_cvt_pk_bf16_f32 v229, v146, v147
    v_pk_add_f32 v[148:149], v[148:149], v[2:3]
    v_cvt_pk_bf16_f32 v230, v148, v149
    v_lshlrev_b32 v148, 16, v230
    v_and_b32 v149, s58, v230
    v_pk_mul_f32 v[148:149], v[148:149], v[4:5]
    v_cvt_pk_bf16_f32 v230, v148, v149
    v_pk_add_f32 v[150:151], v[150:151], v[2:3]
    v_cvt_pk_bf16_f32 v231, v150, v151
    v_lshlrev_b32 v150, 16, v231
    v_and_b32 v151, s58, v231
    v_pk_mul_f32 v[150:151], v[150:151], v[4:5]
    v_cvt_pk_bf16_f32 v231, v150, v151
    buffer_store_dwordx4 v[228:231], v1, s[32:35], s57 offen offset:1024 sc1
    v_mov_b32 v1, 136
winit_13:
    global_load_dword v2, v1, s[28:29] sc1
    s_sub_i32 s54, s54, 1
    s_cmp_lt_i32 s54, 0
    s_waitcnt vmcnt(0)
    s_cbranch_scc1 winitd_14
    v_cmp_gt_u32 vcc, 4, v2
    s_cbranch_vccz winitd_14
    s_sleep 8
    s_branch winit_13
winitd_14:
    s_lshl_b32 s57, s56, 7
    v_mov_b32 v1, 0
    v_mov_b32 v2, 1
    s_mov_b64 exec, 1
    buffer_store_dword v2, v1, s[32:35], s57 offen sc1
    s_mov_b64 exec, -1
L_noln1:
    s_mul_i32 s60, s53, 43691
    s_lshr_b32 s60, s60, 17
    s_mul_i32 s57, s60, 3
    s_sub_u32 s61, s53, s57
    s_cmp_lg_u32 s52, 0
    s_cbranch_scc1 held_15
    s_sleep 60
    v_mov_b32 v10, 136
winit_16:
    global_load_dword v11, v10, s[28:29] sc1
    s_sub_i32 s54, s54, 1
    s_cmp_lt_i32 s54, 0
    s_waitcnt vmcnt(0)
    s_cbranch_scc1 winitd_17
    v_cmp_gt_u32 vcc, 4, v11
    s_cbranch_vccz winitd_17
    s_sleep 8
    s_branch winit_16
winitd_17:
    s_add_u32 s57, s53, 0
    s_lshl_b32 s57, s57, 7
    s_add_u32 s57, s57, 16384
hold_18:
    buffer_load_dword v11, off, s[32:35], s57 sc1
    s_sub_i32 s54, s54, 1
    s_cmp_lt_i32 s54, 0
    s_waitcnt vmcnt(0)
    s_cbranch_scc1 holdd_19
    v_cmp_gt_u32 vcc, 2, v11
    s_cbranch_vccz holdd_19
    s_sleep 16
    s_branch hold_18
holdd_19:
held_15:
    s_waitcnt vmcnt(0)
    s_barrier
L_ffn2:
    s_mov_b32 s36, s20
    s_and_b32 s37, s21, 0xffff
    s_mov_b32 s38, 5308416
    s_mov_b32 s39, 0x20000
    s_mov_b32 s40, s22
    s_and_b32 s41, s23, 0xffff
    s_mov_b32 s42, 5308416
    s_mov_b32 s43, 0x20000
    s_mov_b32 s44, s24
    s_and_b32 s45, s25, 0xffff
    s_mov_b32 s46, 5308416
    s_mov_b32 s47, 0x20000
    s_mov_b32 s48, s26
    s_and_b32 s49, s27, 0xffff
    s_mov_b32 s50, 2359296
    s_mov_b32 s51, 0x20000
    v_lshlrev_b32 v1, 4, v0
    s_lshl_b32 s62, s60, 8
    s_mul_i32 s65, s52, 9216
    s_mul_i32 s63, s60, 147456
    s_add_u32 s63, s63, s65
    s_lshl_b32 s56, s52, 10
    s_and_b32 s57, s52, 1
    s_lshl_b32 s57, s57, 2
    s_lshl_b32 s58, s52, 2
    v_lshrrev_b32 v10, 4, v0
    v_or_b32 v11, s57, v10
    v_lshlrev_b32 v11, 1, v11
    v_and_b32 v12, 15, v0
    v_xor_b32 v11, v11, v12
    v_lshlrev_b32 v11, 4, v11
    v_add_u32 v10, s58, v10
    s_mov_b32 s57, 9216
    v_mul_lo_u32 v10, v10, s57
    v_add_u32 v9, v10, v11
    v_bfe_u32 v10, v0, 2, 3
    s_lshl_b32 s57, s52, 1
    v_xor_b32 v10, s57, v10
    v_lshlrev_b32 v10, 5, v10
    v_and_b32 v11, 3, v0
    v_lshl_add_u32 v10, v11, 3, v10
    v_bfe_u32 v11, v0, 2, 2
    v_lshl_add_u32 v10, v11, 8, v10
    v_lshrrev_b32 v11, 4, v0
    v_lshl_add_u32 v5, v11, 10, v10
    v_xor_b32 v6, 32, v5
    v_lshrrev_b32 v10, 2, v0
    v_mul_u32_u24 v10, 1152, v10
    v_and_b32 v11, 3, v0
    v_lshl_add_u32 v10, v11, 3, v10
    s_mul_i32 s57, s52, 288
    v_add_u32 v3, s57, v10
    s_add_u32 m0, s56, 0
    s_add_u32 s59, s62, 0
    buffer_load_dwordx4 v9, s[36:39], s59 offen lds
    s_add_u32 m0, s56, 4096
    s_add_u32 s59, s62, 1179648
    buffer_load_dwordx4 v9, s[36:39], s59 offen lds
    s_add_u32 m0, s56, 8192
    s_add_u32 s59, s62, 147456
    buffer_load_dwordx4 v9, s[36:39], s59 offen lds
    s_add_u32 m0, s56, 12288
    s_add_u32 s59, s62, 1327104
    buffer_load_dwordx4 v9, s[36:39], s59 offen lds
    s_add_u32 m0, s56, 16384
    s_add_u32 s59, s62, 0
    buffer_load_dwordx4 v9, s[40:43], s59 offen lds
    s_add_u32 m0, s56, 20480
    s_add_u32 s59, s62, 1179648
    buffer_load_dwordx4 v9, s[40:43], s59 offen lds
    s_add_u32 m0, s56, 24576
    s_add_u32 s59, s62, 147456
    buffer_load_dwordx4 v9, s[40:43], s59 offen lds
    s_add_u32 m0, s56, 28672
    s_add_u32 s59, s62, 1327104
    buffer_load_dwordx4 v9, s[40:43], s59 offen lds
    s_add_u32 m0, s56, 32768
    s_add_u32 s59, s62, 294912
    buffer_load_dwordx4 v9, s[36:39], s59 offen lds
    s_add_u32 m0, s56, 36864
    s_add_u32 s59, s62, 1474560
    buffer_load_dwordx4 v9, s[36:39], s59 offen lds
    s_add_u32 m0, s56, 40960
    s_add_u32 s59, s62, 442368
    buffer_load_dwordx4 v9, s[36:39], s59 offen lds
    s_add_u32 m0, s56, 45056
    s_add_u32 s59, s62, 1622016
    buffer_load_dwordx4 v9, s[36:39], s59 offen lds
    s_add_u32 m0, s56, 49152
    s_add_u32 s59, s62, 294912
    buffer_load_dwordx4 v9, s[40:43], s59 offen lds
    s_add_u32 m0, s56, 53248
    s_add_u32 s59, s62, 1474560
    buffer_load_dwordx4 v9, s[40:43], s59 offen lds
    s_add_u32 m0, s56, 57344
    s_add_u32 s59, s62, 442368
    buffer_load_dwordx4 v9, s[40:43], s59 offen lds
    s_add_u32 m0, s56, 61440
    s_add_u32 s59, s62, 1622016
    buffer_load_dwordx4 v9, s[40:43], s59 offen lds
    s_add_u32 m0, s56, 65536
    s_add_u32 s59, s62, 589824
    buffer_load_dwordx4 v9, s[36:39], s59 offen lds
    s_add_u32 m0, s56, 69632
    s_add_u32 s59, s62, 1769472
    buffer_load_dwordx4 v9, s[36:39], s59 offen lds
    s_add_u32 m0, s56, 73728
    s_add_u32 s59, s62, 737280
    buffer_load_dwordx4 v9, s[36:39], s59 offen lds
    s_add_u32 m0, s56, 77824
    s_add_u32 s59, s62, 1916928
    buffer_load_dwordx4 v9, s[36:39], s59 offen lds
    s_add_u32 m0, s56, 81920
    s_add_u32 s59, s62, 589824
    buffer_load_dwordx4 v9, s[40:43], s59 offen lds
    s_add_u32 m0, s56, 86016
    s_add_u32 s59, s62, 1769472
    buffer_load_dwordx4 v9, s[40:43], s59 offen lds
    s_add_u32 m0, s56, 90112
    s_add_u32 s59, s62, 737280
    buffer_load_dwordx4 v9, s[40:43], s59 offen lds
    s_add_u32 m0, s56, 94208
    s_add_u32 s59, s62, 1916928
    buffer_load_dwordx4 v9, s[40:43], s59 offen lds
    s_add_u32 m0, s56, 98304
    s_add_u32 s59, s62, 884736
    buffer_load_dwordx4 v9, s[36:39], s59 offen lds
    s_add_u32 m0, s56, 102400
    s_add_u32 s59, s62, 2064384
    buffer_load_dwordx4 v9, s[36:39], s59 offen lds
    s_add_u32 m0, s56, 106496
    s_add_u32 s59, s62, 1032192
    buffer_load_dwordx4 v9, s[36:39], s59 offen lds
    s_add_u32 m0, s56, 110592
    s_add_u32 s59, s62, 2211840
    buffer_load_dwordx4 v9, s[36:39], s59 offen lds
    s_add_u32 m0, s56, 114688
    s_add_u32 s59, s62, 884736
    buffer_load_dwordx4 v9, s[40:43], s59 offen lds
    s_add_u32 m0, s56, 118784
    s_add_u32 s59, s62, 2064384
    buffer_load_dwordx4 v9, s[40:43], s59 offen lds
    s_add_u32 m0, s56, 122880
    s_add_u32 s59, s62, 1032192
    buffer_load_dwordx4 v9, s[40:43], s59 offen lds
    s_add_u32 m0, s56, 126976
    s_add_u32 s59, s62, 2211840
    buffer_load_dwordx4 v9, s[40:43], s59 offen lds
    s_add_u32 m0, s56, 131072
    s_add_u32 s59, s62, 2359296
    buffer_load_dwordx4 v9, s[36:39], s59 offen lds
    s_add_u32 m0, s56, 135168
    s_add_u32 s59, s62, 3538944
    buffer_load_dwordx4 v9, s[36:39], s59 offen lds
    s_add_u32 m0, s56, 139264
    s_add_u32 s59, s62, 2506752
    buffer_load_dwordx4 v9, s[36:39], s59 offen lds
    s_add_u32 m0, s56, 143360
    s_add_u32 s59, s62, 3686400
    buffer_load_dwordx4 v9, s[36:39], s59 offen lds
    s_waitcnt vmcnt(32) lgkmcnt(0)
    s_barrier
    v_add_u32 v7, 0, v5
    v_add_u32 v8, 0, v6
    ds_read_b64_tr_b16 a[0:1], v7 offset:0
    ds_read_b64_tr_b16 a[2:3], v7 offset:4096
    ds_read_b64_tr_b16 a[72:73], v8 offset:0
    ds_read_b64_tr_b16 a[74:75], v8 offset:4096
    ds_read_b64_tr_b16 a[4:5], v7 offset:8192
    ds_read_b64_tr_b16 a[6:7], v7 offset:12288
    ds_read_b64_tr_b16 a[76:77], v8 offset:8192
    ds_read_b64_tr_b16 a[78:79], v8 offset:12288
    s_waitcnt vmcnt(28) lgkmcnt(0)
    s_barrier
    s_add_u32 m0, s56, 0
    s_add_u32 s59, s62, 2359296
    buffer_load_dwordx4 v9, s[40:43], s59 offen lds
    s_add_u32 m0, s56, 4096
    s_add_u32 s59, s62, 3538944
    buffer_load_dwordx4 v9, s[40:43], s59 offen lds
    s_add_u32 m0, s56, 8192
    s_add_u32 s59, s62, 2506752
    buffer_load_dwordx4 v9, s[40:43], s59 offen lds
    s_add_u32 m0, s56, 12288
    s_add_u32 s59, s62, 3686400
    buffer_load_dwordx4 v9, s[40:43], s59 offen lds
    v_add_u32 v7, 16384, v5
    v_add_u32 v8, 16384, v6
    ds_read_b64_tr_b16 a[144:145], v7 offset:0
    ds_read_b64_tr_b16 a[146:147], v7 offset:4096
    ds_read_b64_tr_b16 a[216:217], v8 offset:0
    ds_read_b64_tr_b16 a[218:219], v8 offset:4096
    ds_read_b64_tr_b16 a[148:149], v7 offset:8192
    ds_read_b64_tr_b16 a[150:151], v7 offset:12288
    ds_read_b64_tr_b16 a[220:221], v8 offset:8192
    ds_read_b64_tr_b16 a[222:223], v8 offset:12288
    s_waitcnt vmcnt(28) lgkmcnt(0)
    s_barrier
    s_add_u32 m0, s56, 16384
    s_add_u32 s59, s62, 2654208
    buffer_load_dwordx4 v9, s[36:39], s59 offen lds
    s_add_u32 m0, s56, 20480
    s_add_u32 s59, s62, 3833856
    buffer_load_dwordx4 v9, s[36:39], s59 offen lds
    s_add_u32 m0, s56, 24576
    s_add_u32 s59, s62, 2801664
    buffer_load_dwordx4 v9, s[36:39], s59 offen lds
    s_add_u32 m0, s56, 28672
    s_add_u32 s59, s62, 3981312
    buffer_load_dwordx4 v9, s[36:39], s59 offen lds
    v_add_u32 v7, 32768, v5
    v_add_u32 v8, 32768, v6
    ds_read_b64_tr_b16 a[8:9], v7 offset:0
    ds_read_b64_tr_b16 a[10:11], v7 offset:4096
    ds_read_b64_tr_b16 a[80:81], v8 offset:0
    ds_read_b64_tr_b16 a[82:83], v8 offset:4096
    ds_read_b64_tr_b16 a[12:13], v7 offset:8192
    ds_read_b64_tr_b16 a[14:15], v7 offset:12288
    ds_read_b64_tr_b16 a[84:85], v8 offset:8192
    ds_read_b64_tr_b16 a[86:87], v8 offset:12288
    s_waitcnt vmcnt(28) lgkmcnt(0)
    s_barrier
    s_add_u32 m0, s56, 32768
    s_add_u32 s59, s62, 2654208
    buffer_load_dwordx4 v9, s[40:43], s59 offen lds
    s_add_u32 m0, s56, 36864
    s_add_u32 s59, s62, 3833856
    buffer_load_dwordx4 v9, s[40:43], s59 offen lds
    s_add_u32 m0, s56, 40960
    s_add_u32 s59, s62, 2801664
    buffer_load_dwordx4 v9, s[40:43], s59 offen lds
    s_add_u32 m0, s56, 45056
    s_add_u32 s59, s62, 3981312
    buffer_load_dwordx4 v9, s[40:43], s59 offen lds
    v_add_u32 v7, 49152, v5
    v_add_u32 v8, 49152, v6
    ds_read_b64_tr_b16 a[152:153], v7 offset:0
    ds_read_b64_tr_b16 a[154:155], v7 offset:4096
    ds_read_b64_tr_b16 a[224:225], v8 offset:0
    ds_read_b64_tr_b16 a[226:227], v8 offset:4096
    ds_read_b64_tr_b16 a[156:157], v7 offset:8192
    ds_read_b64_tr_b16 a[158:159], v7 offset:12288
    ds_read_b64_tr_b16 a[228:229], v8 offset:8192
    ds_read_b64_tr_b16 a[230:231], v8 offset:12288
    s_waitcnt vmcnt(28) lgkmcnt(0)
    s_barrier
    s_add_u32 m0, s56, 49152
    s_add_u32 s59, s62, 2949120
    buffer_load_dwordx4 v9, s[36:39], s59 offen lds
    s_add_u32 m0, s56, 53248
    s_add_u32 s59, s62, 4128768
    buffer_load_dwordx4 v9, s[36:39], s59 offen lds
    s_add_u32 m0, s56, 57344
    s_add_u32 s59, s62, 3096576
    buffer_load_dwordx4 v9, s[36:39], s59 offen lds
    s_add_u32 m0, s56, 61440
    s_add_u32 s59, s62, 4276224
    buffer_load_dwordx4 v9, s[36:39], s59 offen lds
    v_add_u32 v7, 65536, v5
    v_add_u32 v8, 65536, v6
    ds_read_b64_tr_b16 a[16:17], v7 offset:0
    ds_read_b64_tr_b16 a[18:19], v7 offset:4096
    ds_read_b64_tr_b16 a[88:89], v8 offset:0
    ds_read_b64_tr_b16 a[90:91], v8 offset:4096
    ds_read_b64_tr_b16 a[20:21], v7 offset:8192
    ds_read_b64_tr_b16 a[22:23], v7 offset:12288
    ds_read_b64_tr_b16 a[92:93], v8 offset:8192
    ds_read_b64_tr_b16 a[94:95], v8 offset:12288
    s_waitcnt vmcnt(28) lgkmcnt(0)
    s_barrier
    s_add_u32 m0, s56, 65536
    s_add_u32 s59, s62, 2949120
    buffer_load_dwordx4 v9, s[40:43], s59 offen lds
    s_add_u32 m0, s56, 69632
    s_add_u32 s59, s62, 4128768
    buffer_load_dwordx4 v9, s[40:43], s59 offen lds
    s_add_u32 m0, s56, 73728
    s_add_u32 s59, s62, 3096576
    buffer_load_dwordx4 v9, s[40:43], s59 offen lds
    s_add_u32 m0, s56, 77824
    s_add_u32 s59, s62, 4276224
    buffer_load_dwordx4 v9, s[40:43], s59 offen lds
    v_add_u32 v7, 81920, v5
    v_add_u32 v8, 81920, v6
    ds_read_b64_tr_b16 a[160:161], v7 offset:0
    ds_read_b64_tr_b16 a[162:163], v7 offset:4096
    ds_read_b64_tr_b16 a[232:233], v8 offset:0
    ds_read_b64_tr_b16 a[234:235], v8 offset:4096
    ds_read_b64_tr_b16 a[164:165], v7 offset:8192
    ds_read_b64_tr_b16 a[166:167], v7 offset:12288
    ds_read_b64_tr_b16 a[236:237], v8 offset:8192
    ds_read_b64_tr_b16 a[238:239], v8 offset:12288
    s_waitcnt vmcnt(28) lgkmcnt(0)
    s_barrier
    s_add_u32 m0, s56, 81920
    s_add_u32 s59, s62, 3244032
    buffer_load_dwordx4 v9, s[36:39], s59 offen lds
    s_add_u32 m0, s56, 86016
    s_add_u32 s59, s62, 4423680
    buffer_load_dwordx4 v9, s[36:39], s59 offen lds
    s_add_u32 m0, s56, 90112
    s_add_u32 s59, s62, 3391488
    buffer_load_dwordx4 v9, s[36:39], s59 offen lds
    s_add_u32 m0, s56, 94208
    s_add_u32 s59, s62, 4571136
    buffer_load_dwordx4 v9, s[36:39], s59 offen lds
    v_add_u32 v7, 98304, v5
    v_add_u32 v8, 98304, v6
    ds_read_b64_tr_b16 a[24:25], v7 offset:0
    ds_read_b64_tr_b16 a[26:27], v7 offset:4096
    ds_read_b64_tr_b16 a[96:97], v8 offset:0
    ds_read_b64_tr_b16 a[98:99], v8 offset:4096
    ds_read_b64_tr_b16 a[28:29], v7 offset:8192
    ds_read_b64_tr_b16 a[30:31], v7 offset:12288
    ds_read_b64_tr_b16 a[100:101], v8 offset:8192
    ds_read_b64_tr_b16 a[102:103], v8 offset:12288
    s_waitcnt vmcnt(28) lgkmcnt(0)
    s_barrier
    s_add_u32 m0, s56, 98304
    s_add_u32 s59, s62, 3244032
    buffer_load_dwordx4 v9, s[40:43], s59 offen lds
    s_add_u32 m0, s56, 102400
    s_add_u32 s59, s62, 4423680
    buffer_load_dwordx4 v9, s[40:43], s59 offen lds
    s_add_u32 m0, s56, 106496
    s_add_u32 s59, s62, 3391488
    buffer_load_dwordx4 v9, s[40:43], s59 offen lds
    s_add_u32 m0, s56, 110592
    s_add_u32 s59, s62, 4571136
    buffer_load_dwordx4 v9, s[40:43], s59 offen lds
    v_add_u32 v7, 114688, v5
    v_add_u32 v8, 114688, v6
    ds_read_b64_tr_b16 a[168:169], v7 offset:0
    ds_read_b64_tr_b16 a[170:171], v7 offset:4096
    ds_read_b64_tr_b16 a[240:241], v8 offset:0
    ds_read_b64_tr_b16 a[242:243], v8 offset:4096
    ds_read_b64_tr_b16 a[172:173], v7 offset:8192
    ds_read_b64_tr_b16 a[174:175], v7 offset:12288
    ds_read_b64_tr_b16 a[244:245], v8 offset:8192
    ds_read_b64_tr_b16 a[246:247], v8 offset:12288
    s_waitcnt vmcnt(28) lgkmcnt(0)
    s_barrier
    s_add_u32 m0, s56, 114688
    s_add_u32 s59, s62, 4718592
    buffer_load_dwordx4 v9, s[36:39], s59 offen lds
    s_add_u32 m0, s56, 118784
    s_add_u32 s59, s62, 4866048
    buffer_load_dwordx4 v9, s[36:39], s59 offen lds
    s_add_u32 m0, s56, 122880
    s_add_u32 s59, s62, 5013504
    buffer_load_dwordx4 v9, s[36:39], s59 offen lds
    s_add_u32 m0, s56, 126976
    s_add_u32 s59, s62, 5160960
    buffer_load_dwordx4 v9, s[36:39], s59 offen lds
    v_add_u32 v7, 131072, v5
    v_add_u32 v8, 131072, v6
    ds_read_b64_tr_b16 a[32:33], v7 offset:0
    ds_read_b64_tr_b16 a[34:35], v7 offset:4096
    ds_read_b64_tr_b16 a[104:105], v8 offset:0
    ds_read_b64_tr_b16 a[106:107], v8 offset:4096
    ds_read_b64_tr_b16 a[36:37], v7 offset:8192
    ds_read_b64_tr_b16 a[38:39], v7 offset:12288
    ds_read_b64_tr_b16 a[108:109], v8 offset:8192
    ds_read_b64_tr_b16 a[110:111], v8 offset:12288
    s_waitcnt vmcnt(28) lgkmcnt(0)
    s_barrier
    s_add_u32 m0, s56, 131072
    s_add_u32 s59, s62, 4718592
    buffer_load_dwordx4 v9, s[40:43], s59 offen lds
    s_add_u32 m0, s56, 135168
    s_add_u32 s59, s62, 4866048
    buffer_load_dwordx4 v9, s[40:43], s59 offen lds
    s_add_u32 m0, s56, 139264
    s_add_u32 s59, s62, 5013504
    buffer_load_dwordx4 v9, s[40:43], s59 offen lds
    s_add_u32 m0, s56, 143360
    s_add_u32 s59, s62, 5160960
    buffer_load_dwordx4 v9, s[40:43], s59 offen lds
    v_add_u32 v7, 0, v5
    v_add_u32 v8, 0, v6
    ds_read_b64_tr_b16 a[176:177], v7 offset:0
    ds_read_b64_tr_b16 a[178:179], v7 offset:4096
    ds_read_b64_tr_b16 a[248:249], v8 offset:0
    ds_read_b64_tr_b16 a[250:251], v8 offset:4096
    ds_read_b64_tr_b16 a[180:181], v7 offset:8192
    ds_read_b64_tr_b16 a[182:183], v7 offset:12288
    ds_read_b64_tr_b16 a[252:253], v8 offset:8192
    ds_read_b64_tr_b16 a[254:255], v8 offset:12288
    s_waitcnt vmcnt(28) lgkmcnt(0)
    s_barrier
    v_add_u32 v7, 16384, v5
    v_add_u32 v8, 16384, v6
    ds_read_b64_tr_b16 a[40:41], v7 offset:0
    ds_read_b64_tr_b16 a[42:43], v7 offset:4096
    ds_read_b64_tr_b16 a[112:113], v8 offset:0
    ds_read_b64_tr_b16 a[114:115], v8 offset:4096
    ds_read_b64_tr_b16 a[44:45], v7 offset:8192
    ds_read_b64_tr_b16 a[46:47], v7 offset:12288
    ds_read_b64_tr_b16 a[116:117], v8 offset:8192
    ds_read_b64_tr_b16 a[118:119], v8 offset:12288
    s_waitcnt vmcnt(24) lgkmcnt(0)
    s_barrier
    v_add_u32 v7, 32768, v5
    v_add_u32 v8, 32768, v6
    ds_read_b64_tr_b16 a[184:185], v7 offset:0
    ds_read_b64_tr_b16 a[186:187], v7 offset:4096
    ds_read_b64_tr_b16 v[80:81], v8 offset:0
    ds_read_b64_tr_b16 v[82:83], v8 offset:4096
    ds_read_b64_tr_b16 a[188:189], v7 offset:8192
    ds_read_b64_tr_b16 a[190:191], v7 offset:12288
    ds_read_b64_tr_b16 v[84:85], v8 offset:8192
    ds_read_b64_tr_b16 v[86:87], v8 offset:12288
    s_waitcnt vmcnt(20) lgkmcnt(0)
    s_barrier
    s_add_u32 m0, s65, 0
    s_add_u32 s59, s63, 0
    buffer_load_dwordx4 v1, s[44:47], s59 offen offset:0 lds
    buffer_load_dwordx4 v1, s[44:47], s59 offen offset:1024 lds
    buffer_load_dwordx4 v1, s[44:47], s59 offen offset:2048 lds
    buffer_load_dwordx4 v1, s[44:47], s59 offen offset:3072 lds
    s_add_u32 m0, s65, 4096
    s_add_u32 s59, s63, 4096
    buffer_load_dwordx4 v1, s[44:47], s59 offen offset:0 lds
    buffer_load_dwordx4 v1, s[44:47], s59 offen offset:1024 lds
    buffer_load_dwordx4 v1, s[44:47], s59 offen offset:2048 lds
    buffer_load_dwordx4 v1, s[44:47], s59 offen offset:3072 lds
    s_add_u32 m0, s65, 8192
    s_add_u32 s59, s63, 8192
    buffer_load_dwordx4 v1, s[44:47], s59 offen offset:0 lds
    v_add_u32 v7, 49152, v5
    v_add_u32 v8, 49152, v6
    ds_read_b64_tr_b16 a[48:49], v7 offset:0
    ds_read_b64_tr_b16 a[50:51], v7 offset:4096
    ds_read_b64_tr_b16 a[120:121], v8 offset:0
    ds_read_b64_tr_b16 a[122:123], v8 offset:4096
    ds_read_b64_tr_b16 a[52:53], v7 offset:8192
    ds_read_b64_tr_b16 a[54:55], v7 offset:12288
    ds_read_b64_tr_b16 a[124:125], v8 offset:8192
    ds_read_b64_tr_b16 a[126:127], v8 offset:12288
    s_waitcnt vmcnt(25) lgkmcnt(0)
    s_barrier
    v_add_u32 v7, 65536, v5
    v_add_u32 v8, 65536, v6
    ds_read_b64_tr_b16 a[192:193], v7 offset:0
    ds_read_b64_tr_b16 a[194:195], v7 offset:4096
    ds_read_b64_tr_b16 v[88:89], v8 offset:0
    ds_read_b64_tr_b16 v[90:91], v8 offset:4096
    ds_read_b64_tr_b16 a[196:197], v7 offset:8192
    ds_read_b64_tr_b16 a[198:199], v7 offset:12288
    ds_read_b64_tr_b16 v[92:93], v8 offset:8192
    ds_read_b64_tr_b16 v[94:95], v8 offset:12288
    s_waitcnt vmcnt(21) lgkmcnt(0)
    s_barrier
    s_add_u32 m0, s65, 36864
    s_add_u32 s59, s63, 36864
    buffer_load_dwordx4 v1, s[44:47], s59 offen offset:0 lds
    buffer_load_dwordx4 v1, s[44:47], s59 offen offset:1024 lds
    buffer_load_dwordx4 v1, s[44:47], s59 offen offset:2048 lds
    buffer_load_dwordx4 v1, s[44:47], s59 offen offset:3072 lds
    s_add_u32 m0, s65, 40960
    s_add_u32 s59, s63, 40960
    buffer_load_dwordx4 v1, s[44:47], s59 offen offset:0 lds
    buffer_load_dwordx4 v1, s[44:47], s59 offen offset:1024 lds
    buffer_load_dwordx4 v1, s[44:47], s59 offen offset:2048 lds
    buffer_load_dwordx4 v1, s[44:47], s59 offen offset:3072 lds
    s_add_u32 m0, s65, 45056
    s_add_u32 s59, s63, 45056
    buffer_load_dwordx4 v1, s[44:47], s59 offen offset:0 lds
    v_add_u32 v7, 81920, v5
    v_add_u32 v8, 81920, v6
    ds_read_b64_tr_b16 a[56:57], v7 offset:0
    ds_read_b64_tr_b16 a[58:59], v7 offset:4096
    ds_read_b64_tr_b16 a[128:129], v8 offset:0
    ds_read_b64_tr_b16 a[130:131], v8 offset:4096
    ds_read_b64_tr_b16 a[60:61], v7 offset:8192
    ds_read_b64_tr_b16 a[62:63], v7 offset:12288
    ds_read_b64_tr_b16 a[132:133], v8 offset:8192
    ds_read_b64_tr_b16 a[134:135], v8 offset:12288
    s_waitcnt vmcnt(26) lgkmcnt(0)
    s_barrier
    v_add_u32 v7, 98304, v5
    v_add_u32 v8, 98304, v6
    ds_read_b64_tr_b16 a[200:201], v7 offset:0
    ds_read_b64_tr_b16 a[202:203], v7 offset:4096
    ds_read_b64_tr_b16 v[96:97], v8 offset:0
    ds_read_b64_tr_b16 v[98:99], v8 offset:4096
    ds_read_b64_tr_b16 a[204:205], v7 offset:8192
    ds_read_b64_tr_b16 a[206:207], v7 offset:12288
    ds_read_b64_tr_b16 v[100:101], v8 offset:8192
    ds_read_b64_tr_b16 v[102:103], v8 offset:12288
    s_waitcnt vmcnt(22) lgkmcnt(0)
    s_barrier
    s_add_u32 m0, s65, 73728
    s_add_u32 s59, s63, 73728
    buffer_load_dwordx4 v1, s[44:47], s59 offen offset:0 lds
    buffer_load_dwordx4 v1, s[44:47], s59 offen offset:1024 lds
    buffer_load_dwordx4 v1, s[44:47], s59 offen offset:2048 lds
    buffer_load_dwordx4 v1, s[44:47], s59 offen offset:3072 lds
    s_add_u32 m0, s65, 77824
    s_add_u32 s59, s63, 77824
    buffer_load_dwordx4 v1, s[44:47], s59 offen offset:0 lds
    buffer_load_dwordx4 v1, s[44:47], s59 offen offset:1024 lds
    buffer_load_dwordx4 v1, s[44:47], s59 offen offset:2048 lds
    buffer_load_dwordx4 v1, s[44:47], s59 offen offset:3072 lds
    s_add_u32 m0, s65, 81920
    s_add_u32 s59, s63, 81920
    buffer_load_dwordx4 v1, s[44:47], s59 offen offset:0 lds
    v_add_u32 v7, 114688, v5
    v_add_u32 v8, 114688, v6
    ds_read_b64_tr_b16 a[64:65], v7 offset:0
    ds_read_b64_tr_b16 a[66:67], v7 offset:4096
    ds_read_b64_tr_b16 a[136:137], v8 offset:0
    ds_read_b64_tr_b16 a[138:139], v8 offset:4096
    ds_read_b64_tr_b16 a[68:69], v7 offset:8192
    ds_read_b64_tr_b16 a[70:71], v7 offset:12288
    ds_read_b64_tr_b16 a[140:141], v8 offset:8192
    ds_read_b64_tr_b16 a[142:143], v8 offset:12288
    s_waitcnt vmcnt(27) lgkmcnt(0)
    s_barrier
    v_add_u32 v7, 131072, v5
    v_add_u32 v8, 131072, v6
    ds_read_b64_tr_b16 a[208:209], v7 offset:0
    ds_read_b64_tr_b16 a[210:211], v7 offset:4096
    ds_read_b64_tr_b16 v[104:105], v8 offset:0
    ds_read_b64_tr_b16 v[106:107], v8 offset:4096
    ds_read_b64_tr_b16 a[212:213], v7 offset:8192
    ds_read_b64_tr_b16 a[214:215], v7 offset:12288
    ds_read_b64_tr_b16 v[108:109], v8 offset:8192
    ds_read_b64_tr_b16 v[110:111], v8 offset:12288
    s_waitcnt vmcnt(18) lgkmcnt(0)
    s_barrier
    s_add_u32 m0, s65, 110592
    s_add_u32 s59, s63, 110592
    buffer_load_dwordx4 v1, s[44:47], s59 offen offset:0 lds
    buffer_load_dwordx4 v1, s[44:47], s59 offen offset:1024 lds
    buffer_load_dwordx4 v1, s[44:47], s59 offen offset:2048 lds
    buffer_load_dwordx4 v1, s[44:47], s59 offen offset:3072 lds
    s_add_u32 m0, s65, 114688
    s_add_u32 s59, s63, 114688
    buffer_load_dwordx4 v1, s[44:47], s59 offen offset:0 lds
    buffer_load_dwordx4 v1, s[44:47], s59 offen offset:1024 lds
    buffer_load_dwordx4 v1, s[44:47], s59 offen offset:2048 lds
    buffer_load_dwordx4 v1, s[44:47], s59 offen offset:3072 lds
    s_add_u32 m0, s65, 118784
    s_add_u32 s59, s63, 118784
    buffer_load_dwordx4 v1, s[44:47], s59 offen offset:0 lds
    v_add_u32 v4, 0, v3
    ds_read_b64_tr_b16 v[112:113], v4 offset:0
    ds_read_b64_tr_b16 v[114:115], v4 offset:18432
    ds_read_b64_tr_b16 v[116:117], v4 offset:32
    ds_read_b64_tr_b16 v[118:119], v4 offset:18464
    ds_read_b64_tr_b16 v[120:121], v4 offset:64
    ds_read_b64_tr_b16 v[122:123], v4 offset:18496
    ds_read_b64_tr_b16 v[124:125], v4 offset:96
    ds_read_b64_tr_b16 v[126:127], v4 offset:18528
    ds_read_b64_tr_b16 v[128:129], v4 offset:128
    ds_read_b64_tr_b16 v[130:131], v4 offset:18560
    ds_read_b64_tr_b16 v[132:133], v4 offset:160
    ds_read_b64_tr_b16 v[134:135], v4 offset:18592
    ds_read_b64_tr_b16 v[136:137], v4 offset:192
    ds_read_b64_tr_b16 v[138:139], v4 offset:18624
    ds_read_b64_tr_b16 v[140:141], v4 offset:224
    ds_read_b64_tr_b16 v[142:143], v4 offset:18656
    ds_read_b64_tr_b16 v[144:145], v4 offset:256
    ds_read_b64_tr_b16 v[146:147], v4 offset:18688
    s_waitcnt vmcnt(18) lgkmcnt(0)
    s_barrier
    v_add_u32 v4, 36864, v3
    ds_read_b64_tr_b16 v[148:149], v4 offset:0
    ds_read_b64_tr_b16 v[150:151], v4 offset:18432
    ds_read_b64_tr_b16 v[152:153], v4 offset:32
    ds_read_b64_tr_b16 v[154:155], v4 offset:18464
    ds_read_b64_tr_b16 v[156:157], v4 offset:64
    ds_read_b64_tr_b16 v[158:159], v4 offset:18496
    ds_read_b64_tr_b16 v[160:161], v4 offset:96
    ds_read_b64_tr_b16 v[162:163], v4 offset:18528
    ds_read_b64_tr_b16 v[164:165], v4 offset:128
    ds_read_b64_tr_b16 v[166:167], v4 offset:18560
    ds_read_b64_tr_b16 v[168:169], v4 offset:160
    ds_read_b64_tr_b16 v[170:171], v4 offset:18592
    ds_read_b64_tr_b16 v[172:173], v4 offset:192
    ds_read_b64_tr_b16 v[174:175], v4 offset:18624
    ds_read_b64_tr_b16 v[176:177], v4 offset:224
    ds_read_b64_tr_b16 v[178:179], v4 offset:18656
    ds_read_b64_tr_b16 v[180:181], v4 offset:256
    ds_read_b64_tr_b16 v[182:183], v4 offset:18688
    s_waitcnt vmcnt(9) lgkmcnt(0)
    s_barrier
    v_add_u32 v4, 73728, v3
    ds_read_b64_tr_b16 v[184:185], v4 offset:0
    ds_read_b64_tr_b16 v[186:187], v4 offset:18432
    ds_read_b64_tr_b16 v[188:189], v4 offset:32
    ds_read_b64_tr_b16 v[190:191], v4 offset:18464
    ds_read_b64_tr_b16 v[192:193], v4 offset:64
    ds_read_b64_tr_b16 v[194:195], v4 offset:18496
    ds_read_b64_tr_b16 v[196:197], v4 offset:96
    ds_read_b64_tr_b16 v[198:199], v4 offset:18528
    ds_read_b64_tr_b16 v[200:201], v4 offset:128
    ds_read_b64_tr_b16 v[202:203], v4 offset:18560
    ds_read_b64_tr_b16 v[204:205], v4 offset:160
    ds_read_b64_tr_b16 v[206:207], v4 offset:18592
    ds_read_b64_tr_b16 v[208:209], v4 offset:192
    ds_read_b64_tr_b16 v[210:211], v4 offset:18624
    ds_read_b64_tr_b16 v[212:213], v4 offset:224
    ds_read_b64_tr_b16 v[214:215], v4 offset:18656
    ds_read_b64_tr_b16 v[216:217], v4 offset:256
    ds_read_b64_tr_b16 v[218:219], v4 offset:18688
    s_waitcnt vmcnt(0) lgkmcnt(0)
    s_barrier
    v_add_u32 v4, 110592, v3
    ds_read_b64_tr_b16 v[220:221], v4 offset:0
    ds_read_b64_tr_b16 v[222:223], v4 offset:18432
    ds_read_b64_tr_b16 v[224:225], v4 offset:32
    ds_read_b64_tr_b16 v[226:227], v4 offset:18464
    ds_read_b64_tr_b16 v[228:229], v4 offset:64
    ds_read_b64_tr_b16 v[230:231], v4 offset:18496
    ds_read_b64_tr_b16 v[232:233], v4 offset:96
    ds_read_b64_tr_b16 v[234:235], v4 offset:18528
    ds_read_b64_tr_b16 v[236:237], v4 offset:128
    ds_read_b64_tr_b16 v[238:239], v4 offset:18560
    ds_read_b64_tr_b16 v[240:241], v4 offset:160
    ds_read_b64_tr_b16 v[242:243], v4 offset:18592
    ds_read_b64_tr_b16 v[244:245], v4 offset:192
    ds_read_b64_tr_b16 v[246:247], v4 offset:18624
    ds_read_b64_tr_b16 v[248:249], v4 offset:224
    ds_read_b64_tr_b16 v[250:251], v4 offset:18656
    ds_read_b64_tr_b16 v[252:253], v4 offset:256
    ds_read_b64_tr_b16 v[254:255], v4 offset:18688
    s_waitcnt lgkmcnt(0)
    s_barrier
    v_and_b32 v10, 15, v0
    v_lshrrev_b32 v11, 4, v0
    v_lshrrev_b32 v9, 1, v10
    v_xor_b32 v9, v9, v11
    v_mul_u32_u24 v2, 1152, v10
    v_lshl_add_u32 v2, v9, 4, v2
    v_xor_b32 v3, 64, v2
    s_lshl_b32 s57, s52, 11
    s_add_u32 s57, s57, 73728
    v_add_u32 v4, s57, v1
    v_lshl_add_u32 v5, v10, 2, v11
    v_lshlrev_b32 v5, 4, v5
    v_mul_u32_u24 v6, 36864, v11
    v_lshl_add_u32 v6, v10, 4, v6
    v_min_u32 v7, 35, v0
    v_lshlrev_b32 v7, 9, v7
    v_lshrrev_b32 v9, 2, v10
    v_lshl_add_u32 v9, v11, 4, v9
    v_mul_u32_u24 v9, 1152, v9
    v_and_b32 v8, 3, v10
    v_lshl_add_u32 v9, v8, 3, v9
    v_mov_b32 v8, 2130706432
    v_cmp_gt_u32 vcc, 2, v11
    s_nop 1
    v_cndmask_b32 v8, v8, v9, vcc
    v_and_b32 v9, 1, v10
    v_lshlrev_b32 v9, 4, v9
    v_mov_b32 v11, 0x3f80
    v_lshlrev_b32 v9, v9, v11
    v_lshrrev_b32 v11, 1, v10
    v_cmp_eq_u32 vcc, 0, v11
    s_nop 1
    v_cndmask_b32 v12, 0, v9, vcc
    v_cmp_eq_u32 vcc, 1, v11
    s_nop 1
    v_cndmask_b32 v13, 0, v9, vcc
    v_cmp_eq_u32 vcc, 2, v11
    s_nop 1
    v_cndmask_b32 v14, 0, v9, vcc
    v_cmp_eq_u32 vcc, 3, v11
    s_nop 1
    v_cndmask_b32 v15, 0, v9, vcc
    v_lshlrev_b32 v10, 7, v10
    v_add_u32 v11, 73728, v1
    s_mov_b32 s64, s61
    s_mul_i32 s66, s61, 36864
    s_add_u32 s66, s66, s65
    s_add_u32 s66, s66, 2686976
    s_and_b32 s67, s61, 3
    s_lshl_b32 s67, s67, 11
    s_add_u32 s67, s67, 124928
    s_mul_i32 s68, s61, 1327104
    s_add_u32 s68, s68, 110100480
    s_lshl_b32 s72, s60, 10
    s_lshl_b32 s57, s52, 8
    s_add_u32 s72, s72, s57
    s_add_u32 s72, s72, s68
    s_mul_i32 s57, s60, 36864
    s_add_u32 s68, s68, s57
    s_add_u32 s68, s68, s65
    s_cmp_eq_u32 s61, 63
    s_cselect_b32 s71, 0, s61
    s_mul_i32 s71, s71, 18432
    s_add_u32 s71, s71, 69632
    s_lshl_b32 s70, s60, 9
    s_lshl_b32 s57, s52, 7
    s_add_u32 s70, s70, s57
    s_add_u32 s70, s70, s71
    s_mul_i32 s57, s60, 7282
    s_lshr_b32 s57, s57, 16
    s_lshl_b32 s57, s57, 7
    s_add_u32 s71, s71, s57
    s_mul_i32 s73, s61, 36864
    s_lshl_b32 s57, s60, 5
    s_add_u32 s73, s73, s57
    s_mul_i32 s57, s52, 4608
    s_add_u32 s73, s73, s57
    s_mov_b32 s77, 0xffff0000
    s_mov_b32 s78, 0xbdd2d3e8
    v_mov_b32 v0, 0xc0135761
    s_mov_b32 s74, 2130706432
    s_mov_b32 s75, 2130706432
    s_mov_b32 s76, 0
    s_mov_b32 s79, 2130706432
    s_mov_b32 s80, 2130706432
    s_mov_b32 s81, 0
    s_mov_b32 s82, 36864
    s_mov_b32 s83, s65
    s_lshl_b32 s84, s52, 11
    s_add_u32 s84, s84, 81920
    s_cmp_eq_u32 s61, 63
    s_cbranch_scc1 fxtra_25
    s_add_u32 s57, s68, 75644928
    v_mov_b32 v16, -1
    v_mov_b32 v17, -1
    v_mov_b32 v18, -1
    v_mov_b32 v19, -1
    buffer_store_dwordx4 v[16:19], v1, s[32:35], s57 offen offset:0 sc1
    buffer_store_dwordx4 v[16:19], v1, s[32:35], s57 offen offset:1024 sc1
    buffer_store_dwordx4 v[16:19], v1, s[32:35], s57 offen offset:2048 sc1
    buffer_store_dwordx4 v[16:19], v1, s[32:35], s57 offen offset:3072 sc1
    s_add_u32 s57, s57, 4096
    buffer_store_dwordx4 v[16:19], v1, s[32:35], s57 offen offset:0 sc1
    buffer_store_dwordx4 v[16:19], v1, s[32:35], s57 offen offset:1024 sc1
    buffer_store_dwordx4 v[16:19], v1, s[32:35], s57 offen offset:2048 sc1
    buffer_store_dwordx4 v[16:19], v1, s[32:35], s57 offen offset:3072 sc1
    s_add_u32 s57, s57, 4096
    buffer_store_dwordx4 v[16:19], v1, s[32:35], s57 offen offset:0 sc1
    s_add_u32 s57, s57, 3973120
    buffer_store_dwordx4 v[16:19], v1, s[32:35], s57 offen offset:0 sc1
    buffer_store_dwordx4 v[16:19], v1, s[32:35], s57 offen offset:1024 sc1
    buffer_store_dwordx4 v[16:19], v1, s[32:35], s57 offen offset:2048 sc1
    buffer_store_dwordx4 v[16:19], v1, s[32:35], s57 offen offset:3072 sc1
    s_add_u32 s57, s57, 4096
    buffer_store_dwordx4 v[16:19], v1, s[32:35], s57 offen offset:0 sc1
    buffer_store_dwordx4 v[16:19], v1, s[32:35], s57 offen offset:1024 sc1
    buffer_store_dwordx4 v[16:19], v1, s[32:35], s57 offen offset:2048 sc1
    buffer_store_dwordx4 v[16:19], v1, s[32:35], s57 offen offset:3072 sc1
    s_add_u32 s57, s57, 4096
    buffer_store_dwordx4 v[16:19], v1, s[32:35], s57 offen offset:0 sc1
    s_add_u32 s57, s57, 3973120
    s_cmp_eq_u32 s61, 0
    s_cselect_b32 s57, s57, 2130706432
    buffer_store_dwordx4 v[16:19], v1, s[32:35], s57 offen offset:0 sc1
    buffer_store_dwordx4 v[16:19], v1, s[32:35], s57 offen offset:1024 sc1
    buffer_store_dwordx4 v[16:19], v1, s[32:35], s57 offen offset:2048 sc1
    buffer_store_dwordx4 v[16:19], v1, s[32:35], s57 offen offset:3072 sc1
    s_add_u32 s57, s57, 4096
    buffer_store_dwordx4 v[16:19], v1, s[32:35], s57 offen offset:0 sc1
    buffer_store_dwordx4 v[16:19], v1, s[32:35], s57 offen offset:1024 sc1
    buffer_store_dwordx4 v[16:19], v1, s[32:35], s57 offen offset:2048 sc1
    buffer_store_dwordx4 v[16:19], v1, s[32:35], s57 offen offset:3072 sc1
    s_add_u32 s57, s57, 4096
    buffer_store_dwordx4 v[16:19], v1, s[32:35], s57 offen offset:0 sc1
    s_add_u32 s57, s57, 3973120
    s_branch fjoin_26
fxtra_25:
fz_27:
    buffer_load_dword v9, v7, s[32:35], s71 offen sc1
    buffer_load_dword v16, off, s[32:35], s70 sc1
    buffer_load_dword v17, v10, s[32:35], s67 offen sc1
    s_sub_i32 s54, s54, 1
    s_cmp_lt_i32 s54, 0
    s_waitcnt vmcnt(0)
    s_cbranch_scc1 fzd_28
    v_min_u32 v9, v9, v16
    v_cmp_gt_u32 s[86:87], 60, v17
    v_cmp_eq_u32 vcc, 0, v9
    s_nop 0
    s_or_b64 vcc, vcc, s[86:87]
    s_cbranch_vccz fzd_28
    s_sleep 8
    s_branch fz_27
fzd_28:
    s_mov_b32 s70, 2130706432
fjoin_26:
fwait_21:
    s_cmp_ge_u32 s64, 57
    s_cbranch_scc1 fxdata_29
fl_30:
    buffer_load_dword v9, v10, s[32:35], s67 offen sc1
    s_sub_i32 s54, s54, 1
    s_cmp_lt_i32 s54, 0
    s_waitcnt vmcnt(0)
    s_cbranch_scc1 fld_31
    v_cmp_ge_u32 vcc, s64, v9
    s_cbranch_vccz fld_31
    s_sleep 1
    s_branch fl_30
fld_31:
    s_add_u32 m0, s83, 0
    s_add_u32 s59, s66, 0
    buffer_load_dwordx4 v1, s[32:35], s59 offen offset:0 sc1 lds
    buffer_load_dwordx4 v1, s[32:35], s59 offen offset:1024 sc1 lds
    buffer_load_dwordx4 v1, s[32:35], s59 offen offset:2048 sc1 lds
    buffer_load_dwordx4 v1, s[32:35], s59 offen offset:3072 sc1 lds
    s_add_u32 m0, s83, 4096
    s_add_u32 s59, s66, 4096
    buffer_load_dwordx4 v1, s[32:35], s59 offen offset:0 sc1 lds
    buffer_load_dwordx4 v1, s[32:35], s59 offen offset:1024 sc1 lds
    buffer_load_dwordx4 v1, s[32:35], s59 offen offset:2048 sc1 lds
    buffer_load_dwordx4 v1, s[32:35], s59 offen offset:3072 sc1 lds
    s_add_u32 m0, s83, 8192
    s_add_u32 s59, s66, 8192
    buffer_load_dwordx4 v1, s[32:35], s59 offen offset:0 sc1 lds
    s_waitcnt vmcnt(0)
floop_20:
    s_barrier
    s_add_u32 s66, s66, 110592
    s_add_u32 s88, s64, 3
    s_and_b32 s67, s88, 3
    s_lshl_b32 s67, s67, 11
    s_add_u32 s67, s67, 124928
    s_add_u32 s83, s83, s82
    buffer_load_dword v66, v10, s[32:35], s67 offen sc1
    buffer_load_dword v67, v7, s[32:35], s71 offen sc1
    ds_read_b128 v[48:51], v2 offset:0
    ds_read_b128 v[52:55], v3 offset:0
    ds_read_b128 v[56:59], v2 offset:128
    ds_read_b128 v[60:63], v3 offset:128
    s_waitcnt lgkmcnt(3)
    v_mfma_f32_16x16x32_bf16 v[16:19], a[0:3], v[48:51], 0
    v_mfma_f32_16x16x32_bf16 v[20:23], a[72:75], v[48:51], 0
    v_mfma_f32_16x16x32_bf16 v[24:27], a[144:147], v[48:51], 0
    v_mfma_f32_16x16x32_bf16 v[28:31], a[216:219], v[48:51], 0
    ds_read_b128 v[48:51], v2 offset:256
    s_waitcnt lgkmcnt(3)
    v_mfma_f32_16x16x32_bf16 v[16:19], a[4:7], v[52:55], v[16:19]
    v_mfma_f32_16x16x32_bf16 v[20:23], a[76:79], v[52:55], v[20:23]
    v_mfma_f32_16x16x32_bf16 v[24:27], a[148:151], v[52:55], v[24:27]
    v_mfma_f32_16x16x32_bf16 v[28:31], a[220:223], v[52:55], v[28:31]
    ds_read_b128 v[52:55], v3 offset:256
    s_waitcnt lgkmcnt(3)
    v_mfma_f32_16x16x32_bf16 v[16:19], a[8:11], v[56:59], v[16:19]
    v_mfma_f32_16x16x32_bf16 v[20:23], a[80:83], v[56:59], v[20:23]
    v_mfma_f32_16x16x32_bf16 v[24:27], a[152:155], v[56:59], v[24:27]
    v_mfma_f32_16x16x32_bf16 v[28:31], a[224:227], v[56:59], v[28:31]
    ds_read_b128 v[56:59], v2 offset:384
    s_waitcnt lgkmcnt(3)
    v_mfma_f32_16x16x32_bf16 v[16:19], a[12:15], v[60:63], v[16:19]
    v_mfma_f32_16x16x32_bf16 v[20:23], a[84:87], v[60:63], v[20:23]
    v_mfma_f32_16x16x32_bf16 v[24:27], a[156:159], v[60:63], v[24:27]
    v_mfma_f32_16x16x32_bf16 v[28:31], a[228:231], v[60:63], v[28:31]
    ds_read_b128 v[60:63], v3 offset:384
    s_waitcnt lgkmcnt(3)
    v_mfma_f32_16x16x32_bf16 v[16:19], a[16:19], v[48:51], v[16:19]
    v_mfma_f32_16x16x32_bf16 v[20:23], a[88:91], v[48:51], v[20:23]
    v_mfma_f32_16x16x32_bf16 v[24:27], a[160:163], v[48:51], v[24:27]
    v_mfma_f32_16x16x32_bf16 v[28:31], a[232:235], v[48:51], v[28:31]
    ds_read_b128 v[48:51], v2 offset:512
    s_waitcnt lgkmcnt(3)
    v_mfma_f32_16x16x32_bf16 v[16:19], a[20:23], v[52:55], v[16:19]
    v_mfma_f32_16x16x32_bf16 v[20:23], a[92:95], v[52:55], v[20:23]
    v_mfma_f32_16x16x32_bf16 v[24:27], a[164:167], v[52:55], v[24:27]
    v_mfma_f32_16x16x32_bf16 v[28:31], a[236:239], v[52:55], v[28:31]
    ds_read_b128 v[52:55], v3 offset:512
    s_waitcnt lgkmcnt(3)
    v_mfma_f32_16x16x32_bf16 v[16:19], a[24:27], v[56:59], v[16:19]
    v_mfma_f32_16x16x32_bf16 v[20:23], a[96:99], v[56:59], v[20:23]
    v_mfma_f32_16x16x32_bf16 v[24:27], a[168:171], v[56:59], v[24:27]
    v_mfma_f32_16x16x32_bf16 v[28:31], a[240:243], v[56:59], v[28:31]
    ds_read_b128 v[56:59], v2 offset:640
    s_waitcnt lgkmcnt(3)
    v_mfma_f32_16x16x32_bf16 v[16:19], a[28:31], v[60:63], v[16:19]
    v_mfma_f32_16x16x32_bf16 v[20:23], a[100:103], v[60:63], v[20:23]
    v_mfma_f32_16x16x32_bf16 v[24:27], a[172:175], v[60:63], v[24:27]
    v_mfma_f32_16x16x32_bf16 v[28:31], a[244:247], v[60:63], v[28:31]
    ds_read_b128 v[60:63], v3 offset:640
    s_waitcnt lgkmcnt(3)
    v_mfma_f32_16x16x32_bf16 v[16:19], a[32:35], v[48:51], v[16:19]
    v_mfma_f32_16x16x32_bf16 v[20:23], a[104:107], v[48:51], v[20:23]
    v_mfma_f32_16x16x32_bf16 v[24:27], a[176:179], v[48:51], v[24:27]
    v_mfma_f32_16x16x32_bf16 v[28:31], a[248:251], v[48:51], v[28:31]
    ds_read_b128 v[48:51], v2 offset:768
    s_waitcnt lgkmcnt(3)
    v_mfma_f32_16x16x32_bf16 v[16:19], a[36:39], v[52:55], v[16:19]
    v_mfma_f32_16x16x32_bf16 v[20:23], a[108:111], v[52:55], v[20:23]
    v_mfma_f32_16x16x32_bf16 v[24:27], a[180:183], v[52:55], v[24:27]
    v_mfma_f32_16x16x32_bf16 v[28:31], a[252:255], v[52:55], v[28:31]
    ds_read_b128 v[52:55], v3 offset:768
    s_waitcnt lgkmcnt(3)
    v_mfma_f32_16x16x32_bf16 v[16:19], a[40:43], v[56:59], v[16:19]
    v_mfma_f32_16x16x32_bf16 v[20:23], a[112:115], v[56:59], v[20:23]
    v_mfma_f32_16x16x32_bf16 v[24:27], a[184:187], v[56:59], v[24:27]
    v_mfma_f32_16x16x32_bf16 v[28:31], v[80:83], v[56:59], v[28:31]
    ds_read_b128 v[56:59], v2 offset:896
    s_waitcnt lgkmcnt(3)
    v_mfma_f32_16x16x32_bf16 v[16:19], a[44:47], v[60:63], v[16:19]
    v_mfma_f32_16x16x32_bf16 v[20:23], a[116:119], v[60:63], v[20:23]
    v_mfma_f32_16x16x32_bf16 v[24:27], a[188:191], v[60:63], v[24:27]
    v_mfma_f32_16x16x32_bf16 v[28:31], v[84:87], v[60:63], v[28:31]
    ds_read_b128 v[60:63], v3 offset:896
    s_waitcnt lgkmcnt(3)
    v_mfma_f32_16x16x32_bf16 v[16:19], a[48:51], v[48:51], v[16:19]
    v_mfma_f32_16x16x32_bf16 v[20:23], a[120:123], v[48:51], v[20:23]
    v_mfma_f32_16x16x32_bf16 v[24:27], a[192:195], v[48:51], v[24:27]
    v_mfma_f32_16x16x32_bf16 v[28:31], v[88:91], v[48:51], v[28:31]
    ds_read_b128 v[48:51], v2 offset:1024
    s_waitcnt lgkmcnt(3)
    v_mfma_f32_16x16x32_bf16 v[16:19], a[52:55], v[52:55], v[16:19]
    v_mfma_f32_16x16x32_bf16 v[20:23], a[124:127], v[52:55], v[20:23]
    v_mfma_f32_16x16x32_bf16 v[24:27], a[196:199], v[52:55], v[24:27]
    v_mfma_f32_16x16x32_bf16 v[28:31], v[92:95], v[52:55], v[28:31]
    ds_read_b128 v[52:55], v3 offset:1024
    s_waitcnt lgkmcnt(3)
    v_mfma_f32_16x16x32_bf16 v[16:19], a[56:59], v[56:59], v[16:19]
    v_mfma_f32_16x16x32_bf16 v[20:23], a[128:131], v[56:59], v[20:23]
    v_mfma_f32_16x16x32_bf16 v[24:27], a[200:203], v[56:59], v[24:27]
    v_mfma_f32_16x16x32_bf16 v[28:31], v[96:99], v[56:59], v[28:31]
    s_waitcnt lgkmcnt(2)
    v_mfma_f32_16x16x32_bf16 v[16:19], a[60:63], v[60:63], v[16:19]
    v_mfma_f32_16x16x32_bf16 v[20:23], a[132:135], v[60:63], v[20:23]
    v_mfma_f32_16x16x32_bf16 v[24:27], a[204:207], v[60:63], v[24:27]
    v_mfma_f32_16x16x32_bf16 v[28:31], v[100:103], v[60:63], v[28:31]
    s_waitcnt lgkmcnt(1)
    v_mfma_f32_16x16x32_bf16 v[16:19], a[64:67], v[48:51], v[16:19]
    v_mfma_f32_16x16x32_bf16 v[20:23], a[136:139], v[48:51], v[20:23]
    v_mfma_f32_16x16x32_bf16 v[24:27], a[208:211], v[48:51], v[24:27]
    v_mfma_f32_16x16x32_bf16 v[28:31], v[104:107], v[48:51], v[28:31]
    s_waitcnt lgkmcnt(0)
    v_mfma_f32_16x16x32_bf16 v[16:19], a[68:71], v[52:55], v[16:19]
    v_mfma_f32_16x16x32_bf16 v[20:23], a[140:143], v[52:55], v[20:23]
    v_mfma_f32_16x16x32_bf16 v[24:27], a[212:215], v[52:55], v[24:27]
    v_mfma_f32_16x16x32_bf16 v[28:31], v[108:111], v[52:55], v[28:31]
    v_mov_b32 v9, s76
    s_waitcnt vmcnt(0)
    v_cmp_gt_u32 vcc, s81, v67
    v_cmp_ge_u32 s[86:87], s88, v66
    s_mov_b64 exec, 1
    buffer_store_dword v9, off, s[32:35], s70 sc1
    s_mov_b64 exec, -1
    s_cbranch_vccnz fpoll_22
fpret_23:
    s_cmp_ge_u32 s64, 60
    s_cselect_b64 s[86:87], -1, s[86:87]
    s_cmp_eq_u64 s[86:87], 0
    s_cselect_b32 s85, s66, 2130706432
    ds_read_b128 v[56:59], v2 offset:18432
    v_cvt_pk_bf16_f32 v20, v20, v21
    s_add_u32 m0, s84, 0
    s_add_u32 s57, s80, 5046272
    buffer_load_dwordx2 v[74:75], v8, s[32:35], s57 offen sc1
    ds_read_b128 v[60:63], v3 offset:18432
    v_cvt_pk_bf16_f32 v18, v18, v19
    v_cvt_pk_bf16_f32 v22, v22, v23
    ds_read_b128 v[48:51], v2 offset:18560
    s_waitcnt lgkmcnt(2)
    v_mfma_f32_16x16x32_bf16 v[32:35], a[0:3], v[56:59], 0
    buffer_load_dwordx4 v6, s[32:35], s79 offen sc1 lds
    s_add_u32 s79, s79, 147456
    v_mfma_f32_16x16x32_bf16 v[40:43], a[144:147], v[56:59], 0
    ds_read_b128 v[52:55], v3 offset:18560
    s_add_u32 m0, s84, 1024
    s_waitcnt lgkmcnt(2)
    v_mfma_f32_16x16x32_bf16 v[32:35], a[4:7], v[60:63], v[32:35]
    buffer_load_dwordx4 v6, s[32:35], s79 offen sc1 lds
    s_add_u32 m0, s84, 8192
    v_mfma_f32_16x16x32_bf16 v[44:47], a[216:219], v[56:59], 0
    s_add_u32 s79, s79, 147456
    s_waitcnt lgkmcnt(1)
    v_mfma_f32_16x16x32_bf16 v[32:35], a[8:11], v[48:51], v[32:35]
    buffer_load_dwordx4 v6, s[32:35], s79 offen sc1 lds
    v_and_b32 v19, s77, v18
    v_mfma_f32_16x16x32_bf16 v[40:43], a[148:151], v[60:63], v[40:43]
    v_lshlrev_b32 v18, 16, v18
    v_and_b32 v23, s77, v22
    v_mfma_f32_16x16x32_bf16 v[36:39], a[72:75], v[56:59], 0
    s_add_u32 s79, s79, 147456
    v_mfma_f32_16x16x32_bf16 v[36:39], a[76:79], v[60:63], v[36:39]
    ds_read_b128 v[56:59], v2 offset:18688
    v_and_b32 v21, s77, v20
    v_cvt_pk_bf16_f32 v16, v16, v17
    v_mfma_f32_16x16x32_bf16 v[44:47], a[220:223], v[60:63], v[44:47]
    s_add_u32 m0, s84, 9216
    v_mul_f32 v69, v19, v19
    s_waitcnt lgkmcnt(1)
    v_mfma_f32_16x16x32_bf16 v[32:35], a[12:15], v[52:55], v[32:35]
    buffer_load_dwordx4 v6, s[32:35], s79 offen sc1 lds
    v_and_b32 v17, s77, v16
    v_mfma_f32_16x16x32_bf16 v[44:47], a[224:227], v[48:51], v[44:47]
    s_add_u32 m0, s84, 16384
    v_mul_f32 v73, v21, v21
    v_lshlrev_b32 v22, 16, v22
    v_mfma_f32_16x16x32_bf16 v[44:47], a[228:231], v[52:55], v[44:47]
    s_add_u32 s79, s79, 147456
    v_cvt_pk_bf16_f32 v30, v30, v31
    s_waitcnt lgkmcnt(0)
    v_mfma_f32_16x16x32_bf16 v[32:35], a[16:19], v[56:59], v[32:35]
    buffer_load_dwordx4 v6, s[32:35], s79 offen sc1 lds
    v_mul_f32 v76, v22, v22
    v_mfma_f32_16x16x32_bf16 v[44:47], a[232:235], v[56:59], v[44:47]
    s_add_u32 m0, s84, 17408
    ds_read_b128 v[60:63], v3 offset:18688
    v_cvt_pk_bf16_f32 v26, v26, v27
    v_mfma_f32_16x16x32_bf16 v[36:39], a[80:83], v[48:51], v[36:39]
    v_mul_f32 v65, v17, v17
    s_add_u32 s79, s79, 147456
    v_mfma_f32_16x16x32_bf16 v[40:43], a[152:155], v[48:51], v[40:43]
    ds_read_b128 v[48:51], v2 offset:18816
    v_fma_f32 v65, v65, s78, v0
    v_fma_f32 v76, v76, s78, v0
    v_mfma_f32_16x16x32_bf16 v[36:39], a[84:87], v[52:55], v[36:39]
    v_lshlrev_b32 v16, 16, v16
    v_lshlrev_b32 v20, 16, v20
    v_mfma_f32_16x16x32_bf16 v[40:43], a[156:159], v[52:55], v[40:43]
    v_mul_f32 v68, v18, v18
    v_mul_f32 v76, v76, v22
    v_mfma_f32_16x16x32_bf16 v[40:43], a[160:163], v[56:59], v[40:43]
    s_add_u32 s59, s85, 0
    v_exp_f32 v76, v76
    s_waitcnt lgkmcnt(1)
    v_mfma_f32_16x16x32_bf16 v[32:35], a[20:23], v[60:63], v[32:35]
    buffer_load_dwordx4 v6, s[32:35], s79 offen sc1 lds
    v_fma_f32 v73, v73, s78, v0
    v_mul_f32 v77, v23, v23
    v_mfma_f32_16x16x32_bf16 v[40:43], a[164:167], v[60:63], v[40:43]
    s_add_u32 s79, s79, 147456
    v_mul_f32 v72, v20, v20
    v_fma_f32 v68, v68, s78, v0
    v_mfma_f32_16x16x32_bf16 v[44:47], a[236:239], v[60:63], v[44:47]
    s_add_u32 m0, s84, 24576
    v_and_b32 v31, s77, v30
    s_waitcnt lgkmcnt(0)
    v_mfma_f32_16x16x32_bf16 v[40:43], a[168:171], v[48:51], v[40:43]
    ds_read_b128 v[52:55], v3 offset:18816
    v_mul_f32 v64, v16, v16
    v_fma_f32 v64, v64, s78, v0
    v_mfma_f32_16x16x32_bf16 v[36:39], a[88:91], v[56:59], v[36:39]
    ds_read_b128 v[56:59], v2 offset:18944
    v_fma_f32 v69, v69, s78, v0
    v_mfma_f32_16x16x32_bf16 v[36:39], a[92:95], v[60:63], v[36:39]
    v_mul_f32 v64, v64, v16
    v_mul_f32 v73, v73, v21
    v_mfma_f32_16x16x32_bf16 v[36:39], a[96:99], v[48:51], v[36:39]
    v_mul_f32 v65, v65, v17
    v_fma_f32 v77, v77, s78, v0
    v_mfma_f32_16x16x32_bf16 v[32:35], a[24:27], v[48:51], v[32:35]
    v_exp_f32 v65, v65
    s_waitcnt lgkmcnt(1)
    v_mfma_f32_16x16x32_bf16 v[40:43], a[172:175], v[52:55], v[40:43]
    buffer_load_dwordx4 v6, s[32:35], s79 offen sc1 lds
    v_and_b32 v27, s77, v26
    v_mfma_f32_16x16x32_bf16 v[44:47], a[240:243], v[48:51], v[44:47]
    s_add_u32 s79, s79, 147456
    v_exp_f32 v64, v64
    s_waitcnt lgkmcnt(0)
    v_mfma_f32_16x16x32_bf16 v[40:43], a[176:179], v[56:59], v[40:43]
    ds_read_b128 v[60:63], v3 offset:18944
    v_lshlrev_b32 v26, 16, v26
    v_mul_f32 v77, v77, v23
    v_mfma_f32_16x16x32_bf16 v[44:47], a[244:247], v[52:55], v[44:47]
    s_add_u32 m0, s84, 25600
    v_fma_f32 v72, v72, s78, v0
    v_mul_f32 v68, v68, v18
    v_mfma_f32_16x16x32_bf16 v[32:35], a[28:31], v[52:55], v[32:35]
    v_exp_f32 v68, v68
    v_mfma_f32_16x16x32_bf16 v[36:39], a[100:103], v[52:55], v[36:39]
    ds_read_b128 v[52:55], v3 offset:19072
    v_exp_f32 v77, v77
    v_mfma_f32_16x16x32_bf16 v[44:47], a[248:251], v[56:59], v[44:47]
    buffer_load_dwordx4 v6, s[32:35], s79 offen sc1 lds
    v_add_f32 v76, 1.0, v76
    v_mfma_f32_16x16x32_bf16 v[36:39], a[104:107], v[56:59], v[36:39]
    v_exp_f32 v73, v73
    s_waitcnt lgkmcnt(1)
    v_mfma_f32_16x16x32_bf16 v[40:43], a[180:183], v[60:63], v[40:43]
    ds_read_b128 v[48:51], v2 offset:19072
    v_add_f32 v64, 1.0, v64
    v_add_f32 v77, 1.0, v77
    v_mfma_f32_16x16x32_bf16 v[36:39], a[108:111], v[60:63], v[36:39]
    s_add_u32 s79, s79, 147456
    v_cvt_pk_bf16_f32 v28, v28, v29
    v_add_f32 v73, 1.0, v73
    v_mfma_f32_16x16x32_bf16 v[32:35], a[32:35], v[56:59], v[32:35]
    v_mul_f32 v72, v72, v20
    v_mul_f32 v69, v69, v19
    v_mfma_f32_16x16x32_bf16 v[32:35], a[36:39], v[60:63], v[32:35]
    ds_read_b128 v[56:59], v2 offset:19200
    v_add_f32 v68, 1.0, v68
    v_mfma_f32_16x16x32_bf16 v[44:47], a[252:255], v[60:63], v[44:47]
    s_add_u32 m0, s84, 32768
    v_exp_f32 v72, v72
    s_waitcnt lgkmcnt(1)
    v_mfma_f32_16x16x32_bf16 v[44:47], v[80:83], v[48:51], v[44:47]
    buffer_load_dwordx4 v6, s[32:35], s79 offen sc1 lds
    v_mfma_f32_16x16x32_bf16 v[32:35], a[40:43], v[48:51], v[32:35]
    ds_read_b128 v[60:63], v3 offset:19200
    v_rcp_f32 v68, v68
    s_add_u32 m0, s83, 0
    v_mfma_f32_16x16x32_bf16 v[32:35], a[44:47], v[52:55], v[32:35]
    buffer_load_dwordx4 v1, s[32:35], s59 offen offset:2048 sc1 lds
    v_add_f32 v72, 1.0, v72
    v_mfma_f32_16x16x32_bf16 v[40:43], a[184:187], v[48:51], v[40:43]
    v_exp_f32 v69, v69
    s_waitcnt lgkmcnt(1)
    v_mfma_f32_16x16x32_bf16 v[32:35], a[48:51], v[56:59], v[32:35]
    buffer_load_dwordx4 v1, s[32:35], s59 offen offset:1024 sc1 lds
    v_mfma_f32_16x16x32_bf16 v[36:39], a[112:115], v[48:51], v[36:39]
    ds_read_b128 v[48:51], v2 offset:19328
    v_rcp_f32 v77, v77
    s_waitcnt lgkmcnt(1)
    v_mfma_f32_16x16x32_bf16 v[32:35], a[52:55], v[60:63], v[32:35]
    buffer_load_dwordx4 v1, s[32:35], s59 offen offset:0 sc1 lds
    v_add_f32 v69, 1.0, v69
    v_mfma_f32_16x16x32_bf16 v[44:47], v[84:87], v[52:55], v[44:47]
    v_rcp_f32 v76, v76
    v_mfma_f32_16x16x32_bf16 v[40:43], a[188:191], v[52:55], v[40:43]
    buffer_load_dwordx4 v1, s[32:35], s59 offen offset:3072 sc1 lds
    s_add_u32 s59, s85, 4096
    v_mfma_f32_16x16x32_bf16 v[36:39], a[116:119], v[52:55], v[36:39]
    ds_read_b128 v[52:55], v3 offset:19328
    v_rcp_f32 v64, v64
    v_mfma_f32_16x16x32_bf16 v[40:43], a[192:195], v[56:59], v[40:43]
    s_add_u32 m0, s83, 4096
    v_rcp_f32 v72, v72
    s_waitcnt lgkmcnt(1)
    v_mfma_f32_16x16x32_bf16 v[32:35], a[56:59], v[48:51], v[32:35]
    buffer_load_dwordx4 v1, s[32:35], s59 offen offset:0 sc1 lds
    v_mul_f32 v64, v64, v16
    v_mfma_f32_16x16x32_bf16 v[44:47], v[88:91], v[56:59], v[44:47]
    v_add_f32 v65, 1.0, v65
    v_rcp_f32 v65, v65
    v_mfma_f32_16x16x32_bf16 v[36:39], a[120:123], v[56:59], v[36:39]
    ds_read_b128 v[56:59], v2 offset:19456
    v_cvt_pk_bf16_f32 v24, v24, v25
    v_and_b32 v25, s77, v24
    v_mfma_f32_16x16x32_bf16 v[44:47], v[92:95], v[60:63], v[44:47]
    v_rcp_f32 v69, v69
    s_waitcnt lgkmcnt(1)
    v_mfma_f32_16x16x32_bf16 v[32:35], a[60:63], v[52:55], v[32:35]
    buffer_load_dwordx4 v1, s[32:35], s59 offen offset:1024 sc1 lds
    v_and_b32 v29, s77, v28
    v_lshlrev_b32 v28, 16, v28
    v_mfma_f32_16x16x32_bf16 v[36:39], a[124:127], v[60:63], v[36:39]
    v_mul_f32 v76, v76, v22
    v_lshlrev_b32 v24, 16, v24
    v_mfma_f32_16x16x32_bf16 v[40:43], a[196:199], v[60:63], v[40:43]
    ds_read_b128 v[60:63], v3 offset:19456
    v_rcp_f32 v73, v73
    s_waitcnt lgkmcnt(1)
    v_mfma_f32_16x16x32_bf16 v[32:35], a[64:67], v[56:59], v[32:35]
    buffer_load_dwordx4 v1, s[32:35], s59 offen offset:3072 sc1 lds
    v_mul_f32 v69, v69, v19
    v_mul_f32 v65, v65, v17
    v_mfma_f32_16x16x32_bf16 v[36:39], a[128:131], v[48:51], v[36:39]
    v_cvt_pk_bf16_f32 v64, v64, v65
    v_and_b32 v65, s77, v64
    v_lshlrev_b32 v64, 16, v64
    v_mul_f32 v77, v77, v23
    v_cvt_pk_bf16_f32 v76, v76, v77
    v_mfma_f32_16x16x32_bf16 v[36:39], a[132:135], v[52:55], v[36:39]
    v_mul_f32 v72, v72, v20
    s_waitcnt lgkmcnt(0)
    v_mfma_f32_16x16x32_bf16 v[32:35], a[68:71], v[60:63], v[32:35]
    buffer_load_dwordx4 v1, s[32:35], s59 offen offset:2048 sc1 lds
    v_mul_f32 v68, v68, v18
    v_mfma_f32_16x16x32_bf16 v[36:39], a[136:139], v[56:59], v[36:39]
    s_add_u32 s59, s85, 8192
    v_mul_f32 v73, v73, v21
    v_and_b32 v77, s77, v76
    v_mfma_f32_16x16x32_bf16 v[44:47], v[96:99], v[48:51], v[44:47]
    v_cvt_pk_bf16_f32 v72, v72, v73
    v_cvt_pk_bf16_f32 v68, v68, v69
    v_mfma_f32_16x16x32_bf16 v[44:47], v[100:103], v[52:55], v[44:47]
    s_add_u32 m0, s83, 8192
    v_and_b32 v69, s77, v68
    v_mfma_f32_16x16x32_bf16 v[44:47], v[104:107], v[56:59], v[44:47]
    buffer_load_dwordx4 v1, s[32:35], s59 offen offset:0 sc1 lds
    v_cvt_pk_bf16_f32 v34, v34, v35
    v_and_b32 v35, s77, v34
    v_cvt_pk_bf16_f32 v32, v32, v33
    v_lshlrev_b32 v68, 16, v68
    v_and_b32 v73, s77, v72
    v_lshlrev_b32 v72, 16, v72
    v_lshlrev_b32 v34, 16, v34
    v_mfma_f32_16x16x32_bf16 v[36:39], a[140:143], v[60:63], v[36:39]
    v_mul_f32 v69, v69, v27
    v_mul_f32 v68, v68, v26
    v_lshlrev_b32 v76, 16, v76
    v_mul_f32 v73, v73, v29
    v_mul_f32 v72, v72, v28
    v_cvt_pk_bf16_f32 v17, v68, v69
    v_mul_f32 v69, v35, v35
    v_mul_f32 v77, v77, v31
    v_mfma_f32_16x16x32_bf16 v[44:47], v[108:111], v[60:63], v[44:47]
    v_cvt_pk_bf16_f32 v38, v38, v39
    v_mul_f32 v65, v65, v25
    v_and_b32 v39, s77, v38
    v_mul_f32 v68, v34, v34
    v_and_b32 v33, s77, v32
    v_lshlrev_b32 v30, 16, v30
    v_mul_f32 v76, v76, v30
    v_mfma_f32_16x16x32_bf16 v[40:43], a[200:203], v[48:51], v[40:43]
    v_mul_f32 v64, v64, v24
    v_cvt_pk_bf16_f32 v16, v64, v65
    v_cvt_pk_bf16_f32 v18, v72, v73
    v_lshlrev_b32 v32, 16, v32
    v_cvt_pk_bf16_f32 v36, v36, v37
    v_and_b32 v37, s77, v36
    v_mul_f32 v73, v37, v37
    v_mul_f32 v64, v32, v32
    v_lshlrev_b32 v36, 16, v36
    v_fma_f32 v64, v64, s78, v0
    v_fma_f32 v69, v69, s78, v0
    v_mul_f32 v65, v33, v33
    v_lshlrev_b32 v38, 16, v38
    v_mfma_f32_16x16x32_bf16 v[40:43], a[204:207], v[52:55], v[40:43]
    v_mul_f32 v69, v69, v35
    v_fma_f32 v73, v73, s78, v0
    v_mul_f32 v64, v64, v32
    v_exp_f32 v64, v64
    v_cvt_pk_bf16_f32 v19, v76, v77
    v_mul_f32 v77, v39, v39
    v_mul_f32 v76, v38, v38
    v_fma_f32 v68, v68, s78, v0
    v_mul_f32 v68, v68, v34
    v_add_f32 v64, 1.0, v64
    v_fma_f32 v77, v77, s78, v0
    v_mul_f32 v77, v77, v39
    v_fma_f32 v65, v65, s78, v0
    v_mul_f32 v73, v73, v37
    v_exp_f32 v69, v69
    v_exp_f32 v77, v77
    v_exp_f32 v68, v68
    v_mul_f32 v65, v65, v33
    v_add_f32 v77, 1.0, v77
    v_mul_f32 v72, v36, v36
    v_exp_f32 v65, v65
    v_cvt_pk_bf16_f32 v46, v46, v47
    v_add_f32 v69, 1.0, v69
    v_rcp_f32 v64, v64
    v_add_f32 v65, 1.0, v65
    v_mul_f32 v64, v64, v32
    v_rcp_f32 v69, v69
    v_cvt_pk_bf16_f32 v44, v44, v45
    v_add_f32 v68, 1.0, v68
    v_mfma_f32_16x16x32_bf16 v[40:43], a[208:211], v[56:59], v[40:43]
    v_rcp_f32 v68, v68
    v_fma_f32 v76, v76, s78, v0
    v_and_b32 v45, s77, v44
    v_mul_f32 v68, v68, v34
    v_rcp_f32 v77, v77
    v_mfma_f32_16x16x32_bf16 v[40:43], a[212:215], v[60:63], v[40:43]
    ds_write_b128 v4, v[16:19] offset:0
    v_exp_f32 v73, v73
    v_fma_f32 v72, v72, s78, v0
    v_lshlrev_b32 v44, 16, v44
    s_nop 3
    v_cvt_pk_bf16_f32 v42, v42, v43
    v_rcp_f32 v65, v65
    v_mul_f32 v69, v69, v35
    v_mul_f32 v76, v76, v38
    v_add_f32 v73, 1.0, v73
    v_rcp_f32 v73, v73
    v_mul_f32 v77, v77, v39
    v_mul_f32 v73, v73, v37
    v_mul_f32 v72, v72, v36
    v_exp_f32 v76, v76
    v_and_b32 v43, s77, v42
    v_cvt_pk_bf16_f32 v40, v40, v41
    v_and_b32 v41, s77, v40
    v_exp_f32 v72, v72
    v_mul_f32 v65, v65, v33
    v_cvt_pk_bf16_f32 v64, v64, v65
    v_and_b32 v65, s77, v64
    v_add_f32 v72, 1.0, v72
    v_rcp_f32 v72, v72
    v_lshlrev_b32 v42, 16, v42
    v_mul_f32 v65, v65, v41
    v_add_f32 v76, 1.0, v76
    v_and_b32 v47, s77, v46
    v_rcp_f32 v76, v76
    v_cvt_pk_bf16_f32 v68, v68, v69
    v_and_b32 v69, s77, v68
    v_lshlrev_b32 v40, 16, v40
    v_lshlrev_b32 v68, 16, v68
    v_mul_f32 v76, v76, v38
    v_mul_f32 v72, v72, v36
    v_lshlrev_b32 v64, 16, v64
    v_cvt_pk_bf16_f32 v72, v72, v73
    v_lshlrev_b32 v46, 16, v46
    v_cvt_pk_bf16_f32 v76, v76, v77
    v_and_b32 v77, s77, v76
    v_lshlrev_b32 v76, 16, v76
    v_mul_f32 v76, v76, v46
    v_and_b32 v73, s77, v72
    v_mul_f32 v77, v77, v47
    v_lshlrev_b32 v72, 16, v72
    v_mul_f32 v64, v64, v40
    v_mul_f32 v73, v73, v45
    v_mul_f32 v69, v69, v43
    v_mul_f32 v72, v72, v44
    v_cvt_pk_bf16_f32 v32, v64, v65
    v_cvt_pk_bf16_f32 v35, v76, v77
    v_cvt_pk_bf16_f32 v34, v72, v73
    v_mul_f32 v68, v68, v42
    v_cvt_pk_bf16_f32 v33, v68, v69
    ds_write_b128 v4, v[32:35] offset:1024
    s_waitcnt lgkmcnt(0)
    s_barrier
    ds_read_b128 v[16:19], v11 offset:0
    s_waitcnt vmcnt(18)
    v_lshlrev_b32 v72, 16, v74
    ds_read_b128 v[20:23], v11 offset:1024
    ds_read_b128 v[40:43], v11 offset:6144
    ds_read_b128 v[28:31], v11 offset:3072
    s_waitcnt lgkmcnt(3)
    v_mfma_f32_16x16x32_bf16 v[56:59], v[116:119], v[16:19], 0
    ds_read_b128 v[24:27], v11 offset:2048
    v_mfma_f32_16x16x32_bf16 v[48:51], v[112:115], v[16:19], 0
    ds_read_b128 v[36:39], v11 offset:5120
    s_waitcnt lgkmcnt(4)
    v_mfma_f32_16x16x32_bf16 v[68:71], v[120:123], v[20:23], 0
    ds_read_b128 v[32:35], v11 offset:4096
    v_mfma_f32_16x16x32_bf16 v[64:67], v[120:123], v[16:19], 0
    ds_read_b128 v[44:47], v11 offset:7168
    v_mfma_f32_16x16x32_bf16 v[60:63], v[116:119], v[20:23], 0
    s_waitcnt lgkmcnt(3)
    v_mfma_f32_16x16x32_bf16 v[56:59], v[152:155], v[24:27], v[56:59]
    v_mfma_f32_16x16x32_bf16 v[48:51], v[148:151], v[24:27], v[48:51]
    s_waitcnt lgkmcnt(1)
    v_mfma_f32_16x16x32_bf16 v[56:59], v[188:191], v[32:35], v[56:59]
    v_mfma_f32_16x16x32_bf16 v[56:59], v[224:227], v[40:43], v[56:59]
    v_mfma_f32_16x16x32_bf16 v[68:71], v[156:159], v[28:31], v[68:71]
    v_mfma_f32_16x16x32_bf16 v[48:51], v[184:187], v[32:35], v[48:51]
    v_mfma_f32_16x16x32_bf16 v[48:51], v[220:223], v[40:43], v[48:51]
    v_mfma_f32_16x16x32_bf16 v[64:67], v[156:159], v[24:27], v[64:67]
    v_mfma_f32_16x16x32_bf16 v[60:63], v[152:155], v[28:31], v[60:63]
    v_mfma_f32_16x16x32_bf16 v[68:71], v[192:195], v[36:39], v[68:71]
    v_cvt_pk_bf16_f32 v56, v56, v57
    v_cvt_pk_bf16_f32 v48, v48, v49
    v_mfma_f32_16x16x32_bf16 v[64:67], v[192:195], v[32:35], v[64:67]
    v_mfma_f32_16x16x32_bf16 v[52:55], v[112:115], v[20:23], 0
    v_mfma_f32_16x16x32_bf16 v[60:63], v[188:191], v[36:39], v[60:63]
    s_waitcnt lgkmcnt(0)
    v_mfma_f32_16x16x32_bf16 v[60:63], v[224:227], v[44:47], v[60:63]
    v_cvt_pk_bf16_f32 v57, v58, v59
    v_mfma_f32_16x16x32_bf16 v[68:71], v[228:231], v[44:47], v[68:71]
    v_mfma_f32_16x16x32_bf16 v[52:55], v[148:151], v[28:31], v[52:55]
    v_mfma_f32_16x16x32_bf16 v[52:55], v[184:187], v[36:39], v[52:55]
    v_cvt_pk_bf16_f32 v58, v60, v61
    v_mfma_f32_16x16x32_bf16 v[52:55], v[220:223], v[44:47], v[52:55]
    v_cvt_pk_bf16_f32 v59, v62, v63
    v_mfma_f32_16x16x32_bf16 v[64:67], v[228:231], v[40:43], v[64:67]
    v_mfma_f32_16x16x32_bf16 v[60:63], v[128:131], v[20:23], 0
    buffer_store_dwordx4 v[56:59], v5, s[32:35], s68 offen offset:1024 sc1
    s_nop 3
    v_cvt_pk_bf16_f32 v64, v64, v65
    v_mfma_f32_16x16x32_bf16 v[56:59], v[128:131], v[16:19], 0
    v_cvt_pk_bf16_f32 v49, v50, v51
    v_mfma_f32_16x16x32_bf16 v[60:63], v[164:167], v[28:31], v[60:63]
    v_cvt_pk_bf16_f32 v51, v54, v55
    v_cvt_pk_bf16_f32 v50, v52, v53
    v_mfma_f32_16x16x32_bf16 v[56:59], v[164:167], v[24:27], v[56:59]
    v_mfma_f32_16x16x32_bf16 v[56:59], v[200:203], v[32:35], v[56:59]
    buffer_store_dwordx4 v[48:51], v5, s[32:35], s68 offen offset:0 sc1
    v_cvt_pk_bf16_f32 v65, v66, v67
    v_mfma_f32_16x16x32_bf16 v[56:59], v[236:239], v[40:43], v[56:59]
    s_add_u32 s58, s68, 4096
    v_mfma_f32_16x16x32_bf16 v[60:63], v[200:203], v[36:39], v[60:63]
    v_mfma_f32_16x16x32_bf16 v[52:55], v[124:127], v[20:23], 0
    s_add_u32 s69, s68, 8192
    v_cvt_pk_bf16_f32 v67, v70, v71
    v_mfma_f32_16x16x32_bf16 v[48:51], v[124:127], v[16:19], 0
    v_mfma_f32_16x16x32_bf16 v[48:51], v[160:163], v[24:27], v[48:51]
    v_cvt_pk_bf16_f32 v66, v68, v69
    v_mfma_f32_16x16x32_bf16 v[60:63], v[236:239], v[44:47], v[60:63]
    buffer_store_dwordx4 v[64:67], v5, s[32:35], s68 offen offset:2048 sc1
    v_mfma_f32_16x16x32_bf16 v[68:71], v[132:135], v[20:23], 0
    v_mfma_f32_16x16x32_bf16 v[48:51], v[196:199], v[32:35], v[48:51]
    v_cvt_pk_bf16_f32 v56, v56, v57
    v_mfma_f32_16x16x32_bf16 v[68:71], v[168:171], v[28:31], v[68:71]
    v_mfma_f32_16x16x32_bf16 v[68:71], v[204:207], v[36:39], v[68:71]
    v_cvt_pk_bf16_f32 v57, v58, v59
    v_mfma_f32_16x16x32_bf16 v[48:51], v[232:235], v[40:43], v[48:51]
    v_cvt_pk_bf16_f32 v58, v60, v61
    v_mfma_f32_16x16x32_bf16 v[52:55], v[160:163], v[28:31], v[52:55]
    v_mfma_f32_16x16x32_bf16 v[52:55], v[196:199], v[36:39], v[52:55]
    v_cvt_pk_bf16_f32 v59, v62, v63
    v_mfma_f32_16x16x32_bf16 v[52:55], v[232:235], v[44:47], v[52:55]
    v_mfma_f32_16x16x32_bf16 v[64:67], v[132:135], v[16:19], 0
    v_cvt_pk_bf16_f32 v48, v48, v49
    v_cvt_pk_bf16_f32 v49, v50, v51
    v_mfma_f32_16x16x32_bf16 v[64:67], v[168:171], v[24:27], v[64:67]
    v_mfma_f32_16x16x32_bf16 v[68:71], v[240:243], v[44:47], v[68:71]
    v_mfma_f32_16x16x32_bf16 v[64:67], v[204:207], v[32:35], v[64:67]
    v_cvt_pk_bf16_f32 v51, v54, v55
    v_mfma_f32_16x16x32_bf16 v[64:67], v[240:243], v[40:43], v[64:67]
    v_cvt_pk_bf16_f32 v50, v52, v53
    v_mfma_f32_16x16x32_bf16 v[60:63], v[140:143], v[20:23], 0
    buffer_store_dwordx4 v[48:51], v5, s[32:35], s68 offen offset:3072 sc1
    v_mfma_f32_16x16x32_bf16 v[60:63], v[176:179], v[28:31], v[60:63]
    v_cvt_pk_bf16_f32 v64, v64, v65
    v_mfma_f32_16x16x32_bf16 v[60:63], v[212:215], v[36:39], v[60:63]
    v_mfma_f32_16x16x32_bf16 v[48:51], v[136:139], v[16:19], 0
    v_mfma_f32_16x16x32_bf16 v[52:55], v[136:139], v[20:23], 0
    buffer_store_dwordx4 v[56:59], v5, s[32:35], s58 offen offset:0 sc1
    v_and_b32 v73, s77, v74
    v_mfma_f32_16x16x32_bf16 v[56:59], v[140:143], v[16:19], 0
    v_mfma_f32_16x16x32_bf16 v[56:59], v[176:179], v[24:27], v[56:59]
    v_cvt_pk_bf16_f32 v65, v66, v67
    v_cvt_pk_bf16_f32 v67, v70, v71
    v_mfma_f32_16x16x32_bf16 v[56:59], v[212:215], v[32:35], v[56:59]
    v_add_u32 v3, s82, v3
    v_mfma_f32_16x16x32_bf16 v[48:51], v[172:175], v[24:27], v[48:51]
    v_mfma_f32_16x16x32_bf16 v[48:51], v[208:211], v[32:35], v[48:51]
    v_mfma_f32_16x16x32_bf16 v[56:59], v[248:251], v[40:43], v[56:59]
    v_cvt_pk_bf16_f32 v66, v68, v69
    v_mfma_f32_16x16x32_bf16 v[60:63], v[248:251], v[44:47], v[60:63]
    v_mfma_f32_16x16x32_bf16 v[48:51], v[244:247], v[40:43], v[48:51]
    v_add_u32 v2, s82, v2
    v_mfma_f32_16x16x32_bf16 v[52:55], v[172:175], v[28:31], v[52:55]
    buffer_store_dwordx4 v[64:67], v5, s[32:35], s58 offen offset:1024 sc1
    v_cvt_pk_bf16_f32 v56, v56, v57
    v_cvt_pk_bf16_f32 v57, v58, v59
    v_cvt_pk_bf16_f32 v58, v60, v61
    v_mfma_f32_16x16x32_bf16 v[64:67], v[144:147], v[16:19], 0
    v_cvt_pk_bf16_f32 v48, v48, v49
    v_cvt_pk_bf16_f32 v49, v50, v51
    v_mfma_f32_16x16x32_bf16 v[52:55], v[208:211], v[36:39], v[52:55]
    v_mfma_f32_16x16x32_bf16 v[64:67], v[180:183], v[24:27], v[64:67]
    v_cvt_pk_bf16_f32 v59, v62, v63
    v_mfma_f32_16x16x32_bf16 v[52:55], v[244:247], v[44:47], v[52:55]
    buffer_store_dwordx4 v[56:59], v5, s[32:35], s58 offen offset:3072 sc1
    v_mfma_f32_16x16x32_bf16 v[68:71], v[144:147], v[20:23], 0
    s_nop 4
    v_cvt_pk_bf16_f32 v51, v54, v55
    v_mfma_f32_16x16x32_bf16 v[64:67], v[216:219], v[32:35], v[64:67]
    v_mfma_f32_16x16x32_bf16 v[64:67], v[252:255], v[40:43], v[64:67]
    s_waitcnt vmcnt(16)
    ds_read_b128 v[20:23], v4 offset:9216
    v_mfma_f32_16x16x32_bf16 v[68:71], v[180:183], v[28:31], v[68:71]
    ds_read_b128 v[16:19], v4 offset:8192
    v_mfma_f32_16x16x32_bf16 v[68:71], v[216:219], v[36:39], v[68:71]
    v_cvt_pk_bf16_f32 v50, v52, v53
    v_mfma_f32_16x16x32_bf16 v[68:71], v[252:255], v[44:47], v[68:71]
    buffer_store_dwordx4 v[48:51], v5, s[32:35], s58 offen offset:2048 sc1
    ds_read_b128 v[36:39], v4 offset:25600
    v_cvt_pk_bf16_f32 v64, v64, v65
    ds_read_b128 v[28:31], v4 offset:17408
    v_cvt_pk_bf16_f32 v65, v66, v67
    s_nop 1
    v_cvt_pk_bf16_f32 v67, v70, v71
    v_cvt_pk_bf16_f32 v66, v68, v69
    s_waitcnt lgkmcnt(2)
    v_mfma_f32_16x16x32_bf16 v[76:79], v[12:15], v[16:19], 0
    ds_read_b128 v[24:27], v4 offset:16384
    buffer_store_dwordx4 v[64:67], v5, s[32:35], s69 offen offset:0 sc1
    v_mfma_f32_16x16x32_bf16 v[76:79], v[12:15], v[20:23], v[76:79]
    ds_read_b128 v[40:43], v4 offset:32768
    ds_read_b128 v[32:35], v4 offset:24576
    ds_read_b128 v[44:47], v4 offset:33792
    s_waitcnt lgkmcnt(3)
    v_mfma_f32_16x16x32_bf16 v[76:79], v[12:15], v[24:27], v[76:79]
    v_mfma_f32_16x16x32_bf16 v[76:79], v[12:15], v[28:31], v[76:79]
    ds_read_b128 v[16:19], v4 offset:40960
    s_add_u32 s79, s79, 147456
    s_waitcnt lgkmcnt(2)
    v_mfma_f32_16x16x32_bf16 v[76:79], v[12:15], v[32:35], v[76:79]
    v_mfma_f32_16x16x32_bf16 v[76:79], v[12:15], v[36:39], v[76:79]
    v_mfma_f32_16x16x32_bf16 v[76:79], v[12:15], v[40:43], v[76:79]
    s_waitcnt lgkmcnt(1)
    v_mfma_f32_16x16x32_bf16 v[76:79], v[12:15], v[44:47], v[76:79]
    s_waitcnt lgkmcnt(0)
    v_mfma_f32_16x16x32_bf16 v[76:79], v[12:15], v[16:19], v[76:79]
    s_nop 7
    v_cvt_pk_bf16_f32 v76, v76, v77
    v_and_b32 v77, s77, v76
    v_lshlrev_b32 v76, 16, v76
    v_add_f32 v77, v77, v73
    v_and_b32 v73, s77, v75
    v_cvt_pk_bf16_f32 v78, v78, v79
    v_and_b32 v79, s77, v78
    v_add_f32 v76, v76, v72
    v_lshlrev_b32 v72, 16, v75
    v_add_f32 v79, v79, v73
    v_cvt_pk_bf16_f32 v74, v76, v77
    v_lshlrev_b32 v78, 16, v78
    v_add_f32 v78, v78, v72
    v_cvt_pk_bf16_f32 v75, v78, v79
    buffer_store_dwordx2 v[74:75], v8, s[48:51], s80 offen
    s_sub_u32 s82, 0, s82
    s_mov_b32 s79, s74
    s_mov_b32 s80, s75
    s_mov_b32 s81, s76
    s_mov_b32 s74, s72
    s_mov_b32 s75, s73
    s_add_u32 s76, s64, 1
    s_add_u32 s64, s64, 3
    s_add_u32 s68, s68, 3981312
    s_add_u32 s72, s72, 3981312
    s_add_u32 s73, s73, 110592
    s_cmp_lg_u32 s85, 2130706432
    s_waitcnt vmcnt(10)
    s_cbranch_scc1 floop_20
    s_cmp_ge_u32 s64, 63
    s_cbranch_scc1 fend_24
    s_cmp_ge_u32 s64, 60
    s_cbranch_scc1 fxdata_29
    v_mov_b32 v9, s76
    s_waitcnt vmcnt(0)
    s_mov_b64 exec, 1
    buffer_store_dword v9, off, s[32:35], s70 sc1
    s_mov_b64 exec, -1
    s_branch fwait_21
fend_24:
fdata_32:
    s_add_u32 s57, s80, 5046272
    buffer_load_dwordx2 v[64:65], v8, s[32:35], s57 offen sc1
    buffer_load_dwordx4 v[16:19], v6, s[32:35], s79 offen sc1
    s_add_u32 s79, s79, 147456
    buffer_load_dwordx4 v[20:23], v6, s[32:35], s79 offen sc1
    s_add_u32 s79, s79, 147456
    buffer_load_dwordx4 v[24:27], v6, s[32:35], s79 offen sc1
    s_add_u32 s79, s79, 147456
    buffer_load_dwordx4 v[28:31], v6, s[32:35], s79 offen sc1
    s_add_u32 s79, s79, 147456
    buffer_load_dwordx4 v[32:35], v6, s[32:35], s79 offen sc1
    s_add_u32 s79, s79, 147456
    buffer_load_dwordx4 v[36:39], v6, s[32:35], s79 offen sc1
    s_add_u32 s79, s79, 147456
    buffer_load_dwordx4 v[40:43], v6, s[32:35], s79 offen sc1
    s_add_u32 s79, s79, 147456
    buffer_load_dwordx4 v[44:47], v6, s[32:35], s79 offen sc1
    s_add_u32 s79, s79, 147456
    buffer_load_dwordx4 v[48:51], v6, s[32:35], s79 offen sc1
    s_add_u32 s79, s79, 147456
    s_waitcnt vmcnt(8)
    v_mfma_f32_16x16x32_bf16 v[68:71], v[12:15], v[16:19], 0
    s_waitcnt vmcnt(7)
    v_mfma_f32_16x16x32_bf16 v[68:71], v[12:15], v[20:23], v[68:71]
    s_waitcnt vmcnt(6)
    v_mfma_f32_16x16x32_bf16 v[68:71], v[12:15], v[24:27], v[68:71]
    s_waitcnt vmcnt(5)
    v_mfma_f32_16x16x32_bf16 v[68:71], v[12:15], v[28:31], v[68:71]
    s_waitcnt vmcnt(4)
    v_mfma_f32_16x16x32_bf16 v[68:71], v[12:15], v[32:35], v[68:71]
    s_waitcnt vmcnt(3)
    v_mfma_f32_16x16x32_bf16 v[68:71], v[12:15], v[36:39], v[68:71]
    s_waitcnt vmcnt(2)
    v_mfma_f32_16x16x32_bf16 v[68:71], v[12:15], v[40:43], v[68:71]
    s_waitcnt vmcnt(1)
    v_mfma_f32_16x16x32_bf16 v[68:71], v[12:15], v[44:47], v[68:71]
    s_waitcnt vmcnt(0)
    v_mfma_f32_16x16x32_bf16 v[68:71], v[12:15], v[48:51], v[68:71]
    s_nop 7
    v_cvt_pk_bf16_f32 v68, v68, v69
    v_and_b32 v69, s77, v68
    v_lshlrev_b32 v68, 16, v68
    v_lshlrev_b32 v66, 16, v64
    v_and_b32 v67, s77, v64
    v_add_f32 v68, v68, v66
    v_add_f32 v69, v69, v67
    v_cvt_pk_bf16_f32 v64, v68, v69
    v_cvt_pk_bf16_f32 v70, v70, v71
    v_and_b32 v71, s77, v70
    v_lshlrev_b32 v70, 16, v70
    v_lshlrev_b32 v66, 16, v65
    v_and_b32 v67, s77, v65
    v_add_f32 v70, v70, v66
    v_add_f32 v71, v71, v67
    v_cvt_pk_bf16_f32 v65, v70, v71
    buffer_store_dwordx2 v[64:65], v8, s[48:51], s80 offen
    v_max_u32 v9, v64, v65
    v_cmp_le_u32 vcc, 0xffc00000, v9
    s_sub_u32 s79, s79, 1327104
    s_sub_i32 s54, s54, 1
    s_cmp_lt_i32 s54, 0
    s_cselect_b64 vcc, 0, vcc
    s_cbranch_vccnz fdata_32
fdata_33:
    s_add_u32 s57, s75, 5046272
    buffer_load_dwordx2 v[64:65], v8, s[32:35], s57 offen sc1
    buffer_load_dwordx4 v[16:19], v6, s[32:35], s74 offen sc1
    s_add_u32 s74, s74, 147456
    buffer_load_dwordx4 v[20:23], v6, s[32:35], s74 offen sc1
    s_add_u32 s74, s74, 147456
    buffer_load_dwordx4 v[24:27], v6, s[32:35], s74 offen sc1
    s_add_u32 s74, s74, 147456
    buffer_load_dwordx4 v[28:31], v6, s[32:35], s74 offen sc1
    s_add_u32 s74, s74, 147456
    buffer_load_dwordx4 v[32:35], v6, s[32:35], s74 offen sc1
    s_add_u32 s74, s74, 147456
    buffer_load_dwordx4 v[36:39], v6, s[32:35], s74 offen sc1
    s_add_u32 s74, s74, 147456
    buffer_load_dwordx4 v[40:43], v6, s[32:35], s74 offen sc1
    s_add_u32 s74, s74, 147456
    buffer_load_dwordx4 v[44:47], v6, s[32:35], s74 offen sc1
    s_add_u32 s74, s74, 147456
    buffer_load_dwordx4 v[48:51], v6, s[32:35], s74 offen sc1
    s_add_u32 s74, s74, 147456
    s_waitcnt vmcnt(8)
    v_mfma_f32_16x16x32_bf16 v[68:71], v[12:15], v[16:19], 0
    s_waitcnt vmcnt(7)
    v_mfma_f32_16x16x32_bf16 v[68:71], v[12:15], v[20:23], v[68:71]
    s_waitcnt vmcnt(6)
    v_mfma_f32_16x16x32_bf16 v[68:71], v[12:15], v[24:27], v[68:71]
    s_waitcnt vmcnt(5)
    v_mfma_f32_16x16x32_bf16 v[68:71], v[12:15], v[28:31], v[68:71]
    s_waitcnt vmcnt(4)
    v_mfma_f32_16x16x32_bf16 v[68:71], v[12:15], v[32:35], v[68:71]
    s_waitcnt vmcnt(3)
    v_mfma_f32_16x16x32_bf16 v[68:71], v[12:15], v[36:39], v[68:71]
    s_waitcnt vmcnt(2)
    v_mfma_f32_16x16x32_bf16 v[68:71], v[12:15], v[40:43], v[68:71]
    s_waitcnt vmcnt(1)
    v_mfma_f32_16x16x32_bf16 v[68:71], v[12:15], v[44:47], v[68:71]
    s_waitcnt vmcnt(0)
    v_mfma_f32_16x16x32_bf16 v[68:71], v[12:15], v[48:51], v[68:71]
    s_nop 7
    v_cvt_pk_bf16_f32 v68, v68, v69
    v_and_b32 v69, s77, v68
    v_lshlrev_b32 v68, 16, v68
    v_lshlrev_b32 v66, 16, v64
    v_and_b32 v67, s77, v64
    v_add_f32 v68, v68, v66
    v_add_f32 v69, v69, v67
    v_cvt_pk_bf16_f32 v64, v68, v69
    v_cvt_pk_bf16_f32 v70, v70, v71
    v_and_b32 v71, s77, v70
    v_lshlrev_b32 v70, 16, v70
    v_lshlrev_b32 v66, 16, v65
    v_and_b32 v67, s77, v65
    v_add_f32 v70, v70, v66
    v_add_f32 v71, v71, v67
    v_cvt_pk_bf16_f32 v65, v70, v71
    buffer_store_dwordx2 v[64:65], v8, s[48:51], s75 offen
    v_max_u32 v9, v64, v65
    v_cmp_le_u32 vcc, 0xffc00000, v9
    s_sub_u32 s74, s74, 1327104
    s_sub_i32 s54, s54, 1
    s_cmp_lt_i32 s54, 0
    s_cselect_b64 vcc, 0, vcc
    s_cbranch_vccnz fdata_33
    s_waitcnt vmcnt(0)
    s_endpgm
fpoll_22:
fq_34:
    buffer_load_dword v9, v7, s[32:35], s71 offen sc1
    s_sub_i32 s54, s54, 1
    s_cmp_lt_i32 s54, 0
    s_waitcnt vmcnt(0)
    s_cbranch_scc1 fqd_35
    v_cmp_gt_u32 vcc, s81, v9
    s_cbranch_vccz fqd_35
    s_sleep 1
    s_branch fq_34
fqd_35:
    s_branch fpret_23
fxdata_29:
    v_add_u32 v9, s83, v1
fx_36:
    s_add_u32 m0, s83, 0
    s_add_u32 s59, s66, 0
    buffer_load_dwordx4 v1, s[32:35], s59 offen offset:0 sc1 lds
    buffer_load_dwordx4 v1, s[32:35], s59 offen offset:1024 sc1 lds
    buffer_load_dwordx4 v1, s[32:35], s59 offen offset:2048 sc1 lds
    buffer_load_dwordx4 v1, s[32:35], s59 offen offset:3072 sc1 lds
    s_add_u32 m0, s83, 4096
    s_add_u32 s59, s66, 4096
    buffer_load_dwordx4 v1, s[32:35], s59 offen offset:0 sc1 lds
    buffer_load_dwordx4 v1, s[32:35], s59 offen offset:1024 sc1 lds
    buffer_load_dwordx4 v1, s[32:35], s59 offen offset:2048 sc1 lds
    buffer_load_dwordx4 v1, s[32:35], s59 offen offset:3072 sc1 lds
    s_add_u32 m0, s83, 8192
    s_add_u32 s59, s66, 8192
    buffer_load_dwordx4 v1, s[32:35], s59 offen offset:0 sc1 lds
    s_sub_i32 s54, s54, 1
    s_cmp_lt_i32 s54, 0
    s_waitcnt vmcnt(0)
    s_cbranch_scc1 fxd_37
    ds_read_b128 v[16:19], v9 offset:0
    ds_read_b128 v[20:23], v9 offset:1024
    ds_read_b128 v[24:27], v9 offset:2048
    ds_read_b128 v[28:31], v9 offset:3072
    ds_read_b128 v[32:35], v9 offset:4096
    ds_read_b128 v[36:39], v9 offset:5120
    ds_read_b128 v[40:43], v9 offset:6144
    ds_read_b128 v[44:47], v9 offset:7168
    ds_read_b128 v[48:51], v9 offset:8192
    s_waitcnt lgkmcnt(0)
    v_max3_u32 v16, v16, v17, v18
    v_max3_u32 v16, v16, v19, v20
    v_max3_u32 v16, v16, v21, v22
    v_max3_u32 v16, v16, v23, v24
    v_max3_u32 v16, v16, v25, v26
    v_max3_u32 v16, v16, v27, v28
    v_max3_u32 v16, v16, v29, v30
    v_max3_u32 v16, v16, v31, v32
    v_max3_u32 v16, v16, v33, v34
    v_max3_u32 v16, v16, v35, v36
    v_max3_u32 v16, v16, v37, v38
    v_max3_u32 v16, v16, v39, v40
    v_max3_u32 v16, v16, v41, v42
    v_max3_u32 v16, v16, v43, v44
    v_max3_u32 v16, v16, v45, v46
    v_max3_u32 v16, v16, v47, v48
    v_max3_u32 v16, v16, v49, v50
    v_max3_u32 v16, v16, v51, v51
    v_cmp_le_u32 vcc, 0xffc00000, v16
    s_cbranch_vccz fxd_37
    s_sleep 1
    s_branch fx_36
fxd_37:
    s_branch floop_20
L_team:
    s_mov_b32 s36, s8
    s_and_b32 s37, s9, 0xffff
    s_mov_b32 s38, 4718592
    s_mov_b32 s39, 0x20000
    s_mov_b32 s40, s10
    s_and_b32 s41, s11, 0xffff
    s_mov_b32 s42, 4718592
    s_mov_b32 s43, 0x20000
    s_mov_b32 s44, s12
    s_and_b32 s45, s13, 0xffff
    s_mov_b32 s46, 4718592
    s_mov_b32 s47, 0x20000
    s_mov_b32 s48, s14
    s_and_b32 s49, s15, 0xffff
    s_mov_b32 s50, 4718592
    s_mov_b32 s51, 0x20000
    v_mov_b32 v24, v0
    v_lshlrev_b32 v0, 4, v24
    s_lshl_b32 s56, s52, 10
    s_lshl_b32 s60, s53, 8
    s_mul_i32 s61, s53, 147456
    s_mul_i32 s57, s52, 18432
    s_add_u32 s61, s61, s57
    s_mul_i32 s62, s52, 9248
    s_lshl_b32 s57, s53, 2
    s_add_u32 s81, s57, s52
    s_lshl_b32 s63, s52, 12
    v_add_u32 v1, s63, v0
    s_lshl_b32 s57, s52, 1
    s_lshl_b32 s58, s52, 2
    v_bfe_u32 v31, v24, 4, 1
    v_or_b32 v31, s57, v31
    v_lshlrev_b32 v31, 1, v31
    v_and_b32 v32, 15, v24
    v_xor_b32 v31, v31, v32
    v_lshlrev_b32 v31, 4, v31
    v_lshrrev_b32 v32, 4, v24
    v_add_u32 v32, s58, v32
    v_lshl_add_u32 v25, v32, 13, v31
    v_bfe_u32 v31, v24, 2, 1
    v_bfe_u32 v32, v24, 3, 1
    v_bfe_u32 v33, v24, 4, 1
    v_bfe_u32 v34, v24, 5, 1
    v_and_b32 v35, 3, v24
    v_lshl_add_u32 v36, v33, 1, v31
    v_lshl_add_u32 v36, v32, 2, v36
    v_xor_b32 v36, s57, v36
    v_lshlrev_b32 v36, 5, v36
    v_lshl_add_u32 v36, v35, 3, v36
    v_lshl_add_u32 v36, v31, 8, v36
    v_lshl_add_u32 v36, v33, 10, v36
    v_lshl_add_u32 v36, v32, 11, v36
    v_lshl_add_u32 v26, v34, 12, v36
    v_xor_b32 v27, 32, v26
    v_lshl_add_u32 v36, v32, 1, v33
    v_mul_u32_u24 v36, 9248, v36
    v_lshl_add_u32 v37, v34, 2, v31
    v_mul_u32_u24 v37, 1152, v37
    v_add_u32 v36, v36, v37
    v_lshl_add_u32 v36, v35, 3, v36
    s_lshl_b32 s57, s52, 5
    v_add_u32 v28, s57, v36
    v_add_u32 v23, 114688, v1
    s_add_u32 m0, s62, 0
    s_add_u32 s59, s61, 0
    buffer_load_dwordx4 v0, s[48:51], s59 offen offset:0 lds
    buffer_load_dwordx4 v0, s[48:51], s59 offen offset:1024 lds
    buffer_load_dwordx4 v0, s[48:51], s59 offen offset:2048 lds
    buffer_load_dwordx4 v0, s[48:51], s59 offen offset:3072 lds
    s_add_u32 m0, s62, 4096
    s_add_u32 s59, s61, 4096
    buffer_load_dwordx4 v0, s[48:51], s59 offen offset:0 lds
    buffer_load_dwordx4 v0, s[48:51], s59 offen offset:1024 lds
    buffer_load_dwordx4 v0, s[48:51], s59 offen offset:2048 lds
    buffer_load_dwordx4 v0, s[48:51], s59 offen offset:3072 lds
    s_add_u32 m0, s62, 8192
    s_add_u32 s59, s61, 8192
    buffer_load_dwordx4 v0, s[48:51], s59 offen offset:0 lds
    s_add_u32 m0, s62, 36992
    s_add_u32 s59, s61, 9216
    buffer_load_dwordx4 v0, s[48:51], s59 offen offset:0 lds
    buffer_load_dwordx4 v0, s[48:51], s59 offen offset:1024 lds
    buffer_load_dwordx4 v0, s[48:51], s59 offen offset:2048 lds
    buffer_load_dwordx4 v0, s[48:51], s59 offen offset:3072 lds
    s_add_u32 m0, s62, 41088
    s_add_u32 s59, s61, 13312
    buffer_load_dwordx4 v0, s[48:51], s59 offen offset:0 lds
    buffer_load_dwordx4 v0, s[48:51], s59 offen offset:1024 lds
    buffer_load_dwordx4 v0, s[48:51], s59 offen offset:2048 lds
    buffer_load_dwordx4 v0, s[48:51], s59 offen offset:3072 lds
    s_add_u32 m0, s62, 45184
    s_add_u32 s59, s61, 17408
    buffer_load_dwordx4 v0, s[48:51], s59 offen offset:0 lds
    s_add_u32 m0, s62, 73984
    s_add_u32 s59, s61, 73728
    buffer_load_dwordx4 v0, s[48:51], s59 offen offset:0 lds
    buffer_load_dwordx4 v0, s[48:51], s59 offen offset:1024 lds
    buffer_load_dwordx4 v0, s[48:51], s59 offen offset:2048 lds
    buffer_load_dwordx4 v0, s[48:51], s59 offen offset:3072 lds
    s_add_u32 m0, s62, 78080
    s_add_u32 s59, s61, 77824
    buffer_load_dwordx4 v0, s[48:51], s59 offen offset:0 lds
    buffer_load_dwordx4 v0, s[48:51], s59 offen offset:1024 lds
    buffer_load_dwordx4 v0, s[48:51], s59 offen offset:2048 lds
    buffer_load_dwordx4 v0, s[48:51], s59 offen offset:3072 lds
    s_add_u32 m0, s62, 82176
    s_add_u32 s59, s61, 81920
    buffer_load_dwordx4 v0, s[48:51], s59 offen offset:0 lds
    v_and_b32 v31, 15, v24
    v_lshrrev_b32 v32, 4, v24
    v_lshrrev_b32 v33, 2, v31
    v_and_b32 v34, 1, v24
    v_bfe_u32 v35, v24, 1, 1
    v_lshl_add_u32 v36, v33, 1, v34
    v_mov_b32 v41, 0x3f80
    v_lshlrev_b32 v38, 4, v34
    v_lshlrev_b32 v37, v38, v41
    v_cmp_eq_u32 vcc, v32, v33
    s_nop 1
    v_cndmask_b32 v8, 0, v37, vcc
    v_mul_u32_u24 v9, 0xaaaa, v35
    v_add_u32 v9, 0x4444, v9
    v_mov_b32 v10, 0x3f803f80
    v_mov_b32 v11, 0x3f803f80
    v_mov_b32 v12, 0
    v_mov_b32 v13, 0
    v_mov_b32 v14, 0
    v_mov_b32 v15, -1
    v_lshl_add_u32 v38, v32, 3, v36
    v_lshlrev_b32 v38, 4, v38
    s_lshl_b32 s57, s52, 9
    v_add_u32 v5, s57, v38
    v_add_u32 v3, s56, v38
    v_lshl_add_u32 v6, v35, 9, v38
    v_lshl_add_u32 v7, v35, 3, v5
    s_mov_b32 s94, 0xcccccccc
    s_mov_b32 s95, 0xcccccccc
    v_lshrrev_b32 v38, 5, v24
    v_and_b32 v39, 31, v24
    v_lshlrev_b32 v39, 2, v39
    v_lshl_add_u32 v2, v38, 12, v39
    v_lshlrev_b32 v39, 6, v33
    v_lshl_add_u32 v39, v35, 5, v39
    v_lshl_add_u32 v39, v38, 4, v39
    v_lshl_add_u32 v39, v34, 3, v39
    v_bfe_u32 v40, v24, 4, 1
    v_lshl_add_u32 v39, v40, 2, v39
    v_mov_b32 v40, 2130706432
    v_cmp_gt_u32 vcc, 8, v31
    s_nop 1
    v_cndmask_b32 v4, v40, v39, vcc
    v_lshrrev_b32 v38, 3, v31
    v_lshlrev_b32 v38, 4, v38
    v_lshlrev_b32 v37, v38, v41
    v_and_b32 v38, 1, v33
    v_lshl_add_u32 v38, v38, 1, v34
    v_lshl_add_u32 v38, v35, 2, v38
    v_cmp_eq_u32 vcc, 0, v38
    s_nop 1
    v_cndmask_b32 v16, 0, v37, vcc
    v_cmp_eq_u32 vcc, 1, v38
    s_nop 1
    v_cndmask_b32 v17, 0, v37, vcc
    v_cmp_eq_u32 vcc, 2, v38
    s_nop 1
    v_cndmask_b32 v18, 0, v37, vcc
    v_cmp_eq_u32 vcc, 3, v38
    s_nop 1
    v_cndmask_b32 v19, 0, v37, vcc
    v_mul_u32_u24 v38, 1152, v36
    v_lshl_add_u32 v38, v35, 4, v38
    v_lshl_add_u32 v39, v32, 5, v38
    s_lshl_b32 s57, s52, 7
    v_add_u32 v38, s57, v39
    global_load_dwordx4 v[64:67], v38, s[6:7]
    global_load_dwordx4 v[68:71], v38, s[6:7] offset:512
    global_load_dwordx4 v[36:39], v39, s[6:7] offset:1024
    s_mov_b32 s64, 0
    s_lshl_b32 s57, s53, 7
    s_lshl_b32 s58, s52, 13
    s_add_u32 s65, s57, s58
    s_add_u32 s65, s65, 8388608
    s_mul_i32 s57, s52, 40
    s_cmp_lt_u32 s52, 2
    s_cselect_b32 s57, s57, 32
    s_cselect_b32 s58, 72, 40
    s_add_u32 s57, s57, s53
    s_lshl_b32 s68, s57, 12
    s_add_u32 s68, s68, 8388608
    s_lshl_b32 s70, s57, 7
    s_add_u32 s70, s70, 7405568
    s_mov_b32 s69, 2130706432
    s_cmp_lt_u32 s57, s58
    s_cselect_b32 s66, s70, s69
    s_mov_b32 s85, 7405568
    s_cmp_eq_u32 s53, 8
    s_cselect_b32 s74, 7417856, s69
    s_mov_b32 s99, 0
    s_mov_b32 s67, 2130706432
    s_mul_i32 s72, s53, 24576
    s_add_u32 s83, s72, 22028288
    s_lshl_b32 s57, s52, 11
    s_add_u32 s72, s83, s57
    s_add_u32 s73, s72, 8192
    s_add_u32 s83, s83, 786432
    s_mov_b32 s75, 0x3e0293ee
    s_mul_i32 s77, s53, 4096
    s_add_u32 s77, s77, 10485760
    s_add_u32 s77, s77, s56
    s_lshl_b32 s57, s53, 7
    s_add_u32 s78, s57, 40960
    s_lshl_b32 s57, s53, 9
    s_add_u32 s79, s57, 16384
    s_waitcnt vmcnt(21) lgkmcnt(0)
    s_barrier
    v_add_u32 v29, 0, v28
    ds_read_b64_tr_b16 v[40:41], v29 offset:0
    ds_read_b64_tr_b16 v[42:43], v29 offset:2304
    ds_read_b64_tr_b16 v[44:45], v29 offset:512
    ds_read_b64_tr_b16 v[46:47], v29 offset:2816
    ds_read_b64_tr_b16 v[48:49], v29 offset:1024
    ds_read_b64_tr_b16 v[50:51], v29 offset:3328
    ds_read_b64_tr_b16 v[160:161], v29 offset:128
    ds_read_b64_tr_b16 v[162:163], v29 offset:2432
    ds_read_b64_tr_b16 v[176:177], v29 offset:256
    ds_read_b64_tr_b16 v[178:179], v29 offset:2560
    ds_read_b64_tr_b16 v[192:193], v29 offset:384
    ds_read_b64_tr_b16 v[194:195], v29 offset:2688
    ds_read_b64_tr_b16 v[208:209], v29 offset:640
    ds_read_b64_tr_b16 v[210:211], v29 offset:2944
    ds_read_b64_tr_b16 v[224:225], v29 offset:768
    ds_read_b64_tr_b16 v[226:227], v29 offset:3072
    ds_read_b64_tr_b16 v[240:241], v29 offset:896
    ds_read_b64_tr_b16 v[242:243], v29 offset:3200
    s_waitcnt lgkmcnt(12)
    ds_write_b128 v23, v[40:43] offset:0
    ds_write_b128 v23, v[44:47] offset:16384
    ds_write_b128 v23, v[48:51] offset:32768
    s_waitcnt vmcnt(12) lgkmcnt(0)
    s_barrier
    s_add_u32 m0, s62, 0
    s_add_u32 s59, s61, 82944
    buffer_load_dwordx4 v0, s[48:51], s59 offen offset:0 lds
    buffer_load_dwordx4 v0, s[48:51], s59 offen offset:1024 lds
    buffer_load_dwordx4 v0, s[48:51], s59 offen offset:2048 lds
    buffer_load_dwordx4 v0, s[48:51], s59 offen offset:3072 lds
    s_add_u32 m0, s62, 4096
    s_add_u32 s59, s61, 87040
    buffer_load_dwordx4 v0, s[48:51], s59 offen offset:0 lds
    buffer_load_dwordx4 v0, s[48:51], s59 offen offset:1024 lds
    buffer_load_dwordx4 v0, s[48:51], s59 offen offset:2048 lds
    buffer_load_dwordx4 v0, s[48:51], s59 offen offset:3072 lds
    s_add_u32 m0, s62, 8192
    s_add_u32 s59, s61, 91136
    buffer_load_dwordx4 v0, s[48:51], s59 offen offset:0 lds
    v_add_u32 v29, 36992, v28
    ds_read_b64_tr_b16 v[40:41], v29 offset:0
    ds_read_b64_tr_b16 v[42:43], v29 offset:2304
    ds_read_b64_tr_b16 v[44:45], v29 offset:512
    ds_read_b64_tr_b16 v[46:47], v29 offset:2816
    ds_read_b64_tr_b16 v[48:49], v29 offset:1024
    ds_read_b64_tr_b16 v[50:51], v29 offset:3328
    ds_read_b64_tr_b16 v[164:165], v29 offset:128
    ds_read_b64_tr_b16 v[166:167], v29 offset:2432
    ds_read_b64_tr_b16 v[180:181], v29 offset:256
    ds_read_b64_tr_b16 v[182:183], v29 offset:2560
    ds_read_b64_tr_b16 v[196:197], v29 offset:384
    ds_read_b64_tr_b16 v[198:199], v29 offset:2688
    ds_read_b64_tr_b16 v[212:213], v29 offset:640
    ds_read_b64_tr_b16 v[214:215], v29 offset:2944
    ds_read_b64_tr_b16 v[228:229], v29 offset:768
    ds_read_b64_tr_b16 v[230:231], v29 offset:3072
    ds_read_b64_tr_b16 v[244:245], v29 offset:896
    ds_read_b64_tr_b16 v[246:247], v29 offset:3200
    s_waitcnt lgkmcnt(12)
    ds_write_b128 v23, v[40:43] offset:1024
    ds_write_b128 v23, v[44:47] offset:17408
    ds_write_b128 v23, v[48:51] offset:33792
    s_waitcnt vmcnt(12) lgkmcnt(0)
    s_barrier
    s_add_u32 m0, s56, 49152
    s_add_u32 s59, s60, 524288
    buffer_load_dwordx4 v25, s[36:39], s59 offen lds
    s_add_u32 m0, s56, 53248
    s_add_u32 s59, s60, 655360
    buffer_load_dwordx4 v25, s[36:39], s59 offen lds
    s_add_u32 m0, s56, 57344
    s_add_u32 s59, s60, 786432
    buffer_load_dwordx4 v25, s[36:39], s59 offen lds
    s_add_u32 m0, s56, 61440
    s_add_u32 s59, s60, 917504
    buffer_load_dwordx4 v25, s[36:39], s59 offen lds
    v_add_u32 v29, 73984, v28
    ds_read_b64_tr_b16 v[40:41], v29 offset:0
    ds_read_b64_tr_b16 v[42:43], v29 offset:2304
    ds_read_b64_tr_b16 v[44:45], v29 offset:512
    ds_read_b64_tr_b16 v[46:47], v29 offset:2816
    ds_read_b64_tr_b16 v[48:49], v29 offset:1024
    ds_read_b64_tr_b16 v[50:51], v29 offset:3328
    ds_read_b64_tr_b16 v[168:169], v29 offset:128
    ds_read_b64_tr_b16 v[170:171], v29 offset:2432
    ds_read_b64_tr_b16 v[184:185], v29 offset:256
    ds_read_b64_tr_b16 v[186:187], v29 offset:2560
    ds_read_b64_tr_b16 v[200:201], v29 offset:384
    ds_read_b64_tr_b16 v[202:203], v29 offset:2688
    ds_read_b64_tr_b16 v[216:217], v29 offset:640
    ds_read_b64_tr_b16 v[218:219], v29 offset:2944
    ds_read_b64_tr_b16 v[232:233], v29 offset:768
    ds_read_b64_tr_b16 v[234:235], v29 offset:3072
    ds_read_b64_tr_b16 v[248:249], v29 offset:896
    ds_read_b64_tr_b16 v[250:251], v29 offset:3200
    s_waitcnt lgkmcnt(12)
    ds_write_b128 v23, v[40:43] offset:2048
    ds_write_b128 v23, v[44:47] offset:18432
    ds_write_b128 v23, v[48:51] offset:34816
    s_waitcnt vmcnt(4) lgkmcnt(0)
    s_barrier
    s_add_u32 m0, s56, 65536
    s_add_u32 s59, s60, 1048576
    buffer_load_dwordx4 v25, s[36:39], s59 offen lds
    s_add_u32 m0, s56, 69632
    s_add_u32 s59, s60, 1179648
    buffer_load_dwordx4 v25, s[36:39], s59 offen lds
    s_add_u32 m0, s56, 73728
    s_add_u32 s59, s60, 1310720
    buffer_load_dwordx4 v25, s[36:39], s59 offen lds
    s_add_u32 m0, s56, 77824
    s_add_u32 s59, s60, 1441792
    buffer_load_dwordx4 v25, s[36:39], s59 offen lds
    s_add_u32 m0, s56, 81920
    s_add_u32 s59, s60, 1572864
    buffer_load_dwordx4 v25, s[36:39], s59 offen lds
    s_add_u32 m0, s56, 86016
    s_add_u32 s59, s60, 1703936
    buffer_load_dwordx4 v25, s[36:39], s59 offen lds
    s_add_u32 m0, s56, 90112
    s_add_u32 s59, s60, 1835008
    buffer_load_dwordx4 v25, s[36:39], s59 offen lds
    s_add_u32 m0, s56, 94208
    s_add_u32 s59, s60, 1966080
    buffer_load_dwordx4 v25, s[36:39], s59 offen lds
    s_add_u32 m0, s56, 98304
    s_add_u32 s59, s60, 2621440
    buffer_load_dwordx4 v25, s[36:39], s59 offen lds
    s_add_u32 m0, s56, 102400
    s_add_u32 s59, s60, 2752512
    buffer_load_dwordx4 v25, s[36:39], s59 offen lds
    s_add_u32 m0, s56, 106496
    s_add_u32 s59, s60, 2883584
    buffer_load_dwordx4 v25, s[36:39], s59 offen lds
    s_add_u32 m0, s56, 110592
    s_add_u32 s59, s60, 3014656
    buffer_load_dwordx4 v25, s[36:39], s59 offen lds
    v_add_u32 v29, 0, v28
    ds_read_b64_tr_b16 v[40:41], v29 offset:0
    ds_read_b64_tr_b16 v[42:43], v29 offset:2304
    ds_read_b64_tr_b16 v[44:45], v29 offset:512
    ds_read_b64_tr_b16 v[46:47], v29 offset:2816
    ds_read_b64_tr_b16 v[48:49], v29 offset:1024
    ds_read_b64_tr_b16 v[50:51], v29 offset:3328
    ds_read_b64_tr_b16 v[172:173], v29 offset:128
    ds_read_b64_tr_b16 v[174:175], v29 offset:2432
    ds_read_b64_tr_b16 v[188:189], v29 offset:256
    ds_read_b64_tr_b16 v[190:191], v29 offset:2560
    ds_read_b64_tr_b16 v[204:205], v29 offset:384
    ds_read_b64_tr_b16 v[206:207], v29 offset:2688
    ds_read_b64_tr_b16 v[220:221], v29 offset:640
    ds_read_b64_tr_b16 v[222:223], v29 offset:2944
    ds_read_b64_tr_b16 v[236:237], v29 offset:768
    ds_read_b64_tr_b16 v[238:239], v29 offset:3072
    ds_read_b64_tr_b16 v[252:253], v29 offset:896
    ds_read_b64_tr_b16 v[254:255], v29 offset:3200
    s_waitcnt lgkmcnt(12)
    ds_write_b128 v23, v[40:43] offset:3072
    ds_write_b128 v23, v[44:47] offset:19456
    ds_write_b128 v23, v[48:51] offset:35840
    s_waitcnt vmcnt(12) lgkmcnt(0)
    s_barrier
    s_add_u32 m0, s56, 0
    s_add_u32 s59, s60, 3670016
    buffer_load_dwordx4 v25, s[36:39], s59 offen lds
    s_add_u32 m0, s56, 4096
    s_add_u32 s59, s60, 3801088
    buffer_load_dwordx4 v25, s[36:39], s59 offen lds
    s_add_u32 m0, s56, 8192
    s_add_u32 s59, s60, 3932160
    buffer_load_dwordx4 v25, s[36:39], s59 offen lds
    s_add_u32 m0, s56, 12288
    s_add_u32 s59, s60, 4063232
    buffer_load_dwordx4 v25, s[36:39], s59 offen lds
    s_add_u32 m0, s56, 16384
    s_add_u32 s59, s60, 4194304
    buffer_load_dwordx4 v25, s[36:39], s59 offen lds
    s_add_u32 m0, s56, 20480
    s_add_u32 s59, s60, 4325376
    buffer_load_dwordx4 v25, s[36:39], s59 offen lds
    s_add_u32 m0, s56, 24576
    s_add_u32 s59, s60, 4456448
    buffer_load_dwordx4 v25, s[36:39], s59 offen lds
    s_add_u32 m0, s56, 28672
    s_add_u32 s59, s60, 4587520
    buffer_load_dwordx4 v25, s[36:39], s59 offen lds
    s_add_u32 m0, s56, 32768
    s_add_u32 s59, s60, 0
    buffer_load_dwordx4 v25, s[40:43], s59 offen lds
    s_add_u32 m0, s56, 36864
    s_add_u32 s59, s60, 131072
    buffer_load_dwordx4 v25, s[40:43], s59 offen lds
    s_add_u32 m0, s56, 40960
    s_add_u32 s59, s60, 262144
    buffer_load_dwordx4 v25, s[40:43], s59 offen lds
    s_add_u32 m0, s56, 45056
    s_add_u32 s59, s60, 393216
    buffer_load_dwordx4 v25, s[40:43], s59 offen lds
    v_add_u32 v29, 49152, v26
    v_add_u32 v30, 49152, v27
    ds_read_b64_tr_b16 a[0:1], v29 offset:0
    ds_read_b64_tr_b16 a[2:3], v29 offset:512
    ds_read_b64_tr_b16 a[4:5], v29 offset:8192
    ds_read_b64_tr_b16 a[6:7], v29 offset:8704
    ds_read_b64_tr_b16 a[48:49], v30 offset:0
    ds_read_b64_tr_b16 a[50:51], v30 offset:512
    ds_read_b64_tr_b16 a[52:53], v30 offset:8192
    ds_read_b64_tr_b16 a[54:55], v30 offset:8704
    s_waitcnt vmcnt(20) lgkmcnt(0)
    s_barrier
    s_add_u32 m0, s56, 49152
    s_add_u32 s59, s60, 1048576
    buffer_load_dwordx4 v25, s[40:43], s59 offen lds
    s_add_u32 m0, s56, 53248
    s_add_u32 s59, s60, 1179648
    buffer_load_dwordx4 v25, s[40:43], s59 offen lds
    s_add_u32 m0, s56, 57344
    s_add_u32 s59, s60, 1310720
    buffer_load_dwordx4 v25, s[40:43], s59 offen lds
    s_add_u32 m0, s56, 61440
    s_add_u32 s59, s60, 1441792
    buffer_load_dwordx4 v25, s[40:43], s59 offen lds
    v_add_u32 v29, 65536, v26
    v_add_u32 v30, 65536, v27
    ds_read_b64_tr_b16 a[8:9], v29 offset:0
    ds_read_b64_tr_b16 a[10:11], v29 offset:512
    ds_read_b64_tr_b16 a[12:13], v29 offset:8192
    ds_read_b64_tr_b16 a[14:15], v29 offset:8704
    ds_read_b64_tr_b16 a[56:57], v30 offset:0
    ds_read_b64_tr_b16 a[58:59], v30 offset:512
    ds_read_b64_tr_b16 a[60:61], v30 offset:8192
    ds_read_b64_tr_b16 a[62:63], v30 offset:8704
    s_waitcnt vmcnt(20) lgkmcnt(0)
    s_barrier
    s_add_u32 m0, s56, 65536
    s_add_u32 s59, s60, 1572864
    buffer_load_dwordx4 v25, s[40:43], s59 offen lds
    s_add_u32 m0, s56, 69632
    s_add_u32 s59, s60, 1703936
    buffer_load_dwordx4 v25, s[40:43], s59 offen lds
    s_add_u32 m0, s56, 73728
    s_add_u32 s59, s60, 1835008
    buffer_load_dwordx4 v25, s[40:43], s59 offen lds
    s_add_u32 m0, s56, 77824
    s_add_u32 s59, s60, 1966080
    buffer_load_dwordx4 v25, s[40:43], s59 offen lds
    v_add_u32 v29, 81920, v26
    v_add_u32 v30, 81920, v27
    ds_read_b64_tr_b16 a[16:17], v29 offset:0
    ds_read_b64_tr_b16 a[18:19], v29 offset:512
    ds_read_b64_tr_b16 a[20:21], v29 offset:8192
    ds_read_b64_tr_b16 a[22:23], v29 offset:8704
    ds_read_b64_tr_b16 a[64:65], v30 offset:0
    ds_read_b64_tr_b16 a[66:67], v30 offset:512
    ds_read_b64_tr_b16 a[68:69], v30 offset:8192
    ds_read_b64_tr_b16 a[70:71], v30 offset:8704
    s_waitcnt vmcnt(20) lgkmcnt(0)
    s_barrier
    s_add_u32 m0, s56, 81920
    s_add_u32 s59, s60, 2097152
    buffer_load_dwordx4 v25, s[40:43], s59 offen lds
    s_add_u32 m0, s56, 86016
    s_add_u32 s59, s60, 2228224
    buffer_load_dwordx4 v25, s[40:43], s59 offen lds
    s_add_u32 m0, s56, 90112
    s_add_u32 s59, s60, 2359296
    buffer_load_dwordx4 v25, s[40:43], s59 offen lds
    s_add_u32 m0, s56, 94208
    s_add_u32 s59, s60, 2490368
    buffer_load_dwordx4 v25, s[40:43], s59 offen lds
    global_load_dword v72, v13, s[28:29] sc1
    global_load_dword v74, v13, s[28:29] offset:136 sc1
    v_add_u32 v29, 98304, v26
    v_add_u32 v30, 98304, v27
    ds_read_b64_tr_b16 a[24:25], v29 offset:0
    ds_read_b64_tr_b16 a[26:27], v29 offset:512
    ds_read_b64_tr_b16 a[28:29], v29 offset:8192
    ds_read_b64_tr_b16 a[30:31], v29 offset:8704
    ds_read_b64_tr_b16 a[72:73], v30 offset:0
    ds_read_b64_tr_b16 a[74:75], v30 offset:512
    ds_read_b64_tr_b16 a[76:77], v30 offset:8192
    ds_read_b64_tr_b16 a[78:79], v30 offset:8704
    s_waitcnt vmcnt(22) lgkmcnt(0)
    s_barrier
    s_add_u32 m0, s56, 98304
    s_add_u32 s59, s60, 2621440
    buffer_load_dwordx4 v25, s[40:43], s59 offen lds
    s_add_u32 m0, s56, 102400
    s_add_u32 s59, s60, 2752512
    buffer_load_dwordx4 v25, s[40:43], s59 offen lds
    s_add_u32 m0, s56, 106496
    s_add_u32 s59, s60, 2883584
    buffer_load_dwordx4 v25, s[40:43], s59 offen lds
    s_add_u32 m0, s56, 110592
    s_add_u32 s59, s60, 3014656
    buffer_load_dwordx4 v25, s[40:43], s59 offen lds
    v_add_u32 v29, 0, v26
    v_add_u32 v30, 0, v27
    ds_read_b64_tr_b16 a[32:33], v29 offset:0
    ds_read_b64_tr_b16 a[34:35], v29 offset:512
    ds_read_b64_tr_b16 a[36:37], v29 offset:8192
    ds_read_b64_tr_b16 a[38:39], v29 offset:8704
    ds_read_b64_tr_b16 a[80:81], v30 offset:0
    ds_read_b64_tr_b16 a[82:83], v30 offset:512
    ds_read_b64_tr_b16 a[84:85], v30 offset:8192
    ds_read_b64_tr_b16 a[86:87], v30 offset:8704
    s_waitcnt vmcnt(22) lgkmcnt(0)
    s_barrier
    s_add_u32 m0, s56, 0
    s_add_u32 s59, s60, 3670016
    buffer_load_dwordx4 v25, s[40:43], s59 offen lds
    s_add_u32 m0, s56, 4096
    s_add_u32 s59, s60, 3801088
    buffer_load_dwordx4 v25, s[40:43], s59 offen lds
    s_add_u32 m0, s56, 8192
    s_add_u32 s59, s60, 3932160
    buffer_load_dwordx4 v25, s[40:43], s59 offen lds
    s_add_u32 m0, s56, 12288
    s_add_u32 s59, s60, 4063232
    buffer_load_dwordx4 v25, s[40:43], s59 offen lds
    v_add_u32 v29, 16384, v26
    v_add_u32 v30, 16384, v27
    ds_read_b64_tr_b16 a[40:41], v29 offset:0
    ds_read_b64_tr_b16 a[42:43], v29 offset:512
    ds_read_b64_tr_b16 a[44:45], v29 offset:8192
    ds_read_b64_tr_b16 a[46:47], v29 offset:8704
    ds_read_b64_tr_b16 a[88:89], v30 offset:0
    ds_read_b64_tr_b16 a[90:91], v30 offset:512
    ds_read_b64_tr_b16 a[92:93], v30 offset:8192
    ds_read_b64_tr_b16 a[94:95], v30 offset:8704
    s_waitcnt vmcnt(22) lgkmcnt(0)
    s_barrier
    s_add_u32 m0, s56, 16384
    s_add_u32 s59, s60, 4194304
    buffer_load_dwordx4 v25, s[40:43], s59 offen lds
    s_add_u32 m0, s56, 20480
    s_add_u32 s59, s60, 4325376
    buffer_load_dwordx4 v25, s[40:43], s59 offen lds
    s_add_u32 m0, s56, 24576
    s_add_u32 s59, s60, 4456448
    buffer_load_dwordx4 v25, s[40:43], s59 offen lds
    s_add_u32 m0, s56, 28672
    s_add_u32 s59, s60, 4587520
    buffer_load_dwordx4 v25, s[40:43], s59 offen lds
    v_add_u32 v29, 32768, v26
    v_add_u32 v30, 32768, v27
    ds_read_b64_tr_b16 a[96:97], v29 offset:0
    ds_read_b64_tr_b16 a[98:99], v29 offset:512
    ds_read_b64_tr_b16 a[100:101], v29 offset:8192
    ds_read_b64_tr_b16 a[102:103], v29 offset:8704
    ds_read_b64_tr_b16 a[152:153], v30 offset:0
    ds_read_b64_tr_b16 a[154:155], v30 offset:512
    ds_read_b64_tr_b16 a[156:157], v30 offset:8192
    ds_read_b64_tr_b16 a[158:159], v30 offset:8704
    s_waitcnt vmcnt(22) lgkmcnt(0)
    s_barrier
    s_add_u32 m0, s56, 32768
    s_add_u32 s59, s60, 0
    buffer_load_dwordx4 v25, s[44:47], s59 offen lds
    s_add_u32 m0, s56, 36864
    s_add_u32 s59, s60, 131072
    buffer_load_dwordx4 v25, s[44:47], s59 offen lds
    s_add_u32 m0, s56, 40960
    s_add_u32 s59, s60, 262144
    buffer_load_dwordx4 v25, s[44:47], s59 offen lds
    s_add_u32 m0, s56, 45056
    s_add_u32 s59, s60, 393216
    buffer_load_dwordx4 v25, s[44:47], s59 offen lds
    v_add_u32 v29, 49152, v26
    v_add_u32 v30, 49152, v27
    ds_read_b64_tr_b16 a[104:105], v29 offset:0
    ds_read_b64_tr_b16 a[106:107], v29 offset:512
    ds_read_b64_tr_b16 a[108:109], v29 offset:8192
    ds_read_b64_tr_b16 a[110:111], v29 offset:8704
    ds_read_b64_tr_b16 a[160:161], v30 offset:0
    ds_read_b64_tr_b16 a[162:163], v30 offset:512
    ds_read_b64_tr_b16 a[164:165], v30 offset:8192
    ds_read_b64_tr_b16 a[166:167], v30 offset:8704
    s_waitcnt vmcnt(22) lgkmcnt(0)
    s_barrier
    s_add_u32 m0, s56, 49152
    s_add_u32 s59, s60, 524288
    buffer_load_dwordx4 v25, s[44:47], s59 offen lds
    s_add_u32 m0, s56, 53248
    s_add_u32 s59, s60, 655360
    buffer_load_dwordx4 v25, s[44:47], s59 offen lds
    s_add_u32 m0, s56, 57344
    s_add_u32 s59, s60, 786432
    buffer_load_dwordx4 v25, s[44:47], s59 offen lds
    s_add_u32 m0, s56, 61440
    s_add_u32 s59, s60, 917504
    buffer_load_dwordx4 v25, s[44:47], s59 offen lds
    v_add_u32 v29, 65536, v26
    v_add_u32 v30, 65536, v27
    ds_read_b64_tr_b16 a[112:113], v29 offset:0
    ds_read_b64_tr_b16 a[114:115], v29 offset:512
    ds_read_b64_tr_b16 a[116:117], v29 offset:8192
    ds_read_b64_tr_b16 a[118:119], v29 offset:8704
    ds_read_b64_tr_b16 a[168:169], v30 offset:0
    ds_read_b64_tr_b16 a[170:171], v30 offset:512
    ds_read_b64_tr_b16 a[172:173], v30 offset:8192
    ds_read_b64_tr_b16 a[174:175], v30 offset:8704
    s_waitcnt vmcnt(22) lgkmcnt(0)
    s_barrier
    s_add_u32 m0, s56, 65536
    s_add_u32 s59, s60, 1048576
    buffer_load_dwordx4 v25, s[44:47], s59 offen lds
    s_add_u32 m0, s56, 69632
    s_add_u32 s59, s60, 1179648
    buffer_load_dwordx4 v25, s[44:47], s59 offen lds
    s_add_u32 m0, s56, 73728
    s_add_u32 s59, s60, 1310720
    buffer_load_dwordx4 v25, s[44:47], s59 offen lds
    s_add_u32 m0, s56, 77824
    s_add_u32 s59, s60, 1441792
    buffer_load_dwordx4 v25, s[44:47], s59 offen lds
    v_add_u32 v29, 81920, v26
    v_add_u32 v30, 81920, v27
    ds_read_b64_tr_b16 a[120:121], v29 offset:0
    ds_read_b64_tr_b16 a[122:123], v29 offset:512
    ds_read_b64_tr_b16 a[124:125], v29 offset:8192
    ds_read_b64_tr_b16 a[126:127], v29 offset:8704
    ds_read_b64_tr_b16 a[176:177], v30 offset:0
    ds_read_b64_tr_b16 a[178:179], v30 offset:512
    ds_read_b64_tr_b16 a[180:181], v30 offset:8192
    ds_read_b64_tr_b16 a[182:183], v30 offset:8704
    s_waitcnt vmcnt(20) lgkmcnt(0)
    s_barrier
    s_add_u32 m0, s56, 81920
    s_add_u32 s59, s60, 1572864
    buffer_load_dwordx4 v25, s[44:47], s59 offen lds
    s_add_u32 m0, s56, 86016
    s_add_u32 s59, s60, 1703936
    buffer_load_dwordx4 v25, s[44:47], s59 offen lds
    s_add_u32 m0, s56, 90112
    s_add_u32 s59, s60, 1835008
    buffer_load_dwordx4 v25, s[44:47], s59 offen lds
    s_add_u32 m0, s56, 94208
    s_add_u32 s59, s60, 1966080
    buffer_load_dwordx4 v25, s[44:47], s59 offen lds
    v_add_u32 v29, 98304, v26
    v_add_u32 v30, 98304, v27
    ds_read_b64_tr_b16 a[128:129], v29 offset:0
    ds_read_b64_tr_b16 a[130:131], v29 offset:512
    ds_read_b64_tr_b16 a[132:133], v29 offset:8192
    ds_read_b64_tr_b16 a[134:135], v29 offset:8704
    ds_read_b64_tr_b16 a[184:185], v30 offset:0
    ds_read_b64_tr_b16 a[186:187], v30 offset:512
    ds_read_b64_tr_b16 a[188:189], v30 offset:8192
    ds_read_b64_tr_b16 a[190:191], v30 offset:8704
    s_waitcnt vmcnt(20) lgkmcnt(0)
    s_barrier
    s_add_u32 m0, s56, 98304
    s_add_u32 s59, s60, 2097152
    buffer_load_dwordx4 v25, s[44:47], s59 offen lds
    s_add_u32 m0, s56, 102400
    s_add_u32 s59, s60, 2228224
    buffer_load_dwordx4 v25, s[44:47], s59 offen lds
    s_add_u32 m0, s56, 106496
    s_add_u32 s59, s60, 2359296
    buffer_load_dwordx4 v25, s[44:47], s59 offen lds
    s_add_u32 m0, s56, 110592
    s_add_u32 s59, s60, 2490368
    buffer_load_dwordx4 v25, s[44:47], s59 offen lds
    v_add_u32 v29, 0, v26
    v_add_u32 v30, 0, v27
    ds_read_b64_tr_b16 a[136:137], v29 offset:0
    ds_read_b64_tr_b16 a[138:139], v29 offset:512
    ds_read_b64_tr_b16 a[140:141], v29 offset:8192
    ds_read_b64_tr_b16 a[142:143], v29 offset:8704
    ds_read_b64_tr_b16 a[192:193], v30 offset:0
    ds_read_b64_tr_b16 a[194:195], v30 offset:512
    ds_read_b64_tr_b16 a[196:197], v30 offset:8192
    ds_read_b64_tr_b16 a[198:199], v30 offset:8704
    s_waitcnt vmcnt(20) lgkmcnt(0)
    s_barrier
    s_add_u32 m0, s56, 0
    s_add_u32 s59, s60, 2621440
    buffer_load_dwordx4 v25, s[44:47], s59 offen lds
    s_add_u32 m0, s56, 4096
    s_add_u32 s59, s60, 2752512
    buffer_load_dwordx4 v25, s[44:47], s59 offen lds
    s_add_u32 m0, s56, 8192
    s_add_u32 s59, s60, 2883584
    buffer_load_dwordx4 v25, s[44:47], s59 offen lds
    s_add_u32 m0, s56, 12288
    s_add_u32 s59, s60, 3014656
    buffer_load_dwordx4 v25, s[44:47], s59 offen lds
    v_add_u32 v29, 16384, v26
    v_add_u32 v30, 16384, v27
    ds_read_b64_tr_b16 a[144:145], v29 offset:0
    ds_read_b64_tr_b16 a[146:147], v29 offset:512
    ds_read_b64_tr_b16 a[148:149], v29 offset:8192
    ds_read_b64_tr_b16 a[150:151], v29 offset:8704
    ds_read_b64_tr_b16 a[200:201], v30 offset:0
    ds_read_b64_tr_b16 a[202:203], v30 offset:512
    ds_read_b64_tr_b16 a[204:205], v30 offset:8192
    ds_read_b64_tr_b16 a[206:207], v30 offset:8704
    s_waitcnt vmcnt(20) lgkmcnt(0)
    s_barrier
    s_add_u32 m0, s56, 16384
    s_add_u32 s59, s60, 3145728
    buffer_load_dwordx4 v25, s[44:47], s59 offen lds
    s_add_u32 m0, s56, 20480
    s_add_u32 s59, s60, 3276800
    buffer_load_dwordx4 v25, s[44:47], s59 offen lds
    s_add_u32 m0, s56, 24576
    s_add_u32 s59, s60, 3407872
    buffer_load_dwordx4 v25, s[44:47], s59 offen lds
    s_add_u32 m0, s56, 28672
    s_add_u32 s59, s60, 3538944
    buffer_load_dwordx4 v25, s[44:47], s59 offen lds
    v_add_u32 v29, 32768, v26
    v_add_u32 v30, 32768, v27
    ds_read_b64_tr_b16 a[208:209], v29 offset:0
    ds_read_b64_tr_b16 a[210:211], v29 offset:512
    ds_read_b64_tr_b16 a[212:213], v29 offset:8192
    ds_read_b64_tr_b16 a[214:215], v29 offset:8704
    ds_read_b64_tr_b16 v[96:97], v30 offset:0
    ds_read_b64_tr_b16 v[98:99], v30 offset:512
    ds_read_b64_tr_b16 v[100:101], v30 offset:8192
    ds_read_b64_tr_b16 v[102:103], v30 offset:8704
    s_waitcnt vmcnt(20) lgkmcnt(0)
    s_barrier
    s_add_u32 m0, s56, 32768
    s_add_u32 s59, s60, 3670016
    buffer_load_dwordx4 v25, s[44:47], s59 offen lds
    s_add_u32 m0, s56, 36864
    s_add_u32 s59, s60, 3801088
    buffer_load_dwordx4 v25, s[44:47], s59 offen lds
    s_add_u32 m0, s56, 40960
    s_add_u32 s59, s60, 3932160
    buffer_load_dwordx4 v25, s[44:47], s59 offen lds
    s_add_u32 m0, s56, 45056
    s_add_u32 s59, s60, 4063232
    buffer_load_dwordx4 v25, s[44:47], s59 offen lds
    v_add_u32 v29, 49152, v26
    v_add_u32 v30, 49152, v27
    ds_read_b64_tr_b16 a[216:217], v29 offset:0
    ds_read_b64_tr_b16 a[218:219], v29 offset:512
    ds_read_b64_tr_b16 a[220:221], v29 offset:8192
    ds_read_b64_tr_b16 a[222:223], v29 offset:8704
    ds_read_b64_tr_b16 v[104:105], v30 offset:0
    ds_read_b64_tr_b16 v[106:107], v30 offset:512
    ds_read_b64_tr_b16 v[108:109], v30 offset:8192
    ds_read_b64_tr_b16 v[110:111], v30 offset:8704
    s_waitcnt vmcnt(20) lgkmcnt(0)
    s_barrier
    s_add_u32 m0, s56, 49152
    s_add_u32 s59, s60, 2097152
    buffer_load_dwordx4 v25, s[36:39], s59 offen lds
    s_add_u32 m0, s56, 53248
    s_add_u32 s59, s60, 2228224
    buffer_load_dwordx4 v25, s[36:39], s59 offen lds
    s_add_u32 m0, s56, 57344
    s_add_u32 s59, s60, 2359296
    buffer_load_dwordx4 v25, s[36:39], s59 offen lds
    s_add_u32 m0, s56, 61440
    s_add_u32 s59, s60, 2490368
    buffer_load_dwordx4 v25, s[36:39], s59 offen lds
    v_add_u32 v29, 65536, v26
    v_add_u32 v30, 65536, v27
    ds_read_b64_tr_b16 a[224:225], v29 offset:0
    ds_read_b64_tr_b16 a[226:227], v29 offset:512
    ds_read_b64_tr_b16 a[228:229], v29 offset:8192
    ds_read_b64_tr_b16 a[230:231], v29 offset:8704
    ds_read_b64_tr_b16 v[112:113], v30 offset:0
    ds_read_b64_tr_b16 v[114:115], v30 offset:512
    ds_read_b64_tr_b16 v[116:117], v30 offset:8192
    ds_read_b64_tr_b16 v[118:119], v30 offset:8704
    s_waitcnt vmcnt(20) lgkmcnt(0)
    s_barrier
    s_add_u32 m0, s56, 65536
    s_add_u32 s59, s60, 3145728
    buffer_load_dwordx4 v25, s[36:39], s59 offen lds
    s_add_u32 m0, s56, 69632
    s_add_u32 s59, s60, 3276800
    buffer_load_dwordx4 v25, s[36:39], s59 offen lds
    s_add_u32 m0, s56, 73728
    s_add_u32 s59, s60, 3407872
    buffer_load_dwordx4 v25, s[36:39], s59 offen lds
    s_add_u32 m0, s56, 77824
    s_add_u32 s59, s60, 3538944
    buffer_load_dwordx4 v25, s[36:39], s59 offen lds
    v_add_u32 v29, 81920, v26
    v_add_u32 v30, 81920, v27
    ds_read_b64_tr_b16 a[232:233], v29 offset:0
    ds_read_b64_tr_b16 a[234:235], v29 offset:512
    ds_read_b64_tr_b16 a[236:237], v29 offset:8192
    ds_read_b64_tr_b16 a[238:239], v29 offset:8704
    ds_read_b64_tr_b16 v[120:121], v30 offset:0
    ds_read_b64_tr_b16 v[122:123], v30 offset:512
    ds_read_b64_tr_b16 v[124:125], v30 offset:8192
    ds_read_b64_tr_b16 v[126:127], v30 offset:8704
    s_waitcnt vmcnt(20) lgkmcnt(0)
    s_barrier
    s_add_u32 m0, s56, 81920
    s_add_u32 s59, s60, 3145728
    buffer_load_dwordx4 v25, s[40:43], s59 offen lds
    s_add_u32 m0, s56, 86016
    s_add_u32 s59, s60, 3276800
    buffer_load_dwordx4 v25, s[40:43], s59 offen lds
    s_add_u32 m0, s56, 90112
    s_add_u32 s59, s60, 3407872
    buffer_load_dwordx4 v25, s[40:43], s59 offen lds
    s_add_u32 m0, s56, 94208
    s_add_u32 s59, s60, 3538944
    buffer_load_dwordx4 v25, s[40:43], s59 offen lds
    v_readfirstlane_b32 s82, v72
    v_lshlrev_b32 v12, 3, v0
    s_cmp_lt_u32 s82, 32
    s_cbranch_scc1 tps_38
    s_add_u32 s59, s65, 0
    buffer_store_dword v15, v2, s[32:35], s59 offen
    s_add_u32 s59, s65, 32768
    buffer_store_dword v15, v2, s[32:35], s59 offen
    s_add_u32 s59, s65, 65536
    buffer_store_dword v15, v2, s[32:35], s59 offen
    s_add_u32 s59, s65, 98304
    buffer_store_dword v15, v2, s[32:35], s59 offen
    s_add_u32 s59, s65, 131072
    buffer_store_dword v15, v2, s[32:35], s59 offen
    s_add_u32 s59, s65, 163840
    buffer_store_dword v15, v2, s[32:35], s59 offen
    s_add_u32 s59, s65, 196608
    buffer_store_dword v15, v2, s[32:35], s59 offen
    s_add_u32 s59, s65, 229376
    buffer_store_dword v15, v2, s[32:35], s59 offen
    s_add_u32 s59, s65, 262144
    buffer_store_dword v15, v2, s[32:35], s59 offen
    s_add_u32 s59, s65, 524288
    buffer_store_dword v15, v2, s[32:35], s59 offen
    s_add_u32 s59, s65, 557056
    buffer_store_dword v15, v2, s[32:35], s59 offen
    s_add_u32 s59, s65, 589824
    buffer_store_dword v15, v2, s[32:35], s59 offen
    s_add_u32 s59, s65, 622592
    buffer_store_dword v15, v2, s[32:35], s59 offen
    s_add_u32 s59, s65, 655360
    buffer_store_dword v15, v2, s[32:35], s59 offen
    s_add_u32 s59, s65, 688128
    buffer_store_dword v15, v2, s[32:35], s59 offen
    s_add_u32 s59, s65, 720896
    buffer_store_dword v15, v2, s[32:35], s59 offen
    s_add_u32 s59, s65, 753664
    buffer_store_dword v15, v2, s[32:35], s59 offen
    s_add_u32 s59, s65, 786432
    buffer_store_dword v15, v2, s[32:35], s59 offen
    s_add_u32 s59, s66, 16384
    buffer_store_dword v15, v4, s[32:35], s59 offen
    s_add_u32 s59, s66, 32768
    buffer_store_dword v15, v4, s[32:35], s59 offen
    s_add_u32 s59, s66, 49152
    buffer_store_dword v15, v4, s[32:35], s59 offen
    s_mov_b64 exec, 0xff
    buffer_store_dword v15, v12, s[32:35], s74 offen
    s_mov_b64 exec, -1
    s_branch tpj_39
tps_38:
    s_add_u32 s59, s65, 0
    buffer_store_dword v15, v2, s[32:35], s59 offen sc1
    s_add_u32 s59, s65, 32768
    buffer_store_dword v15, v2, s[32:35], s59 offen sc1
    s_add_u32 s59, s65, 65536
    buffer_store_dword v15, v2, s[32:35], s59 offen sc1
    s_add_u32 s59, s65, 98304
    buffer_store_dword v15, v2, s[32:35], s59 offen sc1
    s_add_u32 s59, s65, 131072
    buffer_store_dword v15, v2, s[32:35], s59 offen sc1
    s_add_u32 s59, s65, 163840
    buffer_store_dword v15, v2, s[32:35], s59 offen sc1
    s_add_u32 s59, s65, 196608
    buffer_store_dword v15, v2, s[32:35], s59 offen sc1
    s_add_u32 s59, s65, 229376
    buffer_store_dword v15, v2, s[32:35], s59 offen sc1
    s_add_u32 s59, s65, 262144
    buffer_store_dword v15, v2, s[32:35], s59 offen sc1
    s_add_u32 s59, s65, 524288
    buffer_store_dword v15, v2, s[32:35], s59 offen sc1
    s_add_u32 s59, s65, 557056
    buffer_store_dword v15, v2, s[32:35], s59 offen sc1
    s_add_u32 s59, s65, 589824
    buffer_store_dword v15, v2, s[32:35], s59 offen sc1
    s_add_u32 s59, s65, 622592
    buffer_store_dword v15, v2, s[32:35], s59 offen sc1
    s_add_u32 s59, s65, 655360
    buffer_store_dword v15, v2, s[32:35], s59 offen sc1
    s_add_u32 s59, s65, 688128
    buffer_store_dword v15, v2, s[32:35], s59 offen sc1
    s_add_u32 s59, s65, 720896
    buffer_store_dword v15, v2, s[32:35], s59 offen sc1
    s_add_u32 s59, s65, 753664
    buffer_store_dword v15, v2, s[32:35], s59 offen sc1
    s_add_u32 s59, s65, 786432
    buffer_store_dword v15, v2, s[32:35], s59 offen sc1
    s_add_u32 s59, s66, 16384
    buffer_store_dword v15, v4, s[32:35], s59 offen sc1
    s_add_u32 s59, s66, 32768
    buffer_store_dword v15, v4, s[32:35], s59 offen sc1
    s_add_u32 s59, s66, 49152
    buffer_store_dword v15, v4, s[32:35], s59 offen sc1
    s_mov_b64 exec, 0xff
    buffer_store_dword v15, v12, s[32:35], s74 offen sc1
    s_mov_b64 exec, -1
tpj_39:
    v_add_u32 v29, 98304, v26
    v_add_u32 v30, 98304, v27
    ds_read_b64_tr_b16 a[240:241], v29 offset:0
    ds_read_b64_tr_b16 a[242:243], v29 offset:512
    ds_read_b64_tr_b16 a[244:245], v29 offset:8192
    ds_read_b64_tr_b16 a[246:247], v29 offset:8704
    ds_read_b64_tr_b16 v[128:129], v30 offset:0
    ds_read_b64_tr_b16 v[130:131], v30 offset:512
    ds_read_b64_tr_b16 v[132:133], v30 offset:8192
    ds_read_b64_tr_b16 v[134:135], v30 offset:8704
    s_waitcnt vmcnt(42) lgkmcnt(0)
    s_barrier
    s_add_u32 m0, s56, 98304
    s_add_u32 s59, s60, 4194304
    buffer_load_dwordx4 v25, s[44:47], s59 offen lds
    s_add_u32 m0, s56, 102400
    s_add_u32 s59, s60, 4325376
    buffer_load_dwordx4 v25, s[44:47], s59 offen lds
    s_add_u32 m0, s56, 106496
    s_add_u32 s59, s60, 4456448
    buffer_load_dwordx4 v25, s[44:47], s59 offen lds
    s_add_u32 m0, s56, 110592
    s_add_u32 s59, s60, 4587520
    buffer_load_dwordx4 v25, s[44:47], s59 offen lds
    v_add_u32 v29, 0, v26
    v_add_u32 v30, 0, v27
    ds_read_b64_tr_b16 a[248:249], v29 offset:0
    ds_read_b64_tr_b16 a[250:251], v29 offset:512
    ds_read_b64_tr_b16 a[252:253], v29 offset:8192
    ds_read_b64_tr_b16 a[254:255], v29 offset:8704
    ds_read_b64_tr_b16 v[136:137], v30 offset:0
    ds_read_b64_tr_b16 v[138:139], v30 offset:512
    ds_read_b64_tr_b16 v[140:141], v30 offset:8192
    ds_read_b64_tr_b16 v[142:143], v30 offset:8704
    s_waitcnt vmcnt(42) lgkmcnt(0)
    s_barrier
    v_add_u32 v29, 16384, v26
    v_add_u32 v30, 16384, v27
    ds_read_b64_tr_b16 v[80:81], v29 offset:0
    ds_read_b64_tr_b16 v[82:83], v29 offset:512
    ds_read_b64_tr_b16 v[84:85], v29 offset:8192
    ds_read_b64_tr_b16 v[86:87], v29 offset:8704
    ds_read_b64_tr_b16 v[144:145], v30 offset:0
    ds_read_b64_tr_b16 v[146:147], v30 offset:512
    ds_read_b64_tr_b16 v[148:149], v30 offset:8192
    ds_read_b64_tr_b16 v[150:151], v30 offset:8704
    s_waitcnt vmcnt(38) lgkmcnt(0)
    s_barrier
    s_add_u32 m0, s56, 16384
    s_add_u32 s59, s60, 0
    buffer_load_dwordx4 v25, s[36:39], s59 offen lds
    s_add_u32 m0, s56, 20480
    s_add_u32 s59, s60, 131072
    buffer_load_dwordx4 v25, s[36:39], s59 offen lds
    s_add_u32 m0, s56, 24576
    s_add_u32 s59, s60, 262144
    buffer_load_dwordx4 v25, s[36:39], s59 offen lds
    s_add_u32 m0, s56, 28672
    s_add_u32 s59, s60, 393216
    buffer_load_dwordx4 v25, s[36:39], s59 offen lds
    v_add_u32 v29, 32768, v26
    v_add_u32 v30, 32768, v27
    ds_read_b64_tr_b16 v[88:89], v29 offset:0
    ds_read_b64_tr_b16 v[90:91], v29 offset:512
    ds_read_b64_tr_b16 v[92:93], v29 offset:8192
    ds_read_b64_tr_b16 v[94:95], v29 offset:8704
    ds_read_b64_tr_b16 v[152:153], v30 offset:0
    ds_read_b64_tr_b16 v[154:155], v30 offset:512
    ds_read_b64_tr_b16 v[156:157], v30 offset:8192
    ds_read_b64_tr_b16 v[158:159], v30 offset:8704
    s_waitcnt vmcnt(38) lgkmcnt(0)
    s_barrier
    s_add_u32 m0, s56, 32768
    s_add_u32 s59, s60, 524288
    buffer_load_dwordx4 v25, s[40:43], s59 offen lds
    s_add_u32 m0, s56, 36864
    s_add_u32 s59, s60, 655360
    buffer_load_dwordx4 v25, s[40:43], s59 offen lds
    s_add_u32 m0, s56, 40960
    s_add_u32 s59, s60, 786432
    buffer_load_dwordx4 v25, s[40:43], s59 offen lds
    s_add_u32 m0, s56, 45056
    s_add_u32 s59, s60, 917504
    buffer_load_dwordx4 v25, s[40:43], s59 offen lds
    v_add_u32 v29, 49152, v26
    v_add_u32 v30, 49152, v27
    ds_read_b64_tr_b16 v[40:41], v29 offset:0
    ds_read_b64_tr_b16 v[42:43], v29 offset:512
    ds_read_b64_tr_b16 v[44:45], v29 offset:8192
    ds_read_b64_tr_b16 v[46:47], v29 offset:8704
    ds_read_b64_tr_b16 v[48:49], v30 offset:0
    ds_read_b64_tr_b16 v[50:51], v30 offset:512
    ds_read_b64_tr_b16 v[52:53], v30 offset:8192
    ds_read_b64_tr_b16 v[54:55], v30 offset:8704
    v_add_u32 v29, 49152, v1
    s_waitcnt lgkmcnt(0)
    s_barrier
    ds_write_b128 v29, v[40:43] offset:0
    ds_write_b128 v29, v[44:47] offset:1024
    ds_write_b128 v29, v[48:51] offset:2048
    ds_write_b128 v29, v[52:55] offset:3072
    s_waitcnt vmcnt(38) lgkmcnt(0)
    s_barrier
    v_add_u32 v29, 65536, v26
    v_add_u32 v30, 65536, v27
    ds_read_b64_tr_b16 v[40:41], v29 offset:0
    ds_read_b64_tr_b16 v[42:43], v29 offset:512
    ds_read_b64_tr_b16 v[44:45], v29 offset:8192
    ds_read_b64_tr_b16 v[46:47], v29 offset:8704
    ds_read_b64_tr_b16 v[48:49], v30 offset:0
    ds_read_b64_tr_b16 v[50:51], v30 offset:512
    ds_read_b64_tr_b16 v[52:53], v30 offset:8192
    ds_read_b64_tr_b16 v[54:55], v30 offset:8704
    v_add_u32 v29, 65536, v1
    s_waitcnt lgkmcnt(0)
    s_barrier
    ds_write_b128 v29, v[40:43] offset:0
    ds_write_b128 v29, v[44:47] offset:1024
    ds_write_b128 v29, v[48:51] offset:2048
    ds_write_b128 v29, v[52:55] offset:3072
    s_waitcnt vmcnt(34) lgkmcnt(0)
    s_barrier
    v_add_u32 v29, 81920, v26
    v_add_u32 v30, 81920, v27
    ds_read_b64_tr_b16 v[40:41], v29 offset:0
    ds_read_b64_tr_b16 v[42:43], v29 offset:512
    ds_read_b64_tr_b16 v[44:45], v29 offset:8192
    ds_read_b64_tr_b16 v[46:47], v29 offset:8704
    ds_read_b64_tr_b16 v[48:49], v30 offset:0
    ds_read_b64_tr_b16 v[50:51], v30 offset:512
    ds_read_b64_tr_b16 v[52:53], v30 offset:8192
    ds_read_b64_tr_b16 v[54:55], v30 offset:8704
    v_add_u32 v29, 81920, v1
    s_waitcnt lgkmcnt(0)
    s_barrier
    ds_write_b128 v29, v[40:43] offset:0
    ds_write_b128 v29, v[44:47] offset:1024
    ds_write_b128 v29, v[48:51] offset:2048
    ds_write_b128 v29, v[52:55] offset:3072
    s_waitcnt vmcnt(8) lgkmcnt(0)
    s_barrier
    v_cmp_gt_u32 vcc, 4, v74
    s_cbranch_vccz tini_40
    v_mov_b32 v32, 136
winit_41:
    global_load_dword v33, v32, s[28:29] sc1
    s_sub_i32 s54, s54, 1
    s_cmp_lt_i32 s54, 0
    s_waitcnt vmcnt(0)
    s_cbranch_scc1 winitd_42
    v_cmp_gt_u32 vcc, 4, v33
    s_cbranch_vccz winitd_42
    s_sleep 8
    s_branch winit_41
winitd_42:
tini_40:
    s_lshl_b32 s57, s53, 7
    s_add_u32 s57, s57, 133120
    s_mov_b64 exec, 1
    buffer_store_dword v15, off, s[32:35], s57 sc1
    s_mov_b64 exec, -1
    buffer_load_dword v76, off, s[32:35], s79 offset:0 sc1
    buffer_load_dword v77, off, s[32:35], s79 offset:128 sc1
    buffer_load_dword v78, off, s[32:35], s79 offset:256 sc1
    buffer_load_dword v79, off, s[32:35], s79 offset:384 sc1
    v_add_u32 v29, 98304, v26
    v_add_u32 v30, 98304, v27
    ds_read_b64_tr_b16 v[40:41], v29 offset:0
    ds_read_b64_tr_b16 v[42:43], v29 offset:512
    ds_read_b64_tr_b16 v[44:45], v29 offset:8192
    ds_read_b64_tr_b16 v[46:47], v29 offset:8704
    ds_read_b64_tr_b16 v[48:49], v30 offset:0
    ds_read_b64_tr_b16 v[50:51], v30 offset:512
    ds_read_b64_tr_b16 v[52:53], v30 offset:8192
    ds_read_b64_tr_b16 v[54:55], v30 offset:8704
    v_add_u32 v29, 98304, v1
    s_waitcnt lgkmcnt(0)
    s_barrier
    ds_write_b128 v29, v[40:43] offset:0
    ds_write_b128 v29, v[44:47] offset:1024
    ds_write_b128 v29, v[48:51] offset:2048
    ds_write_b128 v29, v[52:55] offset:3072
    s_waitcnt vmcnt(9) lgkmcnt(0)
    s_barrier
    v_add_u32 v29, 16384, v26
    v_add_u32 v30, 16384, v27
    ds_read_b64_tr_b16 v[40:41], v29 offset:0
    ds_read_b64_tr_b16 v[42:43], v29 offset:512
    ds_read_b64_tr_b16 v[44:45], v29 offset:8192
    ds_read_b64_tr_b16 v[46:47], v29 offset:8704
    ds_read_b64_tr_b16 v[48:49], v30 offset:0
    ds_read_b64_tr_b16 v[50:51], v30 offset:512
    ds_read_b64_tr_b16 v[52:53], v30 offset:8192
    ds_read_b64_tr_b16 v[54:55], v30 offset:8704
    v_add_u32 v29, 16384, v1
    s_waitcnt lgkmcnt(0)
    s_barrier
    ds_write_b128 v29, v[40:43] offset:0
    ds_write_b128 v29, v[44:47] offset:1024
    ds_write_b128 v29, v[48:51] offset:2048
    ds_write_b128 v29, v[52:55] offset:3072
    s_waitcnt vmcnt(5) lgkmcnt(0)
    s_barrier
    v_add_u32 v29, 32768, v26
    v_add_u32 v30, 32768, v27
    ds_read_b64_tr_b16 v[40:41], v29 offset:0
    ds_read_b64_tr_b16 v[42:43], v29 offset:512
    ds_read_b64_tr_b16 v[44:45], v29 offset:8192
    ds_read_b64_tr_b16 v[46:47], v29 offset:8704
    ds_read_b64_tr_b16 v[48:49], v30 offset:0
    ds_read_b64_tr_b16 v[50:51], v30 offset:512
    ds_read_b64_tr_b16 v[52:53], v30 offset:8192
    ds_read_b64_tr_b16 v[54:55], v30 offset:8704
    v_add_u32 v29, 32768, v1
    s_waitcnt lgkmcnt(0)
    s_barrier
    ds_write_b128 v29, v[40:43] offset:0
    ds_write_b128 v29, v[44:47] offset:1024
    ds_write_b128 v29, v[48:51] offset:2048
    ds_write_b128 v29, v[52:55] offset:3072
    s_waitcnt lgkmcnt(0)
    s_barrier
    v_add_u32 v31, s56, v0
    ds_write_b128 v0, v[16:19] offset:15360
    ds_write_b128 v31, v[64:67]
    ds_write_b128 v31, v[68:71] offset:4096
    ds_write_b128 v0, v[36:39] offset:8192
    s_mov_b32 s50, s68
    s_mov_b32 s51, 0x100000
    s_mov_b32 s49, 20000
    s_and_b32 s47, s53, 7
    s_lshl_b32 s47, s47, 7
    s_add_u32 s47, s47, 7417856
    s_mov_b32 s48, s74
    s_mov_b32 s45, 2130706432
    s_mov_b32 s46, 0
    s_mov_b32 s98, 0
    s_add_u32 s36, s65, 0
    s_add_u32 s37, s65, 32768
    s_add_u32 s38, s65, 65536
    s_add_u32 s39, s65, 98304
    s_add_u32 s40, s65, 131072
    s_add_u32 s41, s65, 163840
    s_add_u32 s42, s65, 196608
    s_add_u32 s43, s65, 229376
    s_add_u32 s44, s65, 262144
    s_waitcnt vmcnt(0) lgkmcnt(0)
    v_min_u32 v76, v76, v77
    v_min3_u32 v76, v76, v78, v79
    v_cmp_gt_u32 vcc, 2, v76
    s_cbranch_vccz tall_43
wp0_44:
    buffer_load_dword v76, off, s[32:35], s79 offset:0 sc1
    buffer_load_dword v77, off, s[32:35], s79 offset:128 sc1
    buffer_load_dword v78, off, s[32:35], s79 offset:256 sc1
    buffer_load_dword v79, off, s[32:35], s79 offset:384 sc1
    s_sub_i32 s54, s54, 1
    s_cmp_lt_i32 s54, 0
    s_waitcnt vmcnt(0)
    s_cbranch_scc1 wp0d_45
    v_min_u32 v76, v76, v77
    v_min3_u32 v76, v76, v78, v79
    v_cmp_gt_u32 vcc, 2, v76
    s_cbranch_vccz wp0d_45
    s_sleep 2
    s_branch wp0_44
wp0d_45:
tall_43:
    buffer_load_dwordx4 v[56:59], v0, s[32:35], s72 offen offset:0 sc1
    buffer_load_dwordx4 v[60:63], v0, s[32:35], s72 offen offset:1024 sc1
    s_barrier
    s_cmp_lt_u32 s82, 32
    s_cbranch_scc1 tslow_46
    s_cmp_eq_u32 s52, 1
    s_cbranch_scc1 tcls1_48
    s_cmp_eq_u32 s52, 2
    s_cbranch_scc1 tcls2_49
    s_cmp_eq_u32 s52, 3
    s_cbranch_scc1 tcls3_50
tcls0_47:
    buffer_load_dwordx4 v[64:67], v0, s[32:35], s73 offen offset:0 sc1
    buffer_load_dwordx4 v[68:71], v0, s[32:35], s73 offen offset:1024 sc1
    s_barrier
    buffer_store_dwordx4 v[28:31], v0, s[32:35], s45 offen sc1
    v_add_u32 v1, s63, v0
    v_and_b32 v2, 0x7ffff, v2
    v_or_b32 v2, s51, v2
    v_mov_b64 v[32:33], 0
    v_mov_b64 v[34:35], 0
    v_mov_b64 v[36:37], 0
    v_mov_b64 v[38:39], 0
    v_mov_b64 v[40:41], 0
    v_mov_b64 v[42:43], 0
    v_mov_b64 v[44:45], 0
    v_mov_b64 v[46:47], 0
    v_lshlrev_b32 v12, 3, v0
    ds_read_b128 v[72:75], v1 offset:16384
    ds_read_b128 v[76:79], v1 offset:17408
    ds_read_b128 v[48:51], v1 offset:18432
    ds_read_b128 v[52:55], v1 offset:19456
    s_waitcnt lgkmcnt(0)
    s_branch tw_51
.p2align 6
ttop_54:
    s_cmp_eq_u32 s64, 1
    s_cbranch_scc1 ttop_54a
ttop_54b:
    s_nop 15
    buffer_load_dwordx4 v[56:59], v0, s[32:35], s68 offen offset:0 sc1
    buffer_load_dwordx4 v[60:63], v0, s[32:35], s68 offen offset:1024 sc1
    buffer_load_dwordx4 v[64:67], v0, s[32:35], s68 offen offset:2048 sc1
    buffer_load_dwordx4 v[68:71], v0, s[32:35], s68 offen offset:3072 sc1
    s_and_b32 s57, s64, 3
    s_lshl_b32 s58, s57, 14
    s_add_u32 s81, s70, s58
    s_add_u32 s85, s58, 7405568
    s_xor_b32 s51, s57, 2
    s_lshl_b32 s51, s51, 19
    s_add_u32 s72, s72, 786432
    s_add_u32 s73, s73, 786432
    s_mov_b32 s45, s77
    s_add_u32 s77, s77, 131072
    s_sub_u32 s99, s64, 1
    ds_read_b128 v[16:19], v0 offset:15360
    v_add_u32 v1, s63, v0
    v_and_b32 v2, 0x7ffff, v2
    v_or_b32 v2, s51, v2
    v_mov_b64 v[32:33], 0
    v_mov_b64 v[34:35], 0
    v_mov_b64 v[36:37], 0
    v_mov_b64 v[38:39], 0
    v_mov_b64 v[40:41], 0
    v_mov_b64 v[42:43], 0
    v_mov_b64 v[44:45], 0
    v_mov_b64 v[46:47], 0
    v_lshlrev_b32 v12, 3, v0
    ds_read_b128 v[72:75], v1 offset:16384
    ds_read_b128 v[76:79], v1 offset:17408
    ds_read_b128 v[48:51], v1 offset:18432
    ds_read_b128 v[52:55], v1 offset:19456
    v_mov_b32 v24, s64
    s_waitcnt vmcnt(3) lgkmcnt(4)
    v_mfma_f32_16x16x32_bf16 v[20:23], v[16:19], v[56:59], 0
    s_waitcnt vmcnt(2)
    v_mfma_f32_16x16x32_bf16 v[20:23], v[16:19], v[60:63], v[20:23]
    s_waitcnt vmcnt(1)
    v_mfma_f32_16x16x32_bf16 v[20:23], v[16:19], v[64:67], v[20:23]
    s_waitcnt vmcnt(0)
    v_mfma_f32_16x16x32_bf16 v[20:23], v[16:19], v[68:71], v[20:23]
    s_nop 7
    v_add_f32_dpp v20, v20, v20 row_ror:8 row_mask:0xf bank_mask:0xf
    v_add_f32_dpp v21, v21, v21 row_ror:8 row_mask:0xf bank_mask:0xf
    v_cvt_pk_bf16_f32 v20, v20, v21
    v_cmp_u_f32 vcc, v21, v21
    buffer_store_dword v20, v4, s[32:35], s81 offen
    s_cbranch_vccnz tp_57
tpd_58:
    s_mov_b64 exec, 0xff
    buffer_store_dword v24, v12, s[32:35], s48 offen
    s_mov_b64 exec, -1
    s_lshl_b32 s57, s57, 19
    s_add_u32 s68, s50, s57
    s_and_b32 s57, s99, 3
    s_lshl_b32 s57, s57, 14
    s_add_u32 s67, s70, s57
tm_53:
    s_add_u32 m0, s56, 4096
    s_add_u32 s57, s85, m0
    s_add_u32 s58, s85, 8192
    s_barrier
    buffer_load_dwordx4 v0, s[32:35], s57 offen sc1 lds
    s_mov_b32 m0, 8192
    s_nop 4
    buffer_load_dwordx4 v0, s[32:35], s58 offen sc1 lds
    buffer_load_dwordx4 v[56:59], v0, s[32:35], s72 offen offset:0 sc1
    buffer_load_dwordx4 v[60:63], v0, s[32:35], s72 offen offset:1024 sc1
    s_barrier
    buffer_load_dwordx4 v[64:67], v0, s[32:35], s73 offen offset:0 sc1
    buffer_load_dwordx4 v[68:71], v0, s[32:35], s73 offen offset:1024 sc1
    s_barrier
    buffer_store_dwordx4 v[28:31], v0, s[32:35], s45 offen sc1
    s_cmp_eq_u32 s64, 63
    s_cbranch_scc1 tw_51l
    s_waitcnt lgkmcnt(0)
tw_51:
    s_barrier
    ds_read_b128 v[16:19], v0 offset:0
    ds_read_b128 v[24:27], v0 offset:2048
    ds_read_b128 v[20:23], v0 offset:1024
    buffer_store_dword v15, v2, s[32:35], s37 offen
    s_waitcnt lgkmcnt(2)
    v_smfmac_f32_16x16x64_bf16 v[32:35], v[16:19], v[72:79], v9
    ds_read_b128 v[76:79], v1 offset:33792
    v_smfmac_f32_16x16x64_bf16 v[36:39], v[16:19], v[48:55], v9
    ds_read_b128 v[52:55], v1 offset:35840
    s_waitcnt lgkmcnt(2)
    v_smfmac_f32_16x16x64_bf16 v[32:35], v[20:23], a[0:7], v9
    ds_read_b128 v[28:31], v0 offset:3072
    v_smfmac_f32_16x16x64_bf16 v[36:39], v[20:23], a[48:55], v9
    ds_read_b128 v[48:51], v1 offset:34816
    v_smfmac_f32_16x16x64_bf16 v[40:43], v[16:19], a[96:103], v9
    ds_read_b128 v[72:75], v1 offset:32768
    v_smfmac_f32_16x16x64_bf16 v[44:47], v[16:19], a[152:159], v9
    s_waitcnt vmcnt(6)
    s_barrier
    v_smfmac_f32_16x16x64_bf16 v[32:35], v[24:27], a[8:15], v9
    v_smfmac_f32_16x16x64_bf16 v[36:39], v[24:27], a[56:63], v9
    ds_read_b128 v[16:19], v0 offset:4096
    s_waitcnt lgkmcnt(1)
    v_smfmac_f32_16x16x64_bf16 v[40:43], v[20:23], v[72:79], v9
    ds_read_b128 v[72:75], v1 offset:49152
    v_smfmac_f32_16x16x64_bf16 v[44:47], v[20:23], v[48:55], v9
    ds_read_b128 v[76:79], v1 offset:50176
    v_smfmac_f32_16x16x64_bf16 v[32:35], v[28:31], a[16:23], v9
    ds_read_b128 v[48:51], v1 offset:51200
    v_smfmac_f32_16x16x64_bf16 v[36:39], v[28:31], a[64:71], v9
    ds_read_b128 v[52:55], v1 offset:52224
    v_add_u32 v1, 0x10000, v1
    v_smfmac_f32_16x16x64_bf16 v[40:43], v[24:27], a[104:111], v9
    ds_read_b128 v[20:23], v0 offset:5120
    v_smfmac_f32_16x16x64_bf16 v[44:47], v[24:27], a[160:167], v9
    buffer_store_dword v15, v2, s[32:35], s36 offen
    ds_read_b128 v[24:27], v0 offset:6144
    s_waitcnt lgkmcnt(4)
    v_smfmac_f32_16x16x64_bf16 v[32:35], v[16:19], v[72:79], v9
    ds_read_b128 v[72:75], v1 offset:0
    s_waitcnt lgkmcnt(3)
    v_smfmac_f32_16x16x64_bf16 v[36:39], v[16:19], v[48:55], v9
    ds_read_b128 v[76:79], v1 offset:1024
    v_smfmac_f32_16x16x64_bf16 v[40:43], v[28:31], a[112:119], v9
    buffer_store_dword v15, v2, s[32:35], s40 offen
    v_smfmac_f32_16x16x64_bf16 v[44:47], v[28:31], a[168:175], v9
    ds_read_b128 v[48:51], v1 offset:2048
    s_waitcnt lgkmcnt(4)
    v_smfmac_f32_16x16x64_bf16 v[32:35], v[20:23], a[24:31], v9
    ds_read_b128 v[52:55], v1 offset:3072
    v_smfmac_f32_16x16x64_bf16 v[36:39], v[20:23], a[72:79], v9
    v_smfmac_f32_16x16x64_bf16 v[40:43], v[16:19], a[120:127], v9
    buffer_store_dword v15, v2, s[32:35], s41 offen
    v_smfmac_f32_16x16x64_bf16 v[44:47], v[16:19], a[176:183], v9
    ds_read_b128 v[28:31], v0 offset:7168
    ds_read_b128 v[16:19], v0 offset:8192
    s_waitcnt lgkmcnt(4)
    v_smfmac_f32_16x16x64_bf16 v[32:35], v[24:27], v[72:79], v9
    buffer_store_dword v15, v2, s[32:35], s39 offen
    s_waitcnt lgkmcnt(2)
    v_smfmac_f32_16x16x64_bf16 v[36:39], v[24:27], v[48:55], v9
    ds_read_b128 v[52:55], v1 offset:19456
    ds_read_b128 v[72:75], v1 offset:16384
    v_smfmac_f32_16x16x64_bf16 v[40:43], v[20:23], a[128:135], v9
    buffer_store_dword v15, v2, s[32:35], s42 offen
    v_smfmac_f32_16x16x64_bf16 v[44:47], v[20:23], a[184:191], v9
    ds_read_b128 v[48:51], v1 offset:18432
    ds_read_b128 v[76:79], v1 offset:17408
    s_waitcnt lgkmcnt(5)
    v_smfmac_f32_16x16x64_bf16 v[32:35], v[28:31], a[32:39], v9
    buffer_store_dword v15, v2, s[32:35], s38 offen
    v_smfmac_f32_16x16x64_bf16 v[36:39], v[28:31], a[80:87], v9
    s_waitcnt lgkmcnt(4)
    v_smfmac_f32_16x16x64_bf16 v[32:35], v[16:19], a[40:47], v9
    buffer_store_dword v15, v2, s[32:35], s43 offen
    v_smfmac_f32_16x16x64_bf16 v[36:39], v[16:19], a[88:95], v9
    s_waitcnt lgkmcnt(0)
    v_smfmac_f32_16x16x64_bf16 v[40:43], v[24:27], v[72:79], v9
    buffer_store_dword v15, v2, s[32:35], s44 offen
    v_add_f32 v33, v33, v35
    v_smfmac_f32_16x16x64_bf16 v[44:47], v[24:27], v[48:55], v9
    v_add_f32 v32, v32, v34
    v_smfmac_f32_16x16x64_bf16 v[40:43], v[28:31], a[136:143], v9
    ds_read_b128 v[72:75], v1 offset:32768
    v_add_f32 v36, v36, v38
    v_smfmac_f32_16x16x64_bf16 v[44:47], v[28:31], a[192:199], v9
    v_add_f32 v37, v37, v39
    v_smfmac_f32_16x16x64_bf16 v[40:43], v[16:19], a[144:151], v9
    v_cvt_pk_bf16_f32 v12, v32, v33
    v_mov_b64 v[48:49], 0
    v_cmp_u_f32 vcc, v32, v33
    v_mfma_f32_16x16x16_bf16 v[32:35], v[12:13], v[8:9], 0
    v_cvt_pk_bf16_f32 v12, v36, v37
    v_mov_b64 v[54:55], 0
    v_add_f32 v41, v41, v43
    v_mfma_f32_16x16x16_bf16 v[36:39], v[12:13], v[8:9], 0
    v_add_f32 v40, v40, v42
    v_cvt_pk_bf16_f32 v12, v40, v41
    v_mov_b64 v[52:53], 0
    v_smfmac_f32_16x16x64_bf16 v[44:47], v[16:19], a[200:207], v9
    ds_read_b128 v[76:79], v1 offset:33792
    v_cvt_pk_bf16_f32 v32, v32, v33
    v_cvt_pk_bf16_f32 v33, v34, v35
    v_cvt_pk_bf16_f32 v34, v36, v37
    v_mfma_f32_16x16x16_bf16 v[40:43], v[12:13], v[8:9], 0
    v_cvt_pk_bf16_f32 v35, v38, v39
    v_mov_b64 v[50:51], 0
    v_add_f32 v45, v45, v47
    s_waitcnt vmcnt(13)
    v_mfma_f32_16x16x32_bf16 v[56:59], v[56:59], v[32:35], 0
    v_add_f32 v44, v44, v46
    v_cvt_pk_bf16_f32 v12, v44, v45
    v_smfmac_f32_16x16x64_bf16 v[48:51], v[20:23], a[248:255], v9
    s_cbranch_vccnz tredo_52
tredo_52r:
    v_mfma_f32_16x16x16_bf16 v[44:47], v[12:13], v[8:9], 0
    s_nop 0
    ds_write_b128 v3, v[56:59] offset:9216
    v_cvt_pk_bf16_f32 v40, v40, v41
    v_cvt_pk_bf16_f32 v41, v42, v43
    s_waitcnt vmcnt(12)
    v_mfma_f32_16x16x32_bf16 v[60:63], v[60:63], v[32:35], 0
    s_nop 1
    v_cvt_pk_bf16_f32 v43, v46, v47
    v_cvt_pk_bf16_f32 v42, v44, v45
    v_smfmac_f32_16x16x64_bf16 v[52:55], v[20:23], v[136:143], v9
    buffer_store_dword v15, v4, s[32:35], s67 offen
    v_mfma_f32_16x16x32_bf16 v[44:47], v[40:43], v[32:35], 0
    ds_write_b128 v3, v[60:63] offset:9728
    v_smfmac_f32_16x16x64_bf16 v[48:51], v[24:27], v[80:87], v9
    s_nop 4
    ds_write_b64 v5, v[44:45] offset:13312
    v_smfmac_f32_16x16x64_bf16 v[52:55], v[24:27], v[144:151], v9
    ds_read_b128 v[24:27], v0 offset:1024
    v_smfmac_f32_16x16x64_bf16 v[48:51], v[28:31], v[88:95], v9
    ds_read_b128 v[20:23], v0 offset:0
    v_smfmac_f32_16x16x64_bf16 v[52:55], v[28:31], v[152:159], v9
    ds_read_b128 v[28:31], v0 offset:2048
    s_waitcnt lgkmcnt(3)
    s_barrier
    v_smfmac_f32_16x16x64_bf16 v[48:51], v[16:19], v[72:79], v9
    ds_read_b64 v[46:47], v6 offset:14336
    ds_read_b64 v[44:45], v6 offset:13312
    s_waitcnt lgkmcnt(3)
    v_smfmac_f32_16x16x64_bf16 v[48:51], v[20:23], a[208:215], v9
    ds_read_b128 v[32:35], v6 offset:11264
    v_smfmac_f32_16x16x64_bf16 v[52:55], v[20:23], v[96:103], v9
    ds_read_b128 v[20:23], v0 offset:3072
    v_smfmac_f32_16x16x64_bf16 v[48:51], v[24:27], a[216:223], v9
    ds_read_b128 v[36:39], v6 offset:12288
    v_smfmac_f32_16x16x64_bf16 v[52:55], v[24:27], v[104:111], v9
    ds_read_b128 v[60:63], v6 offset:10240
    s_waitcnt lgkmcnt(4)
    v_add_f32 v45, v45, v47
    v_add_f32 v44, v44, v46
    v_smfmac_f32_16x16x64_bf16 v[48:51], v[28:31], a[224:231], v9
    ds_read_b128 v[56:59], v6 offset:9216
    v_add_f32_dpp v44, v44, v44 quad_perm:[2,3,0,1] row_mask:0xf bank_mask:0xf
    v_smfmac_f32_16x16x64_bf16 v[52:55], v[28:31], v[112:119], v9
    ds_read_b128 v[72:75], v1 offset:34816
    s_waitcnt lgkmcnt(3)
    v_add_f32 v35, v35, v39
    v_smfmac_f32_16x16x64_bf16 v[48:51], v[20:23], a[232:239], v9
    ds_read_b128 v[24:27], v0 offset:4096
    v_add_f32 v34, v34, v38
    v_smfmac_f32_16x16x64_bf16 v[52:55], v[20:23], v[120:127], v9
    ds_read_b128 v[76:79], v1 offset:35840
    v_add_f32 v33, v33, v37
    v_add_f32 v32, v32, v36
    s_waitcnt lgkmcnt(3)
    v_add_f32 v59, v59, v63
    v_add_f32 v59, v59, v35
    v_add_f32_dpp v45, v45, v45 quad_perm:[2,3,0,1] row_mask:0xf bank_mask:0xf
    v_add_f32 v58, v58, v62
    v_add_f32 v56, v56, v60
    v_add_f32 v56, v56, v32
    v_add_f32 v57, v57, v61
    v_add_f32 v58, v58, v34
    v_add_f32 v57, v57, v33
    v_max3_f32 v62, v56, v57, v58
    v_max_f32 v62, v62, v59
    s_waitcnt lgkmcnt(0)
    v_smfmac_f32_16x16x64_bf16 v[52:55], v[16:19], v[72:79], v9
    ds_read_b128 v[76:79], v1 offset:50176
    v_max_f32_dpp v62, v62, v62 quad_perm:[2,3,0,1] row_mask:0xf bank_mask:0xf
    v_max3_f32 v62, v62, v44, v45
    v_mov_b32 v63, v62
    v_smfmac_f32_16x16x64_bf16 v[48:51], v[24:27], a[240:247], v9
    v_permlane32_swap_b32 v62, v63
    v_max_f32 v62, v62, v63
    v_mov_b32 v63, v62
    v_smfmac_f32_16x16x64_bf16 v[52:55], v[24:27], v[128:135], v9
    ds_read_b128 v[72:75], v1 offset:49152
    v_permlane16_swap_b32 v62, v63
    v_max_f32 v62, v62, v63
    v_add_f32 v48, v48, v50
    v_mul_f32 v63, s75, v62
    v_fma_f32 v45, v45, s75, -v63
    v_fma_f32 v59, v59, s75, -v63
    v_exp_f32 v59, v59
    v_add_f32 v52, v52, v54
    v_exp_f32 v45, v45
    v_fma_f32 v58, v58, s75, -v63
    v_add_f32 v53, v53, v55
    v_exp_f32 v58, v58
    v_fma_f32 v57, v57, s75, -v63
    v_fma_f32 v44, v44, s75, -v63
    v_exp_f32 v44, v44
    v_exp_f32 v57, v57
    v_add_f32 v49, v49, v51
    v_cvt_pk_bf16_f32 v44, v44, v45
    v_cndmask_b32 v46, v44, 0, s[94:95]
    v_cvt_pk_bf16_f32 v48, v48, v49
    v_cndmask_b32 v47, 0, v44, s[94:95]
    v_fma_f32 v56, v56, s75, -v63
    v_cvt_pk_bf16_f32 v61, v58, v59
    v_cvt_pk_bf16_f32 v49, v52, v53
    v_exp_f32 v56, v56
    v_mfma_f32_16x16x16_bf16 v[32:35], v[48:49], v[46:47], 0
    v_cvt_pk_bf16_f32 v60, v56, v57
    v_mov_b32_dpp v57, v61 quad_perm:[0,1,0,1] row_mask:0xf bank_mask:0xf
    v_mfma_f32_16x16x16_bf16 v[36:39], v[10:11], v[46:47], 0
    v_mov_b32_dpp v56, v60 quad_perm:[0,1,0,1] row_mask:0xf bank_mask:0xf
    v_mov_b32_dpp v58, v60 quad_perm:[2,3,2,3] row_mask:0xf bank_mask:0xf
    v_mov_b32_dpp v59, v61 quad_perm:[2,3,2,3] row_mask:0xf bank_mask:0xf
    v_mfma_f32_16x16x16_bf16 v[36:39], v[10:11], v[56:57], v[36:39]
    v_mfma_f32_16x16x16_bf16 v[36:39], v[10:11], v[58:59], v[36:39]
    v_mov_b32 v12, 0
    s_waitcnt vmcnt(11)
    v_mfma_f32_16x16x32_bf16 v[68:71], v[68:71], v[56:59], v[32:35]
    ds_read_b128 v[20:23], v1 offset:52224
    v_mfma_f32_16x16x32_bf16 v[64:67], v[64:67], v[56:59], v[32:35]
    s_barrier
    v_rcp_f32 v14, v36
    v_mfma_f32_16x16x16_bf16 v[32:35], v[12:13], v[10:11], 0
    ds_read_b128 v[16:19], v1 offset:51200
    s_nop 3
    v_cndmask_b32 v65, v65, v69, s[94:95]
    v_cndmask_b32 v67, v67, v71, s[94:95]
    v_cndmask_b32 v64, v64, v68, s[94:95]
    v_mul_f32 v64, v64, v14
    v_mul_f32 v65, v65, v14
    v_cvt_pk_bf16_f32 v64, v64, v65
    v_cndmask_b32 v66, v66, v70, s[94:95]
    v_mul_f32 v66, v66, v14
    v_mul_f32 v67, v67, v14
    v_cvt_pk_bf16_f32 v65, v66, v67
    v_mfma_f32_16x16x16_bf16 v[56:59], v[12:13], v[10:11], 0
    ds_write_b64 v7, v[64:65] offset:9216
    v_cndmask_b32 v31, v41, v43, s[94:95]
    v_cndmask_b32 v30, v40, v42, s[94:95]
    v_mfma_f32_16x16x16_bf16 v[44:47], v[12:13], v[10:11], 0
    v_add_u32 v1, 0x10000, v1
    v_mfma_f32_16x16x16_bf16 v[24:27], v[12:13], v[10:11], 0
    v_mfma_f32_16x16x16_bf16 v[52:55], v[12:13], v[10:11], 0
    s_waitcnt lgkmcnt(0)
    s_barrier
    v_mfma_f32_16x16x16_bf16 v[40:43], v[12:13], v[10:11], 0
    ds_read_b128 v[64:67], v6 offset:9216
    v_mov_b64 v[28:29], v[48:49]
    v_mfma_f32_16x16x16_bf16 v[48:51], v[12:13], v[10:11], 0
    ds_read_b128 v[68:71], v6 offset:10240
    v_mfma_f32_16x16x16_bf16 v[60:63], v[12:13], v[10:11], 0
    v_mfma_f32_16x16x16_bf16 v[36:39], v[12:13], v[10:11], 0
    v_xor_b32 v2, 0x100000, v2
    s_waitcnt lgkmcnt(1)
    v_smfmac_f32_16x16x64_bf16 v[24:27], v[64:67], v[72:79], v9
    s_waitcnt lgkmcnt(0)
    v_smfmac_f32_16x16x64_bf16 v[24:27], v[68:71], v[16:23], v9
    ds_read_b128 v[20:23], v1 offset:3072
    v_smfmac_f32_16x16x64_bf16 v[52:55], v[64:67], v[160:167], v9
    ds_read_b128 v[16:19], v1 offset:2048
    v_smfmac_f32_16x16x64_bf16 v[52:55], v[68:71], v[168:175], v9
    ds_read_b128 v[72:75], v1 offset:0
    v_add_f32 v25, v25, v27
    v_smfmac_f32_16x16x64_bf16 v[40:43], v[64:67], v[176:183], v9
    ds_read_b128 v[76:79], v1 offset:1024
    v_add_f32 v24, v24, v26
    v_cvt_pk_bf16_f32 v24, v24, v25
    v_smfmac_f32_16x16x64_bf16 v[40:43], v[68:71], v[184:191], v9
    v_smfmac_f32_16x16x64_bf16 v[60:63], v[64:67], v[192:199], v9
    buffer_store_dword v24, v2, s[32:35], s36 offen
    v_add_f32 v52, v52, v54
    v_add_f32 v53, v53, v55
    v_smfmac_f32_16x16x64_bf16 v[60:63], v[68:71], v[200:207], v9
    v_add_f32 v40, v40, v42
    v_add_f32 v41, v41, v43
    v_cvt_pk_bf16_f32 v40, v40, v41
    v_cvt_pk_bf16_f32 v52, v52, v53
    s_waitcnt lgkmcnt(0)
    v_smfmac_f32_16x16x64_bf16 v[44:47], v[64:67], v[72:79], v9
    buffer_store_dword v52, v2, s[32:35], s37 offen
    v_add_f32 v61, v61, v63
    v_add_f32 v60, v60, v62
    v_smfmac_f32_16x16x64_bf16 v[44:47], v[68:71], v[16:23], v9
    ds_read_b128 v[20:23], v1 offset:19456
    v_smfmac_f32_16x16x64_bf16 v[48:51], v[64:67], v[208:215], v9
    buffer_store_dword v40, v2, s[32:35], s38 offen
    v_cvt_pk_bf16_f32 v60, v60, v61
    v_smfmac_f32_16x16x64_bf16 v[48:51], v[68:71], v[216:223], v9
    ds_read_b128 v[72:75], v1 offset:16384
    ds_read_b128 v[76:79], v1 offset:17408
    v_smfmac_f32_16x16x64_bf16 v[56:59], v[64:67], v[224:231], v9
    buffer_store_dword v60, v2, s[32:35], s39 offen
    v_add_f32 v44, v44, v46
    v_add_f32 v45, v45, v47
    v_cvt_pk_bf16_f32 v44, v44, v45
    v_smfmac_f32_16x16x64_bf16 v[56:59], v[68:71], v[232:239], v9
    ds_read_b128 v[16:19], v1 offset:18432
    v_smfmac_f32_16x16x64_bf16 v[32:35], v[64:67], v[240:247], v9
    buffer_store_dword v44, v2, s[32:35], s40 offen
    v_add_f32 v48, v48, v50
    v_add_f32 v49, v49, v51
    v_cvt_pk_bf16_f32 v48, v48, v49
    v_smfmac_f32_16x16x64_bf16 v[32:35], v[68:71], v[248:255], v9
    s_waitcnt lgkmcnt(1)
    v_smfmac_f32_16x16x64_bf16 v[36:39], v[64:67], v[72:79], v9
    buffer_store_dword v48, v2, s[32:35], s41 offen
    v_add_f32 v57, v57, v59
    v_add_f32 v56, v56, v58
    v_cvt_pk_bf16_f32 v56, v56, v57
    s_waitcnt lgkmcnt(0)
    v_smfmac_f32_16x16x64_bf16 v[36:39], v[68:71], v[16:23], v9
    buffer_store_dword v56, v2, s[32:35], s42 offen
    v_add_f32 v32, v32, v34
    v_add_f32 v33, v33, v35
    v_cvt_pk_bf16_f32 v32, v32, v33
    buffer_store_dword v32, v2, s[32:35], s43 offen
    s_nop 0
    v_add_f32 v36, v36, v38
    v_add_f32 v37, v37, v39
    v_cvt_pk_bf16_f32 v36, v36, v37
    buffer_store_dword v36, v2, s[32:35], s44 offen
    s_add_u32 s64, s64, 1
    s_branch ttop_54
tw_51l:
    s_waitcnt lgkmcnt(0)
    s_barrier
    ds_read_b128 v[16:19], v0 offset:0
    ds_read_b128 v[20:23], v0 offset:1024
    ds_read_b128 v[52:55], v1 offset:35840
    ds_read_b128 v[24:27], v0 offset:2048
    s_waitcnt lgkmcnt(3)
    v_smfmac_f32_16x16x64_bf16 v[44:47], v[16:19], a[152:159], v9
    ds_read_b128 v[48:51], v1 offset:34816
    v_smfmac_f32_16x16x64_bf16 v[36:39], v[16:19], v[96:103], v9
    v_smfmac_f32_16x16x64_bf16 v[40:43], v[16:19], a[96:103], v9
    ds_read_b128 v[28:31], v0 offset:3072
    s_waitcnt lgkmcnt(2)
    v_smfmac_f32_16x16x64_bf16 v[44:47], v[24:27], a[160:167], v9
    ds_read_b128 v[76:79], v1 offset:33792
    v_smfmac_f32_16x16x64_bf16 v[40:43], v[24:27], a[104:111], v9
    ds_read_b128 v[72:75], v1 offset:32768
    s_waitcnt lgkmcnt(3)
    v_smfmac_f32_16x16x64_bf16 v[44:47], v[20:23], v[48:55], v9
    s_waitcnt vmcnt(5)
    s_barrier
    v_smfmac_f32_16x16x64_bf16 v[32:35], v[16:19], a[208:215], v9
    v_smfmac_f32_16x16x64_bf16 v[32:35], v[20:23], a[216:223], v9
    v_smfmac_f32_16x16x64_bf16 v[32:35], v[24:27], a[224:231], v9
    s_waitcnt lgkmcnt(2)
    v_smfmac_f32_16x16x64_bf16 v[32:35], v[28:31], a[232:239], v9
    ds_read_b128 v[16:19], v0 offset:4096
    v_smfmac_f32_16x16x64_bf16 v[36:39], v[20:23], v[104:111], v9
    s_waitcnt lgkmcnt(1)
    v_smfmac_f32_16x16x64_bf16 v[40:43], v[20:23], v[72:79], v9
    v_smfmac_f32_16x16x64_bf16 v[40:43], v[28:31], a[112:119], v9
    ds_read_b128 v[20:23], v0 offset:5120
    v_add_u32 v1, 0x10000, v1
    v_smfmac_f32_16x16x64_bf16 v[36:39], v[24:27], v[112:119], v9
    ds_read_b128 v[52:55], v1 offset:19456
    s_waitcnt lgkmcnt(2)
    v_smfmac_f32_16x16x64_bf16 v[32:35], v[16:19], a[240:247], v9
    ds_read_b128 v[24:27], v0 offset:6144
    v_smfmac_f32_16x16x64_bf16 v[44:47], v[28:31], a[168:175], v9
    v_smfmac_f32_16x16x64_bf16 v[36:39], v[28:31], v[120:127], v9
    ds_read_b128 v[28:31], v0 offset:7168
    v_smfmac_f32_16x16x64_bf16 v[44:47], v[16:19], a[176:183], v9
    ds_read_b128 v[76:79], v1 offset:17408
    v_smfmac_f32_16x16x64_bf16 v[36:39], v[16:19], v[128:135], v9
    ds_read_b128 v[48:51], v1 offset:18432
    s_waitcnt lgkmcnt(5)
    v_smfmac_f32_16x16x64_bf16 v[32:35], v[20:23], a[248:255], v9
    ds_read_b128 v[72:75], v1 offset:16384
    v_smfmac_f32_16x16x64_bf16 v[40:43], v[16:19], a[120:127], v9
    ds_read_b128 v[16:19], v0 offset:8192
    v_smfmac_f32_16x16x64_bf16 v[44:47], v[20:23], a[184:191], v9
    v_smfmac_f32_16x16x64_bf16 v[40:43], v[20:23], a[128:135], v9
    s_waitcnt lgkmcnt(2)
    v_smfmac_f32_16x16x64_bf16 v[44:47], v[24:27], v[48:55], v9
    ds_read_b128 v[48:51], v1 offset:34816
    v_smfmac_f32_16x16x64_bf16 v[32:35], v[24:27], v[80:87], v9
    s_waitcnt lgkmcnt(2)
    v_smfmac_f32_16x16x64_bf16 v[40:43], v[24:27], v[72:79], v9
    v_smfmac_f32_16x16x64_bf16 v[40:43], v[28:31], a[136:143], v9
    ds_read_b128 v[52:55], v1 offset:35840
    s_waitcnt lgkmcnt(2)
    v_smfmac_f32_16x16x64_bf16 v[40:43], v[16:19], a[144:151], v9
    v_smfmac_f32_16x16x64_bf16 v[44:47], v[28:31], a[192:199], v9
    ds_read_b128 v[72:75], v1 offset:32768
    v_smfmac_f32_16x16x64_bf16 v[36:39], v[20:23], v[136:143], v9
    ds_read_b128 v[76:79], v1 offset:33792
    v_add_f32 v40, v40, v42
    v_smfmac_f32_16x16x64_bf16 v[32:35], v[28:31], v[88:95], v9
    v_add_f32 v41, v41, v43
    v_smfmac_f32_16x16x64_bf16 v[44:47], v[16:19], a[200:207], v9
    v_cvt_pk_bf16_f32 v12, v40, v41
    v_smfmac_f32_16x16x64_bf16 v[36:39], v[24:27], v[144:151], v9
    v_smfmac_f32_16x16x64_bf16 v[36:39], v[28:31], v[152:159], v9
    s_waitcnt lgkmcnt(0)
    v_smfmac_f32_16x16x64_bf16 v[32:35], v[16:19], v[72:79], v9
    v_add_f32 v45, v45, v47
    v_smfmac_f32_16x16x64_bf16 v[36:39], v[16:19], v[48:55], v9
    v_cmp_u_f32 vcc, v40, v41
    v_add_f32 v44, v44, v46
    v_mfma_f32_16x16x16_bf16 v[40:43], v[12:13], v[8:9], 0
    v_cvt_pk_bf16_f32 v12, v44, v45
    v_add_f32 v32, v32, v34
    v_add_f32 v33, v33, v35
    v_mfma_f32_16x16x16_bf16 v[44:47], v[12:13], v[8:9], 0
    s_cbranch_vccnz tredo_52l
tredo_52lr:
    v_cvt_pk_bf16_f32 v32, v32, v33
    v_add_f32 v36, v36, v38
    v_add_f32 v37, v37, v39
    v_cvt_pk_bf16_f32 v33, v36, v37
    v_cvt_pk_bf16_f32 v40, v40, v41
    v_cvt_pk_bf16_f32 v41, v42, v43
    s_nop 0
    v_cvt_pk_bf16_f32 v42, v44, v45
    v_cvt_pk_bf16_f32 v43, v46, v47
    v_cndmask_b32 v34, v40, v42, s[94:95]
    v_cndmask_b32 v35, v41, v43, s[94:95]
    buffer_store_dwordx4 v[32:35], v0, s[32:35], s77 offen sc1
    s_endpgm
ttop_54a:
    v_lshlrev_b32 v56, 3, v0
    v_and_b32 v57, 0x780, v56
    s_mov_b32 s57, 133120
    s_mov_b32 s58, 141312
wteam_55:
    buffer_load_dword v58, v56, s[32:35], s57 offen sc1
    buffer_load_dword v59, v57, s[32:35], s58 offen sc1
    s_sub_i32 s54, s54, 1
    s_cmp_lt_i32 s54, 0
    s_waitcnt vmcnt(0)
    s_cbranch_scc1 wteamd_56
    v_and_b32 v58, v58, v59
    v_cmp_eq_u32 vcc, 0, v58
    s_cbranch_vccz wteamd_56
    s_sleep 2
    s_branch wteam_55
wteamd_56:
    s_sleep 8
    s_branch ttop_54b
tp_57:
    buffer_load_dwordx4 v[56:59], v0, s[32:35], s68 offen offset:0 sc1
    buffer_load_dwordx4 v[60:63], v0, s[32:35], s68 offen offset:1024 sc1
    buffer_load_dwordx4 v[64:67], v0, s[32:35], s68 offen offset:2048 sc1
    buffer_load_dwordx4 v[68:71], v0, s[32:35], s68 offen offset:3072 sc1
    s_sub_i32 s54, s54, 1
    s_cmp_lt_i32 s54, 0
    s_cselect_b64 s[96:97], 0, -1
    s_waitcnt vmcnt(3) lgkmcnt(4)
    v_mfma_f32_16x16x32_bf16 v[20:23], v[16:19], v[56:59], 0
    s_waitcnt vmcnt(2)
    v_mfma_f32_16x16x32_bf16 v[20:23], v[16:19], v[60:63], v[20:23]
    s_waitcnt vmcnt(1)
    v_mfma_f32_16x16x32_bf16 v[20:23], v[16:19], v[64:67], v[20:23]
    s_waitcnt vmcnt(0)
    v_mfma_f32_16x16x32_bf16 v[20:23], v[16:19], v[68:71], v[20:23]
    s_nop 7
    v_add_f32_dpp v20, v20, v20 row_ror:8 row_mask:0xf bank_mask:0xf
    v_add_f32_dpp v21, v21, v21 row_ror:8 row_mask:0xf bank_mask:0xf
    v_cvt_pk_bf16_f32 v20, v20, v21
    v_cmp_u_f32 vcc, v21, v21
    buffer_store_dword v20, v4, s[32:35], s81 offen
    s_and_b64 vcc, vcc, s[96:97]
    s_cbranch_vccnz tp_57
    s_cmp_lg_u32 s53, 8
    s_cbranch_scc1 tw_51s
    s_sleep 5
tw_51s:
    s_branch tpd_58
tredo_52l:
    s_cmp_lt_i32 s49, 1
    s_cbranch_scc1 tredo_52lr
tredo_52:
    s_sub_i32 s49, s49, 1
    s_cmp_lt_i32 s49, 0
    s_cbranch_scc1 tredo_52r
    s_mov_b32 s45, s69
    s_waitcnt lgkmcnt(0)
    s_nop 7
    v_add_u32 v1, s63, v0
    v_and_b32 v2, 0x7ffff, v2
    v_or_b32 v2, s51, v2
    v_mov_b64 v[32:33], 0
    v_mov_b64 v[34:35], 0
    v_mov_b64 v[36:37], 0
    v_mov_b64 v[38:39], 0
    v_mov_b64 v[40:41], 0
    v_mov_b64 v[42:43], 0
    v_mov_b64 v[44:45], 0
    v_mov_b64 v[46:47], 0
    v_lshlrev_b32 v12, 3, v0
    ds_read_b128 v[72:75], v1 offset:16384
    ds_read_b128 v[76:79], v1 offset:17408
    ds_read_b128 v[48:51], v1 offset:18432
    ds_read_b128 v[52:55], v1 offset:19456
    s_barrier
    s_branch tm_53
tcls1_48:
    buffer_load_dwordx4 v[64:67], v0, s[32:35], s73 offen offset:0 sc1
    buffer_load_dwordx4 v[68:71], v0, s[32:35], s73 offen offset:1024 sc1
    s_barrier
    buffer_store_dwordx4 v[28:31], v0, s[32:35], s45 offen sc1
    v_add_u32 v1, s63, v0
    v_and_b32 v2, 0x7ffff, v2
    v_or_b32 v2, s51, v2
    v_mov_b64 v[32:33], 0
    v_mov_b64 v[34:35], 0
    v_mov_b64 v[36:37], 0
    v_mov_b64 v[38:39], 0
    v_mov_b64 v[40:41], 0
    v_mov_b64 v[42:43], 0
    v_mov_b64 v[44:45], 0
    v_mov_b64 v[46:47], 0
    ds_read_b128 v[72:75], v1 offset:16384
    ds_read_b128 v[76:79], v1 offset:17408
    ds_read_b128 v[48:51], v1 offset:18432
    ds_read_b128 v[52:55], v1 offset:19456
    s_waitcnt lgkmcnt(0)
    s_branch tw_59
.p2align 6
ttop_62:
    s_cmp_eq_u32 s64, 1
    s_cbranch_scc1 ttop_62a
ttop_62b:
    s_and_b32 s57, s64, 3
    s_lshl_b32 s58, s57, 14
    s_add_u32 s81, s70, s58
    s_add_u32 s85, s58, 7405568
    s_xor_b32 s51, s57, 2
    s_lshl_b32 s51, s51, 19
    s_add_u32 s72, s72, 786432
    s_add_u32 s73, s73, 786432
    s_mov_b32 s45, s77
    s_add_u32 s77, s77, 131072
    s_sub_u32 s99, s64, 1
    s_nop 15
    s_nop 15
    s_nop 13
    buffer_load_dwordx4 v[56:59], v0, s[32:35], s68 offen offset:0 sc1
    buffer_load_dwordx4 v[60:63], v0, s[32:35], s68 offen offset:1024 sc1
    buffer_load_dwordx4 v[64:67], v0, s[32:35], s68 offen offset:2048 sc1
    buffer_load_dwordx4 v[68:71], v0, s[32:35], s68 offen offset:3072 sc1
    ds_read_b128 v[16:19], v0 offset:15360
    v_add_u32 v1, s63, v0
    v_and_b32 v2, 0x7ffff, v2
    v_or_b32 v2, s51, v2
    v_mov_b64 v[32:33], 0
    v_mov_b64 v[34:35], 0
    v_mov_b64 v[36:37], 0
    v_mov_b64 v[38:39], 0
    v_mov_b64 v[40:41], 0
    v_mov_b64 v[42:43], 0
    v_mov_b64 v[44:45], 0
    v_mov_b64 v[46:47], 0
    ds_read_b128 v[72:75], v1 offset:16384
    ds_read_b128 v[76:79], v1 offset:17408
    ds_read_b128 v[48:51], v1 offset:18432
    ds_read_b128 v[52:55], v1 offset:19456
    s_waitcnt vmcnt(3) lgkmcnt(4)
    v_mfma_f32_16x16x32_bf16 v[20:23], v[16:19], v[56:59], 0
    s_waitcnt vmcnt(2)
    v_mfma_f32_16x16x32_bf16 v[20:23], v[16:19], v[60:63], v[20:23]
    s_waitcnt vmcnt(1)
    v_mfma_f32_16x16x32_bf16 v[20:23], v[16:19], v[64:67], v[20:23]
    s_waitcnt vmcnt(0)
    v_mfma_f32_16x16x32_bf16 v[20:23], v[16:19], v[68:71], v[20:23]
    s_nop 7
    v_add_f32_dpp v20, v20, v20 row_ror:8 row_mask:0xf bank_mask:0xf
    v_add_f32_dpp v21, v21, v21 row_ror:8 row_mask:0xf bank_mask:0xf
    v_cvt_pk_bf16_f32 v20, v20, v21
    v_cmp_u_f32 vcc, v21, v21
    buffer_store_dword v20, v4, s[32:35], s81 offen
    s_cbranch_vccnz tp_65
tpd_66:
    s_lshl_b32 s57, s57, 19
    s_add_u32 s68, s50, s57
    s_and_b32 s57, s99, 3
    s_lshl_b32 s57, s57, 14
    s_add_u32 s67, s70, s57
tm_61:
    s_add_u32 m0, s56, 4096
    s_add_u32 s57, s85, m0
    s_add_u32 s58, s85, 8192
    s_barrier
    buffer_load_dwordx4 v0, s[32:35], s57 offen sc1 lds
    s_nop 5
    buffer_load_dwordx4 v[56:59], v0, s[32:35], s72 offen offset:0 sc1
    buffer_load_dwordx4 v[60:63], v0, s[32:35], s72 offen offset:1024 sc1
    s_barrier
    buffer_load_dwordx4 v[64:67], v0, s[32:35], s73 offen offset:0 sc1
    buffer_load_dwordx4 v[68:71], v0, s[32:35], s73 offen offset:1024 sc1
    s_barrier
    buffer_store_dwordx4 v[28:31], v0, s[32:35], s45 offen sc1
    s_cmp_eq_u32 s64, 63
    s_cbranch_scc1 tw_59l
    s_waitcnt lgkmcnt(0)
tw_59:
    s_barrier
    ds_read_b128 v[16:19], v0 offset:0
    ds_read_b128 v[24:27], v0 offset:2048
    ds_read_b128 v[20:23], v0 offset:1024
    buffer_store_dword v15, v2, s[32:35], s37 offen
    s_waitcnt lgkmcnt(2)
    v_smfmac_f32_16x16x64_bf16 v[32:35], v[16:19], v[72:79], v9
    ds_read_b128 v[76:79], v1 offset:33792
    v_smfmac_f32_16x16x64_bf16 v[36:39], v[16:19], v[48:55], v9
    ds_read_b128 v[52:55], v1 offset:35840
    s_waitcnt lgkmcnt(2)
    v_smfmac_f32_16x16x64_bf16 v[32:35], v[20:23], a[0:7], v9
    ds_read_b128 v[28:31], v0 offset:3072
    v_smfmac_f32_16x16x64_bf16 v[36:39], v[20:23], a[48:55], v9
    ds_read_b128 v[48:51], v1 offset:34816
    v_smfmac_f32_16x16x64_bf16 v[40:43], v[16:19], a[96:103], v9
    ds_read_b128 v[72:75], v1 offset:32768
    v_smfmac_f32_16x16x64_bf16 v[44:47], v[16:19], a[152:159], v9
    s_waitcnt vmcnt(6)
    s_barrier
    v_smfmac_f32_16x16x64_bf16 v[32:35], v[24:27], a[8:15], v9
    v_smfmac_f32_16x16x64_bf16 v[36:39], v[24:27], a[56:63], v9
    ds_read_b128 v[16:19], v0 offset:4096
    s_waitcnt lgkmcnt(1)
    v_smfmac_f32_16x16x64_bf16 v[40:43], v[20:23], v[72:79], v9
    ds_read_b128 v[72:75], v1 offset:49152
    v_smfmac_f32_16x16x64_bf16 v[44:47], v[20:23], v[48:55], v9
    ds_read_b128 v[76:79], v1 offset:50176
    v_smfmac_f32_16x16x64_bf16 v[32:35], v[28:31], a[16:23], v9
    ds_read_b128 v[48:51], v1 offset:51200
    v_smfmac_f32_16x16x64_bf16 v[36:39], v[28:31], a[64:71], v9
    ds_read_b128 v[52:55], v1 offset:52224
    v_add_u32 v1, 0x10000, v1
    v_smfmac_f32_16x16x64_bf16 v[40:43], v[24:27], a[104:111], v9
    ds_read_b128 v[20:23], v0 offset:5120
    v_smfmac_f32_16x16x64_bf16 v[44:47], v[24:27], a[160:167], v9
    buffer_store_dword v15, v2, s[32:35], s36 offen
    ds_read_b128 v[24:27], v0 offset:6144
    s_waitcnt lgkmcnt(4)
    v_smfmac_f32_16x16x64_bf16 v[32:35], v[16:19], v[72:79], v9
    ds_read_b128 v[72:75], v1 offset:0
    s_waitcnt lgkmcnt(3)
    v_smfmac_f32_16x16x64_bf16 v[36:39], v[16:19], v[48:55], v9
    ds_read_b128 v[76:79], v1 offset:1024
    v_smfmac_f32_16x16x64_bf16 v[40:43], v[28:31], a[112:119], v9
    buffer_store_dword v15, v2, s[32:35], s40 offen
    v_smfmac_f32_16x16x64_bf16 v[44:47], v[28:31], a[168:175], v9
    ds_read_b128 v[48:51], v1 offset:2048
    s_waitcnt lgkmcnt(4)
    v_smfmac_f32_16x16x64_bf16 v[32:35], v[20:23], a[24:31], v9
    ds_read_b128 v[52:55], v1 offset:3072
    v_smfmac_f32_16x16x64_bf16 v[36:39], v[20:23], a[72:79], v9
    v_smfmac_f32_16x16x64_bf16 v[40:43], v[16:19], a[120:127], v9
    buffer_store_dword v15, v2, s[32:35], s41 offen
    v_smfmac_f32_16x16x64_bf16 v[44:47], v[16:19], a[176:183], v9
    ds_read_b128 v[28:31], v0 offset:7168
    ds_read_b128 v[16:19], v0 offset:8192
    s_waitcnt lgkmcnt(4)
    v_smfmac_f32_16x16x64_bf16 v[32:35], v[24:27], v[72:79], v9
    buffer_store_dword v15, v2, s[32:35], s39 offen
    s_waitcnt lgkmcnt(2)
    v_smfmac_f32_16x16x64_bf16 v[36:39], v[24:27], v[48:55], v9
    ds_read_b128 v[52:55], v1 offset:19456
    ds_read_b128 v[72:75], v1 offset:16384
    v_smfmac_f32_16x16x64_bf16 v[40:43], v[20:23], a[128:135], v9
    buffer_store_dword v15, v2, s[32:35], s42 offen
    v_smfmac_f32_16x16x64_bf16 v[44:47], v[20:23], a[184:191], v9
    ds_read_b128 v[48:51], v1 offset:18432
    ds_read_b128 v[76:79], v1 offset:17408
    s_waitcnt lgkmcnt(5)
    v_smfmac_f32_16x16x64_bf16 v[32:35], v[28:31], a[32:39], v9
    buffer_store_dword v15, v2, s[32:35], s38 offen
    v_smfmac_f32_16x16x64_bf16 v[36:39], v[28:31], a[80:87], v9
    s_waitcnt lgkmcnt(4)
    v_smfmac_f32_16x16x64_bf16 v[32:35], v[16:19], a[40:47], v9
    buffer_store_dword v15, v2, s[32:35], s43 offen
    v_smfmac_f32_16x16x64_bf16 v[36:39], v[16:19], a[88:95], v9
    s_waitcnt lgkmcnt(0)
    v_smfmac_f32_16x16x64_bf16 v[40:43], v[24:27], v[72:79], v9
    buffer_store_dword v15, v2, s[32:35], s44 offen
    v_add_f32 v33, v33, v35
    v_smfmac_f32_16x16x64_bf16 v[44:47], v[24:27], v[48:55], v9
    v_add_f32 v32, v32, v34
    v_smfmac_f32_16x16x64_bf16 v[40:43], v[28:31], a[136:143], v9
    ds_read_b128 v[72:75], v1 offset:32768
    v_add_f32 v36, v36, v38
    v_smfmac_f32_16x16x64_bf16 v[44:47], v[28:31], a[192:199], v9
    v_add_f32 v37, v37, v39
    v_smfmac_f32_16x16x64_bf16 v[40:43], v[16:19], a[144:151], v9
    v_cvt_pk_bf16_f32 v12, v32, v33
    v_mov_b64 v[48:49], 0
    v_cmp_u_f32 vcc, v32, v33
    v_mfma_f32_16x16x16_bf16 v[32:35], v[12:13], v[8:9], 0
    v_cvt_pk_bf16_f32 v12, v36, v37
    v_mov_b64 v[54:55], 0
    v_add_f32 v41, v41, v43
    v_mfma_f32_16x16x16_bf16 v[36:39], v[12:13], v[8:9], 0
    v_add_f32 v40, v40, v42
    v_cvt_pk_bf16_f32 v12, v40, v41
    v_mov_b64 v[52:53], 0
    v_smfmac_f32_16x16x64_bf16 v[44:47], v[16:19], a[200:207], v9
    ds_read_b128 v[76:79], v1 offset:33792
    v_cvt_pk_bf16_f32 v32, v32, v33
    v_cvt_pk_bf16_f32 v33, v34, v35
    v_cvt_pk_bf16_f32 v34, v36, v37
    v_mfma_f32_16x16x16_bf16 v[40:43], v[12:13], v[8:9], 0
    v_cvt_pk_bf16_f32 v35, v38, v39
    v_mov_b64 v[50:51], 0
    v_add_f32 v45, v45, v47
    s_waitcnt vmcnt(13)
    v_mfma_f32_16x16x32_bf16 v[56:59], v[56:59], v[32:35], 0
    v_add_f32 v44, v44, v46
    v_cvt_pk_bf16_f32 v12, v44, v45
    v_smfmac_f32_16x16x64_bf16 v[48:51], v[20:23], a[248:255], v9
    s_cbranch_vccnz tredo_60
tredo_60r:
    v_mfma_f32_16x16x16_bf16 v[44:47], v[12:13], v[8:9], 0
    s_nop 0
    ds_write_b128 v3, v[56:59] offset:9216
    v_cvt_pk_bf16_f32 v40, v40, v41
    v_cvt_pk_bf16_f32 v41, v42, v43
    s_waitcnt vmcnt(12)
    v_mfma_f32_16x16x32_bf16 v[60:63], v[60:63], v[32:35], 0
    s_nop 1
    v_cvt_pk_bf16_f32 v43, v46, v47
    v_cvt_pk_bf16_f32 v42, v44, v45
    v_smfmac_f32_16x16x64_bf16 v[52:55], v[20:23], v[136:143], v9
    buffer_store_dword v15, v4, s[32:35], s67 offen
    v_mfma_f32_16x16x32_bf16 v[44:47], v[40:43], v[32:35], 0
    ds_write_b128 v3, v[60:63] offset:9728
    v_smfmac_f32_16x16x64_bf16 v[48:51], v[24:27], v[80:87], v9
    s_nop 4
    ds_write_b64 v5, v[44:45] offset:13312
    v_smfmac_f32_16x16x64_bf16 v[52:55], v[24:27], v[144:151], v9
    ds_read_b128 v[24:27], v0 offset:1024
    v_smfmac_f32_16x16x64_bf16 v[48:51], v[28:31], v[88:95], v9
    ds_read_b128 v[20:23], v0 offset:0
    v_smfmac_f32_16x16x64_bf16 v[52:55], v[28:31], v[152:159], v9
    ds_read_b128 v[28:31], v0 offset:2048
    s_waitcnt lgkmcnt(3)
    s_barrier
    v_smfmac_f32_16x16x64_bf16 v[48:51], v[16:19], v[72:79], v9
    ds_read_b64 v[46:47], v6 offset:14336
    ds_read_b64 v[44:45], v6 offset:13312
    s_waitcnt lgkmcnt(3)
    v_smfmac_f32_16x16x64_bf16 v[48:51], v[20:23], a[208:215], v9
    ds_read_b128 v[32:35], v6 offset:11264
    v_smfmac_f32_16x16x64_bf16 v[52:55], v[20:23], v[96:103], v9
    ds_read_b128 v[20:23], v0 offset:3072
    v_smfmac_f32_16x16x64_bf16 v[48:51], v[24:27], a[216:223], v9
    ds_read_b128 v[36:39], v6 offset:12288
    v_smfmac_f32_16x16x64_bf16 v[52:55], v[24:27], v[104:111], v9
    ds_read_b128 v[60:63], v6 offset:10240
    s_waitcnt lgkmcnt(4)
    v_add_f32 v45, v45, v47
    v_add_f32 v44, v44, v46
    v_smfmac_f32_16x16x64_bf16 v[48:51], v[28:31], a[224:231], v9
    ds_read_b128 v[56:59], v6 offset:9216
    v_add_f32_dpp v44, v44, v44 quad_perm:[2,3,0,1] row_mask:0xf bank_mask:0xf
    v_smfmac_f32_16x16x64_bf16 v[52:55], v[28:31], v[112:119], v9
    ds_read_b128 v[72:75], v1 offset:34816
    s_waitcnt lgkmcnt(3)
    v_add_f32 v35, v35, v39
    v_smfmac_f32_16x16x64_bf16 v[48:51], v[20:23], a[232:239], v9
    ds_read_b128 v[24:27], v0 offset:4096
    v_add_f32 v34, v34, v38
    v_smfmac_f32_16x16x64_bf16 v[52:55], v[20:23], v[120:127], v9
    ds_read_b128 v[76:79], v1 offset:35840
    v_add_f32 v33, v33, v37
    v_add_f32 v32, v32, v36
    s_waitcnt lgkmcnt(3)
    v_add_f32 v59, v59, v63
    v_add_f32 v59, v59, v35
    v_add_f32_dpp v45, v45, v45 quad_perm:[2,3,0,1] row_mask:0xf bank_mask:0xf
    v_add_f32 v58, v58, v62
    v_add_f32 v56, v56, v60
    v_add_f32 v56, v56, v32
    v_add_f32 v57, v57, v61
    v_add_f32 v58, v58, v34
    v_add_f32 v57, v57, v33
    v_max3_f32 v62, v56, v57, v58
    v_max_f32 v62, v62, v59
    s_waitcnt lgkmcnt(0)
    v_smfmac_f32_16x16x64_bf16 v[52:55], v[16:19], v[72:79], v9
    ds_read_b128 v[76:79], v1 offset:50176
    v_max_f32_dpp v62, v62, v62 quad_perm:[2,3,0,1] row_mask:0xf bank_mask:0xf
    v_max3_f32 v62, v62, v44, v45
    v_mov_b32 v63, v62
    v_smfmac_f32_16x16x64_bf16 v[48:51], v[24:27], a[240:247], v9
    v_permlane32_swap_b32 v62, v63
    v_max_f32 v62, v62, v63
    v_mov_b32 v63, v62
    v_smfmac_f32_16x16x64_bf16 v[52:55], v[24:27], v[128:135], v9
    ds_read_b128 v[72:75], v1 offset:49152
    v_permlane16_swap_b32 v62, v63
    v_max_f32 v62, v62, v63
    v_add_f32 v48, v48, v50
    v_mul_f32 v63, s75, v62
    v_fma_f32 v45, v45, s75, -v63
    v_fma_f32 v59, v59, s75, -v63
    v_exp_f32 v59, v59
    v_add_f32 v52, v52, v54
    v_exp_f32 v45, v45
    v_fma_f32 v58, v58, s75, -v63
    v_add_f32 v53, v53, v55
    v_exp_f32 v58, v58
    v_fma_f32 v57, v57, s75, -v63
    v_fma_f32 v44, v44, s75, -v63
    v_exp_f32 v44, v44
    v_exp_f32 v57, v57
    v_add_f32 v49, v49, v51
    v_cvt_pk_bf16_f32 v44, v44, v45
    v_cndmask_b32 v46, v44, 0, s[94:95]
    v_cvt_pk_bf16_f32 v48, v48, v49
    v_cndmask_b32 v47, 0, v44, s[94:95]
    v_fma_f32 v56, v56, s75, -v63
    v_cvt_pk_bf16_f32 v61, v58, v59
    v_cvt_pk_bf16_f32 v49, v52, v53
    v_exp_f32 v56, v56
    v_mfma_f32_16x16x16_bf16 v[32:35], v[48:49], v[46:47], 0
    v_cvt_pk_bf16_f32 v60, v56, v57
    v_mov_b32_dpp v57, v61 quad_perm:[0,1,0,1] row_mask:0xf bank_mask:0xf
    v_mfma_f32_16x16x16_bf16 v[36:39], v[10:11], v[46:47], 0
    v_mov_b32_dpp v56, v60 quad_perm:[0,1,0,1] row_mask:0xf bank_mask:0xf
    v_mov_b32_dpp v58, v60 quad_perm:[2,3,2,3] row_mask:0xf bank_mask:0xf
    v_mov_b32_dpp v59, v61 quad_perm:[2,3,2,3] row_mask:0xf bank_mask:0xf
    v_mfma_f32_16x16x16_bf16 v[36:39], v[10:11], v[56:57], v[36:39]
    v_mfma_f32_16x16x16_bf16 v[36:39], v[10:11], v[58:59], v[36:39]
    v_mov_b32 v12, 0
    s_waitcnt vmcnt(11)
    v_mfma_f32_16x16x32_bf16 v[68:71], v[68:71], v[56:59], v[32:35]
    ds_read_b128 v[20:23], v1 offset:52224
    v_mfma_f32_16x16x32_bf16 v[64:67], v[64:67], v[56:59], v[32:35]
    s_barrier
    v_rcp_f32 v14, v36
    v_mfma_f32_16x16x16_bf16 v[32:35], v[12:13], v[10:11], 0
    ds_read_b128 v[16:19], v1 offset:51200
    s_nop 3
    v_cndmask_b32 v65, v65, v69, s[94:95]
    v_cndmask_b32 v67, v67, v71, s[94:95]
    v_cndmask_b32 v64, v64, v68, s[94:95]
    v_mul_f32 v64, v64, v14
    v_mul_f32 v65, v65, v14
    v_cvt_pk_bf16_f32 v64, v64, v65
    v_cndmask_b32 v66, v66, v70, s[94:95]
    v_mul_f32 v66, v66, v14
    v_mul_f32 v67, v67, v14
    v_cvt_pk_bf16_f32 v65, v66, v67
    v_mfma_f32_16x16x16_bf16 v[56:59], v[12:13], v[10:11], 0
    ds_write_b64 v7, v[64:65] offset:9216
    v_cndmask_b32 v31, v41, v43, s[94:95]
    v_cndmask_b32 v30, v40, v42, s[94:95]
    v_mfma_f32_16x16x16_bf16 v[44:47], v[12:13], v[10:11], 0
    v_add_u32 v1, 0x10000, v1
    v_mfma_f32_16x16x16_bf16 v[24:27], v[12:13], v[10:11], 0
    v_mfma_f32_16x16x16_bf16 v[52:55], v[12:13], v[10:11], 0
    s_waitcnt lgkmcnt(0)
    s_barrier
    v_mfma_f32_16x16x16_bf16 v[40:43], v[12:13], v[10:11], 0
    ds_read_b128 v[64:67], v6 offset:9216
    v_mov_b64 v[28:29], v[48:49]
    v_mfma_f32_16x16x16_bf16 v[48:51], v[12:13], v[10:11], 0
    ds_read_b128 v[68:71], v6 offset:10240
    v_mfma_f32_16x16x16_bf16 v[60:63], v[12:13], v[10:11], 0
    v_mfma_f32_16x16x16_bf16 v[36:39], v[12:13], v[10:11], 0
    v_xor_b32 v2, 0x100000, v2
    s_waitcnt lgkmcnt(1)
    v_smfmac_f32_16x16x64_bf16 v[24:27], v[64:67], v[72:79], v9
    s_waitcnt lgkmcnt(0)
    v_smfmac_f32_16x16x64_bf16 v[24:27], v[68:71], v[16:23], v9
    ds_read_b128 v[20:23], v1 offset:3072
    v_smfmac_f32_16x16x64_bf16 v[52:55], v[64:67], v[160:167], v9
    ds_read_b128 v[16:19], v1 offset:2048
    v_smfmac_f32_16x16x64_bf16 v[52:55], v[68:71], v[168:175], v9
    ds_read_b128 v[72:75], v1 offset:0
    v_add_f32 v25, v25, v27
    v_smfmac_f32_16x16x64_bf16 v[40:43], v[64:67], v[176:183], v9
    ds_read_b128 v[76:79], v1 offset:1024
    v_add_f32 v24, v24, v26
    v_cvt_pk_bf16_f32 v24, v24, v25
    v_smfmac_f32_16x16x64_bf16 v[40:43], v[68:71], v[184:191], v9
    v_smfmac_f32_16x16x64_bf16 v[60:63], v[64:67], v[192:199], v9
    buffer_store_dword v24, v2, s[32:35], s36 offen
    v_add_f32 v52, v52, v54
    v_add_f32 v53, v53, v55
    v_smfmac_f32_16x16x64_bf16 v[60:63], v[68:71], v[200:207], v9
    v_add_f32 v40, v40, v42
    v_add_f32 v41, v41, v43
    v_cvt_pk_bf16_f32 v40, v40, v41
    v_cvt_pk_bf16_f32 v52, v52, v53
    s_waitcnt lgkmcnt(0)
    v_smfmac_f32_16x16x64_bf16 v[44:47], v[64:67], v[72:79], v9
    buffer_store_dword v52, v2, s[32:35], s37 offen
    v_add_f32 v61, v61, v63
    v_add_f32 v60, v60, v62
    v_smfmac_f32_16x16x64_bf16 v[44:47], v[68:71], v[16:23], v9
    ds_read_b128 v[20:23], v1 offset:19456
    v_smfmac_f32_16x16x64_bf16 v[48:51], v[64:67], v[208:215], v9
    buffer_store_dword v40, v2, s[32:35], s38 offen
    v_cvt_pk_bf16_f32 v60, v60, v61
    v_smfmac_f32_16x16x64_bf16 v[48:51], v[68:71], v[216:223], v9
    ds_read_b128 v[72:75], v1 offset:16384
    ds_read_b128 v[76:79], v1 offset:17408
    v_smfmac_f32_16x16x64_bf16 v[56:59], v[64:67], v[224:231], v9
    buffer_store_dword v60, v2, s[32:35], s39 offen
    v_add_f32 v44, v44, v46
    v_add_f32 v45, v45, v47
    v_cvt_pk_bf16_f32 v44, v44, v45
    v_smfmac_f32_16x16x64_bf16 v[56:59], v[68:71], v[232:239], v9
    ds_read_b128 v[16:19], v1 offset:18432
    v_smfmac_f32_16x16x64_bf16 v[32:35], v[64:67], v[240:247], v9
    buffer_store_dword v44, v2, s[32:35], s40 offen
    v_add_f32 v48, v48, v50
    v_add_f32 v49, v49, v51
    v_cvt_pk_bf16_f32 v48, v48, v49
    v_smfmac_f32_16x16x64_bf16 v[32:35], v[68:71], v[248:255], v9
    s_waitcnt lgkmcnt(1)
    v_smfmac_f32_16x16x64_bf16 v[36:39], v[64:67], v[72:79], v9
    buffer_store_dword v48, v2, s[32:35], s41 offen
    v_add_f32 v57, v57, v59
    v_add_f32 v56, v56, v58
    v_cvt_pk_bf16_f32 v56, v56, v57
    s_waitcnt lgkmcnt(0)
    v_smfmac_f32_16x16x64_bf16 v[36:39], v[68:71], v[16:23], v9
    buffer_store_dword v56, v2, s[32:35], s42 offen
    v_add_f32 v32, v32, v34
    v_add_f32 v33, v33, v35
    v_cvt_pk_bf16_f32 v32, v32, v33
    buffer_store_dword v32, v2, s[32:35], s43 offen
    s_nop 0
    v_add_f32 v36, v36, v38
    v_add_f32 v37, v37, v39
    v_cvt_pk_bf16_f32 v36, v36, v37
    buffer_store_dword v36, v2, s[32:35], s44 offen
    s_add_u32 s64, s64, 1
    s_branch ttop_62
tw_59l:
    s_waitcnt lgkmcnt(0)
    s_barrier
    ds_read_b128 v[16:19], v0 offset:0
    ds_read_b128 v[20:23], v0 offset:1024
    ds_read_b128 v[52:55], v1 offset:35840
    ds_read_b128 v[24:27], v0 offset:2048
    s_waitcnt lgkmcnt(3)
    v_smfmac_f32_16x16x64_bf16 v[44:47], v[16:19], a[152:159], v9
    ds_read_b128 v[48:51], v1 offset:34816
    v_smfmac_f32_16x16x64_bf16 v[36:39], v[16:19], v[96:103], v9
    v_smfmac_f32_16x16x64_bf16 v[40:43], v[16:19], a[96:103], v9
    ds_read_b128 v[28:31], v0 offset:3072
    s_waitcnt lgkmcnt(2)
    v_smfmac_f32_16x16x64_bf16 v[44:47], v[24:27], a[160:167], v9
    ds_read_b128 v[76:79], v1 offset:33792
    v_smfmac_f32_16x16x64_bf16 v[40:43], v[24:27], a[104:111], v9
    ds_read_b128 v[72:75], v1 offset:32768
    s_waitcnt lgkmcnt(3)
    v_smfmac_f32_16x16x64_bf16 v[44:47], v[20:23], v[48:55], v9
    s_waitcnt vmcnt(5)
    s_barrier
    v_smfmac_f32_16x16x64_bf16 v[32:35], v[16:19], a[208:215], v9
    v_smfmac_f32_16x16x64_bf16 v[32:35], v[20:23], a[216:223], v9
    v_smfmac_f32_16x16x64_bf16 v[32:35], v[24:27], a[224:231], v9
    s_waitcnt lgkmcnt(2)
    v_smfmac_f32_16x16x64_bf16 v[32:35], v[28:31], a[232:239], v9
    ds_read_b128 v[16:19], v0 offset:4096
    v_smfmac_f32_16x16x64_bf16 v[36:39], v[20:23], v[104:111], v9
    s_waitcnt lgkmcnt(1)
    v_smfmac_f32_16x16x64_bf16 v[40:43], v[20:23], v[72:79], v9
    v_smfmac_f32_16x16x64_bf16 v[40:43], v[28:31], a[112:119], v9
    ds_read_b128 v[20:23], v0 offset:5120
    v_add_u32 v1, 0x10000, v1
    v_smfmac_f32_16x16x64_bf16 v[36:39], v[24:27], v[112:119], v9
    ds_read_b128 v[52:55], v1 offset:19456
    s_waitcnt lgkmcnt(2)
    v_smfmac_f32_16x16x64_bf16 v[32:35], v[16:19], a[240:247], v9
    ds_read_b128 v[24:27], v0 offset:6144
    v_smfmac_f32_16x16x64_bf16 v[44:47], v[28:31], a[168:175], v9
    v_smfmac_f32_16x16x64_bf16 v[36:39], v[28:31], v[120:127], v9
    ds_read_b128 v[28:31], v0 offset:7168
    v_smfmac_f32_16x16x64_bf16 v[44:47], v[16:19], a[176:183], v9
    ds_read_b128 v[76:79], v1 offset:17408
    v_smfmac_f32_16x16x64_bf16 v[36:39], v[16:19], v[128:135], v9
    ds_read_b128 v[48:51], v1 offset:18432
    s_waitcnt lgkmcnt(5)
    v_smfmac_f32_16x16x64_bf16 v[32:35], v[20:23], a[248:255], v9
    ds_read_b128 v[72:75], v1 offset:16384
    v_smfmac_f32_16x16x64_bf16 v[40:43], v[16:19], a[120:127], v9
    ds_read_b128 v[16:19], v0 offset:8192
    v_smfmac_f32_16x16x64_bf16 v[44:47], v[20:23], a[184:191], v9
    v_smfmac_f32_16x16x64_bf16 v[40:43], v[20:23], a[128:135], v9
    s_waitcnt lgkmcnt(2)
    v_smfmac_f32_16x16x64_bf16 v[44:47], v[24:27], v[48:55], v9
    ds_read_b128 v[48:51], v1 offset:34816
    v_smfmac_f32_16x16x64_bf16 v[32:35], v[24:27], v[80:87], v9
    s_waitcnt lgkmcnt(2)
    v_smfmac_f32_16x16x64_bf16 v[40:43], v[24:27], v[72:79], v9
    v_smfmac_f32_16x16x64_bf16 v[40:43], v[28:31], a[136:143], v9
    ds_read_b128 v[52:55], v1 offset:35840
    s_waitcnt lgkmcnt(2)
    v_smfmac_f32_16x16x64_bf16 v[40:43], v[16:19], a[144:151], v9
    v_smfmac_f32_16x16x64_bf16 v[44:47], v[28:31], a[192:199], v9
    ds_read_b128 v[72:75], v1 offset:32768
    v_smfmac_f32_16x16x64_bf16 v[36:39], v[20:23], v[136:143], v9
    ds_read_b128 v[76:79], v1 offset:33792
    v_add_f32 v40, v40, v42
    v_smfmac_f32_16x16x64_bf16 v[32:35], v[28:31], v[88:95], v9
    v_add_f32 v41, v41, v43
    v_smfmac_f32_16x16x64_bf16 v[44:47], v[16:19], a[200:207], v9
    v_cvt_pk_bf16_f32 v12, v40, v41
    v_smfmac_f32_16x16x64_bf16 v[36:39], v[24:27], v[144:151], v9
    v_smfmac_f32_16x16x64_bf16 v[36:39], v[28:31], v[152:159], v9
    s_waitcnt lgkmcnt(0)
    v_smfmac_f32_16x16x64_bf16 v[32:35], v[16:19], v[72:79], v9
    v_add_f32 v45, v45, v47
    v_smfmac_f32_16x16x64_bf16 v[36:39], v[16:19], v[48:55], v9
    v_cmp_u_f32 vcc, v40, v41
    v_add_f32 v44, v44, v46
    v_mfma_f32_16x16x16_bf16 v[40:43], v[12:13], v[8:9], 0
    v_cvt_pk_bf16_f32 v12, v44, v45
    v_add_f32 v32, v32, v34
    v_add_f32 v33, v33, v35
    v_mfma_f32_16x16x16_bf16 v[44:47], v[12:13], v[8:9], 0
    s_cbranch_vccnz tredo_60l
tredo_60lr:
    v_cvt_pk_bf16_f32 v32, v32, v33
    v_add_f32 v36, v36, v38
    v_add_f32 v37, v37, v39
    v_cvt_pk_bf16_f32 v33, v36, v37
    v_cvt_pk_bf16_f32 v40, v40, v41
    v_cvt_pk_bf16_f32 v41, v42, v43
    s_nop 0
    v_cvt_pk_bf16_f32 v42, v44, v45
    v_cvt_pk_bf16_f32 v43, v46, v47
    v_cndmask_b32 v34, v40, v42, s[94:95]
    v_cndmask_b32 v35, v41, v43, s[94:95]
    buffer_store_dwordx4 v[32:35], v0, s[32:35], s77 offen sc1
    s_endpgm
ttop_62a:
    v_lshlrev_b32 v56, 3, v0
    v_and_b32 v57, 0x780, v56
    s_mov_b32 s57, 133120
    s_mov_b32 s58, 141312
wteam_63:
    buffer_load_dword v58, v56, s[32:35], s57 offen sc1
    buffer_load_dword v59, v57, s[32:35], s58 offen sc1
    s_sub_i32 s54, s54, 1
    s_cmp_lt_i32 s54, 0
    s_waitcnt vmcnt(0)
    s_cbranch_scc1 wteamd_64
    v_and_b32 v58, v58, v59
    v_cmp_eq_u32 vcc, 0, v58
    s_cbranch_vccz wteamd_64
    s_sleep 2
    s_branch wteam_63
wteamd_64:
    s_branch ttop_62b
tp_65:
    buffer_load_dwordx4 v[56:59], v0, s[32:35], s68 offen offset:0 sc1
    buffer_load_dwordx4 v[60:63], v0, s[32:35], s68 offen offset:1024 sc1
    buffer_load_dwordx4 v[64:67], v0, s[32:35], s68 offen offset:2048 sc1
    buffer_load_dwordx4 v[68:71], v0, s[32:35], s68 offen offset:3072 sc1
    s_sub_i32 s54, s54, 1
    s_cmp_lt_i32 s54, 0
    s_cselect_b64 s[96:97], 0, -1
    s_waitcnt vmcnt(3) lgkmcnt(4)
    v_mfma_f32_16x16x32_bf16 v[20:23], v[16:19], v[56:59], 0
    s_waitcnt vmcnt(2)
    v_mfma_f32_16x16x32_bf16 v[20:23], v[16:19], v[60:63], v[20:23]
    s_waitcnt vmcnt(1)
    v_mfma_f32_16x16x32_bf16 v[20:23], v[16:19], v[64:67], v[20:23]
    s_waitcnt vmcnt(0)
    v_mfma_f32_16x16x32_bf16 v[20:23], v[16:19], v[68:71], v[20:23]
    s_nop 7
    v_add_f32_dpp v20, v20, v20 row_ror:8 row_mask:0xf bank_mask:0xf
    v_add_f32_dpp v21, v21, v21 row_ror:8 row_mask:0xf bank_mask:0xf
    v_cvt_pk_bf16_f32 v20, v20, v21
    v_cmp_u_f32 vcc, v21, v21
    buffer_store_dword v20, v4, s[32:35], s81 offen
    s_and_b64 vcc, vcc, s[96:97]
    s_cbranch_vccnz tp_65
    s_branch tpd_66
tredo_60l:
    s_cmp_lt_i32 s49, 1
    s_cbranch_scc1 tredo_60lr
tredo_60:
    s_sub_i32 s49, s49, 1
    s_cmp_lt_i32 s49, 0
    s_cbranch_scc1 tredo_60r
    s_mov_b32 s45, s69
    s_waitcnt lgkmcnt(0)
    s_nop 7
    v_add_u32 v1, s63, v0
    v_and_b32 v2, 0x7ffff, v2
    v_or_b32 v2, s51, v2
    v_mov_b64 v[32:33], 0
    v_mov_b64 v[34:35], 0
    v_mov_b64 v[36:37], 0
    v_mov_b64 v[38:39], 0
    v_mov_b64 v[40:41], 0
    v_mov_b64 v[42:43], 0
    v_mov_b64 v[44:45], 0
    v_mov_b64 v[46:47], 0
    ds_read_b128 v[72:75], v1 offset:16384
    ds_read_b128 v[76:79], v1 offset:17408
    ds_read_b128 v[48:51], v1 offset:18432
    ds_read_b128 v[52:55], v1 offset:19456
    s_barrier
    s_branch tm_61
tcls2_49:
    buffer_load_dwordx4 v[64:67], v0, s[32:35], s73 offen offset:0 sc1
    buffer_load_dwordx4 v[68:71], v0, s[32:35], s73 offen offset:1024 sc1
    s_barrier
    buffer_store_dwordx4 v[28:31], v0, s[32:35], s45 offen sc1
    v_add_u32 v1, s63, v0
    v_and_b32 v2, 0x7ffff, v2
    v_or_b32 v2, s51, v2
    v_mov_b64 v[32:33], 0
    v_mov_b64 v[34:35], 0
    v_mov_b64 v[36:37], 0
    v_mov_b64 v[38:39], 0
    v_mov_b64 v[40:41], 0
    v_mov_b64 v[42:43], 0
    v_mov_b64 v[44:45], 0
    v_mov_b64 v[46:47], 0
    ds_read_b128 v[72:75], v1 offset:16384
    ds_read_b128 v[76:79], v1 offset:17408
    ds_read_b128 v[48:51], v1 offset:18432
    ds_read_b128 v[52:55], v1 offset:19456
    s_waitcnt lgkmcnt(0)
    s_branch tw_67
.p2align 6
ttop_70:
    s_cmp_eq_u32 s64, 1
    s_cbranch_scc1 ttop_70a
ttop_70b:
    s_cmp_ge_u32 s53, 8
    s_cbranch_scc1 tn_73
    s_nop 10
    buffer_load_dwordx4 v[56:59], v0, s[32:35], s68 offen offset:0 sc1
    buffer_load_dwordx4 v[60:63], v0, s[32:35], s68 offen offset:1024 sc1
    buffer_load_dwordx4 v[64:67], v0, s[32:35], s68 offen offset:2048 sc1
    buffer_load_dwordx4 v[68:71], v0, s[32:35], s68 offen offset:3072 sc1
    s_and_b32 s57, s64, 3
    s_lshl_b32 s58, s57, 14
    s_add_u32 s81, s70, s58
    s_add_u32 s85, s58, 7405568
    s_xor_b32 s51, s57, 2
    s_lshl_b32 s51, s51, 19
    s_add_u32 s72, s72, 786432
    s_add_u32 s73, s73, 786432
    s_mov_b32 s45, s77
    s_add_u32 s77, s77, 131072
    s_sub_u32 s99, s64, 1
    ds_read_b128 v[16:19], v0 offset:15360
    v_add_u32 v1, s63, v0
    v_and_b32 v2, 0x7ffff, v2
    v_or_b32 v2, s51, v2
    v_mov_b64 v[32:33], 0
    v_mov_b64 v[34:35], 0
    v_mov_b64 v[36:37], 0
    v_mov_b64 v[38:39], 0
    v_mov_b64 v[40:41], 0
    v_mov_b64 v[42:43], 0
    v_mov_b64 v[44:45], 0
    v_mov_b64 v[46:47], 0
    ds_read_b128 v[72:75], v1 offset:16384
    ds_read_b128 v[76:79], v1 offset:17408
    ds_read_b128 v[48:51], v1 offset:18432
    ds_read_b128 v[52:55], v1 offset:19456
    s_waitcnt vmcnt(3) lgkmcnt(4)
    v_mfma_f32_16x16x32_bf16 v[20:23], v[16:19], v[56:59], 0
    s_waitcnt vmcnt(2)
    v_mfma_f32_16x16x32_bf16 v[20:23], v[16:19], v[60:63], v[20:23]
    s_waitcnt vmcnt(1)
    v_mfma_f32_16x16x32_bf16 v[20:23], v[16:19], v[64:67], v[20:23]
    s_waitcnt vmcnt(0)
    v_mfma_f32_16x16x32_bf16 v[20:23], v[16:19], v[68:71], v[20:23]
    s_nop 7
    v_add_f32_dpp v20, v20, v20 row_ror:8 row_mask:0xf bank_mask:0xf
    v_add_f32_dpp v21, v21, v21 row_ror:8 row_mask:0xf bank_mask:0xf
    v_cvt_pk_bf16_f32 v20, v20, v21
    v_cmp_u_f32 vcc, v21, v21
    buffer_store_dword v20, v4, s[32:35], s81 offen
    s_cbranch_vccnz tp_75
tpd_76:
    s_lshl_b32 s57, s57, 19
    s_add_u32 s68, s50, s57
    s_and_b32 s57, s99, 3
    s_lshl_b32 s57, s57, 14
    s_add_u32 s67, s70, s57
    s_branch tj_74
tn_73:
    s_and_b32 s57, s64, 3
    s_lshl_b32 s58, s57, 14
    s_add_u32 s81, s70, s58
    s_add_u32 s85, s58, 7405568
    s_xor_b32 s51, s57, 2
    s_lshl_b32 s51, s51, 19
    s_add_u32 s72, s72, 786432
    s_add_u32 s73, s73, 786432
    s_mov_b32 s45, s77
    s_add_u32 s77, s77, 131072
    s_sub_u32 s99, s64, 1
    ds_read_b128 v[16:19], v0 offset:15360
    v_add_u32 v1, s63, v0
    v_and_b32 v2, 0x7ffff, v2
    v_or_b32 v2, s51, v2
    v_mov_b64 v[32:33], 0
    v_mov_b64 v[34:35], 0
    v_mov_b64 v[36:37], 0
    v_mov_b64 v[38:39], 0
    v_mov_b64 v[40:41], 0
    v_mov_b64 v[42:43], 0
    v_mov_b64 v[44:45], 0
    v_mov_b64 v[46:47], 0
    ds_read_b128 v[72:75], v1 offset:16384
    ds_read_b128 v[76:79], v1 offset:17408
    ds_read_b128 v[48:51], v1 offset:18432
    ds_read_b128 v[52:55], v1 offset:19456
tj_74:
tm_69:
    s_add_u32 m0, s56, 4096
    s_add_u32 s57, s85, m0
    s_add_u32 s58, s85, 8192
    s_barrier
    buffer_load_dwordx4 v0, s[32:35], s57 offen sc1 lds
    s_nop 5
    buffer_load_dwordx4 v[56:59], v0, s[32:35], s72 offen offset:0 sc1
    buffer_load_dwordx4 v[60:63], v0, s[32:35], s72 offen offset:1024 sc1
    s_barrier
    buffer_load_dwordx4 v[64:67], v0, s[32:35], s73 offen offset:0 sc1
    buffer_load_dwordx4 v[68:71], v0, s[32:35], s73 offen offset:1024 sc1
    s_barrier
    buffer_store_dwordx4 v[28:31], v0, s[32:35], s45 offen sc1
    s_cmp_eq_u32 s64, 63
    s_cbranch_scc1 tw_67l
    s_waitcnt lgkmcnt(0)
tw_67:
    s_barrier
    ds_read_b128 v[16:19], v0 offset:0
    ds_read_b128 v[24:27], v0 offset:2048
    ds_read_b128 v[20:23], v0 offset:1024
    buffer_store_dword v15, v2, s[32:35], s37 offen
    s_waitcnt lgkmcnt(2)
    v_smfmac_f32_16x16x64_bf16 v[32:35], v[16:19], v[72:79], v9
    ds_read_b128 v[76:79], v1 offset:33792
    v_smfmac_f32_16x16x64_bf16 v[36:39], v[16:19], v[48:55], v9
    ds_read_b128 v[52:55], v1 offset:35840
    s_waitcnt lgkmcnt(2)
    v_smfmac_f32_16x16x64_bf16 v[32:35], v[20:23], a[0:7], v9
    ds_read_b128 v[28:31], v0 offset:3072
    v_smfmac_f32_16x16x64_bf16 v[36:39], v[20:23], a[48:55], v9
    ds_read_b128 v[48:51], v1 offset:34816
    v_smfmac_f32_16x16x64_bf16 v[40:43], v[16:19], a[96:103], v9
    ds_read_b128 v[72:75], v1 offset:32768
    v_smfmac_f32_16x16x64_bf16 v[44:47], v[16:19], a[152:159], v9
    s_waitcnt vmcnt(6)
    s_barrier
    v_smfmac_f32_16x16x64_bf16 v[32:35], v[24:27], a[8:15], v9
    v_smfmac_f32_16x16x64_bf16 v[36:39], v[24:27], a[56:63], v9
    ds_read_b128 v[16:19], v0 offset:4096
    s_waitcnt lgkmcnt(1)
    v_smfmac_f32_16x16x64_bf16 v[40:43], v[20:23], v[72:79], v9
    ds_read_b128 v[72:75], v1 offset:49152
    v_smfmac_f32_16x16x64_bf16 v[44:47], v[20:23], v[48:55], v9
    ds_read_b128 v[76:79], v1 offset:50176
    v_smfmac_f32_16x16x64_bf16 v[32:35], v[28:31], a[16:23], v9
    ds_read_b128 v[48:51], v1 offset:51200
    v_smfmac_f32_16x16x64_bf16 v[36:39], v[28:31], a[64:71], v9
    ds_read_b128 v[52:55], v1 offset:52224
    v_add_u32 v1, 0x10000, v1
    v_smfmac_f32_16x16x64_bf16 v[40:43], v[24:27], a[104:111], v9
    ds_read_b128 v[20:23], v0 offset:5120
    v_smfmac_f32_16x16x64_bf16 v[44:47], v[24:27], a[160:167], v9
    buffer_store_dword v15, v2, s[32:35], s36 offen
    ds_read_b128 v[24:27], v0 offset:6144
    s_waitcnt lgkmcnt(4)
    v_smfmac_f32_16x16x64_bf16 v[32:35], v[16:19], v[72:79], v9
    ds_read_b128 v[72:75], v1 offset:0
    s_waitcnt lgkmcnt(3)
    v_smfmac_f32_16x16x64_bf16 v[36:39], v[16:19], v[48:55], v9
    ds_read_b128 v[76:79], v1 offset:1024
    v_smfmac_f32_16x16x64_bf16 v[40:43], v[28:31], a[112:119], v9
    buffer_store_dword v15, v2, s[32:35], s40 offen
    v_smfmac_f32_16x16x64_bf16 v[44:47], v[28:31], a[168:175], v9
    ds_read_b128 v[48:51], v1 offset:2048
    s_waitcnt lgkmcnt(4)
    v_smfmac_f32_16x16x64_bf16 v[32:35], v[20:23], a[24:31], v9
    ds_read_b128 v[52:55], v1 offset:3072
    v_smfmac_f32_16x16x64_bf16 v[36:39], v[20:23], a[72:79], v9
    v_smfmac_f32_16x16x64_bf16 v[40:43], v[16:19], a[120:127], v9
    buffer_store_dword v15, v2, s[32:35], s41 offen
    v_smfmac_f32_16x16x64_bf16 v[44:47], v[16:19], a[176:183], v9
    ds_read_b128 v[28:31], v0 offset:7168
    ds_read_b128 v[16:19], v0 offset:8192
    s_waitcnt lgkmcnt(4)
    v_smfmac_f32_16x16x64_bf16 v[32:35], v[24:27], v[72:79], v9
    buffer_store_dword v15, v2, s[32:35], s39 offen
    s_waitcnt lgkmcnt(2)
    v_smfmac_f32_16x16x64_bf16 v[36:39], v[24:27], v[48:55], v9
    ds_read_b128 v[52:55], v1 offset:19456
    ds_read_b128 v[72:75], v1 offset:16384
    v_smfmac_f32_16x16x64_bf16 v[40:43], v[20:23], a[128:135], v9
    buffer_store_dword v15, v2, s[32:35], s42 offen
    v_smfmac_f32_16x16x64_bf16 v[44:47], v[20:23], a[184:191], v9
    ds_read_b128 v[48:51], v1 offset:18432
    ds_read_b128 v[76:79], v1 offset:17408
    s_waitcnt lgkmcnt(5)
    v_smfmac_f32_16x16x64_bf16 v[32:35], v[28:31], a[32:39], v9
    buffer_store_dword v15, v2, s[32:35], s38 offen
    v_smfmac_f32_16x16x64_bf16 v[36:39], v[28:31], a[80:87], v9
    s_waitcnt lgkmcnt(4)
    v_smfmac_f32_16x16x64_bf16 v[32:35], v[16:19], a[40:47], v9
    buffer_store_dword v15, v2, s[32:35], s43 offen
    v_smfmac_f32_16x16x64_bf16 v[36:39], v[16:19], a[88:95], v9
    s_waitcnt lgkmcnt(0)
    v_smfmac_f32_16x16x64_bf16 v[40:43], v[24:27], v[72:79], v9
    buffer_store_dword v15, v2, s[32:35], s44 offen
    v_add_f32 v33, v33, v35
    v_smfmac_f32_16x16x64_bf16 v[44:47], v[24:27], v[48:55], v9
    v_add_f32 v32, v32, v34
    v_smfmac_f32_16x16x64_bf16 v[40:43], v[28:31], a[136:143], v9
    ds_read_b128 v[72:75], v1 offset:32768
    v_add_f32 v36, v36, v38
    v_smfmac_f32_16x16x64_bf16 v[44:47], v[28:31], a[192:199], v9
    v_add_f32 v37, v37, v39
    v_smfmac_f32_16x16x64_bf16 v[40:43], v[16:19], a[144:151], v9
    v_cvt_pk_bf16_f32 v12, v32, v33
    v_mov_b64 v[48:49], 0
    v_cmp_u_f32 vcc, v32, v33
    v_mfma_f32_16x16x16_bf16 v[32:35], v[12:13], v[8:9], 0
    v_cvt_pk_bf16_f32 v12, v36, v37
    v_mov_b64 v[54:55], 0
    v_add_f32 v41, v41, v43
    v_mfma_f32_16x16x16_bf16 v[36:39], v[12:13], v[8:9], 0
    v_add_f32 v40, v40, v42
    v_cvt_pk_bf16_f32 v12, v40, v41
    v_mov_b64 v[52:53], 0
    v_smfmac_f32_16x16x64_bf16 v[44:47], v[16:19], a[200:207], v9
    ds_read_b128 v[76:79], v1 offset:33792
    v_cvt_pk_bf16_f32 v32, v32, v33
    v_cvt_pk_bf16_f32 v33, v34, v35
    v_cvt_pk_bf16_f32 v34, v36, v37
    v_mfma_f32_16x16x16_bf16 v[40:43], v[12:13], v[8:9], 0
    v_cvt_pk_bf16_f32 v35, v38, v39
    v_mov_b64 v[50:51], 0
    v_add_f32 v45, v45, v47
    s_waitcnt vmcnt(13)
    v_mfma_f32_16x16x32_bf16 v[56:59], v[56:59], v[32:35], 0
    v_add_f32 v44, v44, v46
    v_cvt_pk_bf16_f32 v12, v44, v45
    v_smfmac_f32_16x16x64_bf16 v[48:51], v[20:23], a[248:255], v9
    s_cbranch_vccnz tredo_68
tredo_68r:
    v_mfma_f32_16x16x16_bf16 v[44:47], v[12:13], v[8:9], 0
    s_nop 0
    ds_write_b128 v3, v[56:59] offset:9216
    v_cvt_pk_bf16_f32 v40, v40, v41
    v_cvt_pk_bf16_f32 v41, v42, v43
    s_waitcnt vmcnt(12)
    v_mfma_f32_16x16x32_bf16 v[60:63], v[60:63], v[32:35], 0
    s_nop 1
    v_cvt_pk_bf16_f32 v43, v46, v47
    v_cvt_pk_bf16_f32 v42, v44, v45
    v_smfmac_f32_16x16x64_bf16 v[52:55], v[20:23], v[136:143], v9
    buffer_store_dword v15, v4, s[32:35], s67 offen
    v_mfma_f32_16x16x32_bf16 v[44:47], v[40:43], v[32:35], 0
    ds_write_b128 v3, v[60:63] offset:9728
    v_smfmac_f32_16x16x64_bf16 v[48:51], v[24:27], v[80:87], v9
    s_nop 4
    ds_write_b64 v5, v[44:45] offset:13312
    v_smfmac_f32_16x16x64_bf16 v[52:55], v[24:27], v[144:151], v9
    ds_read_b128 v[24:27], v0 offset:1024
    v_smfmac_f32_16x16x64_bf16 v[48:51], v[28:31], v[88:95], v9
    ds_read_b128 v[20:23], v0 offset:0
    v_smfmac_f32_16x16x64_bf16 v[52:55], v[28:31], v[152:159], v9
    ds_read_b128 v[28:31], v0 offset:2048
    s_waitcnt lgkmcnt(3)
    s_barrier
    v_smfmac_f32_16x16x64_bf16 v[48:51], v[16:19], v[72:79], v9
    ds_read_b64 v[46:47], v6 offset:14336
    ds_read_b64 v[44:45], v6 offset:13312
    s_waitcnt lgkmcnt(3)
    v_smfmac_f32_16x16x64_bf16 v[48:51], v[20:23], a[208:215], v9
    ds_read_b128 v[32:35], v6 offset:11264
    v_smfmac_f32_16x16x64_bf16 v[52:55], v[20:23], v[96:103], v9
    ds_read_b128 v[20:23], v0 offset:3072
    v_smfmac_f32_16x16x64_bf16 v[48:51], v[24:27], a[216:223], v9
    ds_read_b128 v[36:39], v6 offset:12288
    v_smfmac_f32_16x16x64_bf16 v[52:55], v[24:27], v[104:111], v9
    ds_read_b128 v[60:63], v6 offset:10240
    s_waitcnt lgkmcnt(4)
    v_add_f32 v45, v45, v47
    v_add_f32 v44, v44, v46
    v_smfmac_f32_16x16x64_bf16 v[48:51], v[28:31], a[224:231], v9
    ds_read_b128 v[56:59], v6 offset:9216
    v_add_f32_dpp v44, v44, v44 quad_perm:[2,3,0,1] row_mask:0xf bank_mask:0xf
    v_smfmac_f32_16x16x64_bf16 v[52:55], v[28:31], v[112:119], v9
    ds_read_b128 v[72:75], v1 offset:34816
    s_waitcnt lgkmcnt(3)
    v_add_f32 v35, v35, v39
    v_smfmac_f32_16x16x64_bf16 v[48:51], v[20:23], a[232:239], v9
    ds_read_b128 v[24:27], v0 offset:4096
    v_add_f32 v34, v34, v38
    v_smfmac_f32_16x16x64_bf16 v[52:55], v[20:23], v[120:127], v9
    ds_read_b128 v[76:79], v1 offset:35840
    v_add_f32 v33, v33, v37
    v_add_f32 v32, v32, v36
    s_waitcnt lgkmcnt(3)
    v_add_f32 v59, v59, v63
    v_add_f32 v59, v59, v35
    v_add_f32_dpp v45, v45, v45 quad_perm:[2,3,0,1] row_mask:0xf bank_mask:0xf
    v_add_f32 v58, v58, v62
    v_add_f32 v56, v56, v60
    v_add_f32 v56, v56, v32
    v_add_f32 v57, v57, v61
    v_add_f32 v58, v58, v34
    v_add_f32 v57, v57, v33
    v_max3_f32 v62, v56, v57, v58
    v_max_f32 v62, v62, v59
    s_waitcnt lgkmcnt(0)
    v_smfmac_f32_16x16x64_bf16 v[52:55], v[16:19], v[72:79], v9
    ds_read_b128 v[76:79], v1 offset:50176
    v_max_f32_dpp v62, v62, v62 quad_perm:[2,3,0,1] row_mask:0xf bank_mask:0xf
    v_max3_f32 v62, v62, v44, v45
    v_mov_b32 v63, v62
    v_smfmac_f32_16x16x64_bf16 v[48:51], v[24:27], a[240:247], v9
    v_permlane32_swap_b32 v62, v63
    v_max_f32 v62, v62, v63
    v_mov_b32 v63, v62
    v_smfmac_f32_16x16x64_bf16 v[52:55], v[24:27], v[128:135], v9
    ds_read_b128 v[72:75], v1 offset:49152
    v_permlane16_swap_b32 v62, v63
    v_max_f32 v62, v62, v63
    v_add_f32 v48, v48, v50
    v_mul_f32 v63, s75, v62
    v_fma_f32 v45, v45, s75, -v63
    v_fma_f32 v59, v59, s75, -v63
    v_exp_f32 v59, v59
    v_add_f32 v52, v52, v54
    v_exp_f32 v45, v45
    v_fma_f32 v58, v58, s75, -v63
    v_add_f32 v53, v53, v55
    v_exp_f32 v58, v58
    v_fma_f32 v57, v57, s75, -v63
    v_fma_f32 v44, v44, s75, -v63
    v_exp_f32 v44, v44
    v_exp_f32 v57, v57
    v_add_f32 v49, v49, v51
    v_cvt_pk_bf16_f32 v44, v44, v45
    v_cndmask_b32 v46, v44, 0, s[94:95]
    v_cvt_pk_bf16_f32 v48, v48, v49
    v_cndmask_b32 v47, 0, v44, s[94:95]
    v_fma_f32 v56, v56, s75, -v63
    v_cvt_pk_bf16_f32 v61, v58, v59
    v_cvt_pk_bf16_f32 v49, v52, v53
    v_exp_f32 v56, v56
    v_mfma_f32_16x16x16_bf16 v[32:35], v[48:49], v[46:47], 0
    v_cvt_pk_bf16_f32 v60, v56, v57
    v_mov_b32_dpp v57, v61 quad_perm:[0,1,0,1] row_mask:0xf bank_mask:0xf
    v_mfma_f32_16x16x16_bf16 v[36:39], v[10:11], v[46:47], 0
    v_mov_b32_dpp v56, v60 quad_perm:[0,1,0,1] row_mask:0xf bank_mask:0xf
    v_mov_b32_dpp v58, v60 quad_perm:[2,3,2,3] row_mask:0xf bank_mask:0xf
    v_mov_b32_dpp v59, v61 quad_perm:[2,3,2,3] row_mask:0xf bank_mask:0xf
    v_mfma_f32_16x16x16_bf16 v[36:39], v[10:11], v[56:57], v[36:39]
    v_mfma_f32_16x16x16_bf16 v[36:39], v[10:11], v[58:59], v[36:39]
    v_mov_b32 v12, 0
    s_waitcnt vmcnt(11)
    v_mfma_f32_16x16x32_bf16 v[68:71], v[68:71], v[56:59], v[32:35]
    ds_read_b128 v[20:23], v1 offset:52224
    v_mfma_f32_16x16x32_bf16 v[64:67], v[64:67], v[56:59], v[32:35]
    s_barrier
    v_rcp_f32 v14, v36
    v_mfma_f32_16x16x16_bf16 v[32:35], v[12:13], v[10:11], 0
    ds_read_b128 v[16:19], v1 offset:51200
    s_nop 3
    v_cndmask_b32 v65, v65, v69, s[94:95]
    v_cndmask_b32 v67, v67, v71, s[94:95]
    v_cndmask_b32 v64, v64, v68, s[94:95]
    v_mul_f32 v64, v64, v14
    v_mul_f32 v65, v65, v14
    v_cvt_pk_bf16_f32 v64, v64, v65
    v_cndmask_b32 v66, v66, v70, s[94:95]
    v_mul_f32 v66, v66, v14
    v_mul_f32 v67, v67, v14
    v_cvt_pk_bf16_f32 v65, v66, v67
    v_mfma_f32_16x16x16_bf16 v[56:59], v[12:13], v[10:11], 0
    ds_write_b64 v7, v[64:65] offset:9216
    v_cndmask_b32 v31, v41, v43, s[94:95]
    v_cndmask_b32 v30, v40, v42, s[94:95]
    v_mfma_f32_16x16x16_bf16 v[44:47], v[12:13], v[10:11], 0
    v_add_u32 v1, 0x10000, v1
    v_mfma_f32_16x16x16_bf16 v[24:27], v[12:13], v[10:11], 0
    v_mfma_f32_16x16x16_bf16 v[52:55], v[12:13], v[10:11], 0
    s_waitcnt lgkmcnt(0)
    s_barrier
    v_mfma_f32_16x16x16_bf16 v[40:43], v[12:13], v[10:11], 0
    ds_read_b128 v[64:67], v6 offset:9216
    v_mov_b64 v[28:29], v[48:49]
    v_mfma_f32_16x16x16_bf16 v[48:51], v[12:13], v[10:11], 0
    ds_read_b128 v[68:71], v6 offset:10240
    v_mfma_f32_16x16x16_bf16 v[60:63], v[12:13], v[10:11], 0
    v_mfma_f32_16x16x16_bf16 v[36:39], v[12:13], v[10:11], 0
    v_xor_b32 v2, 0x100000, v2
    s_waitcnt lgkmcnt(1)
    v_smfmac_f32_16x16x64_bf16 v[24:27], v[64:67], v[72:79], v9
    s_waitcnt lgkmcnt(0)
    v_smfmac_f32_16x16x64_bf16 v[24:27], v[68:71], v[16:23], v9
    ds_read_b128 v[20:23], v1 offset:3072
    v_smfmac_f32_16x16x64_bf16 v[52:55], v[64:67], v[160:167], v9
    ds_read_b128 v[16:19], v1 offset:2048
    v_smfmac_f32_16x16x64_bf16 v[52:55], v[68:71], v[168:175], v9
    ds_read_b128 v[72:75], v1 offset:0
    v_add_f32 v25, v25, v27
    v_smfmac_f32_16x16x64_bf16 v[40:43], v[64:67], v[176:183], v9
    ds_read_b128 v[76:79], v1 offset:1024
    v_add_f32 v24, v24, v26
    v_cvt_pk_bf16_f32 v24, v24, v25
    v_smfmac_f32_16x16x64_bf16 v[40:43], v[68:71], v[184:191], v9
    v_smfmac_f32_16x16x64_bf16 v[60:63], v[64:67], v[192:199], v9
    buffer_store_dword v24, v2, s[32:35], s36 offen
    v_add_f32 v52, v52, v54
    v_add_f32 v53, v53, v55
    v_smfmac_f32_16x16x64_bf16 v[60:63], v[68:71], v[200:207], v9
    v_add_f32 v40, v40, v42
    v_add_f32 v41, v41, v43
    v_cvt_pk_bf16_f32 v40, v40, v41
    v_cvt_pk_bf16_f32 v52, v52, v53
    s_waitcnt lgkmcnt(0)
    v_smfmac_f32_16x16x64_bf16 v[44:47], v[64:67], v[72:79], v9
    buffer_store_dword v52, v2, s[32:35], s37 offen
    v_add_f32 v61, v61, v63
    v_add_f32 v60, v60, v62
    v_smfmac_f32_16x16x64_bf16 v[44:47], v[68:71], v[16:23], v9
    ds_read_b128 v[20:23], v1 offset:19456
    v_smfmac_f32_16x16x64_bf16 v[48:51], v[64:67], v[208:215], v9
    buffer_store_dword v40, v2, s[32:35], s38 offen
    v_cvt_pk_bf16_f32 v60, v60, v61
    v_smfmac_f32_16x16x64_bf16 v[48:51], v[68:71], v[216:223], v9
    ds_read_b128 v[72:75], v1 offset:16384
    ds_read_b128 v[76:79], v1 offset:17408
    v_smfmac_f32_16x16x64_bf16 v[56:59], v[64:67], v[224:231], v9
    buffer_store_dword v60, v2, s[32:35], s39 offen
    v_add_f32 v44, v44, v46
    v_add_f32 v45, v45, v47
    v_cvt_pk_bf16_f32 v44, v44, v45
    v_smfmac_f32_16x16x64_bf16 v[56:59], v[68:71], v[232:239], v9
    ds_read_b128 v[16:19], v1 offset:18432
    v_smfmac_f32_16x16x64_bf16 v[32:35], v[64:67], v[240:247], v9
    buffer_store_dword v44, v2, s[32:35], s40 offen
    v_add_f32 v48, v48, v50
    v_add_f32 v49, v49, v51
    v_cvt_pk_bf16_f32 v48, v48, v49
    v_smfmac_f32_16x16x64_bf16 v[32:35], v[68:71], v[248:255], v9
    s_waitcnt lgkmcnt(1)
    v_smfmac_f32_16x16x64_bf16 v[36:39], v[64:67], v[72:79], v9
    buffer_store_dword v48, v2, s[32:35], s41 offen
    v_add_f32 v57, v57, v59
    v_add_f32 v56, v56, v58
    v_cvt_pk_bf16_f32 v56, v56, v57
    s_waitcnt lgkmcnt(0)
    v_smfmac_f32_16x16x64_bf16 v[36:39], v[68:71], v[16:23], v9
    buffer_store_dword v56, v2, s[32:35], s42 offen
    v_add_f32 v32, v32, v34
    v_add_f32 v33, v33, v35
    v_cvt_pk_bf16_f32 v32, v32, v33
    buffer_store_dword v32, v2, s[32:35], s43 offen
    s_nop 0
    v_add_f32 v36, v36, v38
    v_add_f32 v37, v37, v39
    v_cvt_pk_bf16_f32 v36, v36, v37
    buffer_store_dword v36, v2, s[32:35], s44 offen
    s_add_u32 s64, s64, 1
    s_branch ttop_70
tw_67l:
    s_waitcnt lgkmcnt(0)
    s_barrier
    ds_read_b128 v[16:19], v0 offset:0
    ds_read_b128 v[20:23], v0 offset:1024
    ds_read_b128 v[52:55], v1 offset:35840
    ds_read_b128 v[24:27], v0 offset:2048
    s_waitcnt lgkmcnt(3)
    v_smfmac_f32_16x16x64_bf16 v[44:47], v[16:19], a[152:159], v9
    ds_read_b128 v[48:51], v1 offset:34816
    v_smfmac_f32_16x16x64_bf16 v[36:39], v[16:19], v[96:103], v9
    v_smfmac_f32_16x16x64_bf16 v[40:43], v[16:19], a[96:103], v9
    ds_read_b128 v[28:31], v0 offset:3072
    s_waitcnt lgkmcnt(2)
    v_smfmac_f32_16x16x64_bf16 v[44:47], v[24:27], a[160:167], v9
    ds_read_b128 v[76:79], v1 offset:33792
    v_smfmac_f32_16x16x64_bf16 v[40:43], v[24:27], a[104:111], v9
    ds_read_b128 v[72:75], v1 offset:32768
    s_waitcnt lgkmcnt(3)
    v_smfmac_f32_16x16x64_bf16 v[44:47], v[20:23], v[48:55], v9
    s_waitcnt vmcnt(5)
    s_barrier
    v_smfmac_f32_16x16x64_bf16 v[32:35], v[16:19], a[208:215], v9
    v_smfmac_f32_16x16x64_bf16 v[32:35], v[20:23], a[216:223], v9
    v_smfmac_f32_16x16x64_bf16 v[32:35], v[24:27], a[224:231], v9
    s_waitcnt lgkmcnt(2)
    v_smfmac_f32_16x16x64_bf16 v[32:35], v[28:31], a[232:239], v9
    ds_read_b128 v[16:19], v0 offset:4096
    v_smfmac_f32_16x16x64_bf16 v[36:39], v[20:23], v[104:111], v9
    s_waitcnt lgkmcnt(1)
    v_smfmac_f32_16x16x64_bf16 v[40:43], v[20:23], v[72:79], v9
    v_smfmac_f32_16x16x64_bf16 v[40:43], v[28:31], a[112:119], v9
    ds_read_b128 v[20:23], v0 offset:5120
    v_add_u32 v1, 0x10000, v1
    v_smfmac_f32_16x16x64_bf16 v[36:39], v[24:27], v[112:119], v9
    ds_read_b128 v[52:55], v1 offset:19456
    s_waitcnt lgkmcnt(2)
    v_smfmac_f32_16x16x64_bf16 v[32:35], v[16:19], a[240:247], v9
    ds_read_b128 v[24:27], v0 offset:6144
    v_smfmac_f32_16x16x64_bf16 v[44:47], v[28:31], a[168:175], v9
    v_smfmac_f32_16x16x64_bf16 v[36:39], v[28:31], v[120:127], v9
    ds_read_b128 v[28:31], v0 offset:7168
    v_smfmac_f32_16x16x64_bf16 v[44:47], v[16:19], a[176:183], v9
    ds_read_b128 v[76:79], v1 offset:17408
    v_smfmac_f32_16x16x64_bf16 v[36:39], v[16:19], v[128:135], v9
    ds_read_b128 v[48:51], v1 offset:18432
    s_waitcnt lgkmcnt(5)
    v_smfmac_f32_16x16x64_bf16 v[32:35], v[20:23], a[248:255], v9
    ds_read_b128 v[72:75], v1 offset:16384
    v_smfmac_f32_16x16x64_bf16 v[40:43], v[16:19], a[120:127], v9
    ds_read_b128 v[16:19], v0 offset:8192
    v_smfmac_f32_16x16x64_bf16 v[44:47], v[20:23], a[184:191], v9
    v_smfmac_f32_16x16x64_bf16 v[40:43], v[20:23], a[128:135], v9
    s_waitcnt lgkmcnt(2)
    v_smfmac_f32_16x16x64_bf16 v[44:47], v[24:27], v[48:55], v9
    ds_read_b128 v[48:51], v1 offset:34816
    v_smfmac_f32_16x16x64_bf16 v[32:35], v[24:27], v[80:87], v9
    s_waitcnt lgkmcnt(2)
    v_smfmac_f32_16x16x64_bf16 v[40:43], v[24:27], v[72:79], v9
    v_smfmac_f32_16x16x64_bf16 v[40:43], v[28:31], a[136:143], v9
    ds_read_b128 v[52:55], v1 offset:35840
    s_waitcnt lgkmcnt(2)
    v_smfmac_f32_16x16x64_bf16 v[40:43], v[16:19], a[144:151], v9
    v_smfmac_f32_16x16x64_bf16 v[44:47], v[28:31], a[192:199], v9
    ds_read_b128 v[72:75], v1 offset:32768
    v_smfmac_f32_16x16x64_bf16 v[36:39], v[20:23], v[136:143], v9
    ds_read_b128 v[76:79], v1 offset:33792
    v_add_f32 v40, v40, v42
    v_smfmac_f32_16x16x64_bf16 v[32:35], v[28:31], v[88:95], v9
    v_add_f32 v41, v41, v43
    v_smfmac_f32_16x16x64_bf16 v[44:47], v[16:19], a[200:207], v9
    v_cvt_pk_bf16_f32 v12, v40, v41
    v_smfmac_f32_16x16x64_bf16 v[36:39], v[24:27], v[144:151], v9
    v_smfmac_f32_16x16x64_bf16 v[36:39], v[28:31], v[152:159], v9
    s_waitcnt lgkmcnt(0)
    v_smfmac_f32_16x16x64_bf16 v[32:35], v[16:19], v[72:79], v9
    v_add_f32 v45, v45, v47
    v_smfmac_f32_16x16x64_bf16 v[36:39], v[16:19], v[48:55], v9
    v_cmp_u_f32 vcc, v40, v41
    v_add_f32 v44, v44, v46
    v_mfma_f32_16x16x16_bf16 v[40:43], v[12:13], v[8:9], 0
    v_cvt_pk_bf16_f32 v12, v44, v45
    v_add_f32 v32, v32, v34
    v_add_f32 v33, v33, v35
    v_mfma_f32_16x16x16_bf16 v[44:47], v[12:13], v[8:9], 0
    s_cbranch_vccnz tredo_68l
tredo_68lr:
    v_cvt_pk_bf16_f32 v32, v32, v33
    v_add_f32 v36, v36, v38
    v_add_f32 v37, v37, v39
    v_cvt_pk_bf16_f32 v33, v36, v37
    v_cvt_pk_bf16_f32 v40, v40, v41
    v_cvt_pk_bf16_f32 v41, v42, v43
    s_nop 0
    v_cvt_pk_bf16_f32 v42, v44, v45
    v_cvt_pk_bf16_f32 v43, v46, v47
    v_cndmask_b32 v34, v40, v42, s[94:95]
    v_cndmask_b32 v35, v41, v43, s[94:95]
    buffer_store_dwordx4 v[32:35], v0, s[32:35], s77 offen sc1
    s_endpgm
ttop_70a:
    v_lshlrev_b32 v56, 3, v0
    v_and_b32 v57, 0x780, v56
    s_mov_b32 s57, 133120
    s_mov_b32 s58, 141312
wteam_71:
    buffer_load_dword v58, v56, s[32:35], s57 offen sc1
    buffer_load_dword v59, v57, s[32:35], s58 offen sc1
    s_sub_i32 s54, s54, 1
    s_cmp_lt_i32 s54, 0
    s_waitcnt vmcnt(0)
    s_cbranch_scc1 wteamd_72
    v_and_b32 v58, v58, v59
    v_cmp_eq_u32 vcc, 0, v58
    s_cbranch_vccz wteamd_72
    s_sleep 2
    s_branch wteam_71
wteamd_72:
    s_branch ttop_70b
tp_75:
    buffer_load_dwordx4 v[56:59], v0, s[32:35], s68 offen offset:0 sc1
    buffer_load_dwordx4 v[60:63], v0, s[32:35], s68 offen offset:1024 sc1
    buffer_load_dwordx4 v[64:67], v0, s[32:35], s68 offen offset:2048 sc1
    buffer_load_dwordx4 v[68:71], v0, s[32:35], s68 offen offset:3072 sc1
    s_sub_i32 s54, s54, 1
    s_cmp_lt_i32 s54, 0
    s_cselect_b64 s[96:97], 0, -1
    s_waitcnt vmcnt(3) lgkmcnt(4)
    v_mfma_f32_16x16x32_bf16 v[20:23], v[16:19], v[56:59], 0
    s_waitcnt vmcnt(2)
    v_mfma_f32_16x16x32_bf16 v[20:23], v[16:19], v[60:63], v[20:23]
    s_waitcnt vmcnt(1)
    v_mfma_f32_16x16x32_bf16 v[20:23], v[16:19], v[64:67], v[20:23]
    s_waitcnt vmcnt(0)
    v_mfma_f32_16x16x32_bf16 v[20:23], v[16:19], v[68:71], v[20:23]
    s_nop 7
    v_add_f32_dpp v20, v20, v20 row_ror:8 row_mask:0xf bank_mask:0xf
    v_add_f32_dpp v21, v21, v21 row_ror:8 row_mask:0xf bank_mask:0xf
    v_cvt_pk_bf16_f32 v20, v20, v21
    v_cmp_u_f32 vcc, v21, v21
    buffer_store_dword v20, v4, s[32:35], s81 offen
    s_and_b64 vcc, vcc, s[96:97]
    s_cbranch_vccnz tp_75
    s_branch tpd_76
tredo_68l:
    s_cmp_lt_i32 s49, 1
    s_cbranch_scc1 tredo_68lr
tredo_68:
    s_sub_i32 s49, s49, 1
    s_cmp_lt_i32 s49, 0
    s_cbranch_scc1 tredo_68r
    s_mov_b32 s45, s69
    s_waitcnt lgkmcnt(0)
    s_nop 7
    v_add_u32 v1, s63, v0
    v_and_b32 v2, 0x7ffff, v2
    v_or_b32 v2, s51, v2
    v_mov_b64 v[32:33], 0
    v_mov_b64 v[34:35], 0
    v_mov_b64 v[36:37], 0
    v_mov_b64 v[38:39], 0
    v_mov_b64 v[40:41], 0
    v_mov_b64 v[42:43], 0
    v_mov_b64 v[44:45], 0
    v_mov_b64 v[46:47], 0
    ds_read_b128 v[72:75], v1 offset:16384
    ds_read_b128 v[76:79], v1 offset:17408
    ds_read_b128 v[48:51], v1 offset:18432
    ds_read_b128 v[52:55], v1 offset:19456
    s_barrier
    s_branch tm_69
tcls3_50:
    buffer_load_dwordx4 v[64:67], v0, s[32:35], s73 offen offset:0 sc1
    buffer_load_dwordx4 v[68:71], v0, s[32:35], s73 offen offset:1024 sc1
    s_barrier
    buffer_store_dwordx4 v[28:31], v0, s[32:35], s45 offen sc1
    v_add_u32 v1, s63, v0
    v_and_b32 v2, 0x7ffff, v2
    v_or_b32 v2, s51, v2
    v_mov_b64 v[32:33], 0
    v_mov_b64 v[34:35], 0
    v_mov_b64 v[36:37], 0
    v_mov_b64 v[38:39], 0
    v_mov_b64 v[40:41], 0
    v_mov_b64 v[42:43], 0
    v_mov_b64 v[44:45], 0
    v_mov_b64 v[46:47], 0
    v_lshlrev_b32 v12, 3, v0
    v_and_b32 v14, 0x180, v12
    ds_read_b128 v[72:75], v1 offset:16384
    ds_read_b128 v[76:79], v1 offset:17408
    ds_read_b128 v[48:51], v1 offset:18432
    ds_read_b128 v[52:55], v1 offset:19456
    s_waitcnt lgkmcnt(0)
    s_branch tw_77
.p2align 6
ttop_80:
    s_and_b32 s57, s64, 3
    s_lshl_b32 s58, s57, 14
    s_add_u32 s81, s70, s58
    s_add_u32 s85, s58, 7405568
    s_xor_b32 s51, s57, 2
    s_lshl_b32 s51, s51, 19
    s_add_u32 s72, s72, 786432
    s_add_u32 s73, s73, 786432
    s_mov_b32 s45, s77
    s_add_u32 s77, s77, 131072
    s_sub_u32 s99, s64, 1
    v_add_u32 v1, s63, v0
    v_and_b32 v2, 0x7ffff, v2
    v_or_b32 v2, s51, v2
    v_mov_b64 v[32:33], 0
    v_mov_b64 v[34:35], 0
    v_mov_b64 v[36:37], 0
    v_mov_b64 v[38:39], 0
    v_mov_b64 v[40:41], 0
    v_mov_b64 v[42:43], 0
    v_mov_b64 v[44:45], 0
    v_mov_b64 v[46:47], 0
    v_lshlrev_b32 v12, 3, v0
    v_and_b32 v14, 0x180, v12
    ds_read_b128 v[72:75], v1 offset:16384
    ds_read_b128 v[76:79], v1 offset:17408
    ds_read_b128 v[48:51], v1 offset:18432
    ds_read_b128 v[52:55], v1 offset:19456
    s_waitcnt vmcnt(18)
    v_readlane_b32 s80, v4, 0
    v_readlane_b32 s57, v4, 1
    v_readlane_b32 s58, v4, 2
    v_readlane_b32 s59, v4, 3
    s_min_u32 s80, s80, s57
    s_min_u32 s58, s58, s59
    s_min_u32 s80, s80, s58
    s_add_u32 s57, s64, 2
    s_min_u32 s57, s57, 64
    s_cmp_lt_u32 s80, s57
    s_cbranch_scc1 t3p_82
t3ok_81:
    s_cmp_lt_u32 s64, 63
    s_cselect_b32 s57, 786432, 0
    s_add_u32 s83, s83, s57
    s_nop 15
    s_nop 8
    s_mov_b64 exec, 1
    buffer_load_dword v56, off, s[32:35], s47 sc1
    s_nop 5
    buffer_load_dword v57, off, s[32:35], s47 sc1
    s_nop 5
    buffer_load_dword v58, off, s[32:35], s47 sc1
    s_nop 5
    buffer_load_dword v59, off, s[32:35], s47 sc1
    s_nop 5
    buffer_load_dword v60, off, s[32:35], s47 sc1
    s_nop 5
    buffer_load_dword v61, off, s[32:35], s47 sc1
    s_nop 5
    buffer_load_dword v62, off, s[32:35], s47 sc1
tk_83:
    s_waitcnt vmcnt(6)
    v_cmp_eq_u32 vcc, s64, v56
    s_sub_i32 s54, s54, 1
    s_cmp_lt_i32 s54, 0
    buffer_load_dword v56, off, s[32:35], s47 sc1
    s_cbranch_vccnz tkd_84
    s_waitcnt vmcnt(6)
    v_cmp_eq_u32 vcc, s64, v57
    buffer_load_dword v57, off, s[32:35], s47 sc1
    s_cbranch_vccnz tkd_84
    s_waitcnt vmcnt(6)
    v_cmp_eq_u32 vcc, s64, v58
    buffer_load_dword v58, off, s[32:35], s47 sc1
    s_cbranch_vccnz tkd_84
    s_waitcnt vmcnt(6)
    v_cmp_eq_u32 vcc, s64, v59
    buffer_load_dword v59, off, s[32:35], s47 sc1
    s_cbranch_vccnz tkd_84
    s_waitcnt vmcnt(6)
    v_cmp_eq_u32 vcc, s64, v60
    buffer_load_dword v60, off, s[32:35], s47 sc1
    s_cbranch_vccnz tkd_84
    s_waitcnt vmcnt(6)
    v_cmp_eq_u32 vcc, s64, v61
    buffer_load_dword v61, off, s[32:35], s47 sc1
    s_cbranch_vccnz tkd_84
    s_waitcnt vmcnt(6)
    v_cmp_eq_u32 vcc, s64, v62
    buffer_load_dword v62, off, s[32:35], s47 sc1
    s_cbranch_vccnz tkd_84
    s_waitcnt vmcnt(6)
    v_cmp_eq_u32 vcc, s64, v56
    s_sub_i32 s54, s54, 1
    s_cmp_lt_i32 s54, 0
    buffer_load_dword v56, off, s[32:35], s47 sc1
    s_cbranch_vccnz tkd_84
    s_waitcnt vmcnt(6)
    v_cmp_eq_u32 vcc, s64, v57
    buffer_load_dword v57, off, s[32:35], s47 sc1
    s_cbranch_vccnz tkd_84
    s_waitcnt vmcnt(6)
    v_cmp_eq_u32 vcc, s64, v58
    buffer_load_dword v58, off, s[32:35], s47 sc1
    s_cbranch_vccnz tkd_84
    s_waitcnt vmcnt(6)
    v_cmp_eq_u32 vcc, s64, v59
    buffer_load_dword v59, off, s[32:35], s47 sc1
    s_cbranch_vccnz tkd_84
    s_waitcnt vmcnt(6)
    v_cmp_eq_u32 vcc, s64, v60
    buffer_load_dword v60, off, s[32:35], s47 sc1
    s_cbranch_vccnz tkd_84
    s_waitcnt vmcnt(6)
    v_cmp_eq_u32 vcc, s64, v61
    buffer_load_dword v61, off, s[32:35], s47 sc1
    s_cbranch_vccnz tkd_84
    s_waitcnt vmcnt(6)
    v_cmp_eq_u32 vcc, s64, v62
    buffer_load_dword v62, off, s[32:35], s47 sc1
    s_cbranch_vccnz tkd_84
    s_cbranch_scc0 tk_83
tkd_84:
    s_mov_b64 exec, -1
    s_mov_b32 m0, 0
    s_nop 0
    buffer_load_dwordx4 v0, s[32:35], s85 offen offset:0 sc1 lds
    buffer_load_dwordx4 v0, s[32:35], s85 offen offset:1024 sc1 lds
    buffer_load_dwordx4 v0, s[32:35], s85 offen offset:2048 sc1 lds
    buffer_load_dwordx4 v0, s[32:35], s85 offen offset:3072 sc1 lds
    s_nop 4
tm_79:
    s_add_u32 m0, s56, 4096
    s_add_u32 s57, s85, m0
    s_add_u32 s58, s85, 8192
    s_barrier
    buffer_load_dwordx4 v0, s[32:35], s57 offen sc1 lds
    s_nop 5
    buffer_load_dwordx4 v[56:59], v0, s[32:35], s72 offen offset:0 sc1
    buffer_load_dwordx4 v[60:63], v0, s[32:35], s72 offen offset:1024 sc1
    s_barrier
    buffer_load_dwordx4 v[64:67], v0, s[32:35], s73 offen offset:0 sc1
    buffer_load_dwordx4 v[68:71], v0, s[32:35], s73 offen offset:1024 sc1
    s_barrier
    buffer_store_dwordx4 v[28:31], v0, s[32:35], s45 offen sc1
    s_cmp_eq_u32 s64, 63
    s_cbranch_scc1 tw_77l
    s_waitcnt lgkmcnt(0) vmcnt(6)
tw_77:
    s_barrier
    buffer_load_dword v4, v12, s[32:35], s83 offen sc1
    ds_read_b128 v[16:19], v0 offset:0
    buffer_load_dword v4, v14, s[32:35], s79 offen sc1
    ds_read_b128 v[24:27], v0 offset:2048
    ds_read_b128 v[20:23], v0 offset:1024
    buffer_store_dword v15, v2, s[32:35], s37 offen
    s_waitcnt lgkmcnt(2)
    v_smfmac_f32_16x16x64_bf16 v[32:35], v[16:19], v[72:79], v9
    ds_read_b128 v[76:79], v1 offset:33792
    v_smfmac_f32_16x16x64_bf16 v[36:39], v[16:19], v[48:55], v9
    ds_read_b128 v[52:55], v1 offset:35840
    s_waitcnt lgkmcnt(2)
    v_smfmac_f32_16x16x64_bf16 v[32:35], v[20:23], a[0:7], v9
    ds_read_b128 v[28:31], v0 offset:3072
    v_smfmac_f32_16x16x64_bf16 v[36:39], v[20:23], a[48:55], v9
    ds_read_b128 v[48:51], v1 offset:34816
    v_smfmac_f32_16x16x64_bf16 v[40:43], v[16:19], a[96:103], v9
    ds_read_b128 v[72:75], v1 offset:32768
    v_smfmac_f32_16x16x64_bf16 v[44:47], v[16:19], a[152:159], v9
    s_waitcnt vmcnt(8)
    s_barrier
    v_smfmac_f32_16x16x64_bf16 v[32:35], v[24:27], a[8:15], v9
    v_smfmac_f32_16x16x64_bf16 v[36:39], v[24:27], a[56:63], v9
    ds_read_b128 v[16:19], v0 offset:4096
    s_waitcnt lgkmcnt(1)
    v_smfmac_f32_16x16x64_bf16 v[40:43], v[20:23], v[72:79], v9
    ds_read_b128 v[72:75], v1 offset:49152
    v_smfmac_f32_16x16x64_bf16 v[44:47], v[20:23], v[48:55], v9
    ds_read_b128 v[76:79], v1 offset:50176
    v_smfmac_f32_16x16x64_bf16 v[32:35], v[28:31], a[16:23], v9
    ds_read_b128 v[48:51], v1 offset:51200
    v_smfmac_f32_16x16x64_bf16 v[36:39], v[28:31], a[64:71], v9
    ds_read_b128 v[52:55], v1 offset:52224
    v_add_u32 v1, 0x10000, v1
    v_smfmac_f32_16x16x64_bf16 v[40:43], v[24:27], a[104:111], v9
    ds_read_b128 v[20:23], v0 offset:5120
    v_smfmac_f32_16x16x64_bf16 v[44:47], v[24:27], a[160:167], v9
    buffer_store_dword v15, v2, s[32:35], s36 offen
    ds_read_b128 v[24:27], v0 offset:6144
    s_waitcnt lgkmcnt(4)
    v_smfmac_f32_16x16x64_bf16 v[32:35], v[16:19], v[72:79], v9
    ds_read_b128 v[72:75], v1 offset:0
    s_waitcnt lgkmcnt(3)
    v_smfmac_f32_16x16x64_bf16 v[36:39], v[16:19], v[48:55], v9
    ds_read_b128 v[76:79], v1 offset:1024
    v_smfmac_f32_16x16x64_bf16 v[40:43], v[28:31], a[112:119], v9
    buffer_store_dword v15, v2, s[32:35], s40 offen
    v_smfmac_f32_16x16x64_bf16 v[44:47], v[28:31], a[168:175], v9
    ds_read_b128 v[48:51], v1 offset:2048
    s_waitcnt lgkmcnt(4)
    v_smfmac_f32_16x16x64_bf16 v[32:35], v[20:23], a[24:31], v9
    ds_read_b128 v[52:55], v1 offset:3072
    v_smfmac_f32_16x16x64_bf16 v[36:39], v[20:23], a[72:79], v9
    v_smfmac_f32_16x16x64_bf16 v[40:43], v[16:19], a[120:127], v9
    buffer_store_dword v15, v2, s[32:35], s41 offen
    v_smfmac_f32_16x16x64_bf16 v[44:47], v[16:19], a[176:183], v9
    ds_read_b128 v[28:31], v0 offset:7168
    ds_read_b128 v[16:19], v0 offset:8192
    s_waitcnt lgkmcnt(4)
    v_smfmac_f32_16x16x64_bf16 v[32:35], v[24:27], v[72:79], v9
    buffer_store_dword v15, v2, s[32:35], s39 offen
    s_waitcnt lgkmcnt(2)
    v_smfmac_f32_16x16x64_bf16 v[36:39], v[24:27], v[48:55], v9
    ds_read_b128 v[52:55], v1 offset:19456
    ds_read_b128 v[72:75], v1 offset:16384
    v_smfmac_f32_16x16x64_bf16 v[40:43], v[20:23], a[128:135], v9
    buffer_store_dword v15, v2, s[32:35], s42 offen
    v_smfmac_f32_16x16x64_bf16 v[44:47], v[20:23], a[184:191], v9
    ds_read_b128 v[48:51], v1 offset:18432
    ds_read_b128 v[76:79], v1 offset:17408
    s_waitcnt lgkmcnt(5)
    v_smfmac_f32_16x16x64_bf16 v[32:35], v[28:31], a[32:39], v9
    buffer_store_dword v15, v2, s[32:35], s38 offen
    v_smfmac_f32_16x16x64_bf16 v[36:39], v[28:31], a[80:87], v9
    s_waitcnt lgkmcnt(4)
    v_smfmac_f32_16x16x64_bf16 v[32:35], v[16:19], a[40:47], v9
    buffer_store_dword v15, v2, s[32:35], s43 offen
    v_smfmac_f32_16x16x64_bf16 v[36:39], v[16:19], a[88:95], v9
    s_waitcnt lgkmcnt(0)
    v_smfmac_f32_16x16x64_bf16 v[40:43], v[24:27], v[72:79], v9
    buffer_store_dword v15, v2, s[32:35], s44 offen
    v_add_f32 v33, v33, v35
    v_smfmac_f32_16x16x64_bf16 v[44:47], v[24:27], v[48:55], v9
    v_add_f32 v32, v32, v34
    v_smfmac_f32_16x16x64_bf16 v[40:43], v[28:31], a[136:143], v9
    ds_read_b128 v[72:75], v1 offset:32768
    v_add_f32 v36, v36, v38
    v_smfmac_f32_16x16x64_bf16 v[44:47], v[28:31], a[192:199], v9
    v_add_f32 v37, v37, v39
    v_smfmac_f32_16x16x64_bf16 v[40:43], v[16:19], a[144:151], v9
    v_cvt_pk_bf16_f32 v12, v32, v33
    v_mov_b64 v[48:49], 0
    v_cmp_u_f32 vcc, v32, v33
    v_mfma_f32_16x16x16_bf16 v[32:35], v[12:13], v[8:9], 0
    v_cvt_pk_bf16_f32 v12, v36, v37
    v_mov_b64 v[54:55], 0
    v_add_f32 v41, v41, v43
    v_mfma_f32_16x16x16_bf16 v[36:39], v[12:13], v[8:9], 0
    v_add_f32 v40, v40, v42
    v_cvt_pk_bf16_f32 v12, v40, v41
    v_mov_b64 v[52:53], 0
    v_smfmac_f32_16x16x64_bf16 v[44:47], v[16:19], a[200:207], v9
    ds_read_b128 v[76:79], v1 offset:33792
    v_cvt_pk_bf16_f32 v32, v32, v33
    v_cvt_pk_bf16_f32 v33, v34, v35
    v_cvt_pk_bf16_f32 v34, v36, v37
    v_mfma_f32_16x16x16_bf16 v[40:43], v[12:13], v[8:9], 0
    v_cvt_pk_bf16_f32 v35, v38, v39
    v_mov_b64 v[50:51], 0
    v_add_f32 v45, v45, v47
    s_waitcnt vmcnt(15)
    v_mfma_f32_16x16x32_bf16 v[56:59], v[56:59], v[32:35], 0
    v_add_f32 v44, v44, v46
    v_cvt_pk_bf16_f32 v12, v44, v45
    v_smfmac_f32_16x16x64_bf16 v[48:51], v[20:23], a[248:255], v9
    s_cbranch_vccnz tredo_78
tredo_78r:
    v_mfma_f32_16x16x16_bf16 v[44:47], v[12:13], v[8:9], 0
    s_nop 0
    ds_write_b128 v3, v[56:59] offset:9216
    v_cvt_pk_bf16_f32 v40, v40, v41
    v_cvt_pk_bf16_f32 v41, v42, v43
    s_waitcnt vmcnt(14)
    v_mfma_f32_16x16x32_bf16 v[60:63], v[60:63], v[32:35], 0
    s_nop 1
    v_cvt_pk_bf16_f32 v43, v46, v47
    v_cvt_pk_bf16_f32 v42, v44, v45
    v_smfmac_f32_16x16x64_bf16 v[52:55], v[20:23], v[136:143], v9
    v_mfma_f32_16x16x32_bf16 v[44:47], v[40:43], v[32:35], 0
    ds_write_b128 v3, v[60:63] offset:9728
    v_smfmac_f32_16x16x64_bf16 v[48:51], v[24:27], v[80:87], v9
    s_nop 4
    ds_write_b64 v5, v[44:45] offset:13312
    v_smfmac_f32_16x16x64_bf16 v[52:55], v[24:27], v[144:151], v9
    ds_read_b128 v[24:27], v0 offset:1024
    v_smfmac_f32_16x16x64_bf16 v[48:51], v[28:31], v[88:95], v9
    ds_read_b128 v[20:23], v0 offset:0
    v_smfmac_f32_16x16x64_bf16 v[52:55], v[28:31], v[152:159], v9
    ds_read_b128 v[28:31], v0 offset:2048
    s_waitcnt lgkmcnt(3)
    s_barrier
    v_smfmac_f32_16x16x64_bf16 v[48:51], v[16:19], v[72:79], v9
    ds_read_b64 v[46:47], v6 offset:14336
    ds_read_b64 v[44:45], v6 offset:13312
    s_waitcnt lgkmcnt(3)
    v_smfmac_f32_16x16x64_bf16 v[48:51], v[20:23], a[208:215], v9
    ds_read_b128 v[32:35], v6 offset:11264
    v_smfmac_f32_16x16x64_bf16 v[52:55], v[20:23], v[96:103], v9
    ds_read_b128 v[20:23], v0 offset:3072
    v_smfmac_f32_16x16x64_bf16 v[48:51], v[24:27], a[216:223], v9
    ds_read_b128 v[36:39], v6 offset:12288
    v_smfmac_f32_16x16x64_bf16 v[52:55], v[24:27], v[104:111], v9
    ds_read_b128 v[60:63], v6 offset:10240
    s_waitcnt lgkmcnt(4)
    v_add_f32 v45, v45, v47
    v_add_f32 v44, v44, v46
    v_smfmac_f32_16x16x64_bf16 v[48:51], v[28:31], a[224:231], v9
    ds_read_b128 v[56:59], v6 offset:9216
    v_add_f32_dpp v44, v44, v44 quad_perm:[2,3,0,1] row_mask:0xf bank_mask:0xf
    v_smfmac_f32_16x16x64_bf16 v[52:55], v[28:31], v[112:119], v9
    ds_read_b128 v[72:75], v1 offset:34816
    s_waitcnt lgkmcnt(3)
    v_add_f32 v35, v35, v39
    v_smfmac_f32_16x16x64_bf16 v[48:51], v[20:23], a[232:239], v9
    ds_read_b128 v[24:27], v0 offset:4096
    v_add_f32 v34, v34, v38
    v_smfmac_f32_16x16x64_bf16 v[52:55], v[20:23], v[120:127], v9
    ds_read_b128 v[76:79], v1 offset:35840
    v_add_f32 v33, v33, v37
    v_add_f32 v32, v32, v36
    s_waitcnt lgkmcnt(3)
    v_add_f32 v59, v59, v63
    v_add_f32 v59, v59, v35
    v_add_f32_dpp v45, v45, v45 quad_perm:[2,3,0,1] row_mask:0xf bank_mask:0xf
    v_add_f32 v58, v58, v62
    v_add_f32 v56, v56, v60
    v_add_f32 v56, v56, v32
    v_add_f32 v57, v57, v61
    v_add_f32 v58, v58, v34
    v_add_f32 v57, v57, v33
    v_max3_f32 v62, v56, v57, v58
    v_max_f32 v62, v62, v59
    s_waitcnt lgkmcnt(0)
    v_smfmac_f32_16x16x64_bf16 v[52:55], v[16:19], v[72:79], v9
    ds_read_b128 v[76:79], v1 offset:50176
    v_max_f32_dpp v62, v62, v62 quad_perm:[2,3,0,1] row_mask:0xf bank_mask:0xf
    v_max3_f32 v62, v62, v44, v45
    v_mov_b32 v63, v62
    v_smfmac_f32_16x16x64_bf16 v[48:51], v[24:27], a[240:247], v9
    v_permlane32_swap_b32 v62, v63
    v_max_f32 v62, v62, v63
    v_mov_b32 v63, v62
    v_smfmac_f32_16x16x64_bf16 v[52:55], v[24:27], v[128:135], v9
    ds_read_b128 v[72:75], v1 offset:49152
    v_permlane16_swap_b32 v62, v63
    v_max_f32 v62, v62, v63
    v_add_f32 v48, v48, v50
    v_mul_f32 v63, s75, v62
    v_fma_f32 v45, v45, s75, -v63
    v_fma_f32 v59, v59, s75, -v63
    v_exp_f32 v59, v59
    v_add_f32 v52, v52, v54
    v_exp_f32 v45, v45
    v_fma_f32 v58, v58, s75, -v63
    v_add_f32 v53, v53, v55
    v_exp_f32 v58, v58
    v_fma_f32 v57, v57, s75, -v63
    v_fma_f32 v44, v44, s75, -v63
    v_exp_f32 v44, v44
    v_exp_f32 v57, v57
    v_add_f32 v49, v49, v51
    v_cvt_pk_bf16_f32 v44, v44, v45
    v_cndmask_b32 v46, v44, 0, s[94:95]
    v_cvt_pk_bf16_f32 v48, v48, v49
    v_cndmask_b32 v47, 0, v44, s[94:95]
    v_fma_f32 v56, v56, s75, -v63
    v_cvt_pk_bf16_f32 v61, v58, v59
    v_cvt_pk_bf16_f32 v49, v52, v53
    v_exp_f32 v56, v56
    v_mfma_f32_16x16x16_bf16 v[32:35], v[48:49], v[46:47], 0
    v_cvt_pk_bf16_f32 v60, v56, v57
    v_mov_b32_dpp v57, v61 quad_perm:[0,1,0,1] row_mask:0xf bank_mask:0xf
    v_mfma_f32_16x16x16_bf16 v[36:39], v[10:11], v[46:47], 0
    v_mov_b32_dpp v56, v60 quad_perm:[0,1,0,1] row_mask:0xf bank_mask:0xf
    v_mov_b32_dpp v58, v60 quad_perm:[2,3,2,3] row_mask:0xf bank_mask:0xf
    v_mov_b32_dpp v59, v61 quad_perm:[2,3,2,3] row_mask:0xf bank_mask:0xf
    v_mfma_f32_16x16x16_bf16 v[36:39], v[10:11], v[56:57], v[36:39]
    v_mfma_f32_16x16x16_bf16 v[36:39], v[10:11], v[58:59], v[36:39]
    v_mov_b32 v12, 0
    s_waitcnt vmcnt(12)
    v_mfma_f32_16x16x32_bf16 v[68:71], v[68:71], v[56:59], v[32:35]
    ds_read_b128 v[20:23], v1 offset:52224
    v_mfma_f32_16x16x32_bf16 v[64:67], v[64:67], v[56:59], v[32:35]
    s_barrier
    v_rcp_f32 v14, v36
    v_mfma_f32_16x16x16_bf16 v[32:35], v[12:13], v[10:11], 0
    ds_read_b128 v[16:19], v1 offset:51200
    s_nop 3
    v_cndmask_b32 v65, v65, v69, s[94:95]
    v_cndmask_b32 v67, v67, v71, s[94:95]
    v_cndmask_b32 v64, v64, v68, s[94:95]
    v_mul_f32 v64, v64, v14
    v_mul_f32 v65, v65, v14
    v_cvt_pk_bf16_f32 v64, v64, v65
    v_cndmask_b32 v66, v66, v70, s[94:95]
    v_mul_f32 v66, v66, v14
    v_mul_f32 v67, v67, v14
    v_cvt_pk_bf16_f32 v65, v66, v67
    v_mfma_f32_16x16x16_bf16 v[56:59], v[12:13], v[10:11], 0
    ds_write_b64 v7, v[64:65] offset:9216
    v_cndmask_b32 v31, v41, v43, s[94:95]
    v_cndmask_b32 v30, v40, v42, s[94:95]
    v_mfma_f32_16x16x16_bf16 v[44:47], v[12:13], v[10:11], 0
    v_add_u32 v1, 0x10000, v1
    v_mfma_f32_16x16x16_bf16 v[24:27], v[12:13], v[10:11], 0
    v_mfma_f32_16x16x16_bf16 v[52:55], v[12:13], v[10:11], 0
    s_waitcnt lgkmcnt(0)
    s_barrier
    v_mfma_f32_16x16x16_bf16 v[40:43], v[12:13], v[10:11], 0
    ds_read_b128 v[64:67], v6 offset:9216
    v_mov_b64 v[28:29], v[48:49]
    v_mfma_f32_16x16x16_bf16 v[48:51], v[12:13], v[10:11], 0
    ds_read_b128 v[68:71], v6 offset:10240
    v_mfma_f32_16x16x16_bf16 v[60:63], v[12:13], v[10:11], 0
    v_mfma_f32_16x16x16_bf16 v[36:39], v[12:13], v[10:11], 0
    v_xor_b32 v2, 0x100000, v2
    s_waitcnt lgkmcnt(1)
    v_smfmac_f32_16x16x64_bf16 v[24:27], v[64:67], v[72:79], v9
    s_waitcnt lgkmcnt(0)
    v_smfmac_f32_16x16x64_bf16 v[24:27], v[68:71], v[16:23], v9
    ds_read_b128 v[20:23], v1 offset:3072
    v_smfmac_f32_16x16x64_bf16 v[52:55], v[64:67], v[160:167], v9
    ds_read_b128 v[16:19], v1 offset:2048
    v_smfmac_f32_16x16x64_bf16 v[52:55], v[68:71], v[168:175], v9
    ds_read_b128 v[72:75], v1 offset:0
    v_add_f32 v25, v25, v27
    v_smfmac_f32_16x16x64_bf16 v[40:43], v[64:67], v[176:183], v9
    ds_read_b128 v[76:79], v1 offset:1024
    v_add_f32 v24, v24, v26
    v_cvt_pk_bf16_f32 v24, v24, v25
    v_smfmac_f32_16x16x64_bf16 v[40:43], v[68:71], v[184:191], v9
    v_smfmac_f32_16x16x64_bf16 v[60:63], v[64:67], v[192:199], v9
    buffer_store_dword v24, v2, s[32:35], s36 offen
    v_add_f32 v52, v52, v54
    v_add_f32 v53, v53, v55
    v_smfmac_f32_16x16x64_bf16 v[60:63], v[68:71], v[200:207], v9
    v_add_f32 v40, v40, v42
    v_add_f32 v41, v41, v43
    v_cvt_pk_bf16_f32 v40, v40, v41
    v_cvt_pk_bf16_f32 v52, v52, v53
    s_waitcnt lgkmcnt(0)
    v_smfmac_f32_16x16x64_bf16 v[44:47], v[64:67], v[72:79], v9
    buffer_store_dword v52, v2, s[32:35], s37 offen
    v_add_f32 v61, v61, v63
    v_add_f32 v60, v60, v62
    v_smfmac_f32_16x16x64_bf16 v[44:47], v[68:71], v[16:23], v9
    ds_read_b128 v[20:23], v1 offset:19456
    v_smfmac_f32_16x16x64_bf16 v[48:51], v[64:67], v[208:215], v9
    buffer_store_dword v40, v2, s[32:35], s38 offen
    v_cvt_pk_bf16_f32 v60, v60, v61
    v_smfmac_f32_16x16x64_bf16 v[48:51], v[68:71], v[216:223], v9
    ds_read_b128 v[72:75], v1 offset:16384
    ds_read_b128 v[76:79], v1 offset:17408
    v_smfmac_f32_16x16x64_bf16 v[56:59], v[64:67], v[224:231], v9
    buffer_store_dword v60, v2, s[32:35], s39 offen
    v_add_f32 v44, v44, v46
    v_add_f32 v45, v45, v47
    v_cvt_pk_bf16_f32 v44, v44, v45
    v_smfmac_f32_16x16x64_bf16 v[56:59], v[68:71], v[232:239], v9
    ds_read_b128 v[16:19], v1 offset:18432
    v_smfmac_f32_16x16x64_bf16 v[32:35], v[64:67], v[240:247], v9
    buffer_store_dword v44, v2, s[32:35], s40 offen
    v_add_f32 v48, v48, v50
    v_add_f32 v49, v49, v51
    v_cvt_pk_bf16_f32 v48, v48, v49
    v_smfmac_f32_16x16x64_bf16 v[32:35], v[68:71], v[248:255], v9
    s_waitcnt lgkmcnt(1)
    v_smfmac_f32_16x16x64_bf16 v[36:39], v[64:67], v[72:79], v9
    buffer_store_dword v48, v2, s[32:35], s41 offen
    v_add_f32 v57, v57, v59
    v_add_f32 v56, v56, v58
    v_cvt_pk_bf16_f32 v56, v56, v57
    s_waitcnt lgkmcnt(0)
    v_smfmac_f32_16x16x64_bf16 v[36:39], v[68:71], v[16:23], v9
    buffer_store_dword v56, v2, s[32:35], s42 offen
    v_add_f32 v32, v32, v34
    v_add_f32 v33, v33, v35
    v_cvt_pk_bf16_f32 v32, v32, v33
    buffer_store_dword v32, v2, s[32:35], s43 offen
    s_nop 0
    v_add_f32 v36, v36, v38
    v_add_f32 v37, v37, v39
    v_cvt_pk_bf16_f32 v36, v36, v37
    buffer_store_dword v36, v2, s[32:35], s44 offen
    s_add_u32 s64, s64, 1
    s_branch ttop_80
tw_77l:
    s_waitcnt lgkmcnt(0) vmcnt(6)
    s_barrier
    ds_read_b128 v[16:19], v0 offset:0
    ds_read_b128 v[20:23], v0 offset:1024
    ds_read_b128 v[52:55], v1 offset:35840
    ds_read_b128 v[24:27], v0 offset:2048
    s_waitcnt lgkmcnt(3)
    v_smfmac_f32_16x16x64_bf16 v[44:47], v[16:19], a[152:159], v9
    ds_read_b128 v[48:51], v1 offset:34816
    v_smfmac_f32_16x16x64_bf16 v[36:39], v[16:19], v[96:103], v9
    v_smfmac_f32_16x16x64_bf16 v[40:43], v[16:19], a[96:103], v9
    ds_read_b128 v[28:31], v0 offset:3072
    s_waitcnt lgkmcnt(2)
    v_smfmac_f32_16x16x64_bf16 v[44:47], v[24:27], a[160:167], v9
    ds_read_b128 v[76:79], v1 offset:33792
    v_smfmac_f32_16x16x64_bf16 v[40:43], v[24:27], a[104:111], v9
    ds_read_b128 v[72:75], v1 offset:32768
    s_waitcnt lgkmcnt(3)
    v_smfmac_f32_16x16x64_bf16 v[44:47], v[20:23], v[48:55], v9
    s_waitcnt vmcnt(5)
    s_barrier
    v_smfmac_f32_16x16x64_bf16 v[32:35], v[16:19], a[208:215], v9
    v_smfmac_f32_16x16x64_bf16 v[32:35], v[20:23], a[216:223], v9
    v_smfmac_f32_16x16x64_bf16 v[32:35], v[24:27], a[224:231], v9
    s_waitcnt lgkmcnt(2)
    v_smfmac_f32_16x16x64_bf16 v[32:35], v[28:31], a[232:239], v9
    ds_read_b128 v[16:19], v0 offset:4096
    v_smfmac_f32_16x16x64_bf16 v[36:39], v[20:23], v[104:111], v9
    s_waitcnt lgkmcnt(1)
    v_smfmac_f32_16x16x64_bf16 v[40:43], v[20:23], v[72:79], v9
    v_smfmac_f32_16x16x64_bf16 v[40:43], v[28:31], a[112:119], v9
    ds_read_b128 v[20:23], v0 offset:5120
    v_add_u32 v1, 0x10000, v1
    v_smfmac_f32_16x16x64_bf16 v[36:39], v[24:27], v[112:119], v9
    ds_read_b128 v[52:55], v1 offset:19456
    s_waitcnt lgkmcnt(2)
    v_smfmac_f32_16x16x64_bf16 v[32:35], v[16:19], a[240:247], v9
    ds_read_b128 v[24:27], v0 offset:6144
    v_smfmac_f32_16x16x64_bf16 v[44:47], v[28:31], a[168:175], v9
    v_smfmac_f32_16x16x64_bf16 v[36:39], v[28:31], v[120:127], v9
    ds_read_b128 v[28:31], v0 offset:7168
    v_smfmac_f32_16x16x64_bf16 v[44:47], v[16:19], a[176:183], v9
    ds_read_b128 v[76:79], v1 offset:17408
    v_smfmac_f32_16x16x64_bf16 v[36:39], v[16:19], v[128:135], v9
    ds_read_b128 v[48:51], v1 offset:18432
    s_waitcnt lgkmcnt(5)
    v_smfmac_f32_16x16x64_bf16 v[32:35], v[20:23], a[248:255], v9
    ds_read_b128 v[72:75], v1 offset:16384
    v_smfmac_f32_16x16x64_bf16 v[40:43], v[16:19], a[120:127], v9
    ds_read_b128 v[16:19], v0 offset:8192
    v_smfmac_f32_16x16x64_bf16 v[44:47], v[20:23], a[184:191], v9
    v_smfmac_f32_16x16x64_bf16 v[40:43], v[20:23], a[128:135], v9
    s_waitcnt lgkmcnt(2)
    v_smfmac_f32_16x16x64_bf16 v[44:47], v[24:27], v[48:55], v9
    ds_read_b128 v[48:51], v1 offset:34816
    v_smfmac_f32_16x16x64_bf16 v[32:35], v[24:27], v[80:87], v9
    s_waitcnt lgkmcnt(2)
    v_smfmac_f32_16x16x64_bf16 v[40:43], v[24:27], v[72:79], v9
    v_smfmac_f32_16x16x64_bf16 v[40:43], v[28:31], a[136:143], v9
    ds_read_b128 v[52:55], v1 offset:35840
    s_waitcnt lgkmcnt(2)
    v_smfmac_f32_16x16x64_bf16 v[40:43], v[16:19], a[144:151], v9
    v_smfmac_f32_16x16x64_bf16 v[44:47], v[28:31], a[192:199], v9
    ds_read_b128 v[72:75], v1 offset:32768
    v_smfmac_f32_16x16x64_bf16 v[36:39], v[20:23], v[136:143], v9
    ds_read_b128 v[76:79], v1 offset:33792
    v_add_f32 v40, v40, v42
    v_smfmac_f32_16x16x64_bf16 v[32:35], v[28:31], v[88:95], v9
    v_add_f32 v41, v41, v43
    v_smfmac_f32_16x16x64_bf16 v[44:47], v[16:19], a[200:207], v9
    v_cvt_pk_bf16_f32 v12, v40, v41
    v_smfmac_f32_16x16x64_bf16 v[36:39], v[24:27], v[144:151], v9
    v_smfmac_f32_16x16x64_bf16 v[36:39], v[28:31], v[152:159], v9
    s_waitcnt lgkmcnt(0)
    v_smfmac_f32_16x16x64_bf16 v[32:35], v[16:19], v[72:79], v9
    v_add_f32 v45, v45, v47
    v_smfmac_f32_16x16x64_bf16 v[36:39], v[16:19], v[48:55], v9
    v_cmp_u_f32 vcc, v40, v41
    v_add_f32 v44, v44, v46
    v_mfma_f32_16x16x16_bf16 v[40:43], v[12:13], v[8:9], 0
    v_cvt_pk_bf16_f32 v12, v44, v45
    v_add_f32 v32, v32, v34
    v_add_f32 v33, v33, v35
    v_mfma_f32_16x16x16_bf16 v[44:47], v[12:13], v[8:9], 0
    s_cbranch_vccnz tredo_78l
tredo_78lr:
    v_cvt_pk_bf16_f32 v32, v32, v33
    v_add_f32 v36, v36, v38
    v_add_f32 v37, v37, v39
    v_cvt_pk_bf16_f32 v33, v36, v37
    v_cvt_pk_bf16_f32 v40, v40, v41
    v_cvt_pk_bf16_f32 v41, v42, v43
    s_nop 0
    v_cvt_pk_bf16_f32 v42, v44, v45
    v_cvt_pk_bf16_f32 v43, v46, v47
    v_cndmask_b32 v34, v40, v42, s[94:95]
    v_cndmask_b32 v35, v41, v43, s[94:95]
    buffer_store_dwordx4 v[32:35], v0, s[32:35], s77 offen sc1
    s_endpgm
t3p_82:
wp_85:
    buffer_load_dword v56, off, s[32:35], s79 offset:0 sc1
    buffer_load_dword v57, off, s[32:35], s79 offset:128 sc1
    buffer_load_dword v58, off, s[32:35], s79 offset:256 sc1
    buffer_load_dword v59, off, s[32:35], s79 offset:384 sc1
    s_sub_i32 s54, s54, 1
    s_cmp_lt_i32 s54, 0
    s_waitcnt vmcnt(0)
    s_cbranch_scc1 wpd_86
    v_min_u32 v56, v56, v57
    v_min3_u32 v56, v56, v58, v59
    v_cmp_gt_u32 vcc, s57, v56
    s_cbranch_vccz wpd_86
    s_sleep 1
    s_branch wp_85
wpd_86:
    s_branch t3ok_81
tredo_78l:
    s_cmp_lt_i32 s49, 1
    s_cbranch_scc1 tredo_78lr
tredo_78:
    s_sub_i32 s49, s49, 1
    s_cmp_lt_i32 s49, 0
    s_cbranch_scc1 tredo_78r
    s_mov_b32 s45, s69
    s_waitcnt lgkmcnt(0)
    s_nop 7
    v_add_u32 v1, s63, v0
    v_and_b32 v2, 0x7ffff, v2
    v_or_b32 v2, s51, v2
    v_mov_b64 v[32:33], 0
    v_mov_b64 v[34:35], 0
    v_mov_b64 v[36:37], 0
    v_mov_b64 v[38:39], 0
    v_mov_b64 v[40:41], 0
    v_mov_b64 v[42:43], 0
    v_mov_b64 v[44:45], 0
    v_mov_b64 v[46:47], 0
    v_lshlrev_b32 v12, 3, v0
    v_and_b32 v14, 0x180, v12
    ds_read_b128 v[72:75], v1 offset:16384
    ds_read_b128 v[76:79], v1 offset:17408
    ds_read_b128 v[48:51], v1 offset:18432
    ds_read_b128 v[52:55], v1 offset:19456
    s_barrier
    s_mov_b32 m0, 0
    s_nop 0
    buffer_load_dwordx4 v0, s[32:35], s85 offen offset:0 sc1 lds
    buffer_load_dwordx4 v0, s[32:35], s85 offen offset:1024 sc1 lds
    buffer_load_dwordx4 v0, s[32:35], s85 offen offset:2048 sc1 lds
    buffer_load_dwordx4 v0, s[32:35], s85 offen offset:3072 sc1 lds
    s_branch tm_79
tslow_46:
    s_cmp_eq_u32 s52, 1
    s_cbranch_scc1 tcls1_88
    s_cmp_eq_u32 s52, 2
    s_cbranch_scc1 tcls2_89
    s_cmp_eq_u32 s52, 3
    s_cbranch_scc1 tcls3_90
tcls0_87:
    buffer_load_dwordx4 v[64:67], v0, s[32:35], s73 offen offset:0 sc1
    buffer_load_dwordx4 v[68:71], v0, s[32:35], s73 offen offset:1024 sc1
    s_barrier
    buffer_store_dwordx4 v[28:31], v0, s[32:35], s45 offen sc1
    v_add_u32 v1, s63, v0
    v_and_b32 v2, 0x7ffff, v2
    v_or_b32 v2, s51, v2
    v_mov_b64 v[32:33], 0
    v_mov_b64 v[34:35], 0
    v_mov_b64 v[36:37], 0
    v_mov_b64 v[38:39], 0
    v_mov_b64 v[40:41], 0
    v_mov_b64 v[42:43], 0
    v_mov_b64 v[44:45], 0
    v_mov_b64 v[46:47], 0
    v_lshlrev_b32 v12, 3, v0
    ds_read_b128 v[72:75], v1 offset:16384
    ds_read_b128 v[76:79], v1 offset:17408
    ds_read_b128 v[48:51], v1 offset:18432
    ds_read_b128 v[52:55], v1 offset:19456
    s_waitcnt lgkmcnt(0)
    s_branch tw_91
.p2align 6
ttop_94:
    s_cmp_eq_u32 s64, 1
    s_cbranch_scc1 ttop_94a
ttop_94b:
    s_nop 15
    buffer_load_dwordx4 v[56:59], v0, s[32:35], s68 offen offset:0 sc1
    buffer_load_dwordx4 v[60:63], v0, s[32:35], s68 offen offset:1024 sc1
    buffer_load_dwordx4 v[64:67], v0, s[32:35], s68 offen offset:2048 sc1
    buffer_load_dwordx4 v[68:71], v0, s[32:35], s68 offen offset:3072 sc1
    s_and_b32 s57, s64, 3
    s_lshl_b32 s58, s57, 14
    s_add_u32 s81, s70, s58
    s_add_u32 s85, s58, 7405568
    s_xor_b32 s51, s57, 2
    s_lshl_b32 s51, s51, 19
    s_add_u32 s72, s72, 786432
    s_add_u32 s73, s73, 786432
    s_mov_b32 s45, s77
    s_add_u32 s77, s77, 131072
    s_sub_u32 s99, s64, 1
    ds_read_b128 v[16:19], v0 offset:15360
    v_add_u32 v1, s63, v0
    v_and_b32 v2, 0x7ffff, v2
    v_or_b32 v2, s51, v2
    v_mov_b64 v[32:33], 0
    v_mov_b64 v[34:35], 0
    v_mov_b64 v[36:37], 0
    v_mov_b64 v[38:39], 0
    v_mov_b64 v[40:41], 0
    v_mov_b64 v[42:43], 0
    v_mov_b64 v[44:45], 0
    v_mov_b64 v[46:47], 0
    v_lshlrev_b32 v12, 3, v0
    ds_read_b128 v[72:75], v1 offset:16384
    ds_read_b128 v[76:79], v1 offset:17408
    ds_read_b128 v[48:51], v1 offset:18432
    ds_read_b128 v[52:55], v1 offset:19456
    v_mov_b32 v24, s64
    s_waitcnt vmcnt(3) lgkmcnt(4)
    v_mfma_f32_16x16x32_bf16 v[20:23], v[16:19], v[56:59], 0
    s_waitcnt vmcnt(2)
    v_mfma_f32_16x16x32_bf16 v[20:23], v[16:19], v[60:63], v[20:23]
    s_waitcnt vmcnt(1)
    v_mfma_f32_16x16x32_bf16 v[20:23], v[16:19], v[64:67], v[20:23]
    s_waitcnt vmcnt(0)
    v_mfma_f32_16x16x32_bf16 v[20:23], v[16:19], v[68:71], v[20:23]
    s_nop 7
    v_add_f32_dpp v20, v20, v20 row_ror:8 row_mask:0xf bank_mask:0xf
    v_add_f32_dpp v21, v21, v21 row_ror:8 row_mask:0xf bank_mask:0xf
    v_cvt_pk_bf16_f32 v20, v20, v21
    v_cmp_u_f32 vcc, v21, v21
    buffer_store_dword v20, v4, s[32:35], s81 offen sc1
    s_cbranch_vccnz tp_97
tpd_98:
    s_mov_b64 exec, 0xff
    buffer_store_dword v24, v12, s[32:35], s48 offen sc1
    s_mov_b64 exec, -1
    s_lshl_b32 s57, s57, 19
    s_add_u32 s68, s50, s57
    s_and_b32 s57, s99, 3
    s_lshl_b32 s57, s57, 14
    s_add_u32 s67, s70, s57
tm_93:
    s_add_u32 m0, s56, 4096
    s_add_u32 s57, s85, m0
    s_add_u32 s58, s85, 8192
    s_barrier
    buffer_load_dwordx4 v0, s[32:35], s57 offen sc1 lds
    s_mov_b32 m0, 8192
    s_nop 4
    buffer_load_dwordx4 v0, s[32:35], s58 offen sc1 lds
    buffer_load_dwordx4 v[56:59], v0, s[32:35], s72 offen offset:0 sc1
    buffer_load_dwordx4 v[60:63], v0, s[32:35], s72 offen offset:1024 sc1
    s_barrier
    buffer_load_dwordx4 v[64:67], v0, s[32:35], s73 offen offset:0 sc1
    buffer_load_dwordx4 v[68:71], v0, s[32:35], s73 offen offset:1024 sc1
    s_barrier
    buffer_store_dwordx4 v[28:31], v0, s[32:35], s45 offen sc1
    s_cmp_eq_u32 s64, 63
    s_cbranch_scc1 tw_91l
    s_waitcnt lgkmcnt(0)
tw_91:
    s_barrier
    ds_read_b128 v[16:19], v0 offset:0
    ds_read_b128 v[24:27], v0 offset:2048
    ds_read_b128 v[20:23], v0 offset:1024
    buffer_store_dword v15, v2, s[32:35], s37 offen sc1
    s_waitcnt lgkmcnt(2)
    v_smfmac_f32_16x16x64_bf16 v[32:35], v[16:19], v[72:79], v9
    ds_read_b128 v[76:79], v1 offset:33792
    v_smfmac_f32_16x16x64_bf16 v[36:39], v[16:19], v[48:55], v9
    ds_read_b128 v[52:55], v1 offset:35840
    s_waitcnt lgkmcnt(2)
    v_smfmac_f32_16x16x64_bf16 v[32:35], v[20:23], a[0:7], v9
    ds_read_b128 v[28:31], v0 offset:3072
    v_smfmac_f32_16x16x64_bf16 v[36:39], v[20:23], a[48:55], v9
    ds_read_b128 v[48:51], v1 offset:34816
    v_smfmac_f32_16x16x64_bf16 v[40:43], v[16:19], a[96:103], v9
    ds_read_b128 v[72:75], v1 offset:32768
    v_smfmac_f32_16x16x64_bf16 v[44:47], v[16:19], a[152:159], v9
    s_waitcnt vmcnt(6)
    s_barrier
    v_smfmac_f32_16x16x64_bf16 v[32:35], v[24:27], a[8:15], v9
    v_smfmac_f32_16x16x64_bf16 v[36:39], v[24:27], a[56:63], v9
    ds_read_b128 v[16:19], v0 offset:4096
    s_waitcnt lgkmcnt(1)
    v_smfmac_f32_16x16x64_bf16 v[40:43], v[20:23], v[72:79], v9
    ds_read_b128 v[72:75], v1 offset:49152
    v_smfmac_f32_16x16x64_bf16 v[44:47], v[20:23], v[48:55], v9
    ds_read_b128 v[76:79], v1 offset:50176
    v_smfmac_f32_16x16x64_bf16 v[32:35], v[28:31], a[16:23], v9
    ds_read_b128 v[48:51], v1 offset:51200
    v_smfmac_f32_16x16x64_bf16 v[36:39], v[28:31], a[64:71], v9
    ds_read_b128 v[52:55], v1 offset:52224
    v_add_u32 v1, 0x10000, v1
    v_smfmac_f32_16x16x64_bf16 v[40:43], v[24:27], a[104:111], v9
    ds_read_b128 v[20:23], v0 offset:5120
    v_smfmac_f32_16x16x64_bf16 v[44:47], v[24:27], a[160:167], v9
    buffer_store_dword v15, v2, s[32:35], s36 offen sc1
    ds_read_b128 v[24:27], v0 offset:6144
    s_waitcnt lgkmcnt(4)
    v_smfmac_f32_16x16x64_bf16 v[32:35], v[16:19], v[72:79], v9
    ds_read_b128 v[72:75], v1 offset:0
    s_waitcnt lgkmcnt(3)
    v_smfmac_f32_16x16x64_bf16 v[36:39], v[16:19], v[48:55], v9
    ds_read_b128 v[76:79], v1 offset:1024
    v_smfmac_f32_16x16x64_bf16 v[40:43], v[28:31], a[112:119], v9
    buffer_store_dword v15, v2, s[32:35], s40 offen sc1
    v_smfmac_f32_16x16x64_bf16 v[44:47], v[28:31], a[168:175], v9
    ds_read_b128 v[48:51], v1 offset:2048
    s_waitcnt lgkmcnt(4)
    v_smfmac_f32_16x16x64_bf16 v[32:35], v[20:23], a[24:31], v9
    ds_read_b128 v[52:55], v1 offset:3072
    v_smfmac_f32_16x16x64_bf16 v[36:39], v[20:23], a[72:79], v9
    v_smfmac_f32_16x16x64_bf16 v[40:43], v[16:19], a[120:127], v9
    buffer_store_dword v15, v2, s[32:35], s41 offen sc1
    v_smfmac_f32_16x16x64_bf16 v[44:47], v[16:19], a[176:183], v9
    ds_read_b128 v[28:31], v0 offset:7168
    ds_read_b128 v[16:19], v0 offset:8192
    s_waitcnt lgkmcnt(4)
    v_smfmac_f32_16x16x64_bf16 v[32:35], v[24:27], v[72:79], v9
    buffer_store_dword v15, v2, s[32:35], s39 offen sc1
    s_waitcnt lgkmcnt(2)
    v_smfmac_f32_16x16x64_bf16 v[36:39], v[24:27], v[48:55], v9
    ds_read_b128 v[52:55], v1 offset:19456
    ds_read_b128 v[72:75], v1 offset:16384
    v_smfmac_f32_16x16x64_bf16 v[40:43], v[20:23], a[128:135], v9
    buffer_store_dword v15, v2, s[32:35], s42 offen sc1
    v_smfmac_f32_16x16x64_bf16 v[44:47], v[20:23], a[184:191], v9
    ds_read_b128 v[48:51], v1 offset:18432
    ds_read_b128 v[76:79], v1 offset:17408
    s_waitcnt lgkmcnt(5)
    v_smfmac_f32_16x16x64_bf16 v[32:35], v[28:31], a[32:39], v9
    buffer_store_dword v15, v2, s[32:35], s38 offen sc1
    v_smfmac_f32_16x16x64_bf16 v[36:39], v[28:31], a[80:87], v9
    s_waitcnt lgkmcnt(4)
    v_smfmac_f32_16x16x64_bf16 v[32:35], v[16:19], a[40:47], v9
    buffer_store_dword v15, v2, s[32:35], s43 offen sc1
    v_smfmac_f32_16x16x64_bf16 v[36:39], v[16:19], a[88:95], v9
    s_waitcnt lgkmcnt(0)
    v_smfmac_f32_16x16x64_bf16 v[40:43], v[24:27], v[72:79], v9
    buffer_store_dword v15, v2, s[32:35], s44 offen sc1
    v_add_f32 v33, v33, v35
    v_smfmac_f32_16x16x64_bf16 v[44:47], v[24:27], v[48:55], v9
    v_add_f32 v32, v32, v34
    v_smfmac_f32_16x16x64_bf16 v[40:43], v[28:31], a[136:143], v9
    ds_read_b128 v[72:75], v1 offset:32768
    v_add_f32 v36, v36, v38
    v_smfmac_f32_16x16x64_bf16 v[44:47], v[28:31], a[192:199], v9
    v_add_f32 v37, v37, v39
    v_smfmac_f32_16x16x64_bf16 v[40:43], v[16:19], a[144:151], v9
    v_cvt_pk_bf16_f32 v12, v32, v33
    v_mov_b64 v[48:49], 0
    v_cmp_u_f32 vcc, v32, v33
    v_mfma_f32_16x16x16_bf16 v[32:35], v[12:13], v[8:9], 0
    v_cvt_pk_bf16_f32 v12, v36, v37
    v_mov_b64 v[54:55], 0
    v_add_f32 v41, v41, v43
    v_mfma_f32_16x16x16_bf16 v[36:39], v[12:13], v[8:9], 0
    v_add_f32 v40, v40, v42
    v_cvt_pk_bf16_f32 v12, v40, v41
    v_mov_b64 v[52:53], 0
    v_smfmac_f32_16x16x64_bf16 v[44:47], v[16:19], a[200:207], v9
    ds_read_b128 v[76:79], v1 offset:33792
    v_cvt_pk_bf16_f32 v32, v32, v33
    v_cvt_pk_bf16_f32 v33, v34, v35
    v_cvt_pk_bf16_f32 v34, v36, v37
    v_mfma_f32_16x16x16_bf16 v[40:43], v[12:13], v[8:9], 0
    v_cvt_pk_bf16_f32 v35, v38, v39
    v_mov_b64 v[50:51], 0
    v_add_f32 v45, v45, v47
    s_waitcnt vmcnt(13)
    v_mfma_f32_16x16x32_bf16 v[56:59], v[56:59], v[32:35], 0
    v_add_f32 v44, v44, v46
    v_cvt_pk_bf16_f32 v12, v44, v45
    v_smfmac_f32_16x16x64_bf16 v[48:51], v[20:23], a[248:255], v9
    s_cbranch_vccnz tredo_92
tredo_92r:
    v_mfma_f32_16x16x16_bf16 v[44:47], v[12:13], v[8:9], 0
    s_nop 0
    ds_write_b128 v3, v[56:59] offset:9216
    v_cvt_pk_bf16_f32 v40, v40, v41
    v_cvt_pk_bf16_f32 v41, v42, v43
    s_waitcnt vmcnt(12)
    v_mfma_f32_16x16x32_bf16 v[60:63], v[60:63], v[32:35], 0
    s_nop 1
    v_cvt_pk_bf16_f32 v43, v46, v47
    v_cvt_pk_bf16_f32 v42, v44, v45
    v_smfmac_f32_16x16x64_bf16 v[52:55], v[20:23], v[136:143], v9
    buffer_store_dword v15, v4, s[32:35], s67 offen sc1
    v_mfma_f32_16x16x32_bf16 v[44:47], v[40:43], v[32:35], 0
    ds_write_b128 v3, v[60:63] offset:9728
    v_smfmac_f32_16x16x64_bf16 v[48:51], v[24:27], v[80:87], v9
    s_nop 4
    ds_write_b64 v5, v[44:45] offset:13312
    v_smfmac_f32_16x16x64_bf16 v[52:55], v[24:27], v[144:151], v9
    ds_read_b128 v[24:27], v0 offset:1024
    v_smfmac_f32_16x16x64_bf16 v[48:51], v[28:31], v[88:95], v9
    ds_read_b128 v[20:23], v0 offset:0
    v_smfmac_f32_16x16x64_bf16 v[52:55], v[28:31], v[152:159], v9
    ds_read_b128 v[28:31], v0 offset:2048
    s_waitcnt lgkmcnt(3)
    s_barrier
    v_smfmac_f32_16x16x64_bf16 v[48:51], v[16:19], v[72:79], v9
    ds_read_b64 v[46:47], v6 offset:14336
    ds_read_b64 v[44:45], v6 offset:13312
    s_waitcnt lgkmcnt(3)
    v_smfmac_f32_16x16x64_bf16 v[48:51], v[20:23], a[208:215], v9
    ds_read_b128 v[32:35], v6 offset:11264
    v_smfmac_f32_16x16x64_bf16 v[52:55], v[20:23], v[96:103], v9
    ds_read_b128 v[20:23], v0 offset:3072
    v_smfmac_f32_16x16x64_bf16 v[48:51], v[24:27], a[216:223], v9
    ds_read_b128 v[36:39], v6 offset:12288
    v_smfmac_f32_16x16x64_bf16 v[52:55], v[24:27], v[104:111], v9
    ds_read_b128 v[60:63], v6 offset:10240
    s_waitcnt lgkmcnt(4)
    v_add_f32 v45, v45, v47
    v_add_f32 v44, v44, v46
    v_smfmac_f32_16x16x64_bf16 v[48:51], v[28:31], a[224:231], v9
    ds_read_b128 v[56:59], v6 offset:9216
    v_add_f32_dpp v44, v44, v44 quad_perm:[2,3,0,1] row_mask:0xf bank_mask:0xf
    v_smfmac_f32_16x16x64_bf16 v[52:55], v[28:31], v[112:119], v9
    ds_read_b128 v[72:75], v1 offset:34816
    s_waitcnt lgkmcnt(3)
    v_add_f32 v35, v35, v39
    v_smfmac_f32_16x16x64_bf16 v[48:51], v[20:23], a[232:239], v9
    ds_read_b128 v[24:27], v0 offset:4096
    v_add_f32 v34, v34, v38
    v_smfmac_f32_16x16x64_bf16 v[52:55], v[20:23], v[120:127], v9
    ds_read_b128 v[76:79], v1 offset:35840
    v_add_f32 v33, v33, v37
    v_add_f32 v32, v32, v36
    s_waitcnt lgkmcnt(3)
    v_add_f32 v59, v59, v63
    v_add_f32 v59, v59, v35
    v_add_f32_dpp v45, v45, v45 quad_perm:[2,3,0,1] row_mask:0xf bank_mask:0xf
    v_add_f32 v58, v58, v62
    v_add_f32 v56, v56, v60
    v_add_f32 v56, v56, v32
    v_add_f32 v57, v57, v61
    v_add_f32 v58, v58, v34
    v_add_f32 v57, v57, v33
    v_max3_f32 v62, v56, v57, v58
    v_max_f32 v62, v62, v59
    s_waitcnt lgkmcnt(0)
    v_smfmac_f32_16x16x64_bf16 v[52:55], v[16:19], v[72:79], v9
    ds_read_b128 v[76:79], v1 offset:50176
    v_max_f32_dpp v62, v62, v62 quad_perm:[2,3,0,1] row_mask:0xf bank_mask:0xf
    v_max3_f32 v62, v62, v44, v45
    v_mov_b32 v63, v62
    v_smfmac_f32_16x16x64_bf16 v[48:51], v[24:27], a[240:247], v9
    v_permlane32_swap_b32 v62, v63
    v_max_f32 v62, v62, v63
    v_mov_b32 v63, v62
    v_smfmac_f32_16x16x64_bf16 v[52:55], v[24:27], v[128:135], v9
    ds_read_b128 v[72:75], v1 offset:49152
    v_permlane16_swap_b32 v62, v63
    v_max_f32 v62, v62, v63
    v_add_f32 v48, v48, v50
    v_mul_f32 v63, s75, v62
    v_fma_f32 v45, v45, s75, -v63
    v_fma_f32 v59, v59, s75, -v63
    v_exp_f32 v59, v59
    v_add_f32 v52, v52, v54
    v_exp_f32 v45, v45
    v_fma_f32 v58, v58, s75, -v63
    v_add_f32 v53, v53, v55
    v_exp_f32 v58, v58
    v_fma_f32 v57, v57, s75, -v63
    v_fma_f32 v44, v44, s75, -v63
    v_exp_f32 v44, v44
    v_exp_f32 v57, v57
    v_add_f32 v49, v49, v51
    v_cvt_pk_bf16_f32 v44, v44, v45
    v_cndmask_b32 v46, v44, 0, s[94:95]
    v_cvt_pk_bf16_f32 v48, v48, v49
    v_cndmask_b32 v47, 0, v44, s[94:95]
    v_fma_f32 v56, v56, s75, -v63
    v_cvt_pk_bf16_f32 v61, v58, v59
    v_cvt_pk_bf16_f32 v49, v52, v53
    v_exp_f32 v56, v56
    v_mfma_f32_16x16x16_bf16 v[32:35], v[48:49], v[46:47], 0
    v_cvt_pk_bf16_f32 v60, v56, v57
    v_mov_b32_dpp v57, v61 quad_perm:[0,1,0,1] row_mask:0xf bank_mask:0xf
    v_mfma_f32_16x16x16_bf16 v[36:39], v[10:11], v[46:47], 0
    v_mov_b32_dpp v56, v60 quad_perm:[0,1,0,1] row_mask:0xf bank_mask:0xf
    v_mov_b32_dpp v58, v60 quad_perm:[2,3,2,3] row_mask:0xf bank_mask:0xf
    v_mov_b32_dpp v59, v61 quad_perm:[2,3,2,3] row_mask:0xf bank_mask:0xf
    v_mfma_f32_16x16x16_bf16 v[36:39], v[10:11], v[56:57], v[36:39]
    v_mfma_f32_16x16x16_bf16 v[36:39], v[10:11], v[58:59], v[36:39]
    v_mov_b32 v12, 0
    s_waitcnt vmcnt(11)
    v_mfma_f32_16x16x32_bf16 v[68:71], v[68:71], v[56:59], v[32:35]
    ds_read_b128 v[20:23], v1 offset:52224
    v_mfma_f32_16x16x32_bf16 v[64:67], v[64:67], v[56:59], v[32:35]
    s_barrier
    v_rcp_f32 v14, v36
    v_mfma_f32_16x16x16_bf16 v[32:35], v[12:13], v[10:11], 0
    ds_read_b128 v[16:19], v1 offset:51200
    s_nop 3
    v_cndmask_b32 v65, v65, v69, s[94:95]
    v_cndmask_b32 v67, v67, v71, s[94:95]
    v_cndmask_b32 v64, v64, v68, s[94:95]
    v_mul_f32 v64, v64, v14
    v_mul_f32 v65, v65, v14
    v_cvt_pk_bf16_f32 v64, v64, v65
    v_cndmask_b32 v66, v66, v70, s[94:95]
    v_mul_f32 v66, v66, v14
    v_mul_f32 v67, v67, v14
    v_cvt_pk_bf16_f32 v65, v66, v67
    v_mfma_f32_16x16x16_bf16 v[56:59], v[12:13], v[10:11], 0
    ds_write_b64 v7, v[64:65] offset:9216
    v_cndmask_b32 v31, v41, v43, s[94:95]
    v_cndmask_b32 v30, v40, v42, s[94:95]
    v_mfma_f32_16x16x16_bf16 v[44:47], v[12:13], v[10:11], 0
    v_add_u32 v1, 0x10000, v1
    v_mfma_f32_16x16x16_bf16 v[24:27], v[12:13], v[10:11], 0
    v_mfma_f32_16x16x16_bf16 v[52:55], v[12:13], v[10:11], 0
    s_waitcnt lgkmcnt(0)
    s_barrier
    v_mfma_f32_16x16x16_bf16 v[40:43], v[12:13], v[10:11], 0
    ds_read_b128 v[64:67], v6 offset:9216
    v_mov_b64 v[28:29], v[48:49]
    v_mfma_f32_16x16x16_bf16 v[48:51], v[12:13], v[10:11], 0
    ds_read_b128 v[68:71], v6 offset:10240
    v_mfma_f32_16x16x16_bf16 v[60:63], v[12:13], v[10:11], 0
    v_mfma_f32_16x16x16_bf16 v[36:39], v[12:13], v[10:11], 0
    v_xor_b32 v2, 0x100000, v2
    s_waitcnt lgkmcnt(1)
    v_smfmac_f32_16x16x64_bf16 v[24:27], v[64:67], v[72:79], v9
    s_waitcnt lgkmcnt(0)
    v_smfmac_f32_16x16x64_bf16 v[24:27], v[68:71], v[16:23], v9
    ds_read_b128 v[20:23], v1 offset:3072
    v_smfmac_f32_16x16x64_bf16 v[52:55], v[64:67], v[160:167], v9
    ds_read_b128 v[16:19], v1 offset:2048
    v_smfmac_f32_16x16x64_bf16 v[52:55], v[68:71], v[168:175], v9
    ds_read_b128 v[72:75], v1 offset:0
    v_add_f32 v25, v25, v27
    v_smfmac_f32_16x16x64_bf16 v[40:43], v[64:67], v[176:183], v9
    ds_read_b128 v[76:79], v1 offset:1024
    v_add_f32 v24, v24, v26
    v_cvt_pk_bf16_f32 v24, v24, v25
    v_smfmac_f32_16x16x64_bf16 v[40:43], v[68:71], v[184:191], v9
    v_smfmac_f32_16x16x64_bf16 v[60:63], v[64:67], v[192:199], v9
    buffer_store_dword v24, v2, s[32:35], s36 offen sc1
    v_add_f32 v52, v52, v54
    v_add_f32 v53, v53, v55
    v_smfmac_f32_16x16x64_bf16 v[60:63], v[68:71], v[200:207], v9
    v_add_f32 v40, v40, v42
    v_add_f32 v41, v41, v43
    v_cvt_pk_bf16_f32 v40, v40, v41
    v_cvt_pk_bf16_f32 v52, v52, v53
    s_waitcnt lgkmcnt(0)
    v_smfmac_f32_16x16x64_bf16 v[44:47], v[64:67], v[72:79], v9
    buffer_store_dword v52, v2, s[32:35], s37 offen sc1
    v_add_f32 v61, v61, v63
    v_add_f32 v60, v60, v62
    v_smfmac_f32_16x16x64_bf16 v[44:47], v[68:71], v[16:23], v9
    ds_read_b128 v[20:23], v1 offset:19456
    v_smfmac_f32_16x16x64_bf16 v[48:51], v[64:67], v[208:215], v9
    buffer_store_dword v40, v2, s[32:35], s38 offen sc1
    v_cvt_pk_bf16_f32 v60, v60, v61
    v_smfmac_f32_16x16x64_bf16 v[48:51], v[68:71], v[216:223], v9
    ds_read_b128 v[72:75], v1 offset:16384
    ds_read_b128 v[76:79], v1 offset:17408
    v_smfmac_f32_16x16x64_bf16 v[56:59], v[64:67], v[224:231], v9
    buffer_store_dword v60, v2, s[32:35], s39 offen sc1
    v_add_f32 v44, v44, v46
    v_add_f32 v45, v45, v47
    v_cvt_pk_bf16_f32 v44, v44, v45
    v_smfmac_f32_16x16x64_bf16 v[56:59], v[68:71], v[232:239], v9
    ds_read_b128 v[16:19], v1 offset:18432
    v_smfmac_f32_16x16x64_bf16 v[32:35], v[64:67], v[240:247], v9
    buffer_store_dword v44, v2, s[32:35], s40 offen sc1
    v_add_f32 v48, v48, v50
    v_add_f32 v49, v49, v51
    v_cvt_pk_bf16_f32 v48, v48, v49
    v_smfmac_f32_16x16x64_bf16 v[32:35], v[68:71], v[248:255], v9
    s_waitcnt lgkmcnt(1)
    v_smfmac_f32_16x16x64_bf16 v[36:39], v[64:67], v[72:79], v9
    buffer_store_dword v48, v2, s[32:35], s41 offen sc1
    v_add_f32 v57, v57, v59
    v_add_f32 v56, v56, v58
    v_cvt_pk_bf16_f32 v56, v56, v57
    s_waitcnt lgkmcnt(0)
    v_smfmac_f32_16x16x64_bf16 v[36:39], v[68:71], v[16:23], v9
    buffer_store_dword v56, v2, s[32:35], s42 offen sc1
    v_add_f32 v32, v32, v34
    v_add_f32 v33, v33, v35
    v_cvt_pk_bf16_f32 v32, v32, v33
    buffer_store_dword v32, v2, s[32:35], s43 offen sc1
    s_nop 0
    v_add_f32 v36, v36, v38
    v_add_f32 v37, v37, v39
    v_cvt_pk_bf16_f32 v36, v36, v37
    buffer_store_dword v36, v2, s[32:35], s44 offen sc1
    s_add_u32 s64, s64, 1
    s_branch ttop_94
tw_91l:
    s_waitcnt lgkmcnt(0)
    s_barrier
    ds_read_b128 v[16:19], v0 offset:0
    ds_read_b128 v[20:23], v0 offset:1024
    ds_read_b128 v[52:55], v1 offset:35840
    ds_read_b128 v[24:27], v0 offset:2048
    s_waitcnt lgkmcnt(3)
    v_smfmac_f32_16x16x64_bf16 v[44:47], v[16:19], a[152:159], v9
    ds_read_b128 v[48:51], v1 offset:34816
    v_smfmac_f32_16x16x64_bf16 v[36:39], v[16:19], v[96:103], v9
    v_smfmac_f32_16x16x64_bf16 v[40:43], v[16:19], a[96:103], v9
    ds_read_b128 v[28:31], v0 offset:3072
    s_waitcnt lgkmcnt(2)
    v_smfmac_f32_16x16x64_bf16 v[44:47], v[24:27], a[160:167], v9
    ds_read_b128 v[76:79], v1 offset:33792
    v_smfmac_f32_16x16x64_bf16 v[40:43], v[24:27], a[104:111], v9
    ds_read_b128 v[72:75], v1 offset:32768
    s_waitcnt lgkmcnt(3)
    v_smfmac_f32_16x16x64_bf16 v[44:47], v[20:23], v[48:55], v9
    s_waitcnt vmcnt(5)
    s_barrier
    v_smfmac_f32_16x16x64_bf16 v[32:35], v[16:19], a[208:215], v9
    v_smfmac_f32_16x16x64_bf16 v[32:35], v[20:23], a[216:223], v9
    v_smfmac_f32_16x16x64_bf16 v[32:35], v[24:27], a[224:231], v9
    s_waitcnt lgkmcnt(2)
    v_smfmac_f32_16x16x64_bf16 v[32:35], v[28:31], a[232:239], v9
    ds_read_b128 v[16:19], v0 offset:4096
    v_smfmac_f32_16x16x64_bf16 v[36:39], v[20:23], v[104:111], v9
    s_waitcnt lgkmcnt(1)
    v_smfmac_f32_16x16x64_bf16 v[40:43], v[20:23], v[72:79], v9
    v_smfmac_f32_16x16x64_bf16 v[40:43], v[28:31], a[112:119], v9
    ds_read_b128 v[20:23], v0 offset:5120
    v_add_u32 v1, 0x10000, v1
    v_smfmac_f32_16x16x64_bf16 v[36:39], v[24:27], v[112:119], v9
    ds_read_b128 v[52:55], v1 offset:19456
    s_waitcnt lgkmcnt(2)
    v_smfmac_f32_16x16x64_bf16 v[32:35], v[16:19], a[240:247], v9
    ds_read_b128 v[24:27], v0 offset:6144
    v_smfmac_f32_16x16x64_bf16 v[44:47], v[28:31], a[168:175], v9
    v_smfmac_f32_16x16x64_bf16 v[36:39], v[28:31], v[120:127], v9
    ds_read_b128 v[28:31], v0 offset:7168
    v_smfmac_f32_16x16x64_bf16 v[44:47], v[16:19], a[176:183], v9
    ds_read_b128 v[76:79], v1 offset:17408
    v_smfmac_f32_16x16x64_bf16 v[36:39], v[16:19], v[128:135], v9
    ds_read_b128 v[48:51], v1 offset:18432
    s_waitcnt lgkmcnt(5)
    v_smfmac_f32_16x16x64_bf16 v[32:35], v[20:23], a[248:255], v9
    ds_read_b128 v[72:75], v1 offset:16384
    v_smfmac_f32_16x16x64_bf16 v[40:43], v[16:19], a[120:127], v9
    ds_read_b128 v[16:19], v0 offset:8192
    v_smfmac_f32_16x16x64_bf16 v[44:47], v[20:23], a[184:191], v9
    v_smfmac_f32_16x16x64_bf16 v[40:43], v[20:23], a[128:135], v9
    s_waitcnt lgkmcnt(2)
    v_smfmac_f32_16x16x64_bf16 v[44:47], v[24:27], v[48:55], v9
    ds_read_b128 v[48:51], v1 offset:34816
    v_smfmac_f32_16x16x64_bf16 v[32:35], v[24:27], v[80:87], v9
    s_waitcnt lgkmcnt(2)
    v_smfmac_f32_16x16x64_bf16 v[40:43], v[24:27], v[72:79], v9
    v_smfmac_f32_16x16x64_bf16 v[40:43], v[28:31], a[136:143], v9
    ds_read_b128 v[52:55], v1 offset:35840
    s_waitcnt lgkmcnt(2)
    v_smfmac_f32_16x16x64_bf16 v[40:43], v[16:19], a[144:151], v9
    v_smfmac_f32_16x16x64_bf16 v[44:47], v[28:31], a[192:199], v9
    ds_read_b128 v[72:75], v1 offset:32768
    v_smfmac_f32_16x16x64_bf16 v[36:39], v[20:23], v[136:143], v9
    ds_read_b128 v[76:79], v1 offset:33792
    v_add_f32 v40, v40, v42
    v_smfmac_f32_16x16x64_bf16 v[32:35], v[28:31], v[88:95], v9
    v_add_f32 v41, v41, v43
    v_smfmac_f32_16x16x64_bf16 v[44:47], v[16:19], a[200:207], v9
    v_cvt_pk_bf16_f32 v12, v40, v41
    v_smfmac_f32_16x16x64_bf16 v[36:39], v[24:27], v[144:151], v9
    v_smfmac_f32_16x16x64_bf16 v[36:39], v[28:31], v[152:159], v9
    s_waitcnt lgkmcnt(0)
    v_smfmac_f32_16x16x64_bf16 v[32:35], v[16:19], v[72:79], v9
    v_add_f32 v45, v45, v47
    v_smfmac_f32_16x16x64_bf16 v[36:39], v[16:19], v[48:55], v9
    v_cmp_u_f32 vcc, v40, v41
    v_add_f32 v44, v44, v46
    v_mfma_f32_16x16x16_bf16 v[40:43], v[12:13], v[8:9], 0
    v_cvt_pk_bf16_f32 v12, v44, v45
    v_add_f32 v32, v32, v34
    v_add_f32 v33, v33, v35
    v_mfma_f32_16x16x16_bf16 v[44:47], v[12:13], v[8:9], 0
    s_cbranch_vccnz tredo_92l
tredo_92lr:
    v_cvt_pk_bf16_f32 v32, v32, v33
    v_add_f32 v36, v36, v38
    v_add_f32 v37, v37, v39
    v_cvt_pk_bf16_f32 v33, v36, v37
    v_cvt_pk_bf16_f32 v40, v40, v41
    v_cvt_pk_bf16_f32 v41, v42, v43
    s_nop 0
    v_cvt_pk_bf16_f32 v42, v44, v45
    v_cvt_pk_bf16_f32 v43, v46, v47
    v_cndmask_b32 v34, v40, v42, s[94:95]
    v_cndmask_b32 v35, v41, v43, s[94:95]
    buffer_store_dwordx4 v[32:35], v0, s[32:35], s77 offen sc1
    s_endpgm
ttop_94a:
    v_lshlrev_b32 v56, 3, v0
    v_and_b32 v57, 0x780, v56
    s_mov_b32 s57, 133120
    s_mov_b32 s58, 141312
wteam_95:
    buffer_load_dword v58, v56, s[32:35], s57 offen sc1
    buffer_load_dword v59, v57, s[32:35], s58 offen sc1
    s_sub_i32 s54, s54, 1
    s_cmp_lt_i32 s54, 0
    s_waitcnt vmcnt(0)
    s_cbranch_scc1 wteamd_96
    v_and_b32 v58, v58, v59
    v_cmp_eq_u32 vcc, 0, v58
    s_cbranch_vccz wteamd_96
    s_sleep 2
    s_branch wteam_95
wteamd_96:
    s_sleep 8
    s_branch ttop_94b
tp_97:
    buffer_load_dwordx4 v[56:59], v0, s[32:35], s68 offen offset:0 sc1
    buffer_load_dwordx4 v[60:63], v0, s[32:35], s68 offen offset:1024 sc1
    buffer_load_dwordx4 v[64:67], v0, s[32:35], s68 offen offset:2048 sc1
    buffer_load_dwordx4 v[68:71], v0, s[32:35], s68 offen offset:3072 sc1
    s_sub_i32 s54, s54, 1
    s_cmp_lt_i32 s54, 0
    s_cselect_b64 s[96:97], 0, -1
    s_waitcnt vmcnt(3) lgkmcnt(4)
    v_mfma_f32_16x16x32_bf16 v[20:23], v[16:19], v[56:59], 0
    s_waitcnt vmcnt(2)
    v_mfma_f32_16x16x32_bf16 v[20:23], v[16:19], v[60:63], v[20:23]
    s_waitcnt vmcnt(1)
    v_mfma_f32_16x16x32_bf16 v[20:23], v[16:19], v[64:67], v[20:23]
    s_waitcnt vmcnt(0)
    v_mfma_f32_16x16x32_bf16 v[20:23], v[16:19], v[68:71], v[20:23]
    s_nop 7
    v_add_f32_dpp v20, v20, v20 row_ror:8 row_mask:0xf bank_mask:0xf
    v_add_f32_dpp v21, v21, v21 row_ror:8 row_mask:0xf bank_mask:0xf
    v_cvt_pk_bf16_f32 v20, v20, v21
    v_cmp_u_f32 vcc, v21, v21
    buffer_store_dword v20, v4, s[32:35], s81 offen sc1
    s_and_b64 vcc, vcc, s[96:97]
    s_cbranch_vccnz tp_97
    s_cmp_lg_u32 s53, 8
    s_cbranch_scc1 tw_91s
    s_sleep 5
tw_91s:
    s_branch tpd_98
tredo_92l:
    s_cmp_lt_i32 s49, 1
    s_cbranch_scc1 tredo_92lr
tredo_92:
    s_sub_i32 s49, s49, 1
    s_cmp_lt_i32 s49, 0
    s_cbranch_scc1 tredo_92r
    s_mov_b32 s45, s69
    s_waitcnt lgkmcnt(0)
    s_nop 7
    v_add_u32 v1, s63, v0
    v_and_b32 v2, 0x7ffff, v2
    v_or_b32 v2, s51, v2
    v_mov_b64 v[32:33], 0
    v_mov_b64 v[34:35], 0
    v_mov_b64 v[36:37], 0
    v_mov_b64 v[38:39], 0
    v_mov_b64 v[40:41], 0
    v_mov_b64 v[42:43], 0
    v_mov_b64 v[44:45], 0
    v_mov_b64 v[46:47], 0
    v_lshlrev_b32 v12, 3, v0
    ds_read_b128 v[72:75], v1 offset:16384
    ds_read_b128 v[76:79], v1 offset:17408
    ds_read_b128 v[48:51], v1 offset:18432
    ds_read_b128 v[52:55], v1 offset:19456
    s_barrier
    s_branch tm_93
tcls1_88:
    buffer_load_dwordx4 v[64:67], v0, s[32:35], s73 offen offset:0 sc1
    buffer_load_dwordx4 v[68:71], v0, s[32:35], s73 offen offset:1024 sc1
    s_barrier
    buffer_store_dwordx4 v[28:31], v0, s[32:35], s45 offen sc1
    v_add_u32 v1, s63, v0
    v_and_b32 v2, 0x7ffff, v2
    v_or_b32 v2, s51, v2
    v_mov_b64 v[32:33], 0
    v_mov_b64 v[34:35], 0
    v_mov_b64 v[36:37], 0
    v_mov_b64 v[38:39], 0
    v_mov_b64 v[40:41], 0
    v_mov_b64 v[42:43], 0
    v_mov_b64 v[44:45], 0
    v_mov_b64 v[46:47], 0
    ds_read_b128 v[72:75], v1 offset:16384
    ds_read_b128 v[76:79], v1 offset:17408
    ds_read_b128 v[48:51], v1 offset:18432
    ds_read_b128 v[52:55], v1 offset:19456
    s_waitcnt lgkmcnt(0)
    s_branch tw_99
.p2align 6
ttop_102:
    s_cmp_eq_u32 s64, 1
    s_cbranch_scc1 ttop_102a
ttop_102b:
    s_and_b32 s57, s64, 3
    s_lshl_b32 s58, s57, 14
    s_add_u32 s81, s70, s58
    s_add_u32 s85, s58, 7405568
    s_xor_b32 s51, s57, 2
    s_lshl_b32 s51, s51, 19
    s_add_u32 s72, s72, 786432
    s_add_u32 s73, s73, 786432
    s_mov_b32 s45, s77
    s_add_u32 s77, s77, 131072
    s_sub_u32 s99, s64, 1
    s_nop 15
    s_nop 15
    s_nop 13
    buffer_load_dwordx4 v[56:59], v0, s[32:35], s68 offen offset:0 sc1
    buffer_load_dwordx4 v[60:63], v0, s[32:35], s68 offen offset:1024 sc1
    buffer_load_dwordx4 v[64:67], v0, s[32:35], s68 offen offset:2048 sc1
    buffer_load_dwordx4 v[68:71], v0, s[32:35], s68 offen offset:3072 sc1
    ds_read_b128 v[16:19], v0 offset:15360
    v_add_u32 v1, s63, v0
    v_and_b32 v2, 0x7ffff, v2
    v_or_b32 v2, s51, v2
    v_mov_b64 v[32:33], 0
    v_mov_b64 v[34:35], 0
    v_mov_b64 v[36:37], 0
    v_mov_b64 v[38:39], 0
    v_mov_b64 v[40:41], 0
    v_mov_b64 v[42:43], 0
    v_mov_b64 v[44:45], 0
    v_mov_b64 v[46:47], 0
    ds_read_b128 v[72:75], v1 offset:16384
    ds_read_b128 v[76:79], v1 offset:17408
    ds_read_b128 v[48:51], v1 offset:18432
    ds_read_b128 v[52:55], v1 offset:19456
    s_waitcnt vmcnt(3) lgkmcnt(4)
    v_mfma_f32_16x16x32_bf16 v[20:23], v[16:19], v[56:59], 0
    s_waitcnt vmcnt(2)
    v_mfma_f32_16x16x32_bf16 v[20:23], v[16:19], v[60:63], v[20:23]
    s_waitcnt vmcnt(1)
    v_mfma_f32_16x16x32_bf16 v[20:23], v[16:19], v[64:67], v[20:23]
    s_waitcnt vmcnt(0)
    v_mfma_f32_16x16x32_bf16 v[20:23], v[16:19], v[68:71], v[20:23]
    s_nop 7
    v_add_f32_dpp v20, v20, v20 row_ror:8 row_mask:0xf bank_mask:0xf
    v_add_f32_dpp v21, v21, v21 row_ror:8 row_mask:0xf bank_mask:0xf
    v_cvt_pk_bf16_f32 v20, v20, v21
    v_cmp_u_f32 vcc, v21, v21
    buffer_store_dword v20, v4, s[32:35], s81 offen sc1
    s_cbranch_vccnz tp_105
tpd_106:
    s_lshl_b32 s57, s57, 19
    s_add_u32 s68, s50, s57
    s_and_b32 s57, s99, 3
    s_lshl_b32 s57, s57, 14
    s_add_u32 s67, s70, s57
tm_101:
    s_add_u32 m0, s56, 4096
    s_add_u32 s57, s85, m0
    s_add_u32 s58, s85, 8192
    s_barrier
    buffer_load_dwordx4 v0, s[32:35], s57 offen sc1 lds
    s_nop 5
    buffer_load_dwordx4 v[56:59], v0, s[32:35], s72 offen offset:0 sc1
    buffer_load_dwordx4 v[60:63], v0, s[32:35], s72 offen offset:1024 sc1
    s_barrier
    buffer_load_dwordx4 v[64:67], v0, s[32:35], s73 offen offset:0 sc1
    buffer_load_dwordx4 v[68:71], v0, s[32:35], s73 offen offset:1024 sc1
    s_barrier
    buffer_store_dwordx4 v[28:31], v0, s[32:35], s45 offen sc1
    s_cmp_eq_u32 s64, 63
    s_cbranch_scc1 tw_99l
    s_waitcnt lgkmcnt(0)
tw_99:
    s_barrier
    ds_read_b128 v[16:19], v0 offset:0
    ds_read_b128 v[24:27], v0 offset:2048
    ds_read_b128 v[20:23], v0 offset:1024
    buffer_store_dword v15, v2, s[32:35], s37 offen sc1
    s_waitcnt lgkmcnt(2)
    v_smfmac_f32_16x16x64_bf16 v[32:35], v[16:19], v[72:79], v9
    ds_read_b128 v[76:79], v1 offset:33792
    v_smfmac_f32_16x16x64_bf16 v[36:39], v[16:19], v[48:55], v9
    ds_read_b128 v[52:55], v1 offset:35840
    s_waitcnt lgkmcnt(2)
    v_smfmac_f32_16x16x64_bf16 v[32:35], v[20:23], a[0:7], v9
    ds_read_b128 v[28:31], v0 offset:3072
    v_smfmac_f32_16x16x64_bf16 v[36:39], v[20:23], a[48:55], v9
    ds_read_b128 v[48:51], v1 offset:34816
    v_smfmac_f32_16x16x64_bf16 v[40:43], v[16:19], a[96:103], v9
    ds_read_b128 v[72:75], v1 offset:32768
    v_smfmac_f32_16x16x64_bf16 v[44:47], v[16:19], a[152:159], v9
    s_waitcnt vmcnt(6)
    s_barrier
    v_smfmac_f32_16x16x64_bf16 v[32:35], v[24:27], a[8:15], v9
    v_smfmac_f32_16x16x64_bf16 v[36:39], v[24:27], a[56:63], v9
    ds_read_b128 v[16:19], v0 offset:4096
    s_waitcnt lgkmcnt(1)
    v_smfmac_f32_16x16x64_bf16 v[40:43], v[20:23], v[72:79], v9
    ds_read_b128 v[72:75], v1 offset:49152
    v_smfmac_f32_16x16x64_bf16 v[44:47], v[20:23], v[48:55], v9
    ds_read_b128 v[76:79], v1 offset:50176
    v_smfmac_f32_16x16x64_bf16 v[32:35], v[28:31], a[16:23], v9
    ds_read_b128 v[48:51], v1 offset:51200
    v_smfmac_f32_16x16x64_bf16 v[36:39], v[28:31], a[64:71], v9
    ds_read_b128 v[52:55], v1 offset:52224
    v_add_u32 v1, 0x10000, v1
    v_smfmac_f32_16x16x64_bf16 v[40:43], v[24:27], a[104:111], v9
    ds_read_b128 v[20:23], v0 offset:5120
    v_smfmac_f32_16x16x64_bf16 v[44:47], v[24:27], a[160:167], v9
    buffer_store_dword v15, v2, s[32:35], s36 offen sc1
    ds_read_b128 v[24:27], v0 offset:6144
    s_waitcnt lgkmcnt(4)
    v_smfmac_f32_16x16x64_bf16 v[32:35], v[16:19], v[72:79], v9
    ds_read_b128 v[72:75], v1 offset:0
    s_waitcnt lgkmcnt(3)
    v_smfmac_f32_16x16x64_bf16 v[36:39], v[16:19], v[48:55], v9
    ds_read_b128 v[76:79], v1 offset:1024
    v_smfmac_f32_16x16x64_bf16 v[40:43], v[28:31], a[112:119], v9
    buffer_store_dword v15, v2, s[32:35], s40 offen sc1
    v_smfmac_f32_16x16x64_bf16 v[44:47], v[28:31], a[168:175], v9
    ds_read_b128 v[48:51], v1 offset:2048
    s_waitcnt lgkmcnt(4)
    v_smfmac_f32_16x16x64_bf16 v[32:35], v[20:23], a[24:31], v9
    ds_read_b128 v[52:55], v1 offset:3072
    v_smfmac_f32_16x16x64_bf16 v[36:39], v[20:23], a[72:79], v9
    v_smfmac_f32_16x16x64_bf16 v[40:43], v[16:19], a[120:127], v9
    buffer_store_dword v15, v2, s[32:35], s41 offen sc1
    v_smfmac_f32_16x16x64_bf16 v[44:47], v[16:19], a[176:183], v9
    ds_read_b128 v[28:31], v0 offset:7168
    ds_read_b128 v[16:19], v0 offset:8192
    s_waitcnt lgkmcnt(4)
    v_smfmac_f32_16x16x64_bf16 v[32:35], v[24:27], v[72:79], v9
    buffer_store_dword v15, v2, s[32:35], s39 offen sc1
    s_waitcnt lgkmcnt(2)
    v_smfmac_f32_16x16x64_bf16 v[36:39], v[24:27], v[48:55], v9
    ds_read_b128 v[52:55], v1 offset:19456
    ds_read_b128 v[72:75], v1 offset:16384
    v_smfmac_f32_16x16x64_bf16 v[40:43], v[20:23], a[128:135], v9
    buffer_store_dword v15, v2, s[32:35], s42 offen sc1
    v_smfmac_f32_16x16x64_bf16 v[44:47], v[20:23], a[184:191], v9
    ds_read_b128 v[48:51], v1 offset:18432
    ds_read_b128 v[76:79], v1 offset:17408
    s_waitcnt lgkmcnt(5)
    v_smfmac_f32_16x16x64_bf16 v[32:35], v[28:31], a[32:39], v9
    buffer_store_dword v15, v2, s[32:35], s38 offen sc1
    v_smfmac_f32_16x16x64_bf16 v[36:39], v[28:31], a[80:87], v9
    s_waitcnt lgkmcnt(4)
    v_smfmac_f32_16x16x64_bf16 v[32:35], v[16:19], a[40:47], v9
    buffer_store_dword v15, v2, s[32:35], s43 offen sc1
    v_smfmac_f32_16x16x64_bf16 v[36:39], v[16:19], a[88:95], v9
    s_waitcnt lgkmcnt(0)
    v_smfmac_f32_16x16x64_bf16 v[40:43], v[24:27], v[72:79], v9
    buffer_store_dword v15, v2, s[32:35], s44 offen sc1
    v_add_f32 v33, v33, v35
    v_smfmac_f32_16x16x64_bf16 v[44:47], v[24:27], v[48:55], v9
    v_add_f32 v32, v32, v34
    v_smfmac_f32_16x16x64_bf16 v[40:43], v[28:31], a[136:143], v9
    ds_read_b128 v[72:75], v1 offset:32768
    v_add_f32 v36, v36, v38
    v_smfmac_f32_16x16x64_bf16 v[44:47], v[28:31], a[192:199], v9
    v_add_f32 v37, v37, v39
    v_smfmac_f32_16x16x64_bf16 v[40:43], v[16:19], a[144:151], v9
    v_cvt_pk_bf16_f32 v12, v32, v33
    v_mov_b64 v[48:49], 0
    v_cmp_u_f32 vcc, v32, v33
    v_mfma_f32_16x16x16_bf16 v[32:35], v[12:13], v[8:9], 0
    v_cvt_pk_bf16_f32 v12, v36, v37
    v_mov_b64 v[54:55], 0
    v_add_f32 v41, v41, v43
    v_mfma_f32_16x16x16_bf16 v[36:39], v[12:13], v[8:9], 0
    v_add_f32 v40, v40, v42
    v_cvt_pk_bf16_f32 v12, v40, v41
    v_mov_b64 v[52:53], 0
    v_smfmac_f32_16x16x64_bf16 v[44:47], v[16:19], a[200:207], v9
    ds_read_b128 v[76:79], v1 offset:33792
    v_cvt_pk_bf16_f32 v32, v32, v33
    v_cvt_pk_bf16_f32 v33, v34, v35
    v_cvt_pk_bf16_f32 v34, v36, v37
    v_mfma_f32_16x16x16_bf16 v[40:43], v[12:13], v[8:9], 0
    v_cvt_pk_bf16_f32 v35, v38, v39
    v_mov_b64 v[50:51], 0
    v_add_f32 v45, v45, v47
    s_waitcnt vmcnt(13)
    v_mfma_f32_16x16x32_bf16 v[56:59], v[56:59], v[32:35], 0
    v_add_f32 v44, v44, v46
    v_cvt_pk_bf16_f32 v12, v44, v45
    v_smfmac_f32_16x16x64_bf16 v[48:51], v[20:23], a[248:255], v9
    s_cbranch_vccnz tredo_100
tredo_100r:
    v_mfma_f32_16x16x16_bf16 v[44:47], v[12:13], v[8:9], 0
    s_nop 0
    ds_write_b128 v3, v[56:59] offset:9216
    v_cvt_pk_bf16_f32 v40, v40, v41
    v_cvt_pk_bf16_f32 v41, v42, v43
    s_waitcnt vmcnt(12)
    v_mfma_f32_16x16x32_bf16 v[60:63], v[60:63], v[32:35], 0
    s_nop 1
    v_cvt_pk_bf16_f32 v43, v46, v47
    v_cvt_pk_bf16_f32 v42, v44, v45
    v_smfmac_f32_16x16x64_bf16 v[52:55], v[20:23], v[136:143], v9
    buffer_store_dword v15, v4, s[32:35], s67 offen sc1
    v_mfma_f32_16x16x32_bf16 v[44:47], v[40:43], v[32:35], 0
    ds_write_b128 v3, v[60:63] offset:9728
    v_smfmac_f32_16x16x64_bf16 v[48:51], v[24:27], v[80:87], v9
    s_nop 4
    ds_write_b64 v5, v[44:45] offset:13312
    v_smfmac_f32_16x16x64_bf16 v[52:55], v[24:27], v[144:151], v9
    ds_read_b128 v[24:27], v0 offset:1024
    v_smfmac_f32_16x16x64_bf16 v[48:51], v[28:31], v[88:95], v9
    ds_read_b128 v[20:23], v0 offset:0
    v_smfmac_f32_16x16x64_bf16 v[52:55], v[28:31], v[152:159], v9
    ds_read_b128 v[28:31], v0 offset:2048
    s_waitcnt lgkmcnt(3)
    s_barrier
    v_smfmac_f32_16x16x64_bf16 v[48:51], v[16:19], v[72:79], v9
    ds_read_b64 v[46:47], v6 offset:14336
    ds_read_b64 v[44:45], v6 offset:13312
    s_waitcnt lgkmcnt(3)
    v_smfmac_f32_16x16x64_bf16 v[48:51], v[20:23], a[208:215], v9
    ds_read_b128 v[32:35], v6 offset:11264
    v_smfmac_f32_16x16x64_bf16 v[52:55], v[20:23], v[96:103], v9
    ds_read_b128 v[20:23], v0 offset:3072
    v_smfmac_f32_16x16x64_bf16 v[48:51], v[24:27], a[216:223], v9
    ds_read_b128 v[36:39], v6 offset:12288
    v_smfmac_f32_16x16x64_bf16 v[52:55], v[24:27], v[104:111], v9
    ds_read_b128 v[60:63], v6 offset:10240
    s_waitcnt lgkmcnt(4)
    v_add_f32 v45, v45, v47
    v_add_f32 v44, v44, v46
    v_smfmac_f32_16x16x64_bf16 v[48:51], v[28:31], a[224:231], v9
    ds_read_b128 v[56:59], v6 offset:9216
    v_add_f32_dpp v44, v44, v44 quad_perm:[2,3,0,1] row_mask:0xf bank_mask:0xf
    v_smfmac_f32_16x16x64_bf16 v[52:55], v[28:31], v[112:119], v9
    ds_read_b128 v[72:75], v1 offset:34816
    s_waitcnt lgkmcnt(3)
    v_add_f32 v35, v35, v39
    v_smfmac_f32_16x16x64_bf16 v[48:51], v[20:23], a[232:239], v9
    ds_read_b128 v[24:27], v0 offset:4096
    v_add_f32 v34, v34, v38
    v_smfmac_f32_16x16x64_bf16 v[52:55], v[20:23], v[120:127], v9
    ds_read_b128 v[76:79], v1 offset:35840
    v_add_f32 v33, v33, v37
    v_add_f32 v32, v32, v36
    s_waitcnt lgkmcnt(3)
    v_add_f32 v59, v59, v63
    v_add_f32 v59, v59, v35
    v_add_f32_dpp v45, v45, v45 quad_perm:[2,3,0,1] row_mask:0xf bank_mask:0xf
    v_add_f32 v58, v58, v62
    v_add_f32 v56, v56, v60
    v_add_f32 v56, v56, v32
    v_add_f32 v57, v57, v61
    v_add_f32 v58, v58, v34
    v_add_f32 v57, v57, v33
    v_max3_f32 v62, v56, v57, v58
    v_max_f32 v62, v62, v59
    s_waitcnt lgkmcnt(0)
    v_smfmac_f32_16x16x64_bf16 v[52:55], v[16:19], v[72:79], v9
    ds_read_b128 v[76:79], v1 offset:50176
    v_max_f32_dpp v62, v62, v62 quad_perm:[2,3,0,1] row_mask:0xf bank_mask:0xf
    v_max3_f32 v62, v62, v44, v45
    v_mov_b32 v63, v62
    v_smfmac_f32_16x16x64_bf16 v[48:51], v[24:27], a[240:247], v9
    v_permlane32_swap_b32 v62, v63
    v_max_f32 v62, v62, v63
    v_mov_b32 v63, v62
    v_smfmac_f32_16x16x64_bf16 v[52:55], v[24:27], v[128:135], v9
    ds_read_b128 v[72:75], v1 offset:49152
    v_permlane16_swap_b32 v62, v63
    v_max_f32 v62, v62, v63
    v_add_f32 v48, v48, v50
    v_mul_f32 v63, s75, v62
    v_fma_f32 v45, v45, s75, -v63
    v_fma_f32 v59, v59, s75, -v63
    v_exp_f32 v59, v59
    v_add_f32 v52, v52, v54
    v_exp_f32 v45, v45
    v_fma_f32 v58, v58, s75, -v63
    v_add_f32 v53, v53, v55
    v_exp_f32 v58, v58
    v_fma_f32 v57, v57, s75, -v63
    v_fma_f32 v44, v44, s75, -v63
    v_exp_f32 v44, v44
    v_exp_f32 v57, v57
    v_add_f32 v49, v49, v51
    v_cvt_pk_bf16_f32 v44, v44, v45
    v_cndmask_b32 v46, v44, 0, s[94:95]
    v_cvt_pk_bf16_f32 v48, v48, v49
    v_cndmask_b32 v47, 0, v44, s[94:95]
    v_fma_f32 v56, v56, s75, -v63
    v_cvt_pk_bf16_f32 v61, v58, v59
    v_cvt_pk_bf16_f32 v49, v52, v53
    v_exp_f32 v56, v56
    v_mfma_f32_16x16x16_bf16 v[32:35], v[48:49], v[46:47], 0
    v_cvt_pk_bf16_f32 v60, v56, v57
    v_mov_b32_dpp v57, v61 quad_perm:[0,1,0,1] row_mask:0xf bank_mask:0xf
    v_mfma_f32_16x16x16_bf16 v[36:39], v[10:11], v[46:47], 0
    v_mov_b32_dpp v56, v60 quad_perm:[0,1,0,1] row_mask:0xf bank_mask:0xf
    v_mov_b32_dpp v58, v60 quad_perm:[2,3,2,3] row_mask:0xf bank_mask:0xf
    v_mov_b32_dpp v59, v61 quad_perm:[2,3,2,3] row_mask:0xf bank_mask:0xf
    v_mfma_f32_16x16x16_bf16 v[36:39], v[10:11], v[56:57], v[36:39]
    v_mfma_f32_16x16x16_bf16 v[36:39], v[10:11], v[58:59], v[36:39]
    v_mov_b32 v12, 0
    s_waitcnt vmcnt(11)
    v_mfma_f32_16x16x32_bf16 v[68:71], v[68:71], v[56:59], v[32:35]
    ds_read_b128 v[20:23], v1 offset:52224
    v_mfma_f32_16x16x32_bf16 v[64:67], v[64:67], v[56:59], v[32:35]
    s_barrier
    v_rcp_f32 v14, v36
    v_mfma_f32_16x16x16_bf16 v[32:35], v[12:13], v[10:11], 0
    ds_read_b128 v[16:19], v1 offset:51200
    s_nop 3
    v_cndmask_b32 v65, v65, v69, s[94:95]
    v_cndmask_b32 v67, v67, v71, s[94:95]
    v_cndmask_b32 v64, v64, v68, s[94:95]
    v_mul_f32 v64, v64, v14
    v_mul_f32 v65, v65, v14
    v_cvt_pk_bf16_f32 v64, v64, v65
    v_cndmask_b32 v66, v66, v70, s[94:95]
    v_mul_f32 v66, v66, v14
    v_mul_f32 v67, v67, v14
    v_cvt_pk_bf16_f32 v65, v66, v67
    v_mfma_f32_16x16x16_bf16 v[56:59], v[12:13], v[10:11], 0
    ds_write_b64 v7, v[64:65] offset:9216
    v_cndmask_b32 v31, v41, v43, s[94:95]
    v_cndmask_b32 v30, v40, v42, s[94:95]
    v_mfma_f32_16x16x16_bf16 v[44:47], v[12:13], v[10:11], 0
    v_add_u32 v1, 0x10000, v1
    v_mfma_f32_16x16x16_bf16 v[24:27], v[12:13], v[10:11], 0
    v_mfma_f32_16x16x16_bf16 v[52:55], v[12:13], v[10:11], 0
    s_waitcnt lgkmcnt(0)
    s_barrier
    v_mfma_f32_16x16x16_bf16 v[40:43], v[12:13], v[10:11], 0
    ds_read_b128 v[64:67], v6 offset:9216
    v_mov_b64 v[28:29], v[48:49]
    v_mfma_f32_16x16x16_bf16 v[48:51], v[12:13], v[10:11], 0
    ds_read_b128 v[68:71], v6 offset:10240
    v_mfma_f32_16x16x16_bf16 v[60:63], v[12:13], v[10:11], 0
    v_mfma_f32_16x16x16_bf16 v[36:39], v[12:13], v[10:11], 0
    v_xor_b32 v2, 0x100000, v2
    s_waitcnt lgkmcnt(1)
    v_smfmac_f32_16x16x64_bf16 v[24:27], v[64:67], v[72:79], v9
    s_waitcnt lgkmcnt(0)
    v_smfmac_f32_16x16x64_bf16 v[24:27], v[68:71], v[16:23], v9
    ds_read_b128 v[20:23], v1 offset:3072
    v_smfmac_f32_16x16x64_bf16 v[52:55], v[64:67], v[160:167], v9
    ds_read_b128 v[16:19], v1 offset:2048
    v_smfmac_f32_16x16x64_bf16 v[52:55], v[68:71], v[168:175], v9
    ds_read_b128 v[72:75], v1 offset:0
    v_add_f32 v25, v25, v27
    v_smfmac_f32_16x16x64_bf16 v[40:43], v[64:67], v[176:183], v9
    ds_read_b128 v[76:79], v1 offset:1024
    v_add_f32 v24, v24, v26
    v_cvt_pk_bf16_f32 v24, v24, v25
    v_smfmac_f32_16x16x64_bf16 v[40:43], v[68:71], v[184:191], v9
    v_smfmac_f32_16x16x64_bf16 v[60:63], v[64:67], v[192:199], v9
    buffer_store_dword v24, v2, s[32:35], s36 offen sc1
    v_add_f32 v52, v52, v54
    v_add_f32 v53, v53, v55
    v_smfmac_f32_16x16x64_bf16 v[60:63], v[68:71], v[200:207], v9
    v_add_f32 v40, v40, v42
    v_add_f32 v41, v41, v43
    v_cvt_pk_bf16_f32 v40, v40, v41
    v_cvt_pk_bf16_f32 v52, v52, v53
    s_waitcnt lgkmcnt(0)
    v_smfmac_f32_16x16x64_bf16 v[44:47], v[64:67], v[72:79], v9
    buffer_store_dword v52, v2, s[32:35], s37 offen sc1
    v_add_f32 v61, v61, v63
    v_add_f32 v60, v60, v62
    v_smfmac_f32_16x16x64_bf16 v[44:47], v[68:71], v[16:23], v9
    ds_read_b128 v[20:23], v1 offset:19456
    v_smfmac_f32_16x16x64_bf16 v[48:51], v[64:67], v[208:215], v9
    buffer_store_dword v40, v2, s[32:35], s38 offen sc1
    v_cvt_pk_bf16_f32 v60, v60, v61
    v_smfmac_f32_16x16x64_bf16 v[48:51], v[68:71], v[216:223], v9
    ds_read_b128 v[72:75], v1 offset:16384
    ds_read_b128 v[76:79], v1 offset:17408
    v_smfmac_f32_16x16x64_bf16 v[56:59], v[64:67], v[224:231], v9
    buffer_store_dword v60, v2, s[32:35], s39 offen sc1
    v_add_f32 v44, v44, v46
    v_add_f32 v45, v45, v47
    v_cvt_pk_bf16_f32 v44, v44, v45
    v_smfmac_f32_16x16x64_bf16 v[56:59], v[68:71], v[232:239], v9
    ds_read_b128 v[16:19], v1 offset:18432
    v_smfmac_f32_16x16x64_bf16 v[32:35], v[64:67], v[240:247], v9
    buffer_store_dword v44, v2, s[32:35], s40 offen sc1
    v_add_f32 v48, v48, v50
    v_add_f32 v49, v49, v51
    v_cvt_pk_bf16_f32 v48, v48, v49
    v_smfmac_f32_16x16x64_bf16 v[32:35], v[68:71], v[248:255], v9
    s_waitcnt lgkmcnt(1)
    v_smfmac_f32_16x16x64_bf16 v[36:39], v[64:67], v[72:79], v9
    buffer_store_dword v48, v2, s[32:35], s41 offen sc1
    v_add_f32 v57, v57, v59
    v_add_f32 v56, v56, v58
    v_cvt_pk_bf16_f32 v56, v56, v57
    s_waitcnt lgkmcnt(0)
    v_smfmac_f32_16x16x64_bf16 v[36:39], v[68:71], v[16:23], v9
    buffer_store_dword v56, v2, s[32:35], s42 offen sc1
    v_add_f32 v32, v32, v34
    v_add_f32 v33, v33, v35
    v_cvt_pk_bf16_f32 v32, v32, v33
    buffer_store_dword v32, v2, s[32:35], s43 offen sc1
    s_nop 0
    v_add_f32 v36, v36, v38
    v_add_f32 v37, v37, v39
    v_cvt_pk_bf16_f32 v36, v36, v37
    buffer_store_dword v36, v2, s[32:35], s44 offen sc1
    s_add_u32 s64, s64, 1
    s_branch ttop_102
tw_99l:
    s_waitcnt lgkmcnt(0)
    s_barrier
    ds_read_b128 v[16:19], v0 offset:0
    ds_read_b128 v[20:23], v0 offset:1024
    ds_read_b128 v[52:55], v1 offset:35840
    ds_read_b128 v[24:27], v0 offset:2048
    s_waitcnt lgkmcnt(3)
    v_smfmac_f32_16x16x64_bf16 v[44:47], v[16:19], a[152:159], v9
    ds_read_b128 v[48:51], v1 offset:34816
    v_smfmac_f32_16x16x64_bf16 v[36:39], v[16:19], v[96:103], v9
    v_smfmac_f32_16x16x64_bf16 v[40:43], v[16:19], a[96:103], v9
    ds_read_b128 v[28:31], v0 offset:3072
    s_waitcnt lgkmcnt(2)
    v_smfmac_f32_16x16x64_bf16 v[44:47], v[24:27], a[160:167], v9
    ds_read_b128 v[76:79], v1 offset:33792
    v_smfmac_f32_16x16x64_bf16 v[40:43], v[24:27], a[104:111], v9
    ds_read_b128 v[72:75], v1 offset:32768
    s_waitcnt lgkmcnt(3)
    v_smfmac_f32_16x16x64_bf16 v[44:47], v[20:23], v[48:55], v9
    s_waitcnt vmcnt(5)
    s_barrier
    v_smfmac_f32_16x16x64_bf16 v[32:35], v[16:19], a[208:215], v9
    v_smfmac_f32_16x16x64_bf16 v[32:35], v[20:23], a[216:223], v9
    v_smfmac_f32_16x16x64_bf16 v[32:35], v[24:27], a[224:231], v9
    s_waitcnt lgkmcnt(2)
    v_smfmac_f32_16x16x64_bf16 v[32:35], v[28:31], a[232:239], v9
    ds_read_b128 v[16:19], v0 offset:4096
    v_smfmac_f32_16x16x64_bf16 v[36:39], v[20:23], v[104:111], v9
    s_waitcnt lgkmcnt(1)
    v_smfmac_f32_16x16x64_bf16 v[40:43], v[20:23], v[72:79], v9
    v_smfmac_f32_16x16x64_bf16 v[40:43], v[28:31], a[112:119], v9
    ds_read_b128 v[20:23], v0 offset:5120
    v_add_u32 v1, 0x10000, v1
    v_smfmac_f32_16x16x64_bf16 v[36:39], v[24:27], v[112:119], v9
    ds_read_b128 v[52:55], v1 offset:19456
    s_waitcnt lgkmcnt(2)
    v_smfmac_f32_16x16x64_bf16 v[32:35], v[16:19], a[240:247], v9
    ds_read_b128 v[24:27], v0 offset:6144
    v_smfmac_f32_16x16x64_bf16 v[44:47], v[28:31], a[168:175], v9
    v_smfmac_f32_16x16x64_bf16 v[36:39], v[28:31], v[120:127], v9
    ds_read_b128 v[28:31], v0 offset:7168
    v_smfmac_f32_16x16x64_bf16 v[44:47], v[16:19], a[176:183], v9
    ds_read_b128 v[76:79], v1 offset:17408
    v_smfmac_f32_16x16x64_bf16 v[36:39], v[16:19], v[128:135], v9
    ds_read_b128 v[48:51], v1 offset:18432
    s_waitcnt lgkmcnt(5)
    v_smfmac_f32_16x16x64_bf16 v[32:35], v[20:23], a[248:255], v9
    ds_read_b128 v[72:75], v1 offset:16384
    v_smfmac_f32_16x16x64_bf16 v[40:43], v[16:19], a[120:127], v9
    ds_read_b128 v[16:19], v0 offset:8192
    v_smfmac_f32_16x16x64_bf16 v[44:47], v[20:23], a[184:191], v9
    v_smfmac_f32_16x16x64_bf16 v[40:43], v[20:23], a[128:135], v9
    s_waitcnt lgkmcnt(2)
    v_smfmac_f32_16x16x64_bf16 v[44:47], v[24:27], v[48:55], v9
    ds_read_b128 v[48:51], v1 offset:34816
    v_smfmac_f32_16x16x64_bf16 v[32:35], v[24:27], v[80:87], v9
    s_waitcnt lgkmcnt(2)
    v_smfmac_f32_16x16x64_bf16 v[40:43], v[24:27], v[72:79], v9
    v_smfmac_f32_16x16x64_bf16 v[40:43], v[28:31], a[136:143], v9
    ds_read_b128 v[52:55], v1 offset:35840
    s_waitcnt lgkmcnt(2)
    v_smfmac_f32_16x16x64_bf16 v[40:43], v[16:19], a[144:151], v9
    v_smfmac_f32_16x16x64_bf16 v[44:47], v[28:31], a[192:199], v9
    ds_read_b128 v[72:75], v1 offset:32768
    v_smfmac_f32_16x16x64_bf16 v[36:39], v[20:23], v[136:143], v9
    ds_read_b128 v[76:79], v1 offset:33792
    v_add_f32 v40, v40, v42
    v_smfmac_f32_16x16x64_bf16 v[32:35], v[28:31], v[88:95], v9
    v_add_f32 v41, v41, v43
    v_smfmac_f32_16x16x64_bf16 v[44:47], v[16:19], a[200:207], v9
    v_cvt_pk_bf16_f32 v12, v40, v41
    v_smfmac_f32_16x16x64_bf16 v[36:39], v[24:27], v[144:151], v9
    v_smfmac_f32_16x16x64_bf16 v[36:39], v[28:31], v[152:159], v9
    s_waitcnt lgkmcnt(0)
    v_smfmac_f32_16x16x64_bf16 v[32:35], v[16:19], v[72:79], v9
    v_add_f32 v45, v45, v47
    v_smfmac_f32_16x16x64_bf16 v[36:39], v[16:19], v[48:55], v9
    v_cmp_u_f32 vcc, v40, v41
    v_add_f32 v44, v44, v46
    v_mfma_f32_16x16x16_bf16 v[40:43], v[12:13], v[8:9], 0
    v_cvt_pk_bf16_f32 v12, v44, v45
    v_add_f32 v32, v32, v34
    v_add_f32 v33, v33, v35
    v_mfma_f32_16x16x16_bf16 v[44:47], v[12:13], v[8:9], 0
    s_cbranch_vccnz tredo_100l
tredo_100lr:
    v_cvt_pk_bf16_f32 v32, v32, v33
    v_add_f32 v36, v36, v38
    v_add_f32 v37, v37, v39
    v_cvt_pk_bf16_f32 v33, v36, v37
    v_cvt_pk_bf16_f32 v40, v40, v41
    v_cvt_pk_bf16_f32 v41, v42, v43
    s_nop 0
    v_cvt_pk_bf16_f32 v42, v44, v45
    v_cvt_pk_bf16_f32 v43, v46, v47
    v_cndmask_b32 v34, v40, v42, s[94:95]
    v_cndmask_b32 v35, v41, v43, s[94:95]
    buffer_store_dwordx4 v[32:35], v0, s[32:35], s77 offen sc1
    s_endpgm
ttop_102a:
    v_lshlrev_b32 v56, 3, v0
    v_and_b32 v57, 0x780, v56
    s_mov_b32 s57, 133120
    s_mov_b32 s58, 141312
wteam_103:
    buffer_load_dword v58, v56, s[32:35], s57 offen sc1
    buffer_load_dword v59, v57, s[32:35], s58 offen sc1
    s_sub_i32 s54, s54, 1
    s_cmp_lt_i32 s54, 0
    s_waitcnt vmcnt(0)
    s_cbranch_scc1 wteamd_104
    v_and_b32 v58, v58, v59
    v_cmp_eq_u32 vcc, 0, v58
    s_cbranch_vccz wteamd_104
    s_sleep 2
    s_branch wteam_103
wteamd_104:
    s_branch ttop_102b
tp_105:
    buffer_load_dwordx4 v[56:59], v0, s[32:35], s68 offen offset:0 sc1
    buffer_load_dwordx4 v[60:63], v0, s[32:35], s68 offen offset:1024 sc1
    buffer_load_dwordx4 v[64:67], v0, s[32:35], s68 offen offset:2048 sc1
    buffer_load_dwordx4 v[68:71], v0, s[32:35], s68 offen offset:3072 sc1
    s_sub_i32 s54, s54, 1
    s_cmp_lt_i32 s54, 0
    s_cselect_b64 s[96:97], 0, -1
    s_waitcnt vmcnt(3) lgkmcnt(4)
    v_mfma_f32_16x16x32_bf16 v[20:23], v[16:19], v[56:59], 0
    s_waitcnt vmcnt(2)
    v_mfma_f32_16x16x32_bf16 v[20:23], v[16:19], v[60:63], v[20:23]
    s_waitcnt vmcnt(1)
    v_mfma_f32_16x16x32_bf16 v[20:23], v[16:19], v[64:67], v[20:23]
    s_waitcnt vmcnt(0)
    v_mfma_f32_16x16x32_bf16 v[20:23], v[16:19], v[68:71], v[20:23]
    s_nop 7
    v_add_f32_dpp v20, v20, v20 row_ror:8 row_mask:0xf bank_mask:0xf
    v_add_f32_dpp v21, v21, v21 row_ror:8 row_mask:0xf bank_mask:0xf
    v_cvt_pk_bf16_f32 v20, v20, v21
    v_cmp_u_f32 vcc, v21, v21
    buffer_store_dword v20, v4, s[32:35], s81 offen sc1
    s_and_b64 vcc, vcc, s[96:97]
    s_cbranch_vccnz tp_105
    s_branch tpd_106
tredo_100l:
    s_cmp_lt_i32 s49, 1
    s_cbranch_scc1 tredo_100lr
tredo_100:
    s_sub_i32 s49, s49, 1
    s_cmp_lt_i32 s49, 0
    s_cbranch_scc1 tredo_100r
    s_mov_b32 s45, s69
    s_waitcnt lgkmcnt(0)
    s_nop 7
    v_add_u32 v1, s63, v0
    v_and_b32 v2, 0x7ffff, v2
    v_or_b32 v2, s51, v2
    v_mov_b64 v[32:33], 0
    v_mov_b64 v[34:35], 0
    v_mov_b64 v[36:37], 0
    v_mov_b64 v[38:39], 0
    v_mov_b64 v[40:41], 0
    v_mov_b64 v[42:43], 0
    v_mov_b64 v[44:45], 0
    v_mov_b64 v[46:47], 0
    ds_read_b128 v[72:75], v1 offset:16384
    ds_read_b128 v[76:79], v1 offset:17408
    ds_read_b128 v[48:51], v1 offset:18432
    ds_read_b128 v[52:55], v1 offset:19456
    s_barrier
    s_branch tm_101
tcls2_89:
    buffer_load_dwordx4 v[64:67], v0, s[32:35], s73 offen offset:0 sc1
    buffer_load_dwordx4 v[68:71], v0, s[32:35], s73 offen offset:1024 sc1
    s_barrier
    buffer_store_dwordx4 v[28:31], v0, s[32:35], s45 offen sc1
    v_add_u32 v1, s63, v0
    v_and_b32 v2, 0x7ffff, v2
    v_or_b32 v2, s51, v2
    v_mov_b64 v[32:33], 0
    v_mov_b64 v[34:35], 0
    v_mov_b64 v[36:37], 0
    v_mov_b64 v[38:39], 0
    v_mov_b64 v[40:41], 0
    v_mov_b64 v[42:43], 0
    v_mov_b64 v[44:45], 0
    v_mov_b64 v[46:47], 0
    ds_read_b128 v[72:75], v1 offset:16384
    ds_read_b128 v[76:79], v1 offset:17408
    ds_read_b128 v[48:51], v1 offset:18432
    ds_read_b128 v[52:55], v1 offset:19456
    s_waitcnt lgkmcnt(0)
    s_branch tw_107
.p2align 6
ttop_110:
    s_cmp_eq_u32 s64, 1
    s_cbranch_scc1 ttop_110a
ttop_110b:
    s_cmp_ge_u32 s53, 8
    s_cbranch_scc1 tn_113
    s_nop 10
    buffer_load_dwordx4 v[56:59], v0, s[32:35], s68 offen offset:0 sc1
    buffer_load_dwordx4 v[60:63], v0, s[32:35], s68 offen offset:1024 sc1
    buffer_load_dwordx4 v[64:67], v0, s[32:35], s68 offen offset:2048 sc1
    buffer_load_dwordx4 v[68:71], v0, s[32:35], s68 offen offset:3072 sc1
    s_and_b32 s57, s64, 3
    s_lshl_b32 s58, s57, 14
    s_add_u32 s81, s70, s58
    s_add_u32 s85, s58, 7405568
    s_xor_b32 s51, s57, 2
    s_lshl_b32 s51, s51, 19
    s_add_u32 s72, s72, 786432
    s_add_u32 s73, s73, 786432
    s_mov_b32 s45, s77
    s_add_u32 s77, s77, 131072
    s_sub_u32 s99, s64, 1
    ds_read_b128 v[16:19], v0 offset:15360
    v_add_u32 v1, s63, v0
    v_and_b32 v2, 0x7ffff, v2
    v_or_b32 v2, s51, v2
    v_mov_b64 v[32:33], 0
    v_mov_b64 v[34:35], 0
    v_mov_b64 v[36:37], 0
    v_mov_b64 v[38:39], 0
    v_mov_b64 v[40:41], 0
    v_mov_b64 v[42:43], 0
    v_mov_b64 v[44:45], 0
    v_mov_b64 v[46:47], 0
    ds_read_b128 v[72:75], v1 offset:16384
    ds_read_b128 v[76:79], v1 offset:17408
    ds_read_b128 v[48:51], v1 offset:18432
    ds_read_b128 v[52:55], v1 offset:19456
    s_waitcnt vmcnt(3) lgkmcnt(4)
    v_mfma_f32_16x16x32_bf16 v[20:23], v[16:19], v[56:59], 0
    s_waitcnt vmcnt(2)
    v_mfma_f32_16x16x32_bf16 v[20:23], v[16:19], v[60:63], v[20:23]
    s_waitcnt vmcnt(1)
    v_mfma_f32_16x16x32_bf16 v[20:23], v[16:19], v[64:67], v[20:23]
    s_waitcnt vmcnt(0)
    v_mfma_f32_16x16x32_bf16 v[20:23], v[16:19], v[68:71], v[20:23]
    s_nop 7
    v_add_f32_dpp v20, v20, v20 row_ror:8 row_mask:0xf bank_mask:0xf
    v_add_f32_dpp v21, v21, v21 row_ror:8 row_mask:0xf bank_mask:0xf
    v_cvt_pk_bf16_f32 v20, v20, v21
    v_cmp_u_f32 vcc, v21, v21
    buffer_store_dword v20, v4, s[32:35], s81 offen sc1
    s_cbranch_vccnz tp_115
tpd_116:
    s_lshl_b32 s57, s57, 19
    s_add_u32 s68, s50, s57
    s_and_b32 s57, s99, 3
    s_lshl_b32 s57, s57, 14
    s_add_u32 s67, s70, s57
    s_branch tj_114
tn_113:
    s_and_b32 s57, s64, 3
    s_lshl_b32 s58, s57, 14
    s_add_u32 s81, s70, s58
    s_add_u32 s85, s58, 7405568
    s_xor_b32 s51, s57, 2
    s_lshl_b32 s51, s51, 19
    s_add_u32 s72, s72, 786432
    s_add_u32 s73, s73, 786432
    s_mov_b32 s45, s77
    s_add_u32 s77, s77, 131072
    s_sub_u32 s99, s64, 1
    ds_read_b128 v[16:19], v0 offset:15360
    v_add_u32 v1, s63, v0
    v_and_b32 v2, 0x7ffff, v2
    v_or_b32 v2, s51, v2
    v_mov_b64 v[32:33], 0
    v_mov_b64 v[34:35], 0
    v_mov_b64 v[36:37], 0
    v_mov_b64 v[38:39], 0
    v_mov_b64 v[40:41], 0
    v_mov_b64 v[42:43], 0
    v_mov_b64 v[44:45], 0
    v_mov_b64 v[46:47], 0
    ds_read_b128 v[72:75], v1 offset:16384
    ds_read_b128 v[76:79], v1 offset:17408
    ds_read_b128 v[48:51], v1 offset:18432
    ds_read_b128 v[52:55], v1 offset:19456
tj_114:
tm_109:
    s_add_u32 m0, s56, 4096
    s_add_u32 s57, s85, m0
    s_add_u32 s58, s85, 8192
    s_barrier
    buffer_load_dwordx4 v0, s[32:35], s57 offen sc1 lds
    s_nop 5
    buffer_load_dwordx4 v[56:59], v0, s[32:35], s72 offen offset:0 sc1
    buffer_load_dwordx4 v[60:63], v0, s[32:35], s72 offen offset:1024 sc1
    s_barrier
    buffer_load_dwordx4 v[64:67], v0, s[32:35], s73 offen offset:0 sc1
    buffer_load_dwordx4 v[68:71], v0, s[32:35], s73 offen offset:1024 sc1
    s_barrier
    buffer_store_dwordx4 v[28:31], v0, s[32:35], s45 offen sc1
    s_cmp_eq_u32 s64, 63
    s_cbranch_scc1 tw_107l
    s_waitcnt lgkmcnt(0)
tw_107:
    s_barrier
    ds_read_b128 v[16:19], v0 offset:0
    ds_read_b128 v[24:27], v0 offset:2048
    ds_read_b128 v[20:23], v0 offset:1024
    buffer_store_dword v15, v2, s[32:35], s37 offen sc1
    s_waitcnt lgkmcnt(2)
    v_smfmac_f32_16x16x64_bf16 v[32:35], v[16:19], v[72:79], v9
    ds_read_b128 v[76:79], v1 offset:33792
    v_smfmac_f32_16x16x64_bf16 v[36:39], v[16:19], v[48:55], v9
    ds_read_b128 v[52:55], v1 offset:35840
    s_waitcnt lgkmcnt(2)
    v_smfmac_f32_16x16x64_bf16 v[32:35], v[20:23], a[0:7], v9
    ds_read_b128 v[28:31], v0 offset:3072
    v_smfmac_f32_16x16x64_bf16 v[36:39], v[20:23], a[48:55], v9
    ds_read_b128 v[48:51], v1 offset:34816
    v_smfmac_f32_16x16x64_bf16 v[40:43], v[16:19], a[96:103], v9
    ds_read_b128 v[72:75], v1 offset:32768
    v_smfmac_f32_16x16x64_bf16 v[44:47], v[16:19], a[152:159], v9
    s_waitcnt vmcnt(6)
    s_barrier
    v_smfmac_f32_16x16x64_bf16 v[32:35], v[24:27], a[8:15], v9
    v_smfmac_f32_16x16x64_bf16 v[36:39], v[24:27], a[56:63], v9
    ds_read_b128 v[16:19], v0 offset:4096
    s_waitcnt lgkmcnt(1)
    v_smfmac_f32_16x16x64_bf16 v[40:43], v[20:23], v[72:79], v9
    ds_read_b128 v[72:75], v1 offset:49152
    v_smfmac_f32_16x16x64_bf16 v[44:47], v[20:23], v[48:55], v9
    ds_read_b128 v[76:79], v1 offset:50176
    v_smfmac_f32_16x16x64_bf16 v[32:35], v[28:31], a[16:23], v9
    ds_read_b128 v[48:51], v1 offset:51200
    v_smfmac_f32_16x16x64_bf16 v[36:39], v[28:31], a[64:71], v9
    ds_read_b128 v[52:55], v1 offset:52224
    v_add_u32 v1, 0x10000, v1
    v_smfmac_f32_16x16x64_bf16 v[40:43], v[24:27], a[104:111], v9
    ds_read_b128 v[20:23], v0 offset:5120
    v_smfmac_f32_16x16x64_bf16 v[44:47], v[24:27], a[160:167], v9
    buffer_store_dword v15, v2, s[32:35], s36 offen sc1
    ds_read_b128 v[24:27], v0 offset:6144
    s_waitcnt lgkmcnt(4)
    v_smfmac_f32_16x16x64_bf16 v[32:35], v[16:19], v[72:79], v9
    ds_read_b128 v[72:75], v1 offset:0
    s_waitcnt lgkmcnt(3)
    v_smfmac_f32_16x16x64_bf16 v[36:39], v[16:19], v[48:55], v9
    ds_read_b128 v[76:79], v1 offset:1024
    v_smfmac_f32_16x16x64_bf16 v[40:43], v[28:31], a[112:119], v9
    buffer_store_dword v15, v2, s[32:35], s40 offen sc1
    v_smfmac_f32_16x16x64_bf16 v[44:47], v[28:31], a[168:175], v9
    ds_read_b128 v[48:51], v1 offset:2048
    s_waitcnt lgkmcnt(4)
    v_smfmac_f32_16x16x64_bf16 v[32:35], v[20:23], a[24:31], v9
    ds_read_b128 v[52:55], v1 offset:3072
    v_smfmac_f32_16x16x64_bf16 v[36:39], v[20:23], a[72:79], v9
    v_smfmac_f32_16x16x64_bf16 v[40:43], v[16:19], a[120:127], v9
    buffer_store_dword v15, v2, s[32:35], s41 offen sc1
    v_smfmac_f32_16x16x64_bf16 v[44:47], v[16:19], a[176:183], v9
    ds_read_b128 v[28:31], v0 offset:7168
    ds_read_b128 v[16:19], v0 offset:8192
    s_waitcnt lgkmcnt(4)
    v_smfmac_f32_16x16x64_bf16 v[32:35], v[24:27], v[72:79], v9
    buffer_store_dword v15, v2, s[32:35], s39 offen sc1
    s_waitcnt lgkmcnt(2)
    v_smfmac_f32_16x16x64_bf16 v[36:39], v[24:27], v[48:55], v9
    ds_read_b128 v[52:55], v1 offset:19456
    ds_read_b128 v[72:75], v1 offset:16384
    v_smfmac_f32_16x16x64_bf16 v[40:43], v[20:23], a[128:135], v9
    buffer_store_dword v15, v2, s[32:35], s42 offen sc1
    v_smfmac_f32_16x16x64_bf16 v[44:47], v[20:23], a[184:191], v9
    ds_read_b128 v[48:51], v1 offset:18432
    ds_read_b128 v[76:79], v1 offset:17408
    s_waitcnt lgkmcnt(5)
    v_smfmac_f32_16x16x64_bf16 v[32:35], v[28:31], a[32:39], v9
    buffer_store_dword v15, v2, s[32:35], s38 offen sc1
    v_smfmac_f32_16x16x64_bf16 v[36:39], v[28:31], a[80:87], v9
    s_waitcnt lgkmcnt(4)
    v_smfmac_f32_16x16x64_bf16 v[32:35], v[16:19], a[40:47], v9
    buffer_store_dword v15, v2, s[32:35], s43 offen sc1
    v_smfmac_f32_16x16x64_bf16 v[36:39], v[16:19], a[88:95], v9
    s_waitcnt lgkmcnt(0)
    v_smfmac_f32_16x16x64_bf16 v[40:43], v[24:27], v[72:79], v9
    buffer_store_dword v15, v2, s[32:35], s44 offen sc1
    v_add_f32 v33, v33, v35
    v_smfmac_f32_16x16x64_bf16 v[44:47], v[24:27], v[48:55], v9
    v_add_f32 v32, v32, v34
    v_smfmac_f32_16x16x64_bf16 v[40:43], v[28:31], a[136:143], v9
    ds_read_b128 v[72:75], v1 offset:32768
    v_add_f32 v36, v36, v38
    v_smfmac_f32_16x16x64_bf16 v[44:47], v[28:31], a[192:199], v9
    v_add_f32 v37, v37, v39
    v_smfmac_f32_16x16x64_bf16 v[40:43], v[16:19], a[144:151], v9
    v_cvt_pk_bf16_f32 v12, v32, v33
    v_mov_b64 v[48:49], 0
    v_cmp_u_f32 vcc, v32, v33
    v_mfma_f32_16x16x16_bf16 v[32:35], v[12:13], v[8:9], 0
    v_cvt_pk_bf16_f32 v12, v36, v37
    v_mov_b64 v[54:55], 0
    v_add_f32 v41, v41, v43
    v_mfma_f32_16x16x16_bf16 v[36:39], v[12:13], v[8:9], 0
    v_add_f32 v40, v40, v42
    v_cvt_pk_bf16_f32 v12, v40, v41
    v_mov_b64 v[52:53], 0
    v_smfmac_f32_16x16x64_bf16 v[44:47], v[16:19], a[200:207], v9
    ds_read_b128 v[76:79], v1 offset:33792
    v_cvt_pk_bf16_f32 v32, v32, v33
    v_cvt_pk_bf16_f32 v33, v34, v35
    v_cvt_pk_bf16_f32 v34, v36, v37
    v_mfma_f32_16x16x16_bf16 v[40:43], v[12:13], v[8:9], 0
    v_cvt_pk_bf16_f32 v35, v38, v39
    v_mov_b64 v[50:51], 0
    v_add_f32 v45, v45, v47
    s_waitcnt vmcnt(13)
    v_mfma_f32_16x16x32_bf16 v[56:59], v[56:59], v[32:35], 0
    v_add_f32 v44, v44, v46
    v_cvt_pk_bf16_f32 v12, v44, v45
    v_smfmac_f32_16x16x64_bf16 v[48:51], v[20:23], a[248:255], v9
    s_cbranch_vccnz tredo_108
tredo_108r:
    v_mfma_f32_16x16x16_bf16 v[44:47], v[12:13], v[8:9], 0
    s_nop 0
    ds_write_b128 v3, v[56:59] offset:9216
    v_cvt_pk_bf16_f32 v40, v40, v41
    v_cvt_pk_bf16_f32 v41, v42, v43
    s_waitcnt vmcnt(12)
    v_mfma_f32_16x16x32_bf16 v[60:63], v[60:63], v[32:35], 0
    s_nop 1
    v_cvt_pk_bf16_f32 v43, v46, v47
    v_cvt_pk_bf16_f32 v42, v44, v45
    v_smfmac_f32_16x16x64_bf16 v[52:55], v[20:23], v[136:143], v9
    buffer_store_dword v15, v4, s[32:35], s67 offen sc1
    v_mfma_f32_16x16x32_bf16 v[44:47], v[40:43], v[32:35], 0
    ds_write_b128 v3, v[60:63] offset:9728
    v_smfmac_f32_16x16x64_bf16 v[48:51], v[24:27], v[80:87], v9
    s_nop 4
    ds_write_b64 v5, v[44:45] offset:13312
    v_smfmac_f32_16x16x64_bf16 v[52:55], v[24:27], v[144:151], v9
    ds_read_b128 v[24:27], v0 offset:1024
    v_smfmac_f32_16x16x64_bf16 v[48:51], v[28:31], v[88:95], v9
    ds_read_b128 v[20:23], v0 offset:0
    v_smfmac_f32_16x16x64_bf16 v[52:55], v[28:31], v[152:159], v9
    ds_read_b128 v[28:31], v0 offset:2048
    s_waitcnt lgkmcnt(3)
    s_barrier
    v_smfmac_f32_16x16x64_bf16 v[48:51], v[16:19], v[72:79], v9
    ds_read_b64 v[46:47], v6 offset:14336
    ds_read_b64 v[44:45], v6 offset:13312
    s_waitcnt lgkmcnt(3)
    v_smfmac_f32_16x16x64_bf16 v[48:51], v[20:23], a[208:215], v9
    ds_read_b128 v[32:35], v6 offset:11264
    v_smfmac_f32_16x16x64_bf16 v[52:55], v[20:23], v[96:103], v9
    ds_read_b128 v[20:23], v0 offset:3072
    v_smfmac_f32_16x16x64_bf16 v[48:51], v[24:27], a[216:223], v9
    ds_read_b128 v[36:39], v6 offset:12288
    v_smfmac_f32_16x16x64_bf16 v[52:55], v[24:27], v[104:111], v9
    ds_read_b128 v[60:63], v6 offset:10240
    s_waitcnt lgkmcnt(4)
    v_add_f32 v45, v45, v47
    v_add_f32 v44, v44, v46
    v_smfmac_f32_16x16x64_bf16 v[48:51], v[28:31], a[224:231], v9
    ds_read_b128 v[56:59], v6 offset:9216
    v_add_f32_dpp v44, v44, v44 quad_perm:[2,3,0,1] row_mask:0xf bank_mask:0xf
    v_smfmac_f32_16x16x64_bf16 v[52:55], v[28:31], v[112:119], v9
    ds_read_b128 v[72:75], v1 offset:34816
    s_waitcnt lgkmcnt(3)
    v_add_f32 v35, v35, v39
    v_smfmac_f32_16x16x64_bf16 v[48:51], v[20:23], a[232:239], v9
    ds_read_b128 v[24:27], v0 offset:4096
    v_add_f32 v34, v34, v38
    v_smfmac_f32_16x16x64_bf16 v[52:55], v[20:23], v[120:127], v9
    ds_read_b128 v[76:79], v1 offset:35840
    v_add_f32 v33, v33, v37
    v_add_f32 v32, v32, v36
    s_waitcnt lgkmcnt(3)
    v_add_f32 v59, v59, v63
    v_add_f32 v59, v59, v35
    v_add_f32_dpp v45, v45, v45 quad_perm:[2,3,0,1] row_mask:0xf bank_mask:0xf
    v_add_f32 v58, v58, v62
    v_add_f32 v56, v56, v60
    v_add_f32 v56, v56, v32
    v_add_f32 v57, v57, v61
    v_add_f32 v58, v58, v34
    v_add_f32 v57, v57, v33
    v_max3_f32 v62, v56, v57, v58
    v_max_f32 v62, v62, v59
    s_waitcnt lgkmcnt(0)
    v_smfmac_f32_16x16x64_bf16 v[52:55], v[16:19], v[72:79], v9
    ds_read_b128 v[76:79], v1 offset:50176
    v_max_f32_dpp v62, v62, v62 quad_perm:[2,3,0,1] row_mask:0xf bank_mask:0xf
    v_max3_f32 v62, v62, v44, v45
    v_mov_b32 v63, v62
    v_smfmac_f32_16x16x64_bf16 v[48:51], v[24:27], a[240:247], v9
    v_permlane32_swap_b32 v62, v63
    v_max_f32 v62, v62, v63
    v_mov_b32 v63, v62
    v_smfmac_f32_16x16x64_bf16 v[52:55], v[24:27], v[128:135], v9
    ds_read_b128 v[72:75], v1 offset:49152
    v_permlane16_swap_b32 v62, v63
    v_max_f32 v62, v62, v63
    v_add_f32 v48, v48, v50
    v_mul_f32 v63, s75, v62
    v_fma_f32 v45, v45, s75, -v63
    v_fma_f32 v59, v59, s75, -v63
    v_exp_f32 v59, v59
    v_add_f32 v52, v52, v54
    v_exp_f32 v45, v45
    v_fma_f32 v58, v58, s75, -v63
    v_add_f32 v53, v53, v55
    v_exp_f32 v58, v58
    v_fma_f32 v57, v57, s75, -v63
    v_fma_f32 v44, v44, s75, -v63
    v_exp_f32 v44, v44
    v_exp_f32 v57, v57
    v_add_f32 v49, v49, v51
    v_cvt_pk_bf16_f32 v44, v44, v45
    v_cndmask_b32 v46, v44, 0, s[94:95]
    v_cvt_pk_bf16_f32 v48, v48, v49
    v_cndmask_b32 v47, 0, v44, s[94:95]
    v_fma_f32 v56, v56, s75, -v63
    v_cvt_pk_bf16_f32 v61, v58, v59
    v_cvt_pk_bf16_f32 v49, v52, v53
    v_exp_f32 v56, v56
    v_mfma_f32_16x16x16_bf16 v[32:35], v[48:49], v[46:47], 0
    v_cvt_pk_bf16_f32 v60, v56, v57
    v_mov_b32_dpp v57, v61 quad_perm:[0,1,0,1] row_mask:0xf bank_mask:0xf
    v_mfma_f32_16x16x16_bf16 v[36:39], v[10:11], v[46:47], 0
    v_mov_b32_dpp v56, v60 quad_perm:[0,1,0,1] row_mask:0xf bank_mask:0xf
    v_mov_b32_dpp v58, v60 quad_perm:[2,3,2,3] row_mask:0xf bank_mask:0xf
    v_mov_b32_dpp v59, v61 quad_perm:[2,3,2,3] row_mask:0xf bank_mask:0xf
    v_mfma_f32_16x16x16_bf16 v[36:39], v[10:11], v[56:57], v[36:39]
    v_mfma_f32_16x16x16_bf16 v[36:39], v[10:11], v[58:59], v[36:39]
    v_mov_b32 v12, 0
    s_waitcnt vmcnt(11)
    v_mfma_f32_16x16x32_bf16 v[68:71], v[68:71], v[56:59], v[32:35]
    ds_read_b128 v[20:23], v1 offset:52224
    v_mfma_f32_16x16x32_bf16 v[64:67], v[64:67], v[56:59], v[32:35]
    s_barrier
    v_rcp_f32 v14, v36
    v_mfma_f32_16x16x16_bf16 v[32:35], v[12:13], v[10:11], 0
    ds_read_b128 v[16:19], v1 offset:51200
    s_nop 3
    v_cndmask_b32 v65, v65, v69, s[94:95]
    v_cndmask_b32 v67, v67, v71, s[94:95]
    v_cndmask_b32 v64, v64, v68, s[94:95]
    v_mul_f32 v64, v64, v14
    v_mul_f32 v65, v65, v14
    v_cvt_pk_bf16_f32 v64, v64, v65
    v_cndmask_b32 v66, v66, v70, s[94:95]
    v_mul_f32 v66, v66, v14
    v_mul_f32 v67, v67, v14
    v_cvt_pk_bf16_f32 v65, v66, v67
    v_mfma_f32_16x16x16_bf16 v[56:59], v[12:13], v[10:11], 0
    ds_write_b64 v7, v[64:65] offset:9216
    v_cndmask_b32 v31, v41, v43, s[94:95]
    v_cndmask_b32 v30, v40, v42, s[94:95]
    v_mfma_f32_16x16x16_bf16 v[44:47], v[12:13], v[10:11], 0
    v_add_u32 v1, 0x10000, v1
    v_mfma_f32_16x16x16_bf16 v[24:27], v[12:13], v[10:11], 0
    v_mfma_f32_16x16x16_bf16 v[52:55], v[12:13], v[10:11], 0
    s_waitcnt lgkmcnt(0)
    s_barrier
    v_mfma_f32_16x16x16_bf16 v[40:43], v[12:13], v[10:11], 0
    ds_read_b128 v[64:67], v6 offset:9216
    v_mov_b64 v[28:29], v[48:49]
    v_mfma_f32_16x16x16_bf16 v[48:51], v[12:13], v[10:11], 0
    ds_read_b128 v[68:71], v6 offset:10240
    v_mfma_f32_16x16x16_bf16 v[60:63], v[12:13], v[10:11], 0
    v_mfma_f32_16x16x16_bf16 v[36:39], v[12:13], v[10:11], 0
    v_xor_b32 v2, 0x100000, v2
    s_waitcnt lgkmcnt(1)
    v_smfmac_f32_16x16x64_bf16 v[24:27], v[64:67], v[72:79], v9
    s_waitcnt lgkmcnt(0)
    v_smfmac_f32_16x16x64_bf16 v[24:27], v[68:71], v[16:23], v9
    ds_read_b128 v[20:23], v1 offset:3072
    v_smfmac_f32_16x16x64_bf16 v[52:55], v[64:67], v[160:167], v9
    ds_read_b128 v[16:19], v1 offset:2048
    v_smfmac_f32_16x16x64_bf16 v[52:55], v[68:71], v[168:175], v9
    ds_read_b128 v[72:75], v1 offset:0
    v_add_f32 v25, v25, v27
    v_smfmac_f32_16x16x64_bf16 v[40:43], v[64:67], v[176:183], v9
    ds_read_b128 v[76:79], v1 offset:1024
    v_add_f32 v24, v24, v26
    v_cvt_pk_bf16_f32 v24, v24, v25
    v_smfmac_f32_16x16x64_bf16 v[40:43], v[68:71], v[184:191], v9
    v_smfmac_f32_16x16x64_bf16 v[60:63], v[64:67], v[192:199], v9
    buffer_store_dword v24, v2, s[32:35], s36 offen sc1
    v_add_f32 v52, v52, v54
    v_add_f32 v53, v53, v55
    v_smfmac_f32_16x16x64_bf16 v[60:63], v[68:71], v[200:207], v9
    v_add_f32 v40, v40, v42
    v_add_f32 v41, v41, v43
    v_cvt_pk_bf16_f32 v40, v40, v41
    v_cvt_pk_bf16_f32 v52, v52, v53
    s_waitcnt lgkmcnt(0)
    v_smfmac_f32_16x16x64_bf16 v[44:47], v[64:67], v[72:79], v9
    buffer_store_dword v52, v2, s[32:35], s37 offen sc1
    v_add_f32 v61, v61, v63
    v_add_f32 v60, v60, v62
    v_smfmac_f32_16x16x64_bf16 v[44:47], v[68:71], v[16:23], v9
    ds_read_b128 v[20:23], v1 offset:19456
    v_smfmac_f32_16x16x64_bf16 v[48:51], v[64:67], v[208:215], v9
    buffer_store_dword v40, v2, s[32:35], s38 offen sc1
    v_cvt_pk_bf16_f32 v60, v60, v61
    v_smfmac_f32_16x16x64_bf16 v[48:51], v[68:71], v[216:223], v9
    ds_read_b128 v[72:75], v1 offset:16384
    ds_read_b128 v[76:79], v1 offset:17408
    v_smfmac_f32_16x16x64_bf16 v[56:59], v[64:67], v[224:231], v9
    buffer_store_dword v60, v2, s[32:35], s39 offen sc1
    v_add_f32 v44, v44, v46
    v_add_f32 v45, v45, v47
    v_cvt_pk_bf16_f32 v44, v44, v45
    v_smfmac_f32_16x16x64_bf16 v[56:59], v[68:71], v[232:239], v9
    ds_read_b128 v[16:19], v1 offset:18432
    v_smfmac_f32_16x16x64_bf16 v[32:35], v[64:67], v[240:247], v9
    buffer_store_dword v44, v2, s[32:35], s40 offen sc1
    v_add_f32 v48, v48, v50
    v_add_f32 v49, v49, v51
    v_cvt_pk_bf16_f32 v48, v48, v49
    v_smfmac_f32_16x16x64_bf16 v[32:35], v[68:71], v[248:255], v9
    s_waitcnt lgkmcnt(1)
    v_smfmac_f32_16x16x64_bf16 v[36:39], v[64:67], v[72:79], v9
    buffer_store_dword v48, v2, s[32:35], s41 offen sc1
    v_add_f32 v57, v57, v59
    v_add_f32 v56, v56, v58
    v_cvt_pk_bf16_f32 v56, v56, v57
    s_waitcnt lgkmcnt(0)
    v_smfmac_f32_16x16x64_bf16 v[36:39], v[68:71], v[16:23], v9
    buffer_store_dword v56, v2, s[32:35], s42 offen sc1
    v_add_f32 v32, v32, v34
    v_add_f32 v33, v33, v35
    v_cvt_pk_bf16_f32 v32, v32, v33
    buffer_store_dword v32, v2, s[32:35], s43 offen sc1
    s_nop 0
    v_add_f32 v36, v36, v38
    v_add_f32 v37, v37, v39
    v_cvt_pk_bf16_f32 v36, v36, v37
    buffer_store_dword v36, v2, s[32:35], s44 offen sc1
    s_add_u32 s64, s64, 1
    s_branch ttop_110
tw_107l:
    s_waitcnt lgkmcnt(0)
    s_barrier
    ds_read_b128 v[16:19], v0 offset:0
    ds_read_b128 v[20:23], v0 offset:1024
    ds_read_b128 v[52:55], v1 offset:35840
    ds_read_b128 v[24:27], v0 offset:2048
    s_waitcnt lgkmcnt(3)
    v_smfmac_f32_16x16x64_bf16 v[44:47], v[16:19], a[152:159], v9
    ds_read_b128 v[48:51], v1 offset:34816
    v_smfmac_f32_16x16x64_bf16 v[36:39], v[16:19], v[96:103], v9
    v_smfmac_f32_16x16x64_bf16 v[40:43], v[16:19], a[96:103], v9
    ds_read_b128 v[28:31], v0 offset:3072
    s_waitcnt lgkmcnt(2)
    v_smfmac_f32_16x16x64_bf16 v[44:47], v[24:27], a[160:167], v9
    ds_read_b128 v[76:79], v1 offset:33792
    v_smfmac_f32_16x16x64_bf16 v[40:43], v[24:27], a[104:111], v9
    ds_read_b128 v[72:75], v1 offset:32768
    s_waitcnt lgkmcnt(3)
    v_smfmac_f32_16x16x64_bf16 v[44:47], v[20:23], v[48:55], v9
    s_waitcnt vmcnt(5)
    s_barrier
    v_smfmac_f32_16x16x64_bf16 v[32:35], v[16:19], a[208:215], v9
    v_smfmac_f32_16x16x64_bf16 v[32:35], v[20:23], a[216:223], v9
    v_smfmac_f32_16x16x64_bf16 v[32:35], v[24:27], a[224:231], v9
    s_waitcnt lgkmcnt(2)
    v_smfmac_f32_16x16x64_bf16 v[32:35], v[28:31], a[232:239], v9
    ds_read_b128 v[16:19], v0 offset:4096
    v_smfmac_f32_16x16x64_bf16 v[36:39], v[20:23], v[104:111], v9
    s_waitcnt lgkmcnt(1)
    v_smfmac_f32_16x16x64_bf16 v[40:43], v[20:23], v[72:79], v9
    v_smfmac_f32_16x16x64_bf16 v[40:43], v[28:31], a[112:119], v9
    ds_read_b128 v[20:23], v0 offset:5120
    v_add_u32 v1, 0x10000, v1
    v_smfmac_f32_16x16x64_bf16 v[36:39], v[24:27], v[112:119], v9
    ds_read_b128 v[52:55], v1 offset:19456
    s_waitcnt lgkmcnt(2)
    v_smfmac_f32_16x16x64_bf16 v[32:35], v[16:19], a[240:247], v9
    ds_read_b128 v[24:27], v0 offset:6144
    v_smfmac_f32_16x16x64_bf16 v[44:47], v[28:31], a[168:175], v9
    v_smfmac_f32_16x16x64_bf16 v[36:39], v[28:31], v[120:127], v9
    ds_read_b128 v[28:31], v0 offset:7168
    v_smfmac_f32_16x16x64_bf16 v[44:47], v[16:19], a[176:183], v9
    ds_read_b128 v[76:79], v1 offset:17408
    v_smfmac_f32_16x16x64_bf16 v[36:39], v[16:19], v[128:135], v9
    ds_read_b128 v[48:51], v1 offset:18432
    s_waitcnt lgkmcnt(5)
    v_smfmac_f32_16x16x64_bf16 v[32:35], v[20:23], a[248:255], v9
    ds_read_b128 v[72:75], v1 offset:16384
    v_smfmac_f32_16x16x64_bf16 v[40:43], v[16:19], a[120:127], v9
    ds_read_b128 v[16:19], v0 offset:8192
    v_smfmac_f32_16x16x64_bf16 v[44:47], v[20:23], a[184:191], v9
    v_smfmac_f32_16x16x64_bf16 v[40:43], v[20:23], a[128:135], v9
    s_waitcnt lgkmcnt(2)
    v_smfmac_f32_16x16x64_bf16 v[44:47], v[24:27], v[48:55], v9
    ds_read_b128 v[48:51], v1 offset:34816
    v_smfmac_f32_16x16x64_bf16 v[32:35], v[24:27], v[80:87], v9
    s_waitcnt lgkmcnt(2)
    v_smfmac_f32_16x16x64_bf16 v[40:43], v[24:27], v[72:79], v9
    v_smfmac_f32_16x16x64_bf16 v[40:43], v[28:31], a[136:143], v9
    ds_read_b128 v[52:55], v1 offset:35840
    s_waitcnt lgkmcnt(2)
    v_smfmac_f32_16x16x64_bf16 v[40:43], v[16:19], a[144:151], v9
    v_smfmac_f32_16x16x64_bf16 v[44:47], v[28:31], a[192:199], v9
    ds_read_b128 v[72:75], v1 offset:32768
    v_smfmac_f32_16x16x64_bf16 v[36:39], v[20:23], v[136:143], v9
    ds_read_b128 v[76:79], v1 offset:33792
    v_add_f32 v40, v40, v42
    v_smfmac_f32_16x16x64_bf16 v[32:35], v[28:31], v[88:95], v9
    v_add_f32 v41, v41, v43
    v_smfmac_f32_16x16x64_bf16 v[44:47], v[16:19], a[200:207], v9
    v_cvt_pk_bf16_f32 v12, v40, v41
    v_smfmac_f32_16x16x64_bf16 v[36:39], v[24:27], v[144:151], v9
    v_smfmac_f32_16x16x64_bf16 v[36:39], v[28:31], v[152:159], v9
    s_waitcnt lgkmcnt(0)
    v_smfmac_f32_16x16x64_bf16 v[32:35], v[16:19], v[72:79], v9
    v_add_f32 v45, v45, v47
    v_smfmac_f32_16x16x64_bf16 v[36:39], v[16:19], v[48:55], v9
    v_cmp_u_f32 vcc, v40, v41
    v_add_f32 v44, v44, v46
    v_mfma_f32_16x16x16_bf16 v[40:43], v[12:13], v[8:9], 0
    v_cvt_pk_bf16_f32 v12, v44, v45
    v_add_f32 v32, v32, v34
    v_add_f32 v33, v33, v35
    v_mfma_f32_16x16x16_bf16 v[44:47], v[12:13], v[8:9], 0
    s_cbranch_vccnz tredo_108l
tredo_108lr:
    v_cvt_pk_bf16_f32 v32, v32, v33
    v_add_f32 v36, v36, v38
    v_add_f32 v37, v37, v39
    v_cvt_pk_bf16_f32 v33, v36, v37
    v_cvt_pk_bf16_f32 v40, v40, v41
    v_cvt_pk_bf16_f32 v41, v42, v43
    s_nop 0
    v_cvt_pk_bf16_f32 v42, v44, v45
    v_cvt_pk_bf16_f32 v43, v46, v47
    v_cndmask_b32 v34, v40, v42, s[94:95]
    v_cndmask_b32 v35, v41, v43, s[94:95]
    buffer_store_dwordx4 v[32:35], v0, s[32:35], s77 offen sc1
    s_endpgm
ttop_110a:
    v_lshlrev_b32 v56, 3, v0
    v_and_b32 v57, 0x780, v56
    s_mov_b32 s57, 133120
    s_mov_b32 s58, 141312
wteam_111:
    buffer_load_dword v58, v56, s[32:35], s57 offen sc1
    buffer_load_dword v59, v57, s[32:35], s58 offen sc1
    s_sub_i32 s54, s54, 1
    s_cmp_lt_i32 s54, 0
    s_waitcnt vmcnt(0)
    s_cbranch_scc1 wteamd_112
    v_and_b32 v58, v58, v59
    v_cmp_eq_u32 vcc, 0, v58
    s_cbranch_vccz wteamd_112
    s_sleep 2
    s_branch wteam_111
wteamd_112:
    s_branch ttop_110b
tp_115:
    buffer_load_dwordx4 v[56:59], v0, s[32:35], s68 offen offset:0 sc1
    buffer_load_dwordx4 v[60:63], v0, s[32:35], s68 offen offset:1024 sc1
    buffer_load_dwordx4 v[64:67], v0, s[32:35], s68 offen offset:2048 sc1
    buffer_load_dwordx4 v[68:71], v0, s[32:35], s68 offen offset:3072 sc1
    s_sub_i32 s54, s54, 1
    s_cmp_lt_i32 s54, 0
    s_cselect_b64 s[96:97], 0, -1
    s_waitcnt vmcnt(3) lgkmcnt(4)
    v_mfma_f32_16x16x32_bf16 v[20:23], v[16:19], v[56:59], 0
    s_waitcnt vmcnt(2)
    v_mfma_f32_16x16x32_bf16 v[20:23], v[16:19], v[60:63], v[20:23]
    s_waitcnt vmcnt(1)
    v_mfma_f32_16x16x32_bf16 v[20:23], v[16:19], v[64:67], v[20:23]
    s_waitcnt vmcnt(0)
    v_mfma_f32_16x16x32_bf16 v[20:23], v[16:19], v[68:71], v[20:23]
    s_nop 7
    v_add_f32_dpp v20, v20, v20 row_ror:8 row_mask:0xf bank_mask:0xf
    v_add_f32_dpp v21, v21, v21 row_ror:8 row_mask:0xf bank_mask:0xf
    v_cvt_pk_bf16_f32 v20, v20, v21
    v_cmp_u_f32 vcc, v21, v21
    buffer_store_dword v20, v4, s[32:35], s81 offen sc1
    s_and_b64 vcc, vcc, s[96:97]
    s_cbranch_vccnz tp_115
    s_branch tpd_116
tredo_108l:
    s_cmp_lt_i32 s49, 1
    s_cbranch_scc1 tredo_108lr
tredo_108:
    s_sub_i32 s49, s49, 1
    s_cmp_lt_i32 s49, 0
    s_cbranch_scc1 tredo_108r
    s_mov_b32 s45, s69
    s_waitcnt lgkmcnt(0)
    s_nop 7
    v_add_u32 v1, s63, v0
    v_and_b32 v2, 0x7ffff, v2
    v_or_b32 v2, s51, v2
    v_mov_b64 v[32:33], 0
    v_mov_b64 v[34:35], 0
    v_mov_b64 v[36:37], 0
    v_mov_b64 v[38:39], 0
    v_mov_b64 v[40:41], 0
    v_mov_b64 v[42:43], 0
    v_mov_b64 v[44:45], 0
    v_mov_b64 v[46:47], 0
    ds_read_b128 v[72:75], v1 offset:16384
    ds_read_b128 v[76:79], v1 offset:17408
    ds_read_b128 v[48:51], v1 offset:18432
    ds_read_b128 v[52:55], v1 offset:19456
    s_barrier
    s_branch tm_109
tcls3_90:
    buffer_load_dwordx4 v[64:67], v0, s[32:35], s73 offen offset:0 sc1
    buffer_load_dwordx4 v[68:71], v0, s[32:35], s73 offen offset:1024 sc1
    s_barrier
    buffer_store_dwordx4 v[28:31], v0, s[32:35], s45 offen sc1
    v_add_u32 v1, s63, v0
    v_and_b32 v2, 0x7ffff, v2
    v_or_b32 v2, s51, v2
    v_mov_b64 v[32:33], 0
    v_mov_b64 v[34:35], 0
    v_mov_b64 v[36:37], 0
    v_mov_b64 v[38:39], 0
    v_mov_b64 v[40:41], 0
    v_mov_b64 v[42:43], 0
    v_mov_b64 v[44:45], 0
    v_mov_b64 v[46:47], 0
    v_lshlrev_b32 v12, 3, v0
    v_and_b32 v14, 0x180, v12
    ds_read_b128 v[72:75], v1 offset:16384
    ds_read_b128 v[76:79], v1 offset:17408
    ds_read_b128 v[48:51], v1 offset:18432
    ds_read_b128 v[52:55], v1 offset:19456
    s_waitcnt lgkmcnt(0)
    s_branch tw_117
.p2align 6
ttop_120:
    s_and_b32 s57, s64, 3
    s_lshl_b32 s58, s57, 14
    s_add_u32 s81, s70, s58
    s_add_u32 s85, s58, 7405568
    s_xor_b32 s51, s57, 2
    s_lshl_b32 s51, s51, 19
    s_add_u32 s72, s72, 786432
    s_add_u32 s73, s73, 786432
    s_mov_b32 s45, s77
    s_add_u32 s77, s77, 131072
    s_sub_u32 s99, s64, 1
    v_add_u32 v1, s63, v0
    v_and_b32 v2, 0x7ffff, v2
    v_or_b32 v2, s51, v2
    v_mov_b64 v[32:33], 0
    v_mov_b64 v[34:35], 0
    v_mov_b64 v[36:37], 0
    v_mov_b64 v[38:39], 0
    v_mov_b64 v[40:41], 0
    v_mov_b64 v[42:43], 0
    v_mov_b64 v[44:45], 0
    v_mov_b64 v[46:47], 0
    v_lshlrev_b32 v12, 3, v0
    v_and_b32 v14, 0x180, v12
    ds_read_b128 v[72:75], v1 offset:16384
    ds_read_b128 v[76:79], v1 offset:17408
    ds_read_b128 v[48:51], v1 offset:18432
    ds_read_b128 v[52:55], v1 offset:19456
    s_waitcnt vmcnt(18)
    v_readlane_b32 s80, v4, 0
    v_readlane_b32 s57, v4, 1
    v_readlane_b32 s58, v4, 2
    v_readlane_b32 s59, v4, 3
    s_min_u32 s80, s80, s57
    s_min_u32 s58, s58, s59
    s_min_u32 s80, s80, s58
    s_add_u32 s57, s64, 2
    s_min_u32 s57, s57, 64
    s_cmp_lt_u32 s80, s57
    s_cbranch_scc1 t3p_122
t3ok_121:
    s_cmp_lt_u32 s64, 63
    s_cselect_b32 s57, 786432, 0
    s_add_u32 s83, s83, s57
    s_nop 15
    s_nop 8
    s_mov_b64 exec, 1
    buffer_load_dword v56, off, s[32:35], s47 sc1
    s_nop 5
    buffer_load_dword v57, off, s[32:35], s47 sc1
    s_nop 5
    buffer_load_dword v58, off, s[32:35], s47 sc1
    s_nop 5
    buffer_load_dword v59, off, s[32:35], s47 sc1
    s_nop 5
    buffer_load_dword v60, off, s[32:35], s47 sc1
    s_nop 5
    buffer_load_dword v61, off, s[32:35], s47 sc1
    s_nop 5
    buffer_load_dword v62, off, s[32:35], s47 sc1
tk_123:
    s_waitcnt vmcnt(6)
    v_cmp_eq_u32 vcc, s64, v56
    s_sub_i32 s54, s54, 1
    s_cmp_lt_i32 s54, 0
    buffer_load_dword v56, off, s[32:35], s47 sc1
    s_cbranch_vccnz tkd_124
    s_waitcnt vmcnt(6)
    v_cmp_eq_u32 vcc, s64, v57
    buffer_load_dword v57, off, s[32:35], s47 sc1
    s_cbranch_vccnz tkd_124
    s_waitcnt vmcnt(6)
    v_cmp_eq_u32 vcc, s64, v58
    buffer_load_dword v58, off, s[32:35], s47 sc1
    s_cbranch_vccnz tkd_124
    s_waitcnt vmcnt(6)
    v_cmp_eq_u32 vcc, s64, v59
    buffer_load_dword v59, off, s[32:35], s47 sc1
    s_cbranch_vccnz tkd_124
    s_waitcnt vmcnt(6)
    v_cmp_eq_u32 vcc, s64, v60
    buffer_load_dword v60, off, s[32:35], s47 sc1
    s_cbranch_vccnz tkd_124
    s_waitcnt vmcnt(6)
    v_cmp_eq_u32 vcc, s64, v61
    buffer_load_dword v61, off, s[32:35], s47 sc1
    s_cbranch_vccnz tkd_124
    s_waitcnt vmcnt(6)
    v_cmp_eq_u32 vcc, s64, v62
    buffer_load_dword v62, off, s[32:35], s47 sc1
    s_cbranch_vccnz tkd_124
    s_waitcnt vmcnt(6)
    v_cmp_eq_u32 vcc, s64, v56
    s_sub_i32 s54, s54, 1
    s_cmp_lt_i32 s54, 0
    buffer_load_dword v56, off, s[32:35], s47 sc1
    s_cbranch_vccnz tkd_124
    s_waitcnt vmcnt(6)
    v_cmp_eq_u32 vcc, s64, v57
    buffer_load_dword v57, off, s[32:35], s47 sc1
    s_cbranch_vccnz tkd_124
    s_waitcnt vmcnt(6)
    v_cmp_eq_u32 vcc, s64, v58
    buffer_load_dword v58, off, s[32:35], s47 sc1
    s_cbranch_vccnz tkd_124
    s_waitcnt vmcnt(6)
    v_cmp_eq_u32 vcc, s64, v59
    buffer_load_dword v59, off, s[32:35], s47 sc1
    s_cbranch_vccnz tkd_124
    s_waitcnt vmcnt(6)
    v_cmp_eq_u32 vcc, s64, v60
    buffer_load_dword v60, off, s[32:35], s47 sc1
    s_cbranch_vccnz tkd_124
    s_waitcnt vmcnt(6)
    v_cmp_eq_u32 vcc, s64, v61
    buffer_load_dword v61, off, s[32:35], s47 sc1
    s_cbranch_vccnz tkd_124
    s_waitcnt vmcnt(6)
    v_cmp_eq_u32 vcc, s64, v62
    buffer_load_dword v62, off, s[32:35], s47 sc1
    s_cbranch_vccnz tkd_124
    s_cbranch_scc0 tk_123
tkd_124:
    s_mov_b64 exec, -1
    s_mov_b32 m0, 0
    s_nop 0
    buffer_load_dwordx4 v0, s[32:35], s85 offen offset:0 sc1 lds
    buffer_load_dwordx4 v0, s[32:35], s85 offen offset:1024 sc1 lds
    buffer_load_dwordx4 v0, s[32:35], s85 offen offset:2048 sc1 lds
    buffer_load_dwordx4 v0, s[32:35], s85 offen offset:3072 sc1 lds
    s_nop 4
tm_119:
    s_add_u32 m0, s56, 4096
    s_add_u32 s57, s85, m0
    s_add_u32 s58, s85, 8192
    s_barrier
    buffer_load_dwordx4 v0, s[32:35], s57 offen sc1 lds
    s_nop 5
    buffer_load_dwordx4 v[56:59], v0, s[32:35], s72 offen offset:0 sc1
    buffer_load_dwordx4 v[60:63], v0, s[32:35], s72 offen offset:1024 sc1
    s_barrier
    buffer_load_dwordx4 v[64:67], v0, s[32:35], s73 offen offset:0 sc1
    buffer_load_dwordx4 v[68:71], v0, s[32:35], s73 offen offset:1024 sc1
    s_barrier
    buffer_store_dwordx4 v[28:31], v0, s[32:35], s45 offen sc1
    s_cmp_eq_u32 s64, 63
    s_cbranch_scc1 tw_117l
    s_waitcnt lgkmcnt(0) vmcnt(6)
tw_117:
    s_barrier
    buffer_load_dword v4, v12, s[32:35], s83 offen sc1
    ds_read_b128 v[16:19], v0 offset:0
    buffer_load_dword v4, v14, s[32:35], s79 offen sc1
    ds_read_b128 v[24:27], v0 offset:2048
    ds_read_b128 v[20:23], v0 offset:1024
    buffer_store_dword v15, v2, s[32:35], s37 offen sc1
    s_waitcnt lgkmcnt(2)
    v_smfmac_f32_16x16x64_bf16 v[32:35], v[16:19], v[72:79], v9
    ds_read_b128 v[76:79], v1 offset:33792
    v_smfmac_f32_16x16x64_bf16 v[36:39], v[16:19], v[48:55], v9
    ds_read_b128 v[52:55], v1 offset:35840
    s_waitcnt lgkmcnt(2)
    v_smfmac_f32_16x16x64_bf16 v[32:35], v[20:23], a[0:7], v9
    ds_read_b128 v[28:31], v0 offset:3072
    v_smfmac_f32_16x16x64_bf16 v[36:39], v[20:23], a[48:55], v9
    ds_read_b128 v[48:51], v1 offset:34816
    v_smfmac_f32_16x16x64_bf16 v[40:43], v[16:19], a[96:103], v9
    ds_read_b128 v[72:75], v1 offset:32768
    v_smfmac_f32_16x16x64_bf16 v[44:47], v[16:19], a[152:159], v9
    s_waitcnt vmcnt(8)
    s_barrier
    v_smfmac_f32_16x16x64_bf16 v[32:35], v[24:27], a[8:15], v9
    v_smfmac_f32_16x16x64_bf16 v[36:39], v[24:27], a[56:63], v9
    ds_read_b128 v[16:19], v0 offset:4096
    s_waitcnt lgkmcnt(1)
    v_smfmac_f32_16x16x64_bf16 v[40:43], v[20:23], v[72:79], v9
    ds_read_b128 v[72:75], v1 offset:49152
    v_smfmac_f32_16x16x64_bf16 v[44:47], v[20:23], v[48:55], v9
    ds_read_b128 v[76:79], v1 offset:50176
    v_smfmac_f32_16x16x64_bf16 v[32:35], v[28:31], a[16:23], v9
    ds_read_b128 v[48:51], v1 offset:51200
    v_smfmac_f32_16x16x64_bf16 v[36:39], v[28:31], a[64:71], v9
    ds_read_b128 v[52:55], v1 offset:52224
    v_add_u32 v1, 0x10000, v1
    v_smfmac_f32_16x16x64_bf16 v[40:43], v[24:27], a[104:111], v9
    ds_read_b128 v[20:23], v0 offset:5120
    v_smfmac_f32_16x16x64_bf16 v[44:47], v[24:27], a[160:167], v9
    buffer_store_dword v15, v2, s[32:35], s36 offen sc1
    ds_read_b128 v[24:27], v0 offset:6144
    s_waitcnt lgkmcnt(4)
    v_smfmac_f32_16x16x64_bf16 v[32:35], v[16:19], v[72:79], v9
    ds_read_b128 v[72:75], v1 offset:0
    s_waitcnt lgkmcnt(3)
    v_smfmac_f32_16x16x64_bf16 v[36:39], v[16:19], v[48:55], v9
    ds_read_b128 v[76:79], v1 offset:1024
    v_smfmac_f32_16x16x64_bf16 v[40:43], v[28:31], a[112:119], v9
    buffer_store_dword v15, v2, s[32:35], s40 offen sc1
    v_smfmac_f32_16x16x64_bf16 v[44:47], v[28:31], a[168:175], v9
    ds_read_b128 v[48:51], v1 offset:2048
    s_waitcnt lgkmcnt(4)
    v_smfmac_f32_16x16x64_bf16 v[32:35], v[20:23], a[24:31], v9
    ds_read_b128 v[52:55], v1 offset:3072
    v_smfmac_f32_16x16x64_bf16 v[36:39], v[20:23], a[72:79], v9
    v_smfmac_f32_16x16x64_bf16 v[40:43], v[16:19], a[120:127], v9
    buffer_store_dword v15, v2, s[32:35], s41 offen sc1
    v_smfmac_f32_16x16x64_bf16 v[44:47], v[16:19], a[176:183], v9
    ds_read_b128 v[28:31], v0 offset:7168
    ds_read_b128 v[16:19], v0 offset:8192
    s_waitcnt lgkmcnt(4)
    v_smfmac_f32_16x16x64_bf16 v[32:35], v[24:27], v[72:79], v9
    buffer_store_dword v15, v2, s[32:35], s39 offen sc1
    s_waitcnt lgkmcnt(2)
    v_smfmac_f32_16x16x64_bf16 v[36:39], v[24:27], v[48:55], v9
    ds_read_b128 v[52:55], v1 offset:19456
    ds_read_b128 v[72:75], v1 offset:16384
    v_smfmac_f32_16x16x64_bf16 v[40:43], v[20:23], a[128:135], v9
    buffer_store_dword v15, v2, s[32:35], s42 offen sc1
    v_smfmac_f32_16x16x64_bf16 v[44:47], v[20:23], a[184:191], v9
    ds_read_b128 v[48:51], v1 offset:18432
    ds_read_b128 v[76:79], v1 offset:17408
    s_waitcnt lgkmcnt(5)
    v_smfmac_f32_16x16x64_bf16 v[32:35], v[28:31], a[32:39], v9
    buffer_store_dword v15, v2, s[32:35], s38 offen sc1
    v_smfmac_f32_16x16x64_bf16 v[36:39], v[28:31], a[80:87], v9
    s_waitcnt lgkmcnt(4)
    v_smfmac_f32_16x16x64_bf16 v[32:35], v[16:19], a[40:47], v9
    buffer_store_dword v15, v2, s[32:35], s43 offen sc1
    v_smfmac_f32_16x16x64_bf16 v[36:39], v[16:19], a[88:95], v9
    s_waitcnt lgkmcnt(0)
    v_smfmac_f32_16x16x64_bf16 v[40:43], v[24:27], v[72:79], v9
    buffer_store_dword v15, v2, s[32:35], s44 offen sc1
    v_add_f32 v33, v33, v35
    v_smfmac_f32_16x16x64_bf16 v[44:47], v[24:27], v[48:55], v9
    v_add_f32 v32, v32, v34
    v_smfmac_f32_16x16x64_bf16 v[40:43], v[28:31], a[136:143], v9
    ds_read_b128 v[72:75], v1 offset:32768
    v_add_f32 v36, v36, v38
    v_smfmac_f32_16x16x64_bf16 v[44:47], v[28:31], a[192:199], v9
    v_add_f32 v37, v37, v39
    v_smfmac_f32_16x16x64_bf16 v[40:43], v[16:19], a[144:151], v9
    v_cvt_pk_bf16_f32 v12, v32, v33
    v_mov_b64 v[48:49], 0
    v_cmp_u_f32 vcc, v32, v33
    v_mfma_f32_16x16x16_bf16 v[32:35], v[12:13], v[8:9], 0
    v_cvt_pk_bf16_f32 v12, v36, v37
    v_mov_b64 v[54:55], 0
    v_add_f32 v41, v41, v43
    v_mfma_f32_16x16x16_bf16 v[36:39], v[12:13], v[8:9], 0
    v_add_f32 v40, v40, v42
    v_cvt_pk_bf16_f32 v12, v40, v41
    v_mov_b64 v[52:53], 0
    v_smfmac_f32_16x16x64_bf16 v[44:47], v[16:19], a[200:207], v9
    ds_read_b128 v[76:79], v1 offset:33792
    v_cvt_pk_bf16_f32 v32, v32, v33
    v_cvt_pk_bf16_f32 v33, v34, v35
    v_cvt_pk_bf16_f32 v34, v36, v37
    v_mfma_f32_16x16x16_bf16 v[40:43], v[12:13], v[8:9], 0
    v_cvt_pk_bf16_f32 v35, v38, v39
    v_mov_b64 v[50:51], 0
    v_add_f32 v45, v45, v47
    s_waitcnt vmcnt(15)
    v_mfma_f32_16x16x32_bf16 v[56:59], v[56:59], v[32:35], 0
    v_add_f32 v44, v44, v46
    v_cvt_pk_bf16_f32 v12, v44, v45
    v_smfmac_f32_16x16x64_bf16 v[48:51], v[20:23], a[248:255], v9
    s_cbranch_vccnz tredo_118
tredo_118r:
    v_mfma_f32_16x16x16_bf16 v[44:47], v[12:13], v[8:9], 0
    s_nop 0
    ds_write_b128 v3, v[56:59] offset:9216
    v_cvt_pk_bf16_f32 v40, v40, v41
    v_cvt_pk_bf16_f32 v41, v42, v43
    s_waitcnt vmcnt(14)
    v_mfma_f32_16x16x32_bf16 v[60:63], v[60:63], v[32:35], 0
    s_nop 1
    v_cvt_pk_bf16_f32 v43, v46, v47
    v_cvt_pk_bf16_f32 v42, v44, v45
    v_smfmac_f32_16x16x64_bf16 v[52:55], v[20:23], v[136:143], v9
    v_mfma_f32_16x16x32_bf16 v[44:47], v[40:43], v[32:35], 0
    ds_write_b128 v3, v[60:63] offset:9728
    v_smfmac_f32_16x16x64_bf16 v[48:51], v[24:27], v[80:87], v9
    s_nop 4
    ds_write_b64 v5, v[44:45] offset:13312
    v_smfmac_f32_16x16x64_bf16 v[52:55], v[24:27], v[144:151], v9
    ds_read_b128 v[24:27], v0 offset:1024
    v_smfmac_f32_16x16x64_bf16 v[48:51], v[28:31], v[88:95], v9
    ds_read_b128 v[20:23], v0 offset:0
    v_smfmac_f32_16x16x64_bf16 v[52:55], v[28:31], v[152:159], v9
    ds_read_b128 v[28:31], v0 offset:2048
    s_waitcnt lgkmcnt(3)
    s_barrier
    v_smfmac_f32_16x16x64_bf16 v[48:51], v[16:19], v[72:79], v9
    ds_read_b64 v[46:47], v6 offset:14336
    ds_read_b64 v[44:45], v6 offset:13312
    s_waitcnt lgkmcnt(3)
    v_smfmac_f32_16x16x64_bf16 v[48:51], v[20:23], a[208:215], v9
    ds_read_b128 v[32:35], v6 offset:11264
    v_smfmac_f32_16x16x64_bf16 v[52:55], v[20:23], v[96:103], v9
    ds_read_b128 v[20:23], v0 offset:3072
    v_smfmac_f32_16x16x64_bf16 v[48:51], v[24:27], a[216:223], v9
    ds_read_b128 v[36:39], v6 offset:12288
    v_smfmac_f32_16x16x64_bf16 v[52:55], v[24:27], v[104:111], v9
    ds_read_b128 v[60:63], v6 offset:10240
    s_waitcnt lgkmcnt(4)
    v_add_f32 v45, v45, v47
    v_add_f32 v44, v44, v46
    v_smfmac_f32_16x16x64_bf16 v[48:51], v[28:31], a[224:231], v9
    ds_read_b128 v[56:59], v6 offset:9216
    v_add_f32_dpp v44, v44, v44 quad_perm:[2,3,0,1] row_mask:0xf bank_mask:0xf
    v_smfmac_f32_16x16x64_bf16 v[52:55], v[28:31], v[112:119], v9
    ds_read_b128 v[72:75], v1 offset:34816
    s_waitcnt lgkmcnt(3)
    v_add_f32 v35, v35, v39
    v_smfmac_f32_16x16x64_bf16 v[48:51], v[20:23], a[232:239], v9
    ds_read_b128 v[24:27], v0 offset:4096
    v_add_f32 v34, v34, v38
    v_smfmac_f32_16x16x64_bf16 v[52:55], v[20:23], v[120:127], v9
    ds_read_b128 v[76:79], v1 offset:35840
    v_add_f32 v33, v33, v37
    v_add_f32 v32, v32, v36
    s_waitcnt lgkmcnt(3)
    v_add_f32 v59, v59, v63
    v_add_f32 v59, v59, v35
    v_add_f32_dpp v45, v45, v45 quad_perm:[2,3,0,1] row_mask:0xf bank_mask:0xf
    v_add_f32 v58, v58, v62
    v_add_f32 v56, v56, v60
    v_add_f32 v56, v56, v32
    v_add_f32 v57, v57, v61
    v_add_f32 v58, v58, v34
    v_add_f32 v57, v57, v33
    v_max3_f32 v62, v56, v57, v58
    v_max_f32 v62, v62, v59
    s_waitcnt lgkmcnt(0)
    v_smfmac_f32_16x16x64_bf16 v[52:55], v[16:19], v[72:79], v9
    ds_read_b128 v[76:79], v1 offset:50176
    v_max_f32_dpp v62, v62, v62 quad_perm:[2,3,0,1] row_mask:0xf bank_mask:0xf
    v_max3_f32 v62, v62, v44, v45
    v_mov_b32 v63, v62
    v_smfmac_f32_16x16x64_bf16 v[48:51], v[24:27], a[240:247], v9
    v_permlane32_swap_b32 v62, v63
    v_max_f32 v62, v62, v63
    v_mov_b32 v63, v62
    v_smfmac_f32_16x16x64_bf16 v[52:55], v[24:27], v[128:135], v9
    ds_read_b128 v[72:75], v1 offset:49152
    v_permlane16_swap_b32 v62, v63
    v_max_f32 v62, v62, v63
    v_add_f32 v48, v48, v50
    v_mul_f32 v63, s75, v62
    v_fma_f32 v45, v45, s75, -v63
    v_fma_f32 v59, v59, s75, -v63
    v_exp_f32 v59, v59
    v_add_f32 v52, v52, v54
    v_exp_f32 v45, v45
    v_fma_f32 v58, v58, s75, -v63
    v_add_f32 v53, v53, v55
    v_exp_f32 v58, v58
    v_fma_f32 v57, v57, s75, -v63
    v_fma_f32 v44, v44, s75, -v63
    v_exp_f32 v44, v44
    v_exp_f32 v57, v57
    v_add_f32 v49, v49, v51
    v_cvt_pk_bf16_f32 v44, v44, v45
    v_cndmask_b32 v46, v44, 0, s[94:95]
    v_cvt_pk_bf16_f32 v48, v48, v49
    v_cndmask_b32 v47, 0, v44, s[94:95]
    v_fma_f32 v56, v56, s75, -v63
    v_cvt_pk_bf16_f32 v61, v58, v59
    v_cvt_pk_bf16_f32 v49, v52, v53
    v_exp_f32 v56, v56
    v_mfma_f32_16x16x16_bf16 v[32:35], v[48:49], v[46:47], 0
    v_cvt_pk_bf16_f32 v60, v56, v57
    v_mov_b32_dpp v57, v61 quad_perm:[0,1,0,1] row_mask:0xf bank_mask:0xf
    v_mfma_f32_16x16x16_bf16 v[36:39], v[10:11], v[46:47], 0
    v_mov_b32_dpp v56, v60 quad_perm:[0,1,0,1] row_mask:0xf bank_mask:0xf
    v_mov_b32_dpp v58, v60 quad_perm:[2,3,2,3] row_mask:0xf bank_mask:0xf
    v_mov_b32_dpp v59, v61 quad_perm:[2,3,2,3] row_mask:0xf bank_mask:0xf
    v_mfma_f32_16x16x16_bf16 v[36:39], v[10:11], v[56:57], v[36:39]
    v_mfma_f32_16x16x16_bf16 v[36:39], v[10:11], v[58:59], v[36:39]
    v_mov_b32 v12, 0
    s_waitcnt vmcnt(12)
    v_mfma_f32_16x16x32_bf16 v[68:71], v[68:71], v[56:59], v[32:35]
    ds_read_b128 v[20:23], v1 offset:52224
    v_mfma_f32_16x16x32_bf16 v[64:67], v[64:67], v[56:59], v[32:35]
    s_barrier
    v_rcp_f32 v14, v36
    v_mfma_f32_16x16x16_bf16 v[32:35], v[12:13], v[10:11], 0
    ds_read_b128 v[16:19], v1 offset:51200
    s_nop 3
    v_cndmask_b32 v65, v65, v69, s[94:95]
    v_cndmask_b32 v67, v67, v71, s[94:95]
    v_cndmask_b32 v64, v64, v68, s[94:95]
    v_mul_f32 v64, v64, v14
    v_mul_f32 v65, v65, v14
    v_cvt_pk_bf16_f32 v64, v64, v65
    v_cndmask_b32 v66, v66, v70, s[94:95]
    v_mul_f32 v66, v66, v14
    v_mul_f32 v67, v67, v14
    v_cvt_pk_bf16_f32 v65, v66, v67
    v_mfma_f32_16x16x16_bf16 v[56:59], v[12:13], v[10:11], 0
    ds_write_b64 v7, v[64:65] offset:9216
    v_cndmask_b32 v31, v41, v43, s[94:95]
    v_cndmask_b32 v30, v40, v42, s[94:95]
    v_mfma_f32_16x16x16_bf16 v[44:47], v[12:13], v[10:11], 0
    v_add_u32 v1, 0x10000, v1
    v_mfma_f32_16x16x16_bf16 v[24:27], v[12:13], v[10:11], 0
    v_mfma_f32_16x16x16_bf16 v[52:55], v[12:13], v[10:11], 0
    s_waitcnt lgkmcnt(0)
    s_barrier
    v_mfma_f32_16x16x16_bf16 v[40:43], v[12:13], v[10:11], 0
    ds_read_b128 v[64:67], v6 offset:9216
    v_mov_b64 v[28:29], v[48:49]
    v_mfma_f32_16x16x16_bf16 v[48:51], v[12:13], v[10:11], 0
    ds_read_b128 v[68:71], v6 offset:10240
    v_mfma_f32_16x16x16_bf16 v[60:63], v[12:13], v[10:11], 0
    v_mfma_f32_16x16x16_bf16 v[36:39], v[12:13], v[10:11], 0
    v_xor_b32 v2, 0x100000, v2
    s_waitcnt lgkmcnt(1)
    v_smfmac_f32_16x16x64_bf16 v[24:27], v[64:67], v[72:79], v9
    s_waitcnt lgkmcnt(0)
    v_smfmac_f32_16x16x64_bf16 v[24:27], v[68:71], v[16:23], v9
    ds_read_b128 v[20:23], v1 offset:3072
    v_smfmac_f32_16x16x64_bf16 v[52:55], v[64:67], v[160:167], v9
    ds_read_b128 v[16:19], v1 offset:2048
    v_smfmac_f32_16x16x64_bf16 v[52:55], v[68:71], v[168:175], v9
    ds_read_b128 v[72:75], v1 offset:0
    v_add_f32 v25, v25, v27
    v_smfmac_f32_16x16x64_bf16 v[40:43], v[64:67], v[176:183], v9
    ds_read_b128 v[76:79], v1 offset:1024
    v_add_f32 v24, v24, v26
    v_cvt_pk_bf16_f32 v24, v24, v25
    v_smfmac_f32_16x16x64_bf16 v[40:43], v[68:71], v[184:191], v9
    v_smfmac_f32_16x16x64_bf16 v[60:63], v[64:67], v[192:199], v9
    buffer_store_dword v24, v2, s[32:35], s36 offen sc1
    v_add_f32 v52, v52, v54
    v_add_f32 v53, v53, v55
    v_smfmac_f32_16x16x64_bf16 v[60:63], v[68:71], v[200:207], v9
    v_add_f32 v40, v40, v42
    v_add_f32 v41, v41, v43
    v_cvt_pk_bf16_f32 v40, v40, v41
    v_cvt_pk_bf16_f32 v52, v52, v53
    s_waitcnt lgkmcnt(0)
    v_smfmac_f32_16x16x64_bf16 v[44:47], v[64:67], v[72:79], v9
    buffer_store_dword v52, v2, s[32:35], s37 offen sc1
    v_add_f32 v61, v61, v63
    v_add_f32 v60, v60, v62
    v_smfmac_f32_16x16x64_bf16 v[44:47], v[68:71], v[16:23], v9
    ds_read_b128 v[20:23], v1 offset:19456
    v_smfmac_f32_16x16x64_bf16 v[48:51], v[64:67], v[208:215], v9
    buffer_store_dword v40, v2, s[32:35], s38 offen sc1
    v_cvt_pk_bf16_f32 v60, v60, v61
    v_smfmac_f32_16x16x64_bf16 v[48:51], v[68:71], v[216:223], v9
    ds_read_b128 v[72:75], v1 offset:16384
    ds_read_b128 v[76:79], v1 offset:17408
    v_smfmac_f32_16x16x64_bf16 v[56:59], v[64:67], v[224:231], v9
    buffer_store_dword v60, v2, s[32:35], s39 offen sc1
    v_add_f32 v44, v44, v46
    v_add_f32 v45, v45, v47
    v_cvt_pk_bf16_f32 v44, v44, v45
    v_smfmac_f32_16x16x64_bf16 v[56:59], v[68:71], v[232:239], v9
    ds_read_b128 v[16:19], v1 offset:18432
    v_smfmac_f32_16x16x64_bf16 v[32:35], v[64:67], v[240:247], v9
    buffer_store_dword v44, v2, s[32:35], s40 offen sc1
    v_add_f32 v48, v48, v50
    v_add_f32 v49, v49, v51
    v_cvt_pk_bf16_f32 v48, v48, v49
    v_smfmac_f32_16x16x64_bf16 v[32:35], v[68:71], v[248:255], v9
    s_waitcnt lgkmcnt(1)
    v_smfmac_f32_16x16x64_bf16 v[36:39], v[64:67], v[72:79], v9
    buffer_store_dword v48, v2, s[32:35], s41 offen sc1
    v_add_f32 v57, v57, v59
    v_add_f32 v56, v56, v58
    v_cvt_pk_bf16_f32 v56, v56, v57
    s_waitcnt lgkmcnt(0)
    v_smfmac_f32_16x16x64_bf16 v[36:39], v[68:71], v[16:23], v9
    buffer_store_dword v56, v2, s[32:35], s42 offen sc1
    v_add_f32 v32, v32, v34
    v_add_f32 v33, v33, v35
    v_cvt_pk_bf16_f32 v32, v32, v33
    buffer_store_dword v32, v2, s[32:35], s43 offen sc1
    s_nop 0
    v_add_f32 v36, v36, v38
    v_add_f32 v37, v37, v39
    v_cvt_pk_bf16_f32 v36, v36, v37
    buffer_store_dword v36, v2, s[32:35], s44 offen sc1
    s_add_u32 s64, s64, 1
    s_branch ttop_120
tw_117l:
    s_waitcnt lgkmcnt(0) vmcnt(6)
    s_barrier
    ds_read_b128 v[16:19], v0 offset:0
    ds_read_b128 v[20:23], v0 offset:1024
    ds_read_b128 v[52:55], v1 offset:35840
    ds_read_b128 v[24:27], v0 offset:2048
    s_waitcnt lgkmcnt(3)
    v_smfmac_f32_16x16x64_bf16 v[44:47], v[16:19], a[152:159], v9
    ds_read_b128 v[48:51], v1 offset:34816
    v_smfmac_f32_16x16x64_bf16 v[36:39], v[16:19], v[96:103], v9
    v_smfmac_f32_16x16x64_bf16 v[40:43], v[16:19], a[96:103], v9
    ds_read_b128 v[28:31], v0 offset:3072
    s_waitcnt lgkmcnt(2)
    v_smfmac_f32_16x16x64_bf16 v[44:47], v[24:27], a[160:167], v9
    ds_read_b128 v[76:79], v1 offset:33792
    v_smfmac_f32_16x16x64_bf16 v[40:43], v[24:27], a[104:111], v9
    ds_read_b128 v[72:75], v1 offset:32768
    s_waitcnt lgkmcnt(3)
    v_smfmac_f32_16x16x64_bf16 v[44:47], v[20:23], v[48:55], v9
    s_waitcnt vmcnt(5)
    s_barrier
    v_smfmac_f32_16x16x64_bf16 v[32:35], v[16:19], a[208:215], v9
    v_smfmac_f32_16x16x64_bf16 v[32:35], v[20:23], a[216:223], v9
    v_smfmac_f32_16x16x64_bf16 v[32:35], v[24:27], a[224:231], v9
    s_waitcnt lgkmcnt(2)
    v_smfmac_f32_16x16x64_bf16 v[32:35], v[28:31], a[232:239], v9
    ds_read_b128 v[16:19], v0 offset:4096
    v_smfmac_f32_16x16x64_bf16 v[36:39], v[20:23], v[104:111], v9
    s_waitcnt lgkmcnt(1)
    v_smfmac_f32_16x16x64_bf16 v[40:43], v[20:23], v[72:79], v9
    v_smfmac_f32_16x16x64_bf16 v[40:43], v[28:31], a[112:119], v9
    ds_read_b128 v[20:23], v0 offset:5120
    v_add_u32 v1, 0x10000, v1
    v_smfmac_f32_16x16x64_bf16 v[36:39], v[24:27], v[112:119], v9
    ds_read_b128 v[52:55], v1 offset:19456
    s_waitcnt lgkmcnt(2)
    v_smfmac_f32_16x16x64_bf16 v[32:35], v[16:19], a[240:247], v9
    ds_read_b128 v[24:27], v0 offset:6144
    v_smfmac_f32_16x16x64_bf16 v[44:47], v[28:31], a[168:175], v9
    v_smfmac_f32_16x16x64_bf16 v[36:39], v[28:31], v[120:127], v9
    ds_read_b128 v[28:31], v0 offset:7168
    v_smfmac_f32_16x16x64_bf16 v[44:47], v[16:19], a[176:183], v9
    ds_read_b128 v[76:79], v1 offset:17408
    v_smfmac_f32_16x16x64_bf16 v[36:39], v[16:19], v[128:135], v9
    ds_read_b128 v[48:51], v1 offset:18432
    s_waitcnt lgkmcnt(5)
    v_smfmac_f32_16x16x64_bf16 v[32:35], v[20:23], a[248:255], v9
    ds_read_b128 v[72:75], v1 offset:16384
    v_smfmac_f32_16x16x64_bf16 v[40:43], v[16:19], a[120:127], v9
    ds_read_b128 v[16:19], v0 offset:8192
    v_smfmac_f32_16x16x64_bf16 v[44:47], v[20:23], a[184:191], v9
    v_smfmac_f32_16x16x64_bf16 v[40:43], v[20:23], a[128:135], v9
    s_waitcnt lgkmcnt(2)
    v_smfmac_f32_16x16x64_bf16 v[44:47], v[24:27], v[48:55], v9
    ds_read_b128 v[48:51], v1 offset:34816
    v_smfmac_f32_16x16x64_bf16 v[32:35], v[24:27], v[80:87], v9
    s_waitcnt lgkmcnt(2)
    v_smfmac_f32_16x16x64_bf16 v[40:43], v[24:27], v[72:79], v9
    v_smfmac_f32_16x16x64_bf16 v[40:43], v[28:31], a[136:143], v9
    ds_read_b128 v[52:55], v1 offset:35840
    s_waitcnt lgkmcnt(2)
    v_smfmac_f32_16x16x64_bf16 v[40:43], v[16:19], a[144:151], v9
    v_smfmac_f32_16x16x64_bf16 v[44:47], v[28:31], a[192:199], v9
    ds_read_b128 v[72:75], v1 offset:32768
    v_smfmac_f32_16x16x64_bf16 v[36:39], v[20:23], v[136:143], v9
    ds_read_b128 v[76:79], v1 offset:33792
    v_add_f32 v40, v40, v42
    v_smfmac_f32_16x16x64_bf16 v[32:35], v[28:31], v[88:95], v9
    v_add_f32 v41, v41, v43
    v_smfmac_f32_16x16x64_bf16 v[44:47], v[16:19], a[200:207], v9
    v_cvt_pk_bf16_f32 v12, v40, v41
    v_smfmac_f32_16x16x64_bf16 v[36:39], v[24:27], v[144:151], v9
    v_smfmac_f32_16x16x64_bf16 v[36:39], v[28:31], v[152:159], v9
    s_waitcnt lgkmcnt(0)
    v_smfmac_f32_16x16x64_bf16 v[32:35], v[16:19], v[72:79], v9
    v_add_f32 v45, v45, v47
    v_smfmac_f32_16x16x64_bf16 v[36:39], v[16:19], v[48:55], v9
    v_cmp_u_f32 vcc, v40, v41
    v_add_f32 v44, v44, v46
    v_mfma_f32_16x16x16_bf16 v[40:43], v[12:13], v[8:9], 0
    v_cvt_pk_bf16_f32 v12, v44, v45
    v_add_f32 v32, v32, v34
    v_add_f32 v33, v33, v35
    v_mfma_f32_16x16x16_bf16 v[44:47], v[12:13], v[8:9], 0
    s_cbranch_vccnz tredo_118l
tredo_118lr:
    v_cvt_pk_bf16_f32 v32, v32, v33
    v_add_f32 v36, v36, v38
    v_add_f32 v37, v37, v39
    v_cvt_pk_bf16_f32 v33, v36, v37
    v_cvt_pk_bf16_f32 v40, v40, v41
    v_cvt_pk_bf16_f32 v41, v42, v43
    s_nop 0
    v_cvt_pk_bf16_f32 v42, v44, v45
    v_cvt_pk_bf16_f32 v43, v46, v47
    v_cndmask_b32 v34, v40, v42, s[94:95]
    v_cndmask_b32 v35, v41, v43, s[94:95]
    buffer_store_dwordx4 v[32:35], v0, s[32:35], s77 offen sc1
    s_endpgm
t3p_122:
wp_125:
    buffer_load_dword v56, off, s[32:35], s79 offset:0 sc1
    buffer_load_dword v57, off, s[32:35], s79 offset:128 sc1
    buffer_load_dword v58, off, s[32:35], s79 offset:256 sc1
    buffer_load_dword v59, off, s[32:35], s79 offset:384 sc1
    s_sub_i32 s54, s54, 1
    s_cmp_lt_i32 s54, 0
    s_waitcnt vmcnt(0)
    s_cbranch_scc1 wpd_126
    v_min_u32 v56, v56, v57
    v_min3_u32 v56, v56, v58, v59
    v_cmp_gt_u32 vcc, s57, v56
    s_cbranch_vccz wpd_126
    s_sleep 1
    s_branch wp_125
wpd_126:
    s_branch t3ok_121
tredo_118l:
    s_cmp_lt_i32 s49, 1
    s_cbranch_scc1 tredo_118lr
tredo_118:
    s_sub_i32 s49, s49, 1
    s_cmp_lt_i32 s49, 0
    s_cbranch_scc1 tredo_118r
    s_mov_b32 s45, s69
    s_waitcnt lgkmcnt(0)
    s_nop 7
    v_add_u32 v1, s63, v0
    v_and_b32 v2, 0x7ffff, v2
    v_or_b32 v2, s51, v2
    v_mov_b64 v[32:33], 0
    v_mov_b64 v[34:35], 0
    v_mov_b64 v[36:37], 0
    v_mov_b64 v[38:39], 0
    v_mov_b64 v[40:41], 0
    v_mov_b64 v[42:43], 0
    v_mov_b64 v[44:45], 0
    v_mov_b64 v[46:47], 0
    v_lshlrev_b32 v12, 3, v0
    v_and_b32 v14, 0x180, v12
    ds_read_b128 v[72:75], v1 offset:16384
    ds_read_b128 v[76:79], v1 offset:17408
    ds_read_b128 v[48:51], v1 offset:18432
    ds_read_b128 v[52:55], v1 offset:19456
    s_barrier
    s_mov_b32 m0, 0
    s_nop 0
    buffer_load_dwordx4 v0, s[32:35], s85 offen offset:0 sc1 lds
    buffer_load_dwordx4 v0, s[32:35], s85 offen offset:1024 sc1 lds
    buffer_load_dwordx4 v0, s[32:35], s85 offen offset:2048 sc1 lds
    buffer_load_dwordx4 v0, s[32:35], s85 offen offset:3072 sc1 lds
    s_branch tm_119
L_att:
    s_mul_i32 s60, s53, 43691
    s_lshr_b32 s60, s60, 17
    s_mul_i32 s57, s60, 3
    s_sub_u32 s61, s53, s57
L_att2:
    s_mov_b32 s36, s14
    s_and_b32 s37, s15, 0xffff
    s_mov_b32 s38, 4718592
    s_mov_b32 s39, 0x20000
    v_lshlrev_b32 v1, 4, v0
    s_mul_i32 s56, s52, 9216
    s_mul_i32 s62, s60, 294912
    s_add_u32 s62, s62, s56
    v_lshrrev_b32 v10, 2, v0
    v_mul_u32_u24 v10, 1152, v10
    v_and_b32 v11, 3, v0
    v_lshl_add_u32 v10, v11, 3, v10
    s_mul_i32 s57, s52, 288
    v_add_u32 v5, s57, v10
    s_cmp_eq_u32 s61, 63
    s_cbranch_scc1 aarmd_128
    v_mov_b32 v12, -1
    v_mov_b32 v13, -1
    v_mov_b32 v14, -1
    v_mov_b32 v15, -1
    s_lshl_b32 s57, s61, 4
    s_add_u32 s57, s57, s60
    s_lshl_b32 s57, s57, 2
    s_add_u32 s57, s57, s52
    s_lshl_b32 s57, s57, 11
    s_add_u32 s57, s57, 10485760
aarm_127:
    buffer_store_dwordx4 v[12:15], v1, s[32:35], s57 offen sc1
    buffer_store_dwordx4 v[12:15], v1, s[32:35], s57 offen offset:1024 sc1
    s_add_u32 s57, s57, 393216
    s_cmp_lt_u32 s57, 18874368
    s_cbranch_scc1 aarm_127
    s_waitcnt vmcnt(0)
    s_barrier
    s_cmp_lg_u32 s52, 0
    s_cbranch_scc1 held_129
    s_sleep 60
    v_mov_b32 v10, 136
winit_130:
    global_load_dword v11, v10, s[28:29] sc1
    s_sub_i32 s54, s54, 1
    s_cmp_lt_i32 s54, 0
    s_waitcnt vmcnt(0)
    s_cbranch_scc1 winitd_131
    v_cmp_gt_u32 vcc, 4, v11
    s_cbranch_vccz winitd_131
    s_sleep 8
    s_branch winit_130
winitd_131:
    s_lshl_b32 s57, s53, 7
    s_add_u32 s57, s57, 137216
    s_mov_b64 exec, 1
    buffer_store_dword v12, off, s[32:35], s57 sc1
    s_mov_b64 exec, -1
    s_add_u32 s57, s53, 108
    s_lshl_b32 s57, s57, 7
    s_add_u32 s57, s57, 16384
hold_132:
    buffer_load_dword v11, off, s[32:35], s57 sc1
    s_sub_i32 s54, s54, 1
    s_cmp_lt_i32 s54, 0
    s_waitcnt vmcnt(0)
    s_cbranch_scc1 holdd_133
    v_cmp_gt_u32 vcc, 2, v11
    s_cbranch_vccz holdd_133
    s_sleep 16
    s_branch hold_132
holdd_133:
held_129:
    s_waitcnt vmcnt(0)
    s_barrier
aarmd_128:
    s_add_u32 m0, s56, 0
    s_add_u32 s59, s62, 0
    buffer_load_dwordx4 v1, s[36:39], s59 offen offset:0 lds
    buffer_load_dwordx4 v1, s[36:39], s59 offen offset:1024 lds
    buffer_load_dwordx4 v1, s[36:39], s59 offen offset:2048 lds
    buffer_load_dwordx4 v1, s[36:39], s59 offen offset:3072 lds
    s_add_u32 m0, s56, 4096
    s_add_u32 s59, s62, 4096
    buffer_load_dwordx4 v1, s[36:39], s59 offen offset:0 lds
    buffer_load_dwordx4 v1, s[36:39], s59 offen offset:1024 lds
    buffer_load_dwordx4 v1, s[36:39], s59 offen offset:2048 lds
    buffer_load_dwordx4 v1, s[36:39], s59 offen offset:3072 lds
    s_add_u32 m0, s56, 8192
    s_add_u32 s59, s62, 8192
    buffer_load_dwordx4 v1, s[36:39], s59 offen offset:0 lds
    s_add_u32 m0, s56, 36864
    s_add_u32 s59, s62, 36864
    buffer_load_dwordx4 v1, s[36:39], s59 offen offset:0 lds
    buffer_load_dwordx4 v1, s[36:39], s59 offen offset:1024 lds
    buffer_load_dwordx4 v1, s[36:39], s59 offen offset:2048 lds
    buffer_load_dwordx4 v1, s[36:39], s59 offen offset:3072 lds
    s_add_u32 m0, s56, 40960
    s_add_u32 s59, s62, 40960
    buffer_load_dwordx4 v1, s[36:39], s59 offen offset:0 lds
    buffer_load_dwordx4 v1, s[36:39], s59 offen offset:1024 lds
    buffer_load_dwordx4 v1, s[36:39], s59 offen offset:2048 lds
    buffer_load_dwordx4 v1, s[36:39], s59 offen offset:3072 lds
    s_add_u32 m0, s56, 45056
    s_add_u32 s59, s62, 45056
    buffer_load_dwordx4 v1, s[36:39], s59 offen offset:0 lds
    s_add_u32 m0, s56, 73728
    s_add_u32 s59, s62, 73728
    buffer_load_dwordx4 v1, s[36:39], s59 offen offset:0 lds
    buffer_load_dwordx4 v1, s[36:39], s59 offen offset:1024 lds
    buffer_load_dwordx4 v1, s[36:39], s59 offen offset:2048 lds
    buffer_load_dwordx4 v1, s[36:39], s59 offen offset:3072 lds
    s_add_u32 m0, s56, 77824
    s_add_u32 s59, s62, 77824
    buffer_load_dwordx4 v1, s[36:39], s59 offen offset:0 lds
    buffer_load_dwordx4 v1, s[36:39], s59 offen offset:1024 lds
    buffer_load_dwordx4 v1, s[36:39], s59 offen offset:2048 lds
    buffer_load_dwordx4 v1, s[36:39], s59 offen offset:3072 lds
    s_add_u32 m0, s56, 81920
    s_add_u32 s59, s62, 81920
    buffer_load_dwordx4 v1, s[36:39], s59 offen offset:0 lds
    s_add_u32 m0, s56, 110592
    s_add_u32 s59, s62, 110592
    buffer_load_dwordx4 v1, s[36:39], s59 offen offset:0 lds
    buffer_load_dwordx4 v1, s[36:39], s59 offen offset:1024 lds
    buffer_load_dwordx4 v1, s[36:39], s59 offen offset:2048 lds
    buffer_load_dwordx4 v1, s[36:39], s59 offen offset:3072 lds
    s_add_u32 m0, s56, 114688
    s_add_u32 s59, s62, 114688
    buffer_load_dwordx4 v1, s[36:39], s59 offen offset:0 lds
    buffer_load_dwordx4 v1, s[36:39], s59 offen offset:1024 lds
    buffer_load_dwordx4 v1, s[36:39], s59 offen offset:2048 lds
    buffer_load_dwordx4 v1, s[36:39], s59 offen offset:3072 lds
    s_add_u32 m0, s56, 118784
    s_add_u32 s59, s62, 118784
    buffer_load_dwordx4 v1, s[36:39], s59 offen offset:0 lds
    s_waitcnt vmcnt(27) lgkmcnt(0)
    s_barrier
    v_add_u32 v6, 0, v5
    ds_read_b64_tr_b16 a[0:1], v6 offset:0
    ds_read_b64_tr_b16 a[2:3], v6 offset:18432
    ds_read_b64_tr_b16 a[4:5], v6 offset:32
    ds_read_b64_tr_b16 a[6:7], v6 offset:18464
    ds_read_b64_tr_b16 a[8:9], v6 offset:64
    ds_read_b64_tr_b16 a[10:11], v6 offset:18496
    ds_read_b64_tr_b16 a[12:13], v6 offset:96
    ds_read_b64_tr_b16 a[14:15], v6 offset:18528
    ds_read_b64_tr_b16 a[16:17], v6 offset:128
    ds_read_b64_tr_b16 a[18:19], v6 offset:18560
    ds_read_b64_tr_b16 a[20:21], v6 offset:160
    ds_read_b64_tr_b16 a[22:23], v6 offset:18592
    ds_read_b64_tr_b16 a[24:25], v6 offset:192
    ds_read_b64_tr_b16 a[26:27], v6 offset:18624
    ds_read_b64_tr_b16 a[28:29], v6 offset:224
    ds_read_b64_tr_b16 a[30:31], v6 offset:18656
    ds_read_b64_tr_b16 a[32:33], v6 offset:256
    ds_read_b64_tr_b16 a[34:35], v6 offset:18688
    s_waitcnt vmcnt(18) lgkmcnt(0)
    s_barrier
    s_add_u32 m0, s56, 0
    s_add_u32 s59, s62, 147456
    buffer_load_dwordx4 v1, s[36:39], s59 offen offset:0 lds
    buffer_load_dwordx4 v1, s[36:39], s59 offen offset:1024 lds
    buffer_load_dwordx4 v1, s[36:39], s59 offen offset:2048 lds
    buffer_load_dwordx4 v1, s[36:39], s59 offen offset:3072 lds
    s_add_u32 m0, s56, 4096
    s_add_u32 s59, s62, 151552
    buffer_load_dwordx4 v1, s[36:39], s59 offen offset:0 lds
    buffer_load_dwordx4 v1, s[36:39], s59 offen offset:1024 lds
    buffer_load_dwordx4 v1, s[36:39], s59 offen offset:2048 lds
    buffer_load_dwordx4 v1, s[36:39], s59 offen offset:3072 lds
    s_add_u32 m0, s56, 8192
    s_add_u32 s59, s62, 155648
    buffer_load_dwordx4 v1, s[36:39], s59 offen offset:0 lds
    v_add_u32 v6, 36864, v5
    ds_read_b64_tr_b16 a[36:37], v6 offset:0
    ds_read_b64_tr_b16 a[38:39], v6 offset:18432
    ds_read_b64_tr_b16 a[40:41], v6 offset:32
    ds_read_b64_tr_b16 a[42:43], v6 offset:18464
    ds_read_b64_tr_b16 a[44:45], v6 offset:64
    ds_read_b64_tr_b16 a[46:47], v6 offset:18496
    ds_read_b64_tr_b16 a[48:49], v6 offset:96
    ds_read_b64_tr_b16 a[50:51], v6 offset:18528
    ds_read_b64_tr_b16 a[52:53], v6 offset:128
    ds_read_b64_tr_b16 a[54:55], v6 offset:18560
    ds_read_b64_tr_b16 a[56:57], v6 offset:160
    ds_read_b64_tr_b16 a[58:59], v6 offset:18592
    ds_read_b64_tr_b16 a[60:61], v6 offset:192
    ds_read_b64_tr_b16 a[62:63], v6 offset:18624
    ds_read_b64_tr_b16 a[64:65], v6 offset:224
    ds_read_b64_tr_b16 a[66:67], v6 offset:18656
    ds_read_b64_tr_b16 a[68:69], v6 offset:256
    ds_read_b64_tr_b16 a[70:71], v6 offset:18688
    s_waitcnt vmcnt(18) lgkmcnt(0)
    s_barrier
    s_add_u32 m0, s56, 36864
    s_add_u32 s59, s62, 184320
    buffer_load_dwordx4 v1, s[36:39], s59 offen offset:0 lds
    buffer_load_dwordx4 v1, s[36:39], s59 offen offset:1024 lds
    buffer_load_dwordx4 v1, s[36:39], s59 offen offset:2048 lds
    buffer_load_dwordx4 v1, s[36:39], s59 offen offset:3072 lds
    s_add_u32 m0, s56, 40960
    s_add_u32 s59, s62, 188416
    buffer_load_dwordx4 v1, s[36:39], s59 offen offset:0 lds
    buffer_load_dwordx4 v1, s[36:39], s59 offen offset:1024 lds
    buffer_load_dwordx4 v1, s[36:39], s59 offen offset:2048 lds
    buffer_load_dwordx4 v1, s[36:39], s59 offen offset:3072 lds
    s_add_u32 m0, s56, 45056
    s_add_u32 s59, s62, 192512
    buffer_load_dwordx4 v1, s[36:39], s59 offen offset:0 lds
    v_add_u32 v6, 73728, v5
    ds_read_b64_tr_b16 a[72:73], v6 offset:0
    ds_read_b64_tr_b16 a[74:75], v6 offset:18432
    ds_read_b64_tr_b16 a[76:77], v6 offset:32
    ds_read_b64_tr_b16 a[78:79], v6 offset:18464
    ds_read_b64_tr_b16 a[80:81], v6 offset:64
    ds_read_b64_tr_b16 a[82:83], v6 offset:18496
    ds_read_b64_tr_b16 a[84:85], v6 offset:96
    ds_read_b64_tr_b16 a[86:87], v6 offset:18528
    ds_read_b64_tr_b16 a[88:89], v6 offset:128
    ds_read_b64_tr_b16 a[90:91], v6 offset:18560
    ds_read_b64_tr_b16 a[92:93], v6 offset:160
    ds_read_b64_tr_b16 a[94:95], v6 offset:18592
    ds_read_b64_tr_b16 a[96:97], v6 offset:192
    ds_read_b64_tr_b16 a[98:99], v6 offset:18624
    ds_read_b64_tr_b16 a[100:101], v6 offset:224
    ds_read_b64_tr_b16 a[102:103], v6 offset:18656
    ds_read_b64_tr_b16 a[104:105], v6 offset:256
    ds_read_b64_tr_b16 a[106:107], v6 offset:18688
    s_waitcnt vmcnt(18) lgkmcnt(0)
    s_barrier
    s_add_u32 m0, s56, 73728
    s_add_u32 s59, s62, 221184
    buffer_load_dwordx4 v1, s[36:39], s59 offen offset:0 lds
    buffer_load_dwordx4 v1, s[36:39], s59 offen offset:1024 lds
    buffer_load_dwordx4 v1, s[36:39], s59 offen offset:2048 lds
    buffer_load_dwordx4 v1, s[36:39], s59 offen offset:3072 lds
    s_add_u32 m0, s56, 77824
    s_add_u32 s59, s62, 225280
    buffer_load_dwordx4 v1, s[36:39], s59 offen offset:0 lds
    buffer_load_dwordx4 v1, s[36:39], s59 offen offset:1024 lds
    buffer_load_dwordx4 v1, s[36:39], s59 offen offset:2048 lds
    buffer_load_dwordx4 v1, s[36:39], s59 offen offset:3072 lds
    s_add_u32 m0, s56, 81920
    s_add_u32 s59, s62, 229376
    buffer_load_dwordx4 v1, s[36:39], s59 offen offset:0 lds
    v_add_u32 v6, 110592, v5
    ds_read_b64_tr_b16 a[108:109], v6 offset:0
    ds_read_b64_tr_b16 a[110:111], v6 offset:18432
    ds_read_b64_tr_b16 a[112:113], v6 offset:32
    ds_read_b64_tr_b16 a[114:115], v6 offset:18464
    ds_read_b64_tr_b16 a[116:117], v6 offset:64
    ds_read_b64_tr_b16 a[118:119], v6 offset:18496
    ds_read_b64_tr_b16 a[120:121], v6 offset:96
    ds_read_b64_tr_b16 a[122:123], v6 offset:18528
    ds_read_b64_tr_b16 a[124:125], v6 offset:128
    ds_read_b64_tr_b16 a[126:127], v6 offset:18560
    ds_read_b64_tr_b16 a[128:129], v6 offset:160
    ds_read_b64_tr_b16 a[130:131], v6 offset:18592
    ds_read_b64_tr_b16 a[132:133], v6 offset:192
    ds_read_b64_tr_b16 a[134:135], v6 offset:18624
    ds_read_b64_tr_b16 a[136:137], v6 offset:224
    ds_read_b64_tr_b16 a[138:139], v6 offset:18656
    ds_read_b64_tr_b16 a[140:141], v6 offset:256
    ds_read_b64_tr_b16 a[142:143], v6 offset:18688
    s_waitcnt vmcnt(18) lgkmcnt(0)
    s_barrier
    s_add_u32 m0, s56, 110592
    s_add_u32 s59, s62, 258048
    buffer_load_dwordx4 v1, s[36:39], s59 offen offset:0 lds
    buffer_load_dwordx4 v1, s[36:39], s59 offen offset:1024 lds
    buffer_load_dwordx4 v1, s[36:39], s59 offen offset:2048 lds
    buffer_load_dwordx4 v1, s[36:39], s59 offen offset:3072 lds
    s_add_u32 m0, s56, 114688
    s_add_u32 s59, s62, 262144
    buffer_load_dwordx4 v1, s[36:39], s59 offen offset:0 lds
    buffer_load_dwordx4 v1, s[36:39], s59 offen offset:1024 lds
    buffer_load_dwordx4 v1, s[36:39], s59 offen offset:2048 lds
    buffer_load_dwordx4 v1, s[36:39], s59 offen offset:3072 lds
    s_add_u32 m0, s56, 118784
    s_add_u32 s59, s62, 266240
    buffer_load_dwordx4 v1, s[36:39], s59 offen offset:0 lds
    v_add_u32 v6, 0, v5
    ds_read_b64_tr_b16 a[144:145], v6 offset:0
    ds_read_b64_tr_b16 a[146:147], v6 offset:18432
    ds_read_b64_tr_b16 a[148:149], v6 offset:32
    ds_read_b64_tr_b16 a[150:151], v6 offset:18464
    ds_read_b64_tr_b16 a[152:153], v6 offset:64
    ds_read_b64_tr_b16 a[154:155], v6 offset:18496
    ds_read_b64_tr_b16 a[156:157], v6 offset:96
    ds_read_b64_tr_b16 a[158:159], v6 offset:18528
    ds_read_b64_tr_b16 a[160:161], v6 offset:128
    ds_read_b64_tr_b16 a[162:163], v6 offset:18560
    ds_read_b64_tr_b16 a[164:165], v6 offset:160
    ds_read_b64_tr_b16 a[166:167], v6 offset:18592
    ds_read_b64_tr_b16 a[168:169], v6 offset:192
    ds_read_b64_tr_b16 a[170:171], v6 offset:18624
    ds_read_b64_tr_b16 a[172:173], v6 offset:224
    ds_read_b64_tr_b16 a[174:175], v6 offset:18656
    ds_read_b64_tr_b16 a[176:177], v6 offset:256
    ds_read_b64_tr_b16 a[178:179], v6 offset:18688
    s_waitcnt vmcnt(18) lgkmcnt(0)
    s_barrier
    v_add_u32 v6, 36864, v5
    ds_read_b64_tr_b16 a[180:181], v6 offset:0
    ds_read_b64_tr_b16 a[182:183], v6 offset:18432
    ds_read_b64_tr_b16 a[184:185], v6 offset:32
    ds_read_b64_tr_b16 a[186:187], v6 offset:18464
    ds_read_b64_tr_b16 a[188:189], v6 offset:64
    ds_read_b64_tr_b16 a[190:191], v6 offset:18496
    ds_read_b64_tr_b16 a[192:193], v6 offset:96
    ds_read_b64_tr_b16 a[194:195], v6 offset:18528
    ds_read_b64_tr_b16 a[196:197], v6 offset:128
    ds_read_b64_tr_b16 a[198:199], v6 offset:18560
    ds_read_b64_tr_b16 a[200:201], v6 offset:160
    ds_read_b64_tr_b16 a[202:203], v6 offset:18592
    ds_read_b64_tr_b16 a[204:205], v6 offset:192
    ds_read_b64_tr_b16 a[206:207], v6 offset:18624
    ds_read_b64_tr_b16 a[208:209], v6 offset:224
    ds_read_b64_tr_b16 a[210:211], v6 offset:18656
    ds_read_b64_tr_b16 a[212:213], v6 offset:256
    ds_read_b64_tr_b16 a[214:215], v6 offset:18688
    s_waitcnt vmcnt(9) lgkmcnt(0)
    s_barrier
    v_add_u32 v6, 73728, v5
    ds_read_b64_tr_b16 a[216:217], v6 offset:0
    ds_read_b64_tr_b16 a[218:219], v6 offset:18432
    ds_read_b64_tr_b16 a[220:221], v6 offset:32
    ds_read_b64_tr_b16 a[222:223], v6 offset:18464
    ds_read_b64_tr_b16 a[224:225], v6 offset:64
    ds_read_b64_tr_b16 a[226:227], v6 offset:18496
    ds_read_b64_tr_b16 a[228:229], v6 offset:96
    ds_read_b64_tr_b16 a[230:231], v6 offset:18528
    ds_read_b64_tr_b16 a[232:233], v6 offset:128
    ds_read_b64_tr_b16 a[234:235], v6 offset:18560
    ds_read_b64_tr_b16 a[236:237], v6 offset:160
    ds_read_b64_tr_b16 a[238:239], v6 offset:18592
    ds_read_b64_tr_b16 a[240:241], v6 offset:192
    ds_read_b64_tr_b16 a[242:243], v6 offset:18624
    ds_read_b64_tr_b16 a[244:245], v6 offset:224
    ds_read_b64_tr_b16 a[246:247], v6 offset:18656
    ds_read_b64_tr_b16 a[248:249], v6 offset:256
    ds_read_b64_tr_b16 a[250:251], v6 offset:18688
    s_waitcnt vmcnt(0) lgkmcnt(0)
    s_barrier
    v_add_u32 v6, 110592, v5
    ds_read_b64_tr_b16 a[252:253], v6 offset:0
    ds_read_b64_tr_b16 a[254:255], v6 offset:18432
    ds_read_b64_tr_b16 v[224:225], v6 offset:32
    ds_read_b64_tr_b16 v[226:227], v6 offset:18464
    ds_read_b64_tr_b16 v[228:229], v6 offset:64
    ds_read_b64_tr_b16 v[230:231], v6 offset:18496
    ds_read_b64_tr_b16 v[232:233], v6 offset:96
    ds_read_b64_tr_b16 v[234:235], v6 offset:18528
    ds_read_b64_tr_b16 v[236:237], v6 offset:128
    ds_read_b64_tr_b16 v[238:239], v6 offset:18560
    ds_read_b64_tr_b16 v[240:241], v6 offset:160
    ds_read_b64_tr_b16 v[242:243], v6 offset:18592
    ds_read_b64_tr_b16 v[244:245], v6 offset:192
    ds_read_b64_tr_b16 v[246:247], v6 offset:18624
    ds_read_b64_tr_b16 v[248:249], v6 offset:224
    ds_read_b64_tr_b16 v[250:251], v6 offset:18656
    ds_read_b64_tr_b16 v[252:253], v6 offset:256
    ds_read_b64_tr_b16 v[254:255], v6 offset:18688
    s_waitcnt lgkmcnt(0)
    s_barrier
    s_lshr_b32 s57, s52, 1
    s_and_b32 s58, s52, 1
    s_lshl_b32 s63, s60, 1
    s_add_u32 s63, s63, s57
    s_mov_b32 s64, s61
    s_lshl_b32 s59, s61, 5
    s_add_u32 s59, s59, s63
    s_mul_i32 s66, s59, 24576
    s_add_u32 s66, s66, 22020096
    s_lshl_b32 s65, s58, 10
    s_add_u32 s65, s65, s66
    s_mul_i32 s68, s59, 4096
    s_add_u32 s68, s68, 10485760
    s_lshl_b32 s69, s63, 7
    s_add_u32 s69, s69, 40960
    s_mul_i32 s70, s61, 589824
    s_mul_i32 s59, s60, 2304
    s_add_u32 s70, s70, s59
    s_mul_i32 s59, s52, 147456
    s_add_u32 s70, s70, s59
    s_add_u32 s70, s70, 72351744
    s_cmp_eq_u32 s61, 63
    s_cselect_b32 s71, 0, s61
    s_lshl_b32 s71, s71, 13
    s_lshl_b32 s59, s60, 9
    s_add_u32 s71, s71, s59
    s_lshl_b32 s59, s52, 7
    s_add_u32 s71, s71, s59
    s_add_u32 s71, s71, 45056
    s_mov_b32 s72, 0
    s_mov_b32 s73, 0x3db504f3
    s_mov_b32 s74, 0x3fb8aa3b
    s_mov_b32 s75, 0xffff0000
    v_and_b32 v10, 15, v0
    v_lshrrev_b32 v11, 4, v0
    v_mul_u32_u24 v2, 36864, v11
    v_lshl_add_u32 v2, v10, 4, v2
    v_mul_u32_u24 v5, 2320, v10
    v_lshl_add_u32 v5, v11, 4, v5
    s_mul_i32 s59, s52, 576
    s_add_u32 s59, s59, 32768
    v_add_u32 v5, s59, v5
    v_mul_u32_u24 v6, 2320, v11
    v_lshl_add_u32 v6, v10, 4, v6
    s_mul_i32 s59, s52, 9280
    s_add_u32 s59, s59, 32768
    v_add_u32 v6, s59, v6
    s_lshl_b32 s59, s63, 9
    s_add_u32 s76, s60, 32
    s_lshl_b32 s76, s76, 9
    v_mov_b32 v3, s59
    v_mov_b32 v12, s76
    v_and_b32 v13, 4, v0
    v_cmp_eq_u32 vcc, 0, v13
    s_nop 1
    v_cndmask_b32 v3, v12, v3, vcc
    v_and_b32 v13, 3, v0
    v_lshl_add_u32 v3, v13, 7, v3
    v_add_u32 v3, 16384, v3
    s_lshl_b32 s59, s57, 13
    s_lshl_b32 s76, s58, 10
    s_add_u32 s59, s59, s76
    v_add_u32 v4, s59, v1
    v_mov_b32 v7, 0xce6e6b28
    v_mov_b32 v145, 0
    v_mov_b32 v146, 0
    s_lshl_b32 s59, s58, 4
    v_add_u32 v10, s59, v10
    v_lshlrev_b32 v11, 2, v11
    v_add_u32 v12, 0, v11
    v_cmp_le_u32 s[80:81], v12, v10
    v_add_u32 v12, 1, v11
    v_cmp_le_u32 s[82:83], v12, v10
    v_add_u32 v12, 2, v11
    v_cmp_le_u32 s[84:85], v12, v10
    v_add_u32 v12, 3, v11
    v_cmp_le_u32 s[86:87], v12, v10
    v_add_u32 v12, 16, v11
    v_cmp_le_u32 s[88:89], v12, v10
    v_add_u32 v12, 17, v11
    v_cmp_le_u32 s[90:91], v12, v10
    v_add_u32 v12, 18, v11
    v_cmp_le_u32 s[92:93], v12, v10
    v_add_u32 v12, 19, v11
    v_cmp_le_u32 s[94:95], v12, v10
    s_add_u32 s77, s64, 1
    v_mov_b32 v8, 0
    v_mov_b32 v96, -1
    s_cmp_eq_u32 s61, 63
    s_cbranch_scc1 axtra_138
    s_add_u32 s59, s70, 33619968
    s_add_u32 s57, s70, 35389440
    s_add_u32 s58, s57, 1769472
    s_cmp_eq_u32 s61, 0
    s_cselect_b32 s58, s58, 2130706432
    v_mov_b32 v148, -1
    v_mov_b32 v149, -1
    v_mov_b32 v150, -1
    v_mov_b32 v151, -1
    buffer_store_dwordx4 v[148:151], v2, s[32:35], s59 offen offset:0 sc1
    buffer_store_dwordx4 v[148:151], v2, s[32:35], s59 offen offset:256 sc1
    buffer_store_dwordx4 v[148:151], v2, s[32:35], s59 offen offset:512 sc1
    buffer_store_dwordx4 v[148:151], v2, s[32:35], s59 offen offset:768 sc1
    buffer_store_dwordx4 v[148:151], v2, s[32:35], s59 offen offset:1024 sc1
    buffer_store_dwordx4 v[148:151], v2, s[32:35], s59 offen offset:1280 sc1
    buffer_store_dwordx4 v[148:151], v2, s[32:35], s59 offen offset:1536 sc1
    buffer_store_dwordx4 v[148:151], v2, s[32:35], s59 offen offset:1792 sc1
    buffer_store_dwordx4 v[148:151], v2, s[32:35], s59 offen offset:2048 sc1
    buffer_store_dwordx4 v[148:151], v2, s[32:35], s57 offen offset:0 sc1
    buffer_store_dwordx4 v[148:151], v2, s[32:35], s57 offen offset:256 sc1
    buffer_store_dwordx4 v[148:151], v2, s[32:35], s57 offen offset:512 sc1
    buffer_store_dwordx4 v[148:151], v2, s[32:35], s57 offen offset:768 sc1
    buffer_store_dwordx4 v[148:151], v2, s[32:35], s57 offen offset:1024 sc1
    buffer_store_dwordx4 v[148:151], v2, s[32:35], s57 offen offset:1280 sc1
    buffer_store_dwordx4 v[148:151], v2, s[32:35], s57 offen offset:1536 sc1
    buffer_store_dwordx4 v[148:151], v2, s[32:35], s57 offen offset:1792 sc1
    buffer_store_dwordx4 v[148:151], v2, s[32:35], s57 offen offset:2048 sc1
    buffer_store_dwordx4 v[148:151], v2, s[32:35], s58 offen offset:0 sc1
    buffer_store_dwordx4 v[148:151], v2, s[32:35], s58 offen offset:256 sc1
    buffer_store_dwordx4 v[148:151], v2, s[32:35], s58 offen offset:512 sc1
    buffer_store_dwordx4 v[148:151], v2, s[32:35], s58 offen offset:768 sc1
    buffer_store_dwordx4 v[148:151], v2, s[32:35], s58 offen offset:1024 sc1
    buffer_store_dwordx4 v[148:151], v2, s[32:35], s58 offen offset:1280 sc1
    buffer_store_dwordx4 v[148:151], v2, s[32:35], s58 offen offset:1536 sc1
    buffer_store_dwordx4 v[148:151], v2, s[32:35], s58 offen offset:1792 sc1
    buffer_store_dwordx4 v[148:151], v2, s[32:35], s58 offen offset:2048 sc1
    s_branch ajoin_139
axtra_138:
    v_mov_b32 v10, 136
winit_140:
    global_load_dword v11, v10, s[28:29] sc1
    s_sub_i32 s54, s54, 1
    s_cmp_lt_i32 s54, 0
    s_waitcnt vmcnt(0)
    s_cbranch_scc1 winitd_141
    v_cmp_gt_u32 vcc, 4, v11
    s_cbranch_vccz winitd_141
    s_sleep 8
    s_branch winit_140
winitd_141:
ax_142:
    buffer_load_dword v9, off, s[32:35], s71 sc1
    s_sub_i32 s54, s54, 1
    s_cmp_lt_i32 s54, 0
    s_waitcnt vmcnt(0)
    s_cbranch_scc1 axd_143
    v_cmp_eq_u32 vcc, 0, v9
    s_cbranch_vccz axd_143
    s_sleep 16
    s_branch ax_142
axd_143:
    s_mov_b32 s71, 2130706432
ajoin_139:
ap_144:
    buffer_load_dword v9, v3, s[32:35], 0 offen sc1
    s_sub_i32 s54, s54, 1
    s_cmp_lt_i32 s54, 0
    s_waitcnt vmcnt(0)
    s_cbranch_scc1 apd_145
    v_cmp_gt_u32 vcc, s77, v9
    s_cbranch_vccz apd_145
    s_sleep 8
    s_branch ap_144
apd_145:
    s_add_u32 s78, s65, 4096
    s_add_u32 s79, s66, 8192
    s_add_u32 s96, s66, 12288
    s_add_u32 s97, s66, 16384
    s_add_u32 s98, s66, 20480
    buffer_load_dwordx4 v[16:19], v1, s[32:35], s65 offen offset:0 sc1
    buffer_load_dwordx4 v[20:23], v1, s[32:35], s65 offen offset:2048 sc1
    buffer_load_dwordx4 v[24:27], v1, s[32:35], s78 offen offset:0 sc1
    buffer_load_dwordx4 v[28:31], v1, s[32:35], s78 offen offset:2048 sc1
    buffer_load_dwordx4 v[32:35], v1, s[32:35], s79 offen offset:0 sc1
    buffer_load_dwordx4 v[36:39], v1, s[32:35], s79 offen offset:1024 sc1
    buffer_load_dwordx4 v[40:43], v1, s[32:35], s79 offen offset:2048 sc1
    buffer_load_dwordx4 v[44:47], v1, s[32:35], s79 offen offset:3072 sc1
    buffer_load_dwordx4 v[48:51], v1, s[32:35], s96 offen offset:0 sc1
    buffer_load_dwordx4 v[52:55], v1, s[32:35], s96 offen offset:1024 sc1
    buffer_load_dwordx4 v[56:59], v1, s[32:35], s96 offen offset:2048 sc1
    buffer_load_dwordx4 v[60:63], v1, s[32:35], s96 offen offset:3072 sc1
    buffer_load_dwordx4 v[64:67], v1, s[32:35], s97 offen offset:0 sc1
    buffer_load_dwordx4 v[68:71], v1, s[32:35], s97 offen offset:1024 sc1
    buffer_load_dwordx4 v[72:75], v1, s[32:35], s97 offen offset:2048 sc1
    buffer_load_dwordx4 v[76:79], v1, s[32:35], s97 offen offset:3072 sc1
    buffer_load_dwordx4 v[80:83], v1, s[32:35], s98 offen offset:0 sc1
    buffer_load_dwordx4 v[84:87], v1, s[32:35], s98 offen offset:1024 sc1
    buffer_load_dwordx4 v[88:91], v1, s[32:35], s98 offen offset:2048 sc1
    buffer_load_dwordx4 v[92:95], v1, s[32:35], s98 offen offset:3072 sc1
    s_waitcnt vmcnt(0)
aloop_134:
    s_waitcnt vmcnt(9)
    v_mfma_f32_16x16x32_bf16 v[128:131], v[32:35], v[16:19], 0
    v_mfma_f32_16x16x32_bf16 v[132:135], v[36:39], v[16:19], 0
    v_mfma_f32_16x16x32_bf16 v[128:131], v[40:43], v[20:23], v[128:131]
    v_mfma_f32_16x16x32_bf16 v[132:135], v[44:47], v[20:23], v[132:135]
    v_mfma_f32_16x16x32_bf16 v[128:131], v[48:51], v[24:27], v[128:131]
    v_mfma_f32_16x16x32_bf16 v[132:135], v[52:55], v[24:27], v[132:135]
    v_mfma_f32_16x16x32_bf16 v[128:131], v[56:59], v[28:31], v[128:131]
    v_mfma_f32_16x16x32_bf16 v[132:135], v[60:63], v[28:31], v[132:135]
    s_nop 4
    v_cvt_pk_bf16_f32 v140, v128, v129
    v_lshlrev_b32 v128, 16, v140
    v_and_b32 v129, s75, v140
    v_mul_f32 v128, s73, v128
    v_mul_f32 v129, s73, v129
    v_cvt_pk_bf16_f32 v140, v128, v129
    v_lshlrev_b32 v128, 16, v140
    v_and_b32 v129, s75, v140
    v_cvt_pk_bf16_f32 v141, v130, v131
    v_lshlrev_b32 v130, 16, v141
    v_and_b32 v131, s75, v141
    v_mul_f32 v130, s73, v130
    v_mul_f32 v131, s73, v131
    v_cvt_pk_bf16_f32 v141, v130, v131
    v_lshlrev_b32 v130, 16, v141
    v_and_b32 v131, s75, v141
    v_cvt_pk_bf16_f32 v142, v132, v133
    v_lshlrev_b32 v132, 16, v142
    v_and_b32 v133, s75, v142
    v_mul_f32 v132, s73, v132
    v_mul_f32 v133, s73, v133
    v_cvt_pk_bf16_f32 v142, v132, v133
    v_lshlrev_b32 v132, 16, v142
    v_and_b32 v133, s75, v142
    v_cvt_pk_bf16_f32 v143, v134, v135
    v_lshlrev_b32 v134, 16, v143
    v_and_b32 v135, s75, v143
    v_mul_f32 v134, s73, v134
    v_mul_f32 v135, s73, v135
    v_cvt_pk_bf16_f32 v143, v134, v135
    v_lshlrev_b32 v134, 16, v143
    v_and_b32 v135, s75, v143
    v_cndmask_b32 v128, v7, v128, s[80:81]
    v_cndmask_b32 v129, v7, v129, s[82:83]
    v_cndmask_b32 v130, v7, v130, s[84:85]
    v_cndmask_b32 v131, v7, v131, s[86:87]
    v_cndmask_b32 v132, v7, v132, s[88:89]
    v_cndmask_b32 v133, v7, v133, s[90:91]
    v_cndmask_b32 v134, v7, v134, s[92:93]
    v_cndmask_b32 v135, v7, v135, s[94:95]
    v_max3_f32 v14, v128, v129, v130
    v_max3_f32 v14, v14, v131, v132
    v_max3_f32 v14, v14, v133, v134
    v_max_f32 v14, v14, v135
    v_max3_u32 v9, v96, v97, v98
    v_max3_u32 v9, v9, v99, v100
    v_max3_u32 v9, v9, v101, v102
    v_max3_u32 v9, v9, v103, v104
    v_max3_u32 v9, v9, v105, v106
    v_max3_u32 v9, v9, v107, v108
    v_max3_u32 v9, v9, v109, v110
    v_max3_u32 v9, v9, v111, v111
    v_cmp_le_u32 vcc, 0xffc00000, v9
    s_cbranch_vccz ahave_135
    s_cmp_ge_u32 s64, 60
    s_cbranch_scc1 ahave_135n
    s_waitcnt vmcnt(0)
    s_mov_b64 exec, 1
    buffer_store_dword v8, off, s[32:35], s71 sc1
    s_mov_b64 exec, -1
ahave_135n:
at_146:
    buffer_load_dwordx4 v[96:99], v1, s[32:35], s68 offen offset:0 sc1
    buffer_load_dwordx4 v[100:103], v1, s[32:35], s68 offen offset:1024 sc1
    buffer_load_dwordx4 v[104:107], v1, s[32:35], s68 offen offset:2048 sc1
    buffer_load_dwordx4 v[108:111], v1, s[32:35], s68 offen offset:3072 sc1
    s_sub_i32 s54, s54, 1
    s_cmp_lt_i32 s54, 0
    s_waitcnt vmcnt(0)
    s_cbranch_scc1 atd_147
    v_max3_u32 v9, v96, v97, v98
    v_max3_u32 v9, v9, v99, v100
    v_max3_u32 v9, v9, v101, v102
    v_max3_u32 v9, v9, v103, v104
    v_max3_u32 v9, v9, v105, v106
    v_max3_u32 v9, v9, v107, v108
    v_max3_u32 v9, v9, v109, v110
    v_max3_u32 v9, v9, v111, v111
    v_cmp_le_u32 vcc, 0xffc00000, v9
    s_cbranch_vccz atd_147
    s_sleep 2
    s_branch at_146
atd_147:
ahave_135:
    buffer_load_dword v10, v3, s[32:35], 0 offen sc1
    v_mov_b32_dpp v116, v102 quad_perm:[0,1,0,1] row_mask:0xf bank_mask:0xf
    v_mov_b32_dpp v113, v99 quad_perm:[0,1,0,1] row_mask:0xf bank_mask:0xf
    v_mov_b32_dpp v117, v103 quad_perm:[0,1,0,1] row_mask:0xf bank_mask:0xf
    v_mov_b32_dpp v114, v98 quad_perm:[2,3,2,3] row_mask:0xf bank_mask:0xf
    v_mov_b32_dpp v119, v103 quad_perm:[2,3,2,3] row_mask:0xf bank_mask:0xf
    v_mov_b32_dpp v115, v99 quad_perm:[2,3,2,3] row_mask:0xf bank_mask:0xf
    v_mov_b32_dpp v112, v98 quad_perm:[0,1,0,1] row_mask:0xf bank_mask:0xf
    s_nop 1
    v_mfma_f32_16x16x32_bf16 v[136:139], v[112:115], v[16:19], 0
    v_mov_b32_dpp v127, v111 quad_perm:[2,3,2,3] row_mask:0xf bank_mask:0xf
    v_mov_b32_dpp v122, v106 quad_perm:[2,3,2,3] row_mask:0xf bank_mask:0xf
    v_mov_b32_dpp v126, v110 quad_perm:[2,3,2,3] row_mask:0xf bank_mask:0xf
    v_mov_b32_dpp v118, v102 quad_perm:[2,3,2,3] row_mask:0xf bank_mask:0xf
    v_mov_b32_dpp v121, v107 quad_perm:[0,1,0,1] row_mask:0xf bank_mask:0xf
    v_mov_b32_dpp v123, v107 quad_perm:[2,3,2,3] row_mask:0xf bank_mask:0xf
    v_mov_b32_dpp v120, v106 quad_perm:[0,1,0,1] row_mask:0xf bank_mask:0xf
    v_mfma_f32_16x16x32_bf16 v[136:139], v[116:119], v[20:23], v[136:139]
    v_mov_b32_dpp v124, v110 quad_perm:[0,1,0,1] row_mask:0xf bank_mask:0xf
    v_mov_b32_dpp v125, v111 quad_perm:[0,1,0,1] row_mask:0xf bank_mask:0xf
    v_mfma_f32_16x16x32_bf16 v[136:139], v[120:123], v[24:27], v[136:139]
    v_mfma_f32_16x16x32_bf16 v[136:139], v[124:127], v[28:31], v[136:139]
    s_nop 7
    v_cvt_pk_bf16_f32 v144, v136, v137
    v_lshlrev_b32 v136, 16, v144
    v_mul_f32 v136, s73, v136
    v_and_b32 v137, s75, v144
    v_mul_f32 v137, s73, v137
    s_add_u32 s77, s77, 3
    v_cvt_pk_bf16_f32 v144, v136, v137
    s_add_u32 s68, s68, 393216
    v_lshlrev_b32 v136, 16, v144
    v_and_b32 v137, s75, v144
    v_max3_f32 v14, v14, v136, v137
    v_mov_b32 v15, v14
    s_nop 1
    v_permlane32_swap_b32 v14, v15
    v_max_f32 v14, v14, v15
    v_mov_b32 v15, v14
    s_nop 1
    v_permlane16_swap_b32 v14, v15
    v_max_f32 v14, v14, v15
    v_mul_f32 v14, s74, v14
    v_fma_f32 v137, v137, s74, -v14
    v_fma_f32 v130, v130, s74, -v14
    v_fma_f32 v133, v133, s74, -v14
    v_fma_f32 v132, v132, s74, -v14
    v_exp_f32 v133, v133
    v_fma_f32 v131, v131, s74, -v14
    v_exp_f32 v131, v131
    v_fma_f32 v135, v135, s74, -v14
    v_fma_f32 v136, v136, s74, -v14
    v_exp_f32 v137, v137
    v_exp_f32 v130, v130
    v_fma_f32 v128, v128, s74, -v14
    v_exp_f32 v128, v128
    v_fma_f32 v129, v129, s74, -v14
    v_exp_f32 v136, v136
    v_exp_f32 v129, v129
    v_exp_f32 v132, v132
    v_fma_f32 v134, v134, s74, -v14
    v_exp_f32 v135, v135
    v_add_f32 v15, v130, v131
    v_add_f32 v15, v15, v133
    v_add_f32 v14, v128, v129
    v_exp_f32 v134, v134
    v_add_f32 v14, v14, v132
    v_add_f32 v14, v14, v134
    v_add_f32 v15, v15, v135
    v_add_f32 v15, v15, v137
    v_add_f32 v14, v14, v136
    v_add_f32 v14, v14, v15
    v_mov_b32 v15, v14
    s_add_u32 s65, s65, 2359296
    s_nop 0
    v_permlane32_swap_b32 v14, v15
    v_add_f32 v14, v14, v15
    v_mov_b32 v15, v14
    s_nop 1
    v_permlane16_swap_b32 v14, v15
    v_add_f32 v14, v14, v15
    v_rcp_f32 v14, v14
    v_add_u32 v9, s72, v4
    v_mul_f32 v129, v129, v14
    v_mul_f32 v133, v133, v14
    v_mul_f32 v135, v135, v14
    v_mul_f32 v134, v134, v14
    v_mul_f32 v130, v130, v14
    v_mul_f32 v132, v132, v14
    v_mul_f32 v128, v128, v14
    v_mul_f32 v131, v131, v14
    v_cvt_pk_bf16_f32 v141, v130, v131
    v_cvt_pk_bf16_f32 v142, v132, v133
    v_cvt_pk_bf16_f32 v140, v128, v129
    v_cvt_pk_bf16_f32 v143, v134, v135
    s_nop 1
    v_mfma_f32_16x16x32_bf16 v[160:163], v[76:79], v[140:143], 0
    v_mul_f32 v137, v137, v14
    v_mfma_f32_16x16x32_bf16 v[156:159], v[72:75], v[140:143], 0
    v_mfma_f32_16x16x32_bf16 v[168:171], v[84:87], v[140:143], 0
    v_mul_f32 v136, v136, v14
    v_mfma_f32_16x16x32_bf16 v[164:167], v[80:83], v[140:143], 0
    v_cvt_pk_bf16_f32 v144, v136, v137
    v_mov_b32 v147, v144
    s_nop 0
    v_mfma_f32_16x16x16_bf16 v[156:159], v[100:101], v[144:145], v[156:159]
    v_mfma_f32_16x16x16_bf16 v[160:163], v[100:101], v[146:147], v[160:163]
    s_add_u32 s66, s66, 2359296
    v_mfma_f32_16x16x16_bf16 v[164:167], v[104:105], v[144:145], v[164:167]
    v_cvt_pk_bf16_f32 v156, v156, v157
    v_mfma_f32_16x16x16_bf16 v[168:171], v[104:105], v[146:147], v[168:171]
    v_cvt_pk_bf16_f32 v157, v158, v159
    v_cvt_pk_bf16_f32 v159, v162, v163
    v_mfma_f32_16x16x32_bf16 v[172:175], v[88:91], v[140:143], 0
    v_cvt_pk_bf16_f32 v158, v160, v161
    v_mfma_f32_16x16x32_bf16 v[176:179], v[92:95], v[140:143], 0
    ds_write_b128 v9, v[156:159] offset:2048
    v_cvt_pk_bf16_f32 v164, v164, v165
    v_mfma_f32_16x16x16_bf16 v[172:175], v[108:109], v[144:145], v[172:175]
    v_cvt_pk_bf16_f32 v165, v166, v167
    v_mfma_f32_16x16x16_bf16 v[176:179], v[108:109], v[146:147], v[176:179]
    v_cvt_pk_bf16_f32 v166, v168, v169
    v_cvt_pk_bf16_f32 v167, v170, v171
    v_mfma_f32_16x16x32_bf16 v[152:155], v[68:71], v[140:143], 0
    v_cvt_pk_bf16_f32 v172, v172, v173
    v_mfma_f32_16x16x32_bf16 v[148:151], v[64:67], v[140:143], 0
    ds_write_b128 v9, v[164:167] offset:4096
    v_cvt_pk_bf16_f32 v173, v174, v175
    v_cvt_pk_bf16_f32 v175, v178, v179
    s_nop 2
    v_mfma_f32_16x16x16_bf16 v[148:151], v[96:97], v[144:145], v[148:151]
    v_cvt_pk_bf16_f32 v174, v176, v177
    v_mfma_f32_16x16x16_bf16 v[152:155], v[96:97], v[146:147], v[152:155]
    ds_write_b128 v9, v[172:175] offset:6144
    s_nop 3
    v_cvt_pk_bf16_f32 v148, v148, v149
    v_cvt_pk_bf16_f32 v149, v150, v151
    s_nop 0
    v_cvt_pk_bf16_f32 v151, v154, v155
    v_cvt_pk_bf16_f32 v150, v152, v153
    v_add_u32 v13, s72, v1
    ds_write_b128 v9, v[148:151] offset:0
    s_waitcnt lgkmcnt(0)
    s_barrier
    ds_read_b128 v[112:115], v13 offset:0
    ds_read_b128 v[116:119], v13 offset:1024
    ds_read_b128 v[120:123], v13 offset:2048
    ds_read_b128 v[124:127], v13 offset:3072
    s_waitcnt lgkmcnt(3)
    v_mfma_f32_16x16x32_bf16 v[148:151], a[0:3], v[112:115], 0
    v_mfma_f32_16x16x32_bf16 v[156:159], a[4:7], v[112:115], 0
    v_mfma_f32_16x16x32_bf16 v[164:167], a[8:11], v[112:115], 0
    v_mfma_f32_16x16x32_bf16 v[172:175], a[12:15], v[112:115], 0
    v_mfma_f32_16x16x32_bf16 v[180:183], a[16:19], v[112:115], 0
    v_mfma_f32_16x16x32_bf16 v[188:191], a[20:23], v[112:115], 0
    v_mfma_f32_16x16x32_bf16 v[196:199], a[24:27], v[112:115], 0
    v_mfma_f32_16x16x32_bf16 v[204:207], a[28:31], v[112:115], 0
    v_mfma_f32_16x16x32_bf16 v[212:215], a[32:35], v[112:115], 0
    s_waitcnt lgkmcnt(2)
    v_mfma_f32_16x16x32_bf16 v[152:155], a[0:3], v[116:119], 0
    v_mfma_f32_16x16x32_bf16 v[160:163], a[4:7], v[116:119], 0
    v_mfma_f32_16x16x32_bf16 v[168:171], a[8:11], v[116:119], 0
    v_mfma_f32_16x16x32_bf16 v[176:179], a[12:15], v[116:119], 0
    v_mfma_f32_16x16x32_bf16 v[184:187], a[16:19], v[116:119], 0
    v_mfma_f32_16x16x32_bf16 v[192:195], a[20:23], v[116:119], 0
    v_mfma_f32_16x16x32_bf16 v[200:203], a[24:27], v[116:119], 0
    v_mfma_f32_16x16x32_bf16 v[208:211], a[28:31], v[116:119], 0
    v_mfma_f32_16x16x32_bf16 v[216:219], a[32:35], v[116:119], 0
    s_waitcnt lgkmcnt(1)
    v_mfma_f32_16x16x32_bf16 v[148:151], a[36:39], v[120:123], v[148:151]
    v_mfma_f32_16x16x32_bf16 v[156:159], a[40:43], v[120:123], v[156:159]
    v_mfma_f32_16x16x32_bf16 v[164:167], a[44:47], v[120:123], v[164:167]
    v_mfma_f32_16x16x32_bf16 v[172:175], a[48:51], v[120:123], v[172:175]
    v_mfma_f32_16x16x32_bf16 v[180:183], a[52:55], v[120:123], v[180:183]
    v_mfma_f32_16x16x32_bf16 v[188:191], a[56:59], v[120:123], v[188:191]
    v_mfma_f32_16x16x32_bf16 v[196:199], a[60:63], v[120:123], v[196:199]
    v_mfma_f32_16x16x32_bf16 v[204:207], a[64:67], v[120:123], v[204:207]
    v_mfma_f32_16x16x32_bf16 v[212:215], a[68:71], v[120:123], v[212:215]
    s_waitcnt lgkmcnt(0)
    v_mfma_f32_16x16x32_bf16 v[152:155], a[36:39], v[124:127], v[152:155]
    v_mfma_f32_16x16x32_bf16 v[160:163], a[40:43], v[124:127], v[160:163]
    v_mfma_f32_16x16x32_bf16 v[168:171], a[44:47], v[124:127], v[168:171]
    v_mfma_f32_16x16x32_bf16 v[176:179], a[48:51], v[124:127], v[176:179]
    v_mfma_f32_16x16x32_bf16 v[184:187], a[52:55], v[124:127], v[184:187]
    v_mfma_f32_16x16x32_bf16 v[192:195], a[56:59], v[124:127], v[192:195]
    v_mfma_f32_16x16x32_bf16 v[200:203], a[60:63], v[124:127], v[200:203]
    v_mfma_f32_16x16x32_bf16 v[208:211], a[64:67], v[124:127], v[208:211]
    v_mfma_f32_16x16x32_bf16 v[216:219], a[68:71], v[124:127], v[216:219]
    s_cmp_gt_u32 s77, 63
    s_cselect_b32 s57, 0, s77
    s_cselect_b32 s99, 2130706432, s68
    s_cselect_b32 s65, 2130706432, s65
    s_cselect_b32 s66, 2130706432, s66
    s_waitcnt vmcnt(0)
    v_cmp_gt_u32 vcc, s57, v10
    s_mov_b64 exec, 1
    buffer_store_dword v8, off, s[32:35], s71 sc1
    s_mov_b64 exec, -1
    s_cbranch_vccnz apoll_136
apret_137:
    ds_read_b128 v[112:115], v13 offset:4096
    s_add_u32 s78, s65, 4096
    ds_read_b128 v[116:119], v13 offset:5120
    ds_read_b128 v[124:127], v13 offset:7168
    s_waitcnt lgkmcnt(2)
    v_mfma_f32_16x16x32_bf16 v[148:151], a[72:75], v[112:115], v[148:151]
    buffer_load_dwordx4 v[16:19], v1, s[32:35], s65 offen offset:0 sc1
    v_mfma_f32_16x16x32_bf16 v[172:175], a[84:87], v[112:115], v[172:175]
    s_add_u32 s97, s66, 16384
    s_waitcnt lgkmcnt(1)
    v_mfma_f32_16x16x32_bf16 v[176:179], a[84:87], v[116:119], v[176:179]
    buffer_load_dwordx4 v[20:23], v1, s[32:35], s65 offen offset:2048 sc1
    v_mfma_f32_16x16x32_bf16 v[212:215], a[104:107], v[112:115], v[212:215]
    v_mfma_f32_16x16x32_bf16 v[180:183], a[88:91], v[112:115], v[180:183]
    s_add_u32 s96, s66, 12288
    ds_read_b128 v[120:123], v13 offset:6144
    v_mfma_f32_16x16x32_bf16 v[196:199], a[96:99], v[112:115], v[196:199]
    v_mfma_f32_16x16x32_bf16 v[184:187], a[88:91], v[116:119], v[184:187]
    buffer_load_dwordx4 v[24:27], v1, s[32:35], s78 offen offset:0 sc1
    v_mfma_f32_16x16x32_bf16 v[216:219], a[104:107], v[116:119], v[216:219]
    v_mfma_f32_16x16x32_bf16 v[152:155], a[72:75], v[116:119], v[152:155]
    buffer_load_dwordx4 v[28:31], v1, s[32:35], s78 offen offset:2048 sc1
    v_mfma_f32_16x16x32_bf16 v[192:195], a[92:95], v[116:119], v[192:195]
    s_add_u32 s79, s66, 8192
    v_mfma_f32_16x16x32_bf16 v[168:171], a[80:83], v[116:119], v[168:171]
    buffer_load_dwordx4 v[32:35], v1, s[32:35], s79 offen offset:0 sc1
    s_waitcnt lgkmcnt(0)
    v_mfma_f32_16x16x32_bf16 v[172:175], a[120:123], v[120:123], v[172:175]
    v_mfma_f32_16x16x32_bf16 v[200:203], a[96:99], v[116:119], v[200:203]
    buffer_load_dwordx4 v[36:39], v1, s[32:35], s79 offen offset:1024 sc1
    s_add_u32 s98, s66, 20480
    v_mfma_f32_16x16x32_bf16 v[148:151], a[108:111], v[120:123], v[148:151]
    v_mfma_f32_16x16x32_bf16 v[164:167], a[80:83], v[112:115], v[164:167]
    buffer_load_dwordx4 v[40:43], v1, s[32:35], s79 offen offset:2048 sc1
    v_mfma_f32_16x16x32_bf16 v[164:167], a[116:119], v[120:123], v[164:167]
    v_mfma_f32_16x16x32_bf16 v[156:159], a[76:79], v[112:115], v[156:159]
    v_mfma_f32_16x16x32_bf16 v[196:199], a[132:135], v[120:123], v[196:199]
    v_mfma_f32_16x16x32_bf16 v[188:191], a[92:95], v[112:115], v[188:191]
    buffer_load_dwordx4 v[44:47], v1, s[32:35], s79 offen offset:3072 sc1
    v_mfma_f32_16x16x32_bf16 v[208:211], a[100:103], v[116:119], v[208:211]
    v_mfma_f32_16x16x32_bf16 v[204:207], a[100:103], v[112:115], v[204:207]
    ds_read_b128 v[112:115], v13 offset:8192
    v_mfma_f32_16x16x32_bf16 v[160:163], a[76:79], v[116:119], v[160:163]
    v_mfma_f32_16x16x32_bf16 v[160:163], a[112:115], v[124:127], v[160:163]
    buffer_load_dwordx4 v[48:51], v1, s[32:35], s96 offen offset:0 sc1
    v_mfma_f32_16x16x32_bf16 v[212:215], a[140:143], v[120:123], v[212:215]
    v_mfma_f32_16x16x32_bf16 v[168:171], a[116:119], v[124:127], v[168:171]
    ds_read_b128 v[116:119], v13 offset:9216
    v_mfma_f32_16x16x32_bf16 v[152:155], a[108:111], v[124:127], v[152:155]
    v_mfma_f32_16x16x32_bf16 v[188:191], a[128:131], v[120:123], v[188:191]
    buffer_load_dwordx4 v[52:55], v1, s[32:35], s96 offen offset:1024 sc1
    v_mfma_f32_16x16x32_bf16 v[176:179], a[120:123], v[124:127], v[176:179]
    s_waitcnt lgkmcnt(1)
    v_mfma_f32_16x16x32_bf16 v[172:175], a[156:159], v[112:115], v[172:175]
    v_mfma_f32_16x16x32_bf16 v[216:219], a[140:143], v[124:127], v[216:219]
    v_mfma_f32_16x16x32_bf16 v[156:159], a[112:115], v[120:123], v[156:159]
    buffer_load_dwordx4 v[56:59], v1, s[32:35], s96 offen offset:2048 sc1
    v_mfma_f32_16x16x32_bf16 v[180:183], a[124:127], v[120:123], v[180:183]
    v_mfma_f32_16x16x32_bf16 v[204:207], a[136:139], v[120:123], v[204:207]
    v_mfma_f32_16x16x32_bf16 v[188:191], a[164:167], v[112:115], v[188:191]
    v_mfma_f32_16x16x32_bf16 v[200:203], a[132:135], v[124:127], v[200:203]
    buffer_load_dwordx4 v[60:63], v1, s[32:35], s96 offen offset:3072 sc1
    v_mfma_f32_16x16x32_bf16 v[164:167], a[152:155], v[112:115], v[164:167]
    v_mfma_f32_16x16x32_bf16 v[156:159], a[148:151], v[112:115], v[156:159]
    s_waitcnt lgkmcnt(0)
    v_mfma_f32_16x16x32_bf16 v[216:219], a[176:179], v[116:119], v[216:219]
    ds_read_b128 v[120:123], v13 offset:10240
    v_mfma_f32_16x16x32_bf16 v[148:151], a[144:147], v[112:115], v[148:151]
    buffer_load_dwordx4 v[64:67], v1, s[32:35], s97 offen offset:0 sc1
    v_mfma_f32_16x16x32_bf16 v[204:207], a[172:175], v[112:115], v[204:207]
    v_mfma_f32_16x16x32_bf16 v[196:199], a[168:171], v[112:115], v[196:199]
    v_mfma_f32_16x16x32_bf16 v[168:171], a[152:155], v[116:119], v[168:171]
    v_mfma_f32_16x16x32_bf16 v[208:211], a[136:139], v[124:127], v[208:211]
    buffer_load_dwordx4 v[68:71], v1, s[32:35], s97 offen offset:1024 sc1
    v_mfma_f32_16x16x32_bf16 v[184:187], a[124:127], v[124:127], v[184:187]
    v_mfma_f32_16x16x32_bf16 v[184:187], a[160:163], v[116:119], v[184:187]
    v_mfma_f32_16x16x32_bf16 v[152:155], a[144:147], v[116:119], v[152:155]
    v_mfma_f32_16x16x32_bf16 v[212:215], a[176:179], v[112:115], v[212:215]
    buffer_load_dwordx4 v[72:75], v1, s[32:35], s97 offen offset:2048 sc1
    v_mfma_f32_16x16x32_bf16 v[192:195], a[128:131], v[124:127], v[192:195]
    v_mfma_f32_16x16x32_bf16 v[192:195], a[164:167], v[116:119], v[192:195]
    v_mfma_f32_16x16x32_bf16 v[200:203], a[168:171], v[116:119], v[200:203]
    s_waitcnt lgkmcnt(0)
    v_mfma_f32_16x16x32_bf16 v[164:167], a[188:191], v[120:123], v[164:167]
    buffer_load_dwordx4 v[76:79], v1, s[32:35], s97 offen offset:3072 sc1
    v_mfma_f32_16x16x32_bf16 v[156:159], a[184:187], v[120:123], v[156:159]
    v_mfma_f32_16x16x32_bf16 v[180:183], a[160:163], v[112:115], v[180:183]
    ds_read_b128 v[112:115], v13 offset:12288
    v_mfma_f32_16x16x32_bf16 v[208:211], a[172:175], v[116:119], v[208:211]
    ds_read_b128 v[124:127], v13 offset:11264
    v_mfma_f32_16x16x32_bf16 v[176:179], a[156:159], v[116:119], v[176:179]
    buffer_load_dwordx4 v[80:83], v1, s[32:35], s98 offen offset:0 sc1
    v_mfma_f32_16x16x32_bf16 v[196:199], a[204:207], v[120:123], v[196:199]
    v_mfma_f32_16x16x32_bf16 v[172:175], a[192:195], v[120:123], v[172:175]
    v_mfma_f32_16x16x32_bf16 v[204:207], a[208:211], v[120:123], v[204:207]
    s_waitcnt lgkmcnt(0)
    v_mfma_f32_16x16x32_bf16 v[208:211], a[208:211], v[124:127], v[208:211]
    buffer_load_dwordx4 v[84:87], v1, s[32:35], s98 offen offset:1024 sc1
    v_mfma_f32_16x16x32_bf16 v[192:195], a[200:203], v[124:127], v[192:195]
    v_mfma_f32_16x16x32_bf16 v[160:163], a[148:151], v[116:119], v[160:163]
    v_mfma_f32_16x16x32_bf16 v[200:203], a[204:207], v[124:127], v[200:203]
    v_mfma_f32_16x16x32_bf16 v[148:151], a[180:183], v[120:123], v[148:151]
    buffer_load_dwordx4 v[88:91], v1, s[32:35], s98 offen offset:2048 sc1
    v_mfma_f32_16x16x32_bf16 v[152:155], a[180:183], v[124:127], v[152:155]
    v_mfma_f32_16x16x32_bf16 v[180:183], a[196:199], v[120:123], v[180:183]
    v_mfma_f32_16x16x32_bf16 v[180:183], a[232:235], v[112:115], v[180:183]
    v_mfma_f32_16x16x32_bf16 v[212:215], a[212:215], v[120:123], v[212:215]
    buffer_load_dwordx4 v[92:95], v1, s[32:35], s98 offen offset:3072 sc1
    v_mfma_f32_16x16x32_bf16 v[188:191], a[200:203], v[120:123], v[188:191]
    ds_read_b128 v[116:119], v13 offset:13312
    v_mfma_f32_16x16x32_bf16 v[188:191], a[236:239], v[112:115], v[188:191]
    ds_read_b128 v[120:123], v13 offset:14336
    v_mfma_f32_16x16x32_bf16 v[176:179], a[192:195], v[124:127], v[176:179]
    v_mfma_f32_16x16x32_bf16 v[168:171], a[188:191], v[124:127], v[168:171]
    buffer_load_dwordx4 v[96:99], v1, s[32:35], s99 offen offset:0 sc1
    v_mfma_f32_16x16x32_bf16 v[216:219], a[212:215], v[124:127], v[216:219]
    s_waitcnt lgkmcnt(1)
    v_mfma_f32_16x16x32_bf16 v[168:171], a[224:227], v[116:119], v[168:171]
    v_mfma_f32_16x16x32_bf16 v[172:175], a[228:231], v[112:115], v[172:175]
    s_waitcnt lgkmcnt(0)
    v_mfma_f32_16x16x32_bf16 v[180:183], v[236:239], v[120:123], v[180:183]
    buffer_load_dwordx4 v[100:103], v1, s[32:35], s99 offen offset:1024 sc1
    v_mfma_f32_16x16x32_bf16 v[160:163], a[184:187], v[124:127], v[160:163]
    v_mfma_f32_16x16x32_bf16 v[184:187], a[196:199], v[124:127], v[184:187]
    ds_read_b128 v[124:127], v13 offset:15360
    v_cvt_pk_bf16_f32 v180, v180, v181
    v_mfma_f32_16x16x32_bf16 v[164:167], a[224:227], v[112:115], v[164:167]
    v_cvt_pk_bf16_f32 v181, v182, v183
    v_mfma_f32_16x16x32_bf16 v[164:167], v[228:231], v[120:123], v[164:167]
    buffer_load_dwordx4 v[104:107], v1, s[32:35], s99 offen offset:2048 sc1
    v_mfma_f32_16x16x32_bf16 v[148:151], a[216:219], v[112:115], v[148:151]
    v_mfma_f32_16x16x32_bf16 v[184:187], a[232:235], v[116:119], v[184:187]
    s_waitcnt lgkmcnt(0)
    v_mfma_f32_16x16x32_bf16 v[184:187], v[236:239], v[124:127], v[184:187]
    v_mfma_f32_16x16x32_bf16 v[188:191], v[240:243], v[120:123], v[188:191]
    buffer_load_dwordx4 v[108:111], v1, s[32:35], s99 offen offset:3072 sc1
    v_mfma_f32_16x16x32_bf16 v[192:195], a[236:239], v[116:119], v[192:195]
    v_cvt_pk_bf16_f32 v182, v184, v185
    v_mfma_f32_16x16x32_bf16 v[172:175], v[232:235], v[120:123], v[172:175]
    v_cvt_pk_bf16_f32 v188, v188, v189
    v_mfma_f32_16x16x32_bf16 v[176:179], a[228:231], v[116:119], v[176:179]
    v_cvt_pk_bf16_f32 v183, v186, v187
    v_cvt_pk_bf16_f32 v164, v164, v165
    v_mfma_f32_16x16x32_bf16 v[148:151], a[252:255], v[120:123], v[148:151]
    v_cvt_pk_bf16_f32 v172, v172, v173
    v_cvt_pk_bf16_f32 v165, v166, v167
    v_mfma_f32_16x16x32_bf16 v[192:195], v[240:243], v[124:127], v[192:195]
    v_cvt_pk_bf16_f32 v189, v190, v191
    v_mfma_f32_16x16x32_bf16 v[152:155], a[216:219], v[116:119], v[152:155]
    ds_write_b128 v5, v[180:183] offset:256
    v_mfma_f32_16x16x32_bf16 v[168:171], v[228:231], v[124:127], v[168:171]
    v_cvt_pk_bf16_f32 v190, v192, v193
    v_cvt_pk_bf16_f32 v191, v194, v195
    v_mfma_f32_16x16x32_bf16 v[212:215], a[248:251], v[112:115], v[212:215]
    v_mfma_f32_16x16x32_bf16 v[212:215], v[252:255], v[120:123], v[212:215]
    ds_write_b128 v5, v[188:191] offset:320
    v_cvt_pk_bf16_f32 v173, v174, v175
    v_mfma_f32_16x16x32_bf16 v[216:219], a[248:251], v[116:119], v[216:219]
    v_cvt_pk_bf16_f32 v166, v168, v169
    v_mfma_f32_16x16x32_bf16 v[176:179], v[232:235], v[124:127], v[176:179]
    v_cvt_pk_bf16_f32 v167, v170, v171
    v_mfma_f32_16x16x32_bf16 v[196:199], a[240:243], v[112:115], v[196:199]
    ds_write_b128 v5, v[164:167] offset:128
    v_cvt_pk_bf16_f32 v212, v212, v213
    v_mfma_f32_16x16x32_bf16 v[200:203], a[240:243], v[116:119], v[200:203]
    v_cvt_pk_bf16_f32 v175, v178, v179
    v_cvt_pk_bf16_f32 v174, v176, v177
    v_mfma_f32_16x16x32_bf16 v[196:199], v[244:247], v[120:123], v[196:199]
    v_cvt_pk_bf16_f32 v213, v214, v215
    v_mfma_f32_16x16x32_bf16 v[216:219], v[252:255], v[124:127], v[216:219]
    ds_write_b128 v5, v[172:175] offset:192
    v_cvt_pk_bf16_f32 v148, v148, v149
    v_mfma_f32_16x16x32_bf16 v[152:155], a[252:255], v[124:127], v[152:155]
    v_cvt_pk_bf16_f32 v196, v196, v197
    s_nop 2
    v_cvt_pk_bf16_f32 v215, v218, v219
    v_mfma_f32_16x16x32_bf16 v[200:203], v[244:247], v[124:127], v[200:203]
    v_cvt_pk_bf16_f32 v214, v216, v217
    v_mfma_f32_16x16x32_bf16 v[156:159], a[220:223], v[112:115], v[156:159]
    ds_write_b128 v5, v[212:215] offset:512
    v_cvt_pk_bf16_f32 v197, v198, v199
    v_mfma_f32_16x16x32_bf16 v[204:207], a[244:247], v[112:115], v[204:207]
    v_cvt_pk_bf16_f32 v199, v202, v203
    v_cvt_pk_bf16_f32 v198, v200, v201
    v_mfma_f32_16x16x32_bf16 v[156:159], v[224:227], v[120:123], v[156:159]
    v_cvt_pk_bf16_f32 v149, v150, v151
    v_mfma_f32_16x16x32_bf16 v[208:211], a[244:247], v[116:119], v[208:211]
    ds_write_b128 v5, v[196:199] offset:384
    v_cvt_pk_bf16_f32 v150, v152, v153
    s_nop 2
    v_cvt_pk_bf16_f32 v156, v156, v157
    v_mfma_f32_16x16x32_bf16 v[204:207], v[248:251], v[120:123], v[204:207]
    v_cvt_pk_bf16_f32 v151, v154, v155
    v_mfma_f32_16x16x32_bf16 v[208:211], v[248:251], v[124:127], v[208:211]
    ds_write_b128 v5, v[148:151] offset:0
    s_nop 3
    v_cvt_pk_bf16_f32 v204, v204, v205
    v_cvt_pk_bf16_f32 v205, v206, v207
    v_mfma_f32_16x16x32_bf16 v[160:163], a[220:223], v[116:119], v[160:163]
    v_cvt_pk_bf16_f32 v206, v208, v209
    v_cvt_pk_bf16_f32 v207, v210, v211
    v_mfma_f32_16x16x32_bf16 v[160:163], v[224:227], v[124:127], v[160:163]
    ds_write_b128 v5, v[204:207] offset:448
    v_cvt_pk_bf16_f32 v157, v158, v159
    s_nop 5
    v_cvt_pk_bf16_f32 v159, v162, v163
    v_cvt_pk_bf16_f32 v158, v160, v161
    ds_write_b128 v5, v[156:159] offset:64
    s_waitcnt lgkmcnt(0)
    s_barrier
    ds_read_b128 v[204:207], v6 offset:1792
    ds_read_b128 v[196:199], v6 offset:1536
    ds_read_b128 v[172:175], v6 offset:768
    ds_read_b128 v[180:183], v6 offset:1024
    s_waitcnt lgkmcnt(3)
    buffer_store_dwordx4 v[204:207], v2, s[32:35], s70 offen offset:1792 sc1
    s_waitcnt lgkmcnt(1)
    buffer_store_dwordx4 v[172:175], v2, s[32:35], s70 offen offset:768 sc1
    ds_read_b128 v[148:151], v6 offset:0
    ds_read_b128 v[188:191], v6 offset:1280
    s_waitcnt lgkmcnt(2)
    buffer_store_dwordx4 v[180:183], v2, s[32:35], s70 offen offset:1024 sc1
    ds_read_b128 v[212:215], v6 offset:2048
    ds_read_b128 v[156:159], v6 offset:256
    s_waitcnt lgkmcnt(3)
    buffer_store_dwordx4 v[148:151], v2, s[32:35], s70 offen offset:0 sc1
    buffer_store_dwordx4 v[196:199], v2, s[32:35], s70 offen offset:1536 sc1
    s_waitcnt lgkmcnt(1)
    buffer_store_dwordx4 v[212:215], v2, s[32:35], s70 offen offset:2048 sc1
    ds_read_b128 v[164:167], v6 offset:512
    s_waitcnt lgkmcnt(1)
    buffer_store_dwordx4 v[156:159], v2, s[32:35], s70 offen offset:256 sc1
    s_waitcnt lgkmcnt(0)
    buffer_store_dwordx4 v[164:167], v2, s[32:35], s70 offen offset:512 sc1
    buffer_store_dwordx4 v[188:191], v2, s[32:35], s70 offen offset:1280 sc1
    s_xor_b32 s72, s72, 16384
    s_add_u32 s64, s64, 1
    v_mov_b32 v8, s64
    s_add_u32 s64, s64, 2
    s_add_u32 s70, s70, 1769472
    s_cmp_lt_u32 s64, 63
    s_cbranch_scc1 aloop_134
    s_waitcnt vmcnt(0)
    s_lshl_b32 s57, s61, 2
    s_add_u32 s57, s57, s52
    s_mov_b32 s53, s60
    s_mov_b32 s84, 1
    s_cmp_eq_u32 s57, 3
    s_cbranch_scc1 L_lnr2
    s_endpgm
apoll_136:
ap_148:
    buffer_load_dword v9, v3, s[32:35], 0 offen sc1
    s_sub_i32 s54, s54, 1
    s_cmp_lt_i32 s54, 0
    s_waitcnt vmcnt(0)
    s_cbranch_scc1 apd_149
    v_cmp_gt_u32 vcc, s77, v9
    s_cbranch_vccz apd_149
    s_sleep 8
    s_branch ap_148
apd_149:
    s_branch apret_137
L_lnr:
    s_mov_b32 s84, 0
L_lnr2:
    s_mov_b32 s36, s4
    s_and_b32 s37, s5, 0xffff
    s_mov_b32 s38, 2359296
    s_mov_b32 s39, 0x20000
    v_and_b32 v10, 15, v0
    v_lshrrev_b32 v11, 4, v0
    v_mul_u32_u24 v1, 2304, v11
    v_lshl_add_u32 v1, v10, 4, v1
    s_lshr_b32 s57, s53, 2
    s_lshl_b32 s57, s57, 7
    v_lshl_add_u32 v2, v10, 9, s57
    v_and_b32 v12, 1, v11
    v_mul_u32_u24 v12, 18432, v12
    v_lshrrev_b32 v13, 1, v11
    v_lshl_add_u32 v3, v13, 7, v12
    v_lshl_add_u32 v3, v10, 3, v3
    v_mov_b32 v14, 2130706432
    v_cmp_gt_u32 s[80:81], 2, v11
    s_nop 1
    v_cndmask_b32 v4, v14, v3, s[80:81]
    s_lshr_b32 s57, s53, 1
    v_xor_b32 v15, s57, v10
    v_lshl_add_u32 v15, v13, 4, v15
    v_lshl_add_u32 v5, v15, 4, v12
    v_lshrrev_b32 v15, 3, v10
    v_lshlrev_b32 v15, 2, v15
    v_and_b32 v6, 3, v10
    v_add_u32 v15, v15, v6
    v_xor_b32 v15, s57, v15
    v_lshl_add_u32 v15, v15, 4, v12
    v_bfe_u32 v6, v10, 2, 1
    v_lshl_add_u32 v15, v6, 3, v15
    v_add_u32 v15, 1024, v15
    v_cndmask_b32 v6, v14, v15, s[80:81]
    v_and_b32 v12, 1, v10
    v_lshlrev_b32 v12, 4, v12
    v_mov_b32 v13, 0x3f80
    v_lshlrev_b32 v12, v12, v13
    v_lshrrev_b32 v13, 1, v10
    v_cmp_eq_u32 vcc, 0, v13
    s_nop 1
    v_cndmask_b32 v48, 0, v12, vcc
    v_cmp_eq_u32 vcc, 1, v13
    s_nop 1
    v_cndmask_b32 v49, 0, v12, vcc
    v_cmp_eq_u32 vcc, 2, v13
    s_nop 1
    v_cndmask_b32 v50, 0, v12, vcc
    v_cmp_eq_u32 vcc, 3, v13
    s_nop 1
    v_cndmask_b32 v51, 0, v12, vcc
    v_and_b32 v12, 1, v10
    v_lshlrev_b32 v12, 4, v12
    v_mov_b32 v13, 0x3f80
    v_lshlrev_b32 v12, v12, v13
    v_lshrrev_b32 v13, 1, v10
    v_cmp_eq_u32 vcc, 4, v13
    s_nop 1
    v_cndmask_b32 v52, 0, v12, vcc
    v_cmp_eq_u32 vcc, 5, v13
    s_nop 1
    v_cndmask_b32 v53, 0, v12, vcc
    v_cmp_eq_u32 vcc, 6, v13
    s_nop 1
    v_cndmask_b32 v54, 0, v12, vcc
    v_cmp_eq_u32 vcc, 7, v13
    s_nop 1
    v_cndmask_b32 v55, 0, v12, vcc
    s_mov_b32 s64, s52
    s_mul_i32 s65, s53, 1152
    s_mul_i32 s57, s52, 36864
    s_add_u32 s65, s65, s57
    s_mul_i32 s66, s53, 36864
    s_mul_i32 s57, s52, 589824
    s_add_u32 s66, s66, s57
    s_add_u32 s66, s66, 72351744
    s_lshl_b32 s67, s52, 11
    s_lshl_b32 s57, s53, 7
    s_add_u32 s67, s67, s57
    s_add_u32 s67, s67, 124928
    s_mov_b32 s75, 0xffff0000
    v_mov_b32 v7, 1
    v_mov_b32 v46, 0
    s_cmp_lg_u32 s84, 0
    s_cbranch_scc1 lxtra_150
    ds_write_b32 v46, v46
    s_waitcnt lgkmcnt(0)
    s_barrier
    s_sleep 60
    v_mov_b32 v10, 136
winit_151:
    global_load_dword v11, v10, s[28:29] sc1
    s_sub_i32 s54, s54, 1
    s_cmp_lt_i32 s54, 0
    s_waitcnt vmcnt(0)
    s_cbranch_scc1 winitd_152
    v_cmp_gt_u32 vcc, 4, v11
    s_cbranch_vccz winitd_152
    s_sleep 8
    s_branch winit_151
winitd_152:
    v_mov_b32 v16, -1
    v_mov_b32 v17, -1
    v_mov_b32 v18, -1
    v_mov_b32 v19, -1
    s_add_u32 s72, s65, 7110656
    s_add_u32 s73, s65, 4751360
    buffer_store_dwordx2 v[16:17], v3, s[32:35], s72 offen offset:0 sc1
    buffer_store_dwordx2 v[16:17], v3, s[32:35], s72 offen offset:256 sc1
    buffer_store_dwordx2 v[16:17], v3, s[32:35], s72 offen offset:512 sc1
    buffer_store_dwordx2 v[16:17], v3, s[32:35], s72 offen offset:768 sc1
    buffer_store_dwordx2 v[16:17], v4, s[32:35], s72 offen offset:1024 sc1
    buffer_store_dwordx4 v[16:19], v5, s[32:35], s73 offen sc1
    buffer_store_dwordx4 v[16:19], v5, s[32:35], s73 offen offset:512 sc1
    buffer_store_dwordx2 v[16:17], v6, s[32:35], s73 offen sc1
    s_add_u32 s72, s65, 7258112
    s_add_u32 s73, s65, 4898816
    buffer_store_dwordx2 v[16:17], v3, s[32:35], s72 offen offset:0 sc1
    buffer_store_dwordx2 v[16:17], v3, s[32:35], s72 offen offset:256 sc1
    buffer_store_dwordx2 v[16:17], v3, s[32:35], s72 offen offset:512 sc1
    buffer_store_dwordx2 v[16:17], v3, s[32:35], s72 offen offset:768 sc1
    buffer_store_dwordx2 v[16:17], v4, s[32:35], s72 offen offset:1024 sc1
    buffer_store_dwordx4 v[16:19], v5, s[32:35], s73 offen sc1
    buffer_store_dwordx4 v[16:19], v5, s[32:35], s73 offen offset:512 sc1
    buffer_store_dwordx2 v[16:17], v6, s[32:35], s73 offen sc1
lloop_153:
    s_mul_i32 s57, s64, 43691
    s_lshr_b32 s57, s57, 17
    s_mul_i32 s57, s57, 3
    s_sub_u32 s57, s64, s57
    s_lshl_b32 s68, s57, 13
    s_add_u32 s68, s68, 45056
    s_add_u32 s57, s64, 1
    v_mov_b32 v8, s57
    buffer_load_dwordx2 v[36:37], v3, s[36:39], s65 offen offset:0
    buffer_load_dwordx2 v[38:39], v3, s[36:39], s65 offen offset:256
    buffer_load_dwordx2 v[40:41], v3, s[36:39], s65 offen offset:512
    buffer_load_dwordx2 v[42:43], v3, s[36:39], s65 offen offset:768
    buffer_load_dwordx2 v[44:45], v4, s[36:39], s65 offen offset:1024
lturn_155:
    ds_read_b32 v9, v46
    s_sub_i32 s54, s54, 1
    s_cmp_lt_i32 s54, 0
    s_waitcnt lgkmcnt(0)
    s_cbranch_scc1 lgo_156
    v_cmp_gt_u32 vcc, s64, v9
    s_cbranch_vccz lgo_156
    s_sleep 2
    s_branch lturn_155
lgo_156:
    s_cmp_ge_u32 s64, 57
    s_cselect_b64 s[82:83], -1, 0
    s_waitcnt vmcnt(0)
    s_cbranch_scc1 ldata_154
la_157:
    buffer_load_dword v9, v2, s[32:35], s68 offen sc1
    s_sub_i32 s54, s54, 1
    s_cmp_lt_i32 s54, 0
    s_waitcnt vmcnt(0)
    s_cbranch_scc1 lad_158
    v_cmp_lt_u32 vcc, v9, v8
    s_cbranch_vccz lad_158
    s_sleep 1
    s_branch la_157
lad_158:
    ds_max_u32 v46, v8
ldata_154:
    s_add_u32 s69, s66, 9216
    s_add_u32 s70, s66, 18432
    s_add_u32 s71, s66, 27648
    s_add_u32 s72, s65, 5046272
    s_add_u32 s73, s65, 2686976
    buffer_load_dwordx4 v[64:67], v1, s[32:35], s66 offen offset:0 sc1
    buffer_load_dwordx4 v[68:71], v1, s[32:35], s69 offen offset:0 sc1
    buffer_load_dwordx4 v[72:75], v1, s[32:35], s70 offen offset:0 sc1
    buffer_load_dwordx4 v[76:79], v1, s[32:35], s71 offen offset:0 sc1
    buffer_load_dwordx4 v[80:83], v1, s[32:35], s66 offen offset:256 sc1
    buffer_load_dwordx4 v[84:87], v1, s[32:35], s69 offen offset:256 sc1
    buffer_load_dwordx4 v[88:91], v1, s[32:35], s70 offen offset:256 sc1
    buffer_load_dwordx4 v[92:95], v1, s[32:35], s71 offen offset:256 sc1
    buffer_load_dwordx4 v[96:99], v1, s[32:35], s66 offen offset:512 sc1
    buffer_load_dwordx4 v[100:103], v1, s[32:35], s69 offen offset:512 sc1
    buffer_load_dwordx4 v[104:107], v1, s[32:35], s70 offen offset:512 sc1
    buffer_load_dwordx4 v[108:111], v1, s[32:35], s71 offen offset:512 sc1
    buffer_load_dwordx4 v[112:115], v1, s[32:35], s66 offen offset:768 sc1
    buffer_load_dwordx4 v[116:119], v1, s[32:35], s69 offen offset:768 sc1
    buffer_load_dwordx4 v[120:123], v1, s[32:35], s70 offen offset:768 sc1
    buffer_load_dwordx4 v[124:127], v1, s[32:35], s71 offen offset:768 sc1
    buffer_load_dwordx4 v[128:131], v1, s[32:35], s66 offen offset:1024 sc1
    buffer_load_dwordx4 v[132:135], v1, s[32:35], s69 offen offset:1024 sc1
    buffer_load_dwordx4 v[136:139], v1, s[32:35], s70 offen offset:1024 sc1
    buffer_load_dwordx4 v[140:143], v1, s[32:35], s71 offen offset:1024 sc1
    buffer_load_dwordx4 v[144:147], v1, s[32:35], s66 offen offset:1280 sc1
    buffer_load_dwordx4 v[148:151], v1, s[32:35], s69 offen offset:1280 sc1
    buffer_load_dwordx4 v[152:155], v1, s[32:35], s70 offen offset:1280 sc1
    buffer_load_dwordx4 v[156:159], v1, s[32:35], s71 offen offset:1280 sc1
    buffer_load_dwordx4 v[160:163], v1, s[32:35], s66 offen offset:1536 sc1
    buffer_load_dwordx4 v[164:167], v1, s[32:35], s69 offen offset:1536 sc1
    buffer_load_dwordx4 v[168:171], v1, s[32:35], s70 offen offset:1536 sc1
    buffer_load_dwordx4 v[172:175], v1, s[32:35], s71 offen offset:1536 sc1
    buffer_load_dwordx4 v[176:179], v1, s[32:35], s66 offen offset:1792 sc1
    buffer_load_dwordx4 v[180:183], v1, s[32:35], s69 offen offset:1792 sc1
    buffer_load_dwordx4 v[184:187], v1, s[32:35], s70 offen offset:1792 sc1
    buffer_load_dwordx4 v[188:191], v1, s[32:35], s71 offen offset:1792 sc1
    buffer_load_dwordx4 v[192:195], v1, s[32:35], s66 offen offset:2048 sc1
    buffer_load_dwordx4 v[196:199], v1, s[32:35], s69 offen offset:2048 sc1
    buffer_load_dwordx4 v[200:203], v1, s[32:35], s70 offen offset:2048 sc1
    buffer_load_dwordx4 v[204:207], v1, s[32:35], s71 offen offset:2048 sc1
    v_lshlrev_b32 v208, 16, v36
    v_and_b32 v209, s75, v36
    v_lshlrev_b32 v210, 16, v37
    v_and_b32 v211, s75, v37
    v_lshlrev_b32 v212, 16, v38
    v_and_b32 v213, s75, v38
    v_lshlrev_b32 v214, 16, v39
    v_and_b32 v215, s75, v39
    v_lshlrev_b32 v216, 16, v40
    v_and_b32 v217, s75, v40
    v_lshlrev_b32 v218, 16, v41
    v_and_b32 v219, s75, v41
    v_lshlrev_b32 v220, 16, v42
    v_and_b32 v221, s75, v42
    v_lshlrev_b32 v222, 16, v43
    v_and_b32 v223, s75, v43
    v_lshlrev_b32 v224, 16, v44
    v_and_b32 v225, s75, v44
    v_lshlrev_b32 v226, 16, v45
    v_and_b32 v227, s75, v45
    s_waitcnt vmcnt(35)
    v_mfma_f32_16x16x32_bf16 v[16:19], v[48:51], v[64:67], 0
    s_waitcnt vmcnt(34)
    v_mfma_f32_16x16x32_bf16 v[16:19], v[48:51], v[68:71], v[16:19]
    s_waitcnt vmcnt(33)
    v_mfma_f32_16x16x32_bf16 v[16:19], v[48:51], v[72:75], v[16:19]
    s_waitcnt vmcnt(32)
    v_mfma_f32_16x16x32_bf16 v[16:19], v[48:51], v[76:79], v[16:19]
    s_waitcnt vmcnt(31)
    v_mfma_f32_16x16x32_bf16 v[16:19], v[52:55], v[80:83], v[16:19]
    s_waitcnt vmcnt(30)
    v_mfma_f32_16x16x32_bf16 v[16:19], v[52:55], v[84:87], v[16:19]
    s_waitcnt vmcnt(29)
    v_mfma_f32_16x16x32_bf16 v[16:19], v[52:55], v[88:91], v[16:19]
    s_waitcnt vmcnt(28)
    v_mfma_f32_16x16x32_bf16 v[16:19], v[52:55], v[92:95], v[16:19]
    s_waitcnt vmcnt(27)
    v_mfma_f32_16x16x32_bf16 v[20:23], v[48:51], v[96:99], 0
    s_waitcnt vmcnt(26)
    v_mfma_f32_16x16x32_bf16 v[20:23], v[48:51], v[100:103], v[20:23]
    s_waitcnt vmcnt(25)
    v_mfma_f32_16x16x32_bf16 v[20:23], v[48:51], v[104:107], v[20:23]
    s_waitcnt vmcnt(24)
    v_mfma_f32_16x16x32_bf16 v[20:23], v[48:51], v[108:111], v[20:23]
    v_cvt_pk_bf16_f32 v16, v16, v17
    v_and_b32 v17, s75, v16
    v_lshlrev_b32 v16, 16, v16
    v_add_f32 v208, v208, v16
    v_add_f32 v209, v209, v17
    v_cvt_pk_bf16_f32 v228, v208, v209
    v_lshlrev_b32 v208, 16, v228
    v_and_b32 v209, s75, v228
    v_add_f32 v12, v208, v209
    v_cvt_pk_bf16_f32 v18, v18, v19
    v_and_b32 v19, s75, v18
    v_lshlrev_b32 v18, 16, v18
    v_add_f32 v210, v210, v18
    v_add_f32 v211, v211, v19
    v_cvt_pk_bf16_f32 v229, v210, v211
    v_lshlrev_b32 v210, 16, v229
    v_and_b32 v211, s75, v229
    v_add_f32 v12, v12, v210
    v_add_f32 v12, v12, v211
    s_waitcnt vmcnt(23)
    v_mfma_f32_16x16x32_bf16 v[20:23], v[52:55], v[112:115], v[20:23]
    s_waitcnt vmcnt(22)
    v_mfma_f32_16x16x32_bf16 v[20:23], v[52:55], v[116:119], v[20:23]
    s_waitcnt vmcnt(21)
    v_mfma_f32_16x16x32_bf16 v[20:23], v[52:55], v[120:123], v[20:23]
    s_waitcnt vmcnt(20)
    v_mfma_f32_16x16x32_bf16 v[20:23], v[52:55], v[124:127], v[20:23]
    s_waitcnt vmcnt(19)
    v_mfma_f32_16x16x32_bf16 v[24:27], v[48:51], v[128:131], 0
    s_waitcnt vmcnt(18)
    v_mfma_f32_16x16x32_bf16 v[24:27], v[48:51], v[132:135], v[24:27]
    s_waitcnt vmcnt(17)
    v_mfma_f32_16x16x32_bf16 v[24:27], v[48:51], v[136:139], v[24:27]
    s_waitcnt vmcnt(16)
    v_mfma_f32_16x16x32_bf16 v[24:27], v[48:51], v[140:143], v[24:27]
    v_cvt_pk_bf16_f32 v20, v20, v21
    v_and_b32 v21, s75, v20
    v_lshlrev_b32 v20, 16, v20
    v_add_f32 v212, v212, v20
    v_add_f32 v213, v213, v21
    v_cvt_pk_bf16_f32 v230, v212, v213
    v_lshlrev_b32 v212, 16, v230
    v_and_b32 v213, s75, v230
    v_add_f32 v12, v12, v212
    v_add_f32 v12, v12, v213
    v_cvt_pk_bf16_f32 v22, v22, v23
    v_and_b32 v23, s75, v22
    v_lshlrev_b32 v22, 16, v22
    v_add_f32 v214, v214, v22
    v_add_f32 v215, v215, v23
    v_cvt_pk_bf16_f32 v231, v214, v215
    v_lshlrev_b32 v214, 16, v231
    v_and_b32 v215, s75, v231
    v_add_f32 v12, v12, v214
    v_add_f32 v12, v12, v215
    s_waitcnt vmcnt(15)
    v_mfma_f32_16x16x32_bf16 v[24:27], v[52:55], v[144:147], v[24:27]
    s_waitcnt vmcnt(14)
    v_mfma_f32_16x16x32_bf16 v[24:27], v[52:55], v[148:151], v[24:27]
    s_waitcnt vmcnt(13)
    v_mfma_f32_16x16x32_bf16 v[24:27], v[52:55], v[152:155], v[24:27]
    s_waitcnt vmcnt(12)
    v_mfma_f32_16x16x32_bf16 v[24:27], v[52:55], v[156:159], v[24:27]
    s_waitcnt vmcnt(11)
    v_mfma_f32_16x16x32_bf16 v[28:31], v[48:51], v[160:163], 0
    s_waitcnt vmcnt(10)
    v_mfma_f32_16x16x32_bf16 v[28:31], v[48:51], v[164:167], v[28:31]
    s_waitcnt vmcnt(9)
    v_mfma_f32_16x16x32_bf16 v[28:31], v[48:51], v[168:171], v[28:31]
    s_waitcnt vmcnt(8)
    v_mfma_f32_16x16x32_bf16 v[28:31], v[48:51], v[172:175], v[28:31]
    v_cvt_pk_bf16_f32 v24, v24, v25
    v_and_b32 v25, s75, v24
    v_lshlrev_b32 v24, 16, v24
    v_add_f32 v216, v216, v24
    v_add_f32 v217, v217, v25
    v_cvt_pk_bf16_f32 v232, v216, v217
    v_lshlrev_b32 v216, 16, v232
    v_and_b32 v217, s75, v232
    v_add_f32 v12, v12, v216
    v_add_f32 v12, v12, v217
    v_cvt_pk_bf16_f32 v26, v26, v27
    v_and_b32 v27, s75, v26
    v_lshlrev_b32 v26, 16, v26
    v_add_f32 v218, v218, v26
    v_add_f32 v219, v219, v27
    v_cvt_pk_bf16_f32 v233, v218, v219
    v_lshlrev_b32 v218, 16, v233
    v_and_b32 v219, s75, v233
    v_add_f32 v12, v12, v218
    v_add_f32 v12, v12, v219
    s_waitcnt vmcnt(7)
    v_mfma_f32_16x16x32_bf16 v[28:31], v[52:55], v[176:179], v[28:31]
    s_waitcnt vmcnt(6)
    v_mfma_f32_16x16x32_bf16 v[28:31], v[52:55], v[180:183], v[28:31]
    s_waitcnt vmcnt(5)
    v_mfma_f32_16x16x32_bf16 v[28:31], v[52:55], v[184:187], v[28:31]
    s_waitcnt vmcnt(4)
    v_mfma_f32_16x16x32_bf16 v[28:31], v[52:55], v[188:191], v[28:31]
    s_waitcnt vmcnt(3)
    v_mfma_f32_16x16x32_bf16 v[32:35], v[48:51], v[192:195], 0
    s_waitcnt vmcnt(2)
    v_mfma_f32_16x16x32_bf16 v[32:35], v[48:51], v[196:199], v[32:35]
    s_waitcnt vmcnt(1)
    v_mfma_f32_16x16x32_bf16 v[32:35], v[48:51], v[200:203], v[32:35]
    s_waitcnt vmcnt(0)
    v_mfma_f32_16x16x32_bf16 v[32:35], v[48:51], v[204:207], v[32:35]
    v_cvt_pk_bf16_f32 v28, v28, v29
    v_and_b32 v29, s75, v28
    v_lshlrev_b32 v28, 16, v28
    v_add_f32 v220, v220, v28
    v_add_f32 v221, v221, v29
    v_cvt_pk_bf16_f32 v234, v220, v221
    v_lshlrev_b32 v220, 16, v234
    v_and_b32 v221, s75, v234
    v_add_f32 v12, v12, v220
    v_add_f32 v12, v12, v221
    v_cvt_pk_bf16_f32 v30, v30, v31
    v_and_b32 v31, s75, v30
    v_lshlrev_b32 v30, 16, v30
    v_add_f32 v222, v222, v30
    v_add_f32 v223, v223, v31
    v_cvt_pk_bf16_f32 v235, v222, v223
    v_lshlrev_b32 v222, 16, v235
    v_and_b32 v223, s75, v235
    v_add_f32 v12, v12, v222
    v_add_f32 v12, v12, v223
    v_cmp_u_f32 vcc, v12, v32
    v_cvt_pk_bf16_f32 v32, v32, v33
    v_and_b32 v33, s75, v32
    v_lshlrev_b32 v32, 16, v32
    v_add_f32 v224, v224, v32
    v_add_f32 v225, v225, v33
    v_cvt_pk_bf16_f32 v236, v224, v225
    v_lshlrev_b32 v224, 16, v236
    v_and_b32 v225, s75, v236
    v_add_f32 v12, v12, v224
    v_add_f32 v12, v12, v225
    v_cvt_pk_bf16_f32 v34, v34, v35
    v_and_b32 v35, s75, v34
    v_lshlrev_b32 v34, 16, v34
    v_add_f32 v226, v226, v34
    v_add_f32 v227, v227, v35
    v_cvt_pk_bf16_f32 v237, v226, v227
    v_lshlrev_b32 v226, 16, v237
    v_and_b32 v227, s75, v237
    v_add_f32 v12, v12, v226
    v_add_f32 v12, v12, v227
    s_sub_i32 s54, s54, 1
    s_cmp_lt_i32 s54, 0
    s_cselect_b64 s[82:83], 0, s[82:83]
    s_and_b64 vcc, vcc, s[82:83]
    s_cbranch_vccnz ldata_154
    ds_max_u32 v46, v8
    v_add_f32_dpp v12, v12, v12 row_ror:8 row_mask:0xf bank_mask:0xf
    s_nop 1
    v_add_f32_dpp v12, v12, v12 row_ror:4 row_mask:0xf bank_mask:0xf
    s_nop 1
    v_add_f32_dpp v12, v12, v12 row_ror:2 row_mask:0xf bank_mask:0xf
    s_nop 1
    v_add_f32_dpp v12, v12, v12 row_ror:1 row_mask:0xf bank_mask:0xf
    v_mov_b32 v15, v12
    s_nop 1
    v_permlane32_swap_b32 v12, v15
    v_add_f32 v12, v12, v15
    v_mul_f32 v12, 0xbae38e39, v12
    v_pk_add_f32 v[30:31], v[222:223], v[12:13] op_sel_hi:[1,0]
    v_cndmask_b32 v14, 0, v12, s[80:81]
    v_pk_add_f32 v[16:17], v[208:209], v[12:13] op_sel_hi:[1,0]
    v_pk_mul_f32 v[56:57], v[16:17], v[16:17]
    v_pk_add_f32 v[26:27], v[218:219], v[12:13] op_sel_hi:[1,0]
    v_pk_add_f32 v[34:35], v[226:227], v[14:15] op_sel_hi:[1,0]
    v_pk_add_f32 v[22:23], v[214:215], v[12:13] op_sel_hi:[1,0]
    v_pk_add_f32 v[18:19], v[210:211], v[12:13] op_sel_hi:[1,0]
    v_pk_fma_f32 v[56:57], v[18:19], v[18:19], v[56:57]
    v_pk_add_f32 v[24:25], v[216:217], v[12:13] op_sel_hi:[1,0]
    v_pk_add_f32 v[32:33], v[224:225], v[14:15] op_sel_hi:[1,0]
    v_pk_add_f32 v[20:21], v[212:213], v[12:13] op_sel_hi:[1,0]
    v_pk_add_f32 v[28:29], v[220:221], v[12:13] op_sel_hi:[1,0]
    v_pk_fma_f32 v[56:57], v[20:21], v[20:21], v[56:57]
    v_cvt_pk_bf16_f32 v12, v12, v12
    v_lshlrev_b32 v12, 16, v12
    v_pk_add_f32 v[226:227], v[226:227], v[12:13] op_sel_hi:[1,0]
    v_pk_add_f32 v[214:215], v[214:215], v[12:13] op_sel_hi:[1,0]
    v_pk_fma_f32 v[56:57], v[22:23], v[22:23], v[56:57]
    v_pk_fma_f32 v[56:57], v[24:25], v[24:25], v[56:57]
    v_cvt_pk_bf16_f32 v226, v226, v227
    v_pk_add_f32 v[212:213], v[212:213], v[12:13] op_sel_hi:[1,0]
    v_pk_fma_f32 v[56:57], v[26:27], v[26:27], v[56:57]
    v_pk_fma_f32 v[56:57], v[28:29], v[28:29], v[56:57]
    v_pk_fma_f32 v[56:57], v[30:31], v[30:31], v[56:57]
    v_pk_fma_f32 v[56:57], v[32:33], v[32:33], v[56:57]
    v_cvt_pk_bf16_f32 v212, v212, v213
    v_pk_add_f32 v[218:219], v[218:219], v[12:13] op_sel_hi:[1,0]
    v_pk_add_f32 v[220:221], v[220:221], v[12:13] op_sel_hi:[1,0]
    v_cvt_pk_bf16_f32 v214, v214, v215
    v_pk_fma_f32 v[56:57], v[34:35], v[34:35], v[56:57]
    v_add_f32 v58, v56, v57
    v_pk_add_f32 v[208:209], v[208:209], v[12:13] op_sel_hi:[1,0]
    v_pk_add_f32 v[222:223], v[222:223], v[12:13] op_sel_hi:[1,0]
    v_pk_add_f32 v[216:217], v[216:217], v[12:13] op_sel_hi:[1,0]
    v_and_b32 v215, s75, v214
    v_add_f32_dpp v58, v58, v58 row_ror:8 row_mask:0xf bank_mask:0xf
    v_lshlrev_b32 v214, 16, v214
    v_and_b32 v227, s75, v226
    v_add_f32_dpp v58, v58, v58 row_ror:4 row_mask:0xf bank_mask:0xf
    v_cvt_pk_bf16_f32 v208, v208, v209
    v_pk_add_f32 v[224:225], v[224:225], v[12:13] op_sel_hi:[1,0]
    v_add_f32_dpp v58, v58, v58 row_ror:2 row_mask:0xf bank_mask:0xf
    v_cvt_pk_bf16_f32 v224, v224, v225
    v_cvt_pk_bf16_f32 v220, v220, v221
    v_and_b32 v225, s75, v224
    v_cvt_pk_bf16_f32 v218, v218, v219
    v_add_f32_dpp v58, v58, v58 row_ror:1 row_mask:0xf bank_mask:0xf
    v_mov_b32 v15, v58
    v_pk_add_f32 v[210:211], v[210:211], v[12:13] op_sel_hi:[1,0]
    v_cvt_pk_bf16_f32 v216, v216, v217
    v_permlane32_swap_b32 v58, v15
    v_add_f32 v58, v58, v15
    v_mul_f32 v58, 0x3ae38e39, v58
    v_cvt_pk_bf16_f32 v58, v58, v58
    v_and_b32 v221, s75, v220
    v_and_b32 v217, s75, v216
    v_and_b32 v219, s75, v218
    v_cvt_pk_bf16_f32 v222, v222, v223
    v_and_b32 v223, s75, v222
    v_lshlrev_b32 v222, 16, v222
    v_lshlrev_b32 v58, 16, v58
    v_cvt_pk_bf16_f32 v210, v210, v211
    v_and_b32 v211, s75, v210
    v_add_f32 v58, 0x3727c5ac, v58
    v_cvt_pk_bf16_f32 v58, v58, v58
    v_lshlrev_b32 v58, 16, v58
    v_sqrt_f32 v58, v58
    v_lshlrev_b32 v220, 16, v220
    v_lshlrev_b32 v210, 16, v210
    v_lshlrev_b32 v224, 16, v224
    v_cvt_pk_bf16_f32 v58, v58, v58
    v_lshlrev_b32 v58, 16, v58
    v_rcp_f32 v58, v58
    v_lshlrev_b32 v226, 16, v226
    v_and_b32 v213, s75, v212
    v_pk_mul_f32 v[220:221], v[220:221], v[58:59] op_sel_hi:[1,0]
    v_lshlrev_b32 v216, 16, v216
    v_cvt_pk_bf16_f32 v22, v220, v221
    v_and_b32 v209, s75, v208
    v_lshlrev_b32 v208, 16, v208
    v_pk_mul_f32 v[224:225], v[224:225], v[58:59] op_sel_hi:[1,0]
    v_pk_mul_f32 v[222:223], v[222:223], v[58:59] op_sel_hi:[1,0]
    v_pk_mul_f32 v[216:217], v[216:217], v[58:59] op_sel_hi:[1,0]
    v_pk_mul_f32 v[210:211], v[210:211], v[58:59] op_sel_hi:[1,0]
    v_cvt_pk_bf16_f32 v24, v224, v225
    v_lshlrev_b32 v212, 16, v212
    v_cvt_pk_bf16_f32 v20, v216, v217
    v_pk_mul_f32 v[214:215], v[214:215], v[58:59] op_sel_hi:[1,0]
    v_cvt_pk_bf16_f32 v19, v214, v215
    v_pk_mul_f32 v[226:227], v[226:227], v[58:59] op_sel_hi:[1,0]
    v_lshlrev_b32 v218, 16, v218
    v_pk_mul_f32 v[208:209], v[208:209], v[58:59] op_sel_hi:[1,0]
    v_pk_mul_f32 v[218:219], v[218:219], v[58:59] op_sel_hi:[1,0]
    v_cvt_pk_bf16_f32 v21, v218, v219
    v_cvt_pk_bf16_f32 v16, v208, v209
    v_cvt_pk_bf16_f32 v23, v222, v223
    v_pk_mul_f32 v[212:213], v[212:213], v[58:59] op_sel_hi:[1,0]
    v_cvt_pk_bf16_f32 v18, v212, v213
    v_cvt_pk_bf16_f32 v17, v210, v211
    v_cvt_pk_bf16_f32 v25, v226, v227
    buffer_store_dwordx4 v[16:19], v5, s[32:35], s73 offen sc1
    buffer_store_dwordx2 v[24:25], v6, s[32:35], s73 offen sc1
    buffer_store_dwordx4 v[20:23], v5, s[32:35], s73 offen offset:512 sc1
    buffer_store_dwordx2 v[236:237], v4, s[32:35], s72 offen offset:1024 sc1
    buffer_store_dwordx2 v[234:235], v3, s[32:35], s72 offen offset:768 sc1
    buffer_store_dwordx2 v[230:231], v3, s[32:35], s72 offen offset:256 sc1
    buffer_store_dwordx2 v[232:233], v3, s[32:35], s72 offen offset:512 sc1
    buffer_store_dwordx2 v[228:229], v3, s[32:35], s72 offen offset:0 sc1
    s_add_u32 s64, s64, 4
    s_add_u32 s65, s65, 147456
    s_add_u32 s66, s66, 2359296
    s_waitcnt vmcnt(0)
    s_mov_b64 exec, 1
    buffer_store_dword v8, off, s[32:35], s67 sc1
    s_mov_b64 exec, -1
    s_cmp_lt_u32 s64, 63
    s_cbranch_scc1 lloop_153
    s_endpgm
lxtra_150:
    s_mov_b32 s68, 45056
lx_159:
    buffer_load_dword v9, v2, s[32:35], s68 offen sc1
    buffer_load_dword v10, off, s[32:35], s67 sc1
    s_sub_i32 s54, s54, 1
    s_cmp_lt_i32 s54, 0
    s_waitcnt vmcnt(0)
    s_cbranch_scc1 lxd_160
    v_min_u32 v9, v9, v10
    v_cmp_eq_u32 vcc, 0, v9
    s_cbranch_vccz lxd_160
    s_sleep 2
    s_branch lx_159
lxd_160:
    s_mov_b32 s64, 63
    s_add_u32 s65, s65, 2211840
    s_add_u32 s66, s66, 35389440
    s_mov_b32 s67, 2130706432
    v_mov_b32 v9, 63
    ds_write_b32 v46, v9
    s_branch lloop_153

.p2align 2
.type L_table,@object
L_table:
.long 256
.long 257
.long 258
.long 259
.long 260
.long 261
.long 262
.long 512
.long 513
.long 514
.long 515
.long 516
.long 517
.long 518
.long 519
.long 520
.long 1024
.long 1025
.long 1026
.long 1027
.long 1028
.long 1029
.long 1030
.long 1031
.long 1032
.long 1033
.long 1034
.long 1035
.long 1036
.long 1037
.long 1038
.long 768
.long 263
.long 264
.long 265
.long 266
.long 267
.long 268
.long 269
.long 521
.long 522
.long 523
.long 524
.long 525
.long 526
.long 527
.long 528
.long 529
.long 1039
.long 1040
.long 1041
.long 1042
.long 1043
.long 1044
.long 1045
.long 1046
.long 1047
.long 1048
.long 1049
.long 1050
.long 1051
.long 1052
.long 1053
.long 769
.long 270
.long 271
.long 272
.long 273
.long 274
.long 275
.long 276
.long 530
.long 531
.long 532
.long 533
.long 534
.long 535
.long 1054
.long 1055
.long 1056
.long 1057
.long 1058
.long 1059
.long 1060
.long 1061
.long 1062
.long 1063
.long 1064
.long 1065
.long 1066
.long 1067
.long 1068
.long 770
.long 771
.long 772
.long 773
.long 277
.long 278
.long 279
.long 280
.long 281
.long 282
.long 283
.long 536
.long 537
.long 538
.long 539
.long 540
.long 541
.long 1069
.long 1070
.long 1071
.long 1072
.long 1073
.long 1074
.long 1075
.long 1076
.long 1077
.long 1078
.long 1079
.long 1080
.long 1081
.long 1082
.long 1083
.long 774
.long 775
.long 776
.long 777
.long 284
.long 285
.long 286
.long 287
.long 288
.long 289
.long 290
.long 542
.long 543
.long 544
.long 545
.long 546
.long 547
.long 1084
.long 1085
.long 1086
.long 1087
.long 1088
.long 1089
.long 1090
.long 1091
.long 1092
.long 1093
.long 1094
.long 1095
.long 1096
.long 1097
.long 1098
.long 778
.long 779
.long 780
.long 781
.long 291
.long 292
.long 293
.long 294
.long 295
.long 296
.long 297
.long 548
.long 549
.long 550
.long 551
.long 552
.long 553
.long 1099
.long 1100
.long 1101
.long 1102
.long 1103
.long 1104
.long 1105
.long 1106
.long 1107
.long 1108
.long 1109
.long 1110
.long 1111
.long 1112
.long 1113
.long 782
.long 783
.long 1280
.long 1281
.long 298
.long 299
.long 300
.long 301
.long 302
.long 303
.long 554
.long 555
.long 556
.long 557
.long 558
.long 559
.long 1114
.long 1115
.long 1116
.long 1117
.long 1118
.long 1119
.long 1120
.long 1121
.long 1122
.long 1123
.long 1124
.long 1125
.long 1126
.long 1127
.long 1128
.long 1129
.long 1130
.long 1131
.long 1282
.long 1283
.size L_table, 896
.section .rodata,"a"
.p2align 6
.amdhsa_kernel sequential_preLN__memory_aug_recurrent_mem_tr__geglu_ffn__prompt_kernel
  .amdhsa_next_free_vgpr 512
  .amdhsa_next_free_sgpr 102
  .amdhsa_accum_offset 256
  .amdhsa_group_segment_fixed_size 0
  .amdhsa_kernarg_size 112
  .amdhsa_user_sgpr_count 2
  .amdhsa_user_sgpr_kernarg_segment_ptr 1
  .amdhsa_system_sgpr_workgroup_id_x 1
.end_amdhsa_kernel
```
